```python
import torch

def _softmax(x, axis=-1):
    return torch.softmax(x, dim=axis)

def _gelu(x):
    return torch.nn.functional.gelu(x, approximate='tanh')

def _silu(x):
    return torch.nn.functional.silu(x)

def _sigmoid(x):
    return torch.sigmoid(x)

def _layernorm(x, axis=-1, eps=1e-05):
    m = x.mean(dim=axis, keepdim=True)
    v = x.var(dim=axis, keepdim=True, unbiased=False)
    return (x - m) / torch.sqrt(v + eps)

def _scatter_add(tgt, idx, src, axis=0):
    return tgt.clone().index_add_(axis, idx, src)

def _segment_sum(src, seg, n):
    out = torch.zeros((n,) + src.shape[1:], dtype=src.dtype)
    return out.index_add_(0, seg, src)

def _pad(x, pw):
    flat = tuple((v for pair in reversed(pw) for v in pair))
    return torch.nn.functional.pad(x, flat)
kernel_name = 'parallel_sum__linear_kernel_hedgehog__mixer_gmlp__prompt'

def setup_inputs():

    _w = lambda a: (lambda t: t.to(torch.bfloat16) if t.is_floating_point() else t)(torch.as_tensor(a))

    def _A_setup():
        B, S, D, H = (1, 2048, 512, 32)
        Dh = D // H
        return {'x': _w((lambda *s: torch.randn(*s, dtype=torch.bfloat16) * 0.05)(B, S, D)), 'wqkv': _w((lambda *s: torch.randn(*s, dtype=torch.bfloat16) * 0.8)(D, 3 * D)), 'w_phi': _w((lambda *s: torch.randn(*s, dtype=torch.bfloat16) * 0.8)(H, Dh, Dh) * Dh ** (-0.5)), 'wo': _w((lambda *s: torch.randn(*s, dtype=torch.bfloat16) * 0.1)(D, D))}
    _A_in = _A_setup()

    def _B_setup():
        B, S, D, F = (1, 2048, 512, 1376)
        Fh = F // 2
        return {'x': _w((lambda *s: torch.randn(*s, dtype=torch.bfloat16) * 0.05)(B, S, D)), 'w_in': _w((lambda *s: torch.randn(*s, dtype=torch.bfloat16) * 0.4)(D, 2 * Fh)), 'w_sp': _w(0.01 * (lambda *s: torch.randn(*s, dtype=torch.bfloat16) * 0.4)(S, S)), 'b_sp': _w(1.0 + 0.01 * (lambda *s: torch.randn(*s, dtype=torch.bfloat16) * 0.05)(S)), 'w_out': _w((lambda *s: torch.randn(*s, dtype=torch.bfloat16) * 0.05)(Fh, D))}
    _B_in = _B_setup()
    return {'A_x': _A_in['x'], 'A_wqkv': _A_in['wqkv'], 'A_w_phi': _A_in['w_phi'], 'A_wo': _A_in['wo'], 'B_x': _B_in['x'], 'B_w_in': _B_in['w_in'], 'B_w_sp': _B_in['w_sp'], 'B_b_sp': _B_in['b_sp'], 'B_w_out': _B_in['w_out']}

def reference(A_x, A_wqkv, A_w_phi, A_wo, B_x, B_w_in, B_w_sp, B_b_sp, B_w_out):

    def _A_ref(x, wqkv, w_phi, wo):
        B, S, D = x.shape
        H = 32
        Dh = D // H
        qkv = (lambda x, *d: x.permute(*d))((x @ wqkv).reshape(B, S, 3, H, Dh), 2, 0, 3, 1, 4)
        q, k, v = (qkv[0], qkv[1], qkv[2])
        pq = torch.einsum('bhsd,hdf->bhsf', q, w_phi)
        pk = torch.einsum('bhsd,hdf->bhsf', k, w_phi)
        phi_q = torch.concatenate([_softmax(pq, axis=-1), _softmax(-pq, axis=-1)], axis=-1)
        phi_k = torch.concatenate([_softmax(pk, axis=-1), _softmax(-pk, axis=-1)], axis=-1)
        kv = torch.einsum('bhsf,bhsd->bhfd', phi_k, v)
        z = torch.einsum('bhsf->bhf', phi_k)
        num = torch.einsum('bhqf,bhfd->bhqd', phi_q, kv)
        den = torch.einsum('bhqf,bhf->bhq', phi_q, z)[..., None] + 1e-06
        o = num / den
        return (lambda x, *d: x.permute(*d))(o, 0, 2, 1, 3).reshape(B, S, D) @ wo

    def _B_ref(x, w_in, w_sp, b_sp, w_out):
        B, S, D = x.shape
        F = w_in.shape[-1]
        Fh = F // 2
        z = _gelu(torch.einsum('bsd,df->bsf', x, w_in))
        z1 = z[..., :Fh].clone()
        z2 = _layernorm(z[..., Fh:], axis=-1)
        g = torch.einsum('ts,bsf->btf', w_sp, z2) + b_sp[None, :, None]
        return torch.einsum('bsf,fd->bsd', z1 * g, w_out)
    x = A_x
    xn = _layernorm(x, axis=-1)
    return x + _A_ref(xn, A_wqkv, A_w_phi, A_wo) + _B_ref(xn, B_w_in, B_w_sp, B_b_sp, B_w_out)
```

```asm
; @launch kernel=p1_kernel grid=(256,1,1) block=(256,1,1) lds=131072
; @launch kernel=p2_kernel grid=(256,1,1) block=(256,1,1) lds=117248
; @launch kernel=p3_kernel grid=(256,1,1) block=(256,1,1) lds=65536
.amdgcn_target "amdgcn-amd-amdhsa--gfx950"
.text
.globl p1_kernel
.p2align 8
.type p1_kernel,@function
p1_kernel:
    s_cmp_ge_u32 s2, 256
    s_cbranch_scc1 P1_exit
    s_load_dwordx4 s[4:7], s[0:1], 0
    s_load_dwordx2 s[8:9], s[0:1], 16
    s_load_dwordx2 s[10:11], s[0:1], 40
    s_load_dwordx2 s[12:13], s[0:1], 88
    s_load_dwordx2 s[70:71], s[0:1], 48
    s_load_dwordx2 s[72:73], s[0:1], 24
    s_load_dwordx2 s[74:75], s[0:1], 64
    v_lshrrev_b32 v40, 6, v0
    v_and_b32 v1, 63, v0
    v_readfirstlane_b32 s38, v40
    v_and_b32 v2, 15, v0
    v_bfe_u32 v3, v0, 4, 2
    s_and_b32 s48, s2, 1
    s_lshl_b32 s48, s48, 3
    s_bfe_u32 s37, s2, 0x30003
    s_add_u32 s37, s37, s48
    s_bfe_u32 s48, s2, 0x20001
    s_lshl_b32 s48, s48, 2
    s_lshr_b32 s36, s2, 6
    s_add_u32 s36, s36, s48
    s_lshr_b32 s39, s38, 1
    s_and_b32 s40, s38, 1
    s_mov_b32 s50, 0x3f803f80
    s_mov_b32 s51, 0x3fb8aa3b
    s_mov_b32 s52, 0xbfb8aa3b
    s_mov_b32 s54, 0xbdd2d3e8
    s_lshl_b32 s55, s38, 12
    s_mul_i32 s56, s38, 6144
    v_mov_b32 v40, 0
    v_mov_b32 v41, 0
    v_mov_b32 v42, 0
    v_mov_b32 v43, 0
    v_lshlrev_b32 v44, 4, v0
    ds_write_b128 v44, v[40:43] offset:0
    v_mov_b32 v24, s50
    v_mov_b32 v25, s50
    v_mov_b32 v26, s50
    v_mov_b32 v27, s50
    s_lshl_b32 s48, s36, 7
    s_lshl_b32 s49, s38, 5
    s_add_u32 s48, s48, s49
    v_lshrrev_b32 v40, 3, v1
    v_and_b32 v41, 7, v1
    v_xor_b32 v41, v41, v40
    v_add_u32 v40, s48, v40
    v_lshlrev_b32 v40, 10, v40
    v_lshl_add_u32 v4, v41, 4, v40
    v_add_u32 v5, 8192, v4
    v_add_u32 v6, 16384, v4
    v_add_u32 v7, 24576, v4
    s_movk_i32 s68, 3072
    s_movk_i32 s69, 512
    s_lshl_b32 s44, s37, 6
    s_cmp_lt_u32 s37, 8
    s_cbranch_scc1 P1_par
    s_movk_i32 s68, 2752
    s_movk_i32 s69, 64
    s_and_b32 s53, s37, 3
    s_mul_i32 s44, s53, 176
    s_cmp_lt_u32 s37, 12
    s_cbranch_scc1 P1_par
    s_add_u32 s44, s44, 688
P1_par:
    s_lshl_b32 s67, s68, 3
    s_add_u32 s67, s67, 64
    s_mul_i32 s48, s38, 384
    s_movk_i32 s49, 2731
    v_add_u32 v40, s48, v1
    v_add_u32 v40, 0, v40
    v_mul_lo_u32 v41, v40, s49
    v_lshrrev_b32 v41, 16, v41
    v_mul_u32_u24 v42, 24, v41
    v_sub_u32 v42, v40, v42
    v_bfe_u32 v43, v41, 1, 1
    v_lshrrev_b32 v44, 1, v42
    v_xor_b32 v44, v44, v43
    v_and_b32 v42, 1, v42
    v_lshrrev_b32 v45, 2, v44
    v_and_b32 v46, 3, v44
    v_lshlrev_b32 v46, 4, v46
    v_mul_u32_u24 v45, s69, v45
    v_add3_u32 v45, v45, v46, s44
    v_lshlrev_b32 v45, 1, v45
    v_lshl_add_u32 v45, v42, 4, v45
    v_mul_u32_u24 v41, s68, v41
    v_add_u32 v8, v41, v45
    v_and_b32 v47, 2, v44
    v_lshlrev_b32 v47, 6, v47
    v_sub_u32 v47, s67, v47
    v_add_u32 v11, v8, v47
    v_add_u32 v40, s48, v1
    v_add_u32 v40, 64, v40
    v_mul_lo_u32 v41, v40, s49
    v_lshrrev_b32 v41, 16, v41
    v_mul_u32_u24 v42, 24, v41
    v_sub_u32 v42, v40, v42
    v_bfe_u32 v43, v41, 1, 1
    v_lshrrev_b32 v44, 1, v42
    v_xor_b32 v44, v44, v43
    v_and_b32 v42, 1, v42
    v_lshrrev_b32 v45, 2, v44
    v_and_b32 v46, 3, v44
    v_lshlrev_b32 v46, 4, v46
    v_mul_u32_u24 v45, s69, v45
    v_add3_u32 v45, v45, v46, s44
    v_lshlrev_b32 v45, 1, v45
    v_lshl_add_u32 v45, v42, 4, v45
    v_mul_u32_u24 v41, s68, v41
    v_add_u32 v9, v41, v45
    v_and_b32 v47, 2, v44
    v_lshlrev_b32 v47, 6, v47
    v_sub_u32 v47, s67, v47
    v_add_u32 v12, v9, v47
    v_add_u32 v40, s48, v1
    v_add_u32 v40, 128, v40
    v_mul_lo_u32 v41, v40, s49
    v_lshrrev_b32 v41, 16, v41
    v_mul_u32_u24 v42, 24, v41
    v_sub_u32 v42, v40, v42
    v_bfe_u32 v43, v41, 1, 1
    v_lshrrev_b32 v44, 1, v42
    v_xor_b32 v44, v44, v43
    v_and_b32 v42, 1, v42
    v_lshrrev_b32 v45, 2, v44
    v_and_b32 v46, 3, v44
    v_lshlrev_b32 v46, 4, v46
    v_mul_u32_u24 v45, s69, v45
    v_add3_u32 v45, v45, v46, s44
    v_lshlrev_b32 v45, 1, v45
    v_lshl_add_u32 v45, v42, 4, v45
    v_mul_u32_u24 v41, s68, v41
    v_add_u32 v10, v41, v45
    v_and_b32 v47, 2, v44
    v_lshlrev_b32 v47, 6, v47
    v_sub_u32 v47, s67, v47
    v_add_u32 v13, v10, v47
    s_waitcnt lgkmcnt(0)
    s_mov_b32 s16, s4
    s_mov_b32 s17, s5
    s_mov_b32 s18, 2097152
    s_mov_b32 s19, 0x00020000
    s_movk_i32 s46, 0
    s_add_u32 m0, s55, 8192
    s_nop 0
    buffer_load_dwordx4 v4, s[16:19], s46 offen lds
    s_add_u32 m0, s55, 9216
    s_nop 0
    buffer_load_dwordx4 v5, s[16:19], s46 offen lds
    s_add_u32 m0, s55, 10240
    s_nop 0
    buffer_load_dwordx4 v6, s[16:19], s46 offen lds
    s_add_u32 m0, s55, 11264
    s_nop 0
    buffer_load_dwordx4 v7, s[16:19], s46 offen lds
    s_cmp_ge_u32 s37, 8
    s_cbranch_scc1 P1_bz
    s_mov_b32 s20, s6
    s_mov_b32 s21, s7
    s_mov_b32 s22, 1572864
    s_mov_b32 s23, 0x00020000
    s_mov_b32 s24, s8
    s_mov_b32 s25, s9
    s_mov_b32 s26, 16384
    s_mov_b32 s27, 0x00020000
    v_lshlrev_b32 v40, 1, v2
    v_lshl_add_u32 v40, v3, 7, v40
    s_xor_b32 s48, s39, 0
    s_lshl_b32 s49, s40, 1
    s_add_u32 s48, s48, s49
    s_lshl_b32 s49, s37, 2
    s_add_u32 s48, s48, s49
    s_lshl_b32 s48, s48, 9
    buffer_load_ushort v32, v40, s[24:27], s48 offen offset:0
    buffer_load_ushort v68, v40, s[24:27], s48 offen offset:32
    buffer_load_ushort v33, v40, s[24:27], s48 offen offset:64
    buffer_load_ushort v69, v40, s[24:27], s48 offen offset:96
    s_xor_b32 s48, s39, 1
    s_lshl_b32 s49, s40, 1
    s_add_u32 s48, s48, s49
    s_lshl_b32 s49, s37, 2
    s_add_u32 s48, s48, s49
    s_lshl_b32 s48, s48, 9
    buffer_load_ushort v34, v40, s[24:27], s48 offen offset:0
    buffer_load_ushort v70, v40, s[24:27], s48 offen offset:32
    buffer_load_ushort v35, v40, s[24:27], s48 offen offset:64
    buffer_load_ushort v71, v40, s[24:27], s48 offen offset:96
    s_branch P1_bj
P1_bz:
    s_mov_b32 s20, s10
    s_mov_b32 s21, s11
    s_mov_b32 s22, 1409024
    s_mov_b32 s23, 0x00020000
P1_bj:
    s_mul_i32 s47, s68, 0
    s_add_u32 m0, s56, 57344
    s_nop 0
    buffer_load_dwordx4 v8, s[20:23], s47 offen lds
    s_add_u32 m0, s56, 58368
    s_nop 0
    buffer_load_dwordx4 v9, s[20:23], s47 offen lds
    s_add_u32 m0, s56, 59392
    s_nop 0
    buffer_load_dwordx4 v10, s[20:23], s47 offen lds
    s_add_u32 m0, s56, 60416
    s_nop 0
    buffer_load_dwordx4 v11, s[20:23], s47 offen lds
    s_add_u32 m0, s56, 61440
    s_nop 0
    buffer_load_dwordx4 v12, s[20:23], s47 offen lds
    s_add_u32 m0, s56, 62464
    s_nop 0
    buffer_load_dwordx4 v13, s[20:23], s47 offen lds
    s_movk_i32 s46, 128
    s_add_u32 m0, s55, 24576
    s_nop 0
    buffer_load_dwordx4 v4, s[16:19], s46 offen lds
    s_add_u32 m0, s55, 25600
    s_nop 0
    buffer_load_dwordx4 v5, s[16:19], s46 offen lds
    s_add_u32 m0, s55, 26624
    s_nop 0
    buffer_load_dwordx4 v6, s[16:19], s46 offen lds
    s_add_u32 m0, s55, 27648
    s_nop 0
    buffer_load_dwordx4 v7, s[16:19], s46 offen lds
    s_mul_i32 s47, s68, 64
    s_add_u32 m0, s56, 81920
    s_nop 0
    buffer_load_dwordx4 v8, s[20:23], s47 offen lds
    s_add_u32 m0, s56, 82944
    s_nop 0
    buffer_load_dwordx4 v9, s[20:23], s47 offen lds
    s_add_u32 m0, s56, 83968
    s_nop 0
    buffer_load_dwordx4 v10, s[20:23], s47 offen lds
    s_add_u32 m0, s56, 84992
    s_nop 0
    buffer_load_dwordx4 v11, s[20:23], s47 offen lds
    s_add_u32 m0, s56, 86016
    s_nop 0
    buffer_load_dwordx4 v12, s[20:23], s47 offen lds
    s_add_u32 m0, s56, 87040
    s_nop 0
    buffer_load_dwordx4 v13, s[20:23], s47 offen lds
    s_movk_i32 s46, 256
    s_add_u32 m0, s55, 40960
    s_nop 0
    buffer_load_dwordx4 v4, s[16:19], s46 offen lds
    s_add_u32 m0, s55, 41984
    s_nop 0
    buffer_load_dwordx4 v5, s[16:19], s46 offen lds
    s_add_u32 m0, s55, 43008
    s_nop 0
    buffer_load_dwordx4 v6, s[16:19], s46 offen lds
    s_add_u32 m0, s55, 44032
    s_nop 0
    buffer_load_dwordx4 v7, s[16:19], s46 offen lds
    s_mul_i32 s47, s68, 128
    s_add_u32 m0, s56, 106496
    s_nop 0
    buffer_load_dwordx4 v8, s[20:23], s47 offen lds
    s_add_u32 m0, s56, 107520
    s_nop 0
    buffer_load_dwordx4 v9, s[20:23], s47 offen lds
    s_add_u32 m0, s56, 108544
    s_nop 0
    buffer_load_dwordx4 v10, s[20:23], s47 offen lds
    s_add_u32 m0, s56, 109568
    s_nop 0
    buffer_load_dwordx4 v11, s[20:23], s47 offen lds
    s_add_u32 m0, s56, 110592
    s_nop 0
    buffer_load_dwordx4 v12, s[20:23], s47 offen lds
    s_add_u32 m0, s56, 111616
    s_nop 0
    buffer_load_dwordx4 v13, s[20:23], s47 offen lds
    v_and_b32 v40, 7, v2
    v_xor_b32 v40, v40, v3
    v_lshlrev_b32 v40, 4, v40
    v_lshl_add_u32 v40, v2, 7, v40
    s_lshl_b32 s48, s39, 13
    s_lshl_b32 s49, s40, 12
    s_add_u32 s48, s48, s49
    s_add_u32 s48, s48, 8192
    v_add_u32 v14, s48, v40
    v_xor_b32 v15, 64, v14
    v_xor_b32 v16, 4096, v14
    v_xor_b32 v17, 4096, v15
    v_lshrrev_b32 v40, 2, v2
    v_lshl_add_u32 v40, v3, 3, v40
    v_mul_u32_u24 v40, 384, v40
    v_and_b32 v41, 3, v2
    v_lshl_add_u32 v40, v41, 3, v40
    v_add_u32 v40, 57344, v40
    v_lshrrev_b32 v41, 3, v2
    v_and_b32 v42, 1, v3
    v_lshl_or_b32 v41, v42, 1, v41
    s_lshl_b32 s48, s40, 1
    s_xor_b32 s57, s39, 0
    s_add_u32 s57, s57, 0
    s_add_u32 s57, s57, s48
    v_xor_b32 v42, s57, v41
    v_lshl_add_u32 v18, v42, 5, v40
    s_xor_b32 s57, s39, 0
    s_add_u32 s57, s57, 4
    s_add_u32 s57, s57, s48
    v_xor_b32 v42, s57, v41
    v_lshl_add_u32 v19, v42, 5, v40
    s_xor_b32 s57, s39, 0
    s_add_u32 s57, s57, 8
    s_add_u32 s57, s57, s48
    v_xor_b32 v42, s57, v41
    v_lshl_add_u32 v20, v42, 5, v40
    s_xor_b32 s57, s39, 1
    s_add_u32 s57, s57, 0
    s_add_u32 s57, s57, s48
    v_xor_b32 v42, s57, v41
    v_lshl_add_u32 v21, v42, 5, v40
    s_xor_b32 s57, s39, 1
    s_add_u32 s57, s57, 4
    s_add_u32 s57, s57, s48
    v_xor_b32 v42, s57, v41
    v_lshl_add_u32 v22, v42, 5, v40
    s_xor_b32 s57, s39, 1
    s_add_u32 s57, s57, 8
    s_add_u32 s57, s57, s48
    v_xor_b32 v42, s57, v41
    v_lshl_add_u32 v23, v42, 5, v40
    v_lshlrev_b32 v40, 2, v3
    v_sub_u32 v40, v2, v40
    v_mov_b32 v41, 0x3f80
    v_mov_b32 v42, 0x3f800000
    v_mov_b32 v38, s50
    v_mov_b32 v39, s50
    v_cmp_eq_u32 vcc, 0, v40
    v_cmp_eq_u32 s[66:67], 1, v40
    s_nop 1
    v_cndmask_b32 v36, 0, v41, vcc
    v_cndmask_b32 v36, v36, v42, s[66:67]
    v_cmp_eq_u32 vcc, 2, v40
    v_cmp_eq_u32 s[66:67], 3, v40
    s_nop 1
    v_cndmask_b32 v37, 0, v41, vcc
    v_cndmask_b32 v37, v37, v42, s[66:67]
    s_cmp_ge_u32 s37, 12
    s_cbranch_scc1 P1_z2
    s_cmp_ge_u32 s37, 8
    s_cbranch_scc1 P1_z1
P1_qkv:
    s_mov_b32 s28, s12
    s_mov_b32 s29, s13
    s_mov_b32 s30, 4194304
    s_mov_b32 s31, 0x00020000
    s_add_u32 s32, s12, 13631488
    s_addc_u32 s33, s13, 0
    s_mov_b32 s34, 1114112
    s_mov_b32 s35, 0x00020000
    s_waitcnt vmcnt(20) lgkmcnt(0)
    s_barrier
    ds_read_b128 v[80:83], v14 offset:0
    ds_read_b128 v[84:87], v14 offset:2048
    ds_read_b128 v[88:91], v16 offset:0
    ds_read_b128 v[92:95], v16 offset:2048
    ds_read_b64_tr_b16 v[96:97], v18 offset:0
    ds_read_b64_tr_b16 v[98:99], v18 offset:1536
    ds_read_b64_tr_b16 v[100:101], v19 offset:0
    ds_read_b64_tr_b16 v[102:103], v19 offset:1536
    ds_read_b64_tr_b16 v[104:105], v20 offset:0
    ds_read_b64_tr_b16 v[106:107], v20 offset:1536
    ds_read_b64_tr_b16 v[108:109], v21 offset:0
    ds_read_b64_tr_b16 v[110:111], v21 offset:1536
    ds_read_b64_tr_b16 v[112:113], v22 offset:0
    ds_read_b64_tr_b16 v[114:115], v22 offset:1536
    ds_read_b64_tr_b16 v[116:117], v23 offset:0
    ds_read_b64_tr_b16 v[118:119], v23 offset:1536
    s_waitcnt lgkmcnt(0)
    v_mfma_f32_16x16x32_bf16 v[160:163], v[96:99], v[80:83], 0
    ds_read_b128 v[120:123], v15 offset:0
    v_mfma_f32_16x16x32_bf16 v[184:187], v[96:99], v[84:87], 0
    ds_read_b128 v[124:127], v15 offset:2048
    v_mfma_f32_16x16x32_bf16 v[208:211], v[96:99], v[88:91], 0
    ds_read_b128 v[128:131], v17 offset:0
    v_mfma_f32_16x16x32_bf16 v[232:235], v[96:99], v[92:95], 0
    ds_read_b128 v[132:135], v17 offset:2048
    v_mfma_f32_16x16x32_bf16 v[164:167], v[100:103], v[80:83], 0
    ds_read_b64_tr_b16 v[136:137], v18 offset:12288
    v_mfma_f32_16x16x32_bf16 v[188:191], v[100:103], v[84:87], 0
    ds_read_b64_tr_b16 v[138:139], v18 offset:13824
    v_mfma_f32_16x16x32_bf16 v[212:215], v[100:103], v[88:91], 0
    ds_read_b64_tr_b16 v[140:141], v19 offset:12288
    v_mfma_f32_16x16x32_bf16 v[236:239], v[100:103], v[92:95], 0
    ds_read_b64_tr_b16 v[142:143], v19 offset:13824
    v_mfma_f32_16x16x32_bf16 v[168:171], v[80:83], v[104:107], 0
    ds_read_b64_tr_b16 v[144:145], v20 offset:12288
    v_mfma_f32_16x16x32_bf16 v[192:195], v[84:87], v[104:107], 0
    ds_read_b64_tr_b16 v[146:147], v20 offset:13824
    v_mfma_f32_16x16x32_bf16 v[216:219], v[88:91], v[104:107], 0
    ds_read_b64_tr_b16 v[148:149], v21 offset:12288
    v_mfma_f32_16x16x32_bf16 v[240:243], v[92:95], v[104:107], 0
    ds_read_b64_tr_b16 v[150:151], v21 offset:13824
    v_mfma_f32_16x16x32_bf16 v[172:175], v[108:111], v[80:83], 0
    ds_read_b64_tr_b16 v[152:153], v22 offset:12288
    v_mfma_f32_16x16x32_bf16 v[196:199], v[108:111], v[84:87], 0
    ds_read_b64_tr_b16 v[154:155], v22 offset:13824
    v_mfma_f32_16x16x32_bf16 v[220:223], v[108:111], v[88:91], 0
    ds_read_b64_tr_b16 v[156:157], v23 offset:12288
    v_mfma_f32_16x16x32_bf16 v[244:247], v[108:111], v[92:95], 0
    ds_read_b64_tr_b16 v[158:159], v23 offset:13824
    v_mfma_f32_16x16x32_bf16 v[176:179], v[112:115], v[80:83], 0
    v_mfma_f32_16x16x32_bf16 v[200:203], v[112:115], v[84:87], 0
    v_mfma_f32_16x16x32_bf16 v[224:227], v[112:115], v[88:91], 0
    v_mfma_f32_16x16x32_bf16 v[248:251], v[112:115], v[92:95], 0
    v_mfma_f32_16x16x32_bf16 v[180:183], v[80:83], v[116:119], 0
    v_mfma_f32_16x16x32_bf16 v[204:207], v[84:87], v[116:119], 0
    v_mfma_f32_16x16x32_bf16 v[228:231], v[88:91], v[116:119], 0
    v_mfma_f32_16x16x32_bf16 v[252:255], v[92:95], v[116:119], 0
    v_mfma_f32_16x16x32_bf16 a[0:3], v[24:27], v[80:83], 0
    v_mfma_f32_16x16x32_bf16 a[8:11], v[80:83], v[80:83], 0
    v_mfma_f32_16x16x32_bf16 a[4:7], v[24:27], v[84:87], 0
    v_mfma_f32_16x16x32_bf16 a[12:15], v[84:87], v[84:87], 0
    v_mfma_f32_16x16x32_bf16 a[16:19], v[24:27], v[96:99], 0
    v_mfma_f32_16x16x32_bf16 a[20:23], v[24:27], v[100:103], 0
    v_mfma_f32_16x16x32_bf16 a[24:27], v[24:27], v[104:107], 0
    s_waitcnt vmcnt(10) lgkmcnt(0)
    s_barrier
    v_mfma_f32_16x16x32_bf16 a[0:3], v[24:27], v[120:123], a[0:3]
    ds_read_b128 v[80:83], v14 offset:16384
    ds_read_b128 v[84:87], v14 offset:18432
    v_mfma_f32_16x16x32_bf16 a[8:11], v[120:123], v[120:123], a[8:11]
    ds_read_b128 v[88:91], v16 offset:16384
    ds_read_b128 v[92:95], v16 offset:18432
    v_mfma_f32_16x16x32_bf16 a[4:7], v[24:27], v[124:127], a[4:7]
    ds_read_b64_tr_b16 v[96:97], v18 offset:24576
    ds_read_b64_tr_b16 v[98:99], v18 offset:26112
    v_mfma_f32_16x16x32_bf16 a[12:15], v[124:127], v[124:127], a[12:15]
    ds_read_b64_tr_b16 v[100:101], v19 offset:24576
    ds_read_b64_tr_b16 v[102:103], v19 offset:26112
    v_mfma_f32_16x16x32_bf16 a[16:19], v[24:27], v[136:139], a[16:19]
    ds_read_b64_tr_b16 v[104:105], v20 offset:24576
    ds_read_b64_tr_b16 v[106:107], v20 offset:26112
    v_mfma_f32_16x16x32_bf16 a[20:23], v[24:27], v[140:143], a[20:23]
    ds_read_b64_tr_b16 v[108:109], v21 offset:24576
    ds_read_b64_tr_b16 v[110:111], v21 offset:26112
    v_mfma_f32_16x16x32_bf16 a[24:27], v[24:27], v[144:147], a[24:27]
    ds_read_b64_tr_b16 v[112:113], v22 offset:24576
    ds_read_b64_tr_b16 v[114:115], v22 offset:26112
    v_mfma_f32_16x16x32_bf16 v[160:163], v[136:139], v[120:123], v[160:163]
    ds_read_b64_tr_b16 v[116:117], v23 offset:24576
    ds_read_b64_tr_b16 v[118:119], v23 offset:26112
    v_mfma_f32_16x16x32_bf16 v[184:187], v[136:139], v[124:127], v[184:187]
    s_movk_i32 s46, 384
    s_mov_b32 s47, 589824
    v_mfma_f32_16x16x32_bf16 v[208:211], v[136:139], v[128:131], v[208:211]
    s_add_u32 m0, s55, 8192
    s_nop 0
    buffer_load_dwordx4 v4, s[16:19], s46 offen lds
    v_mfma_f32_16x16x32_bf16 v[232:235], v[136:139], v[132:135], v[232:235]
    s_add_u32 m0, s55, 9216
    s_nop 0
    buffer_load_dwordx4 v5, s[16:19], s46 offen lds
    v_mfma_f32_16x16x32_bf16 v[164:167], v[140:143], v[120:123], v[164:167]
    s_add_u32 m0, s55, 10240
    s_nop 0
    buffer_load_dwordx4 v6, s[16:19], s46 offen lds
    v_mfma_f32_16x16x32_bf16 v[188:191], v[140:143], v[124:127], v[188:191]
    s_add_u32 m0, s55, 11264
    s_nop 0
    buffer_load_dwordx4 v7, s[16:19], s46 offen lds
    v_mfma_f32_16x16x32_bf16 v[212:215], v[140:143], v[128:131], v[212:215]
    s_add_u32 m0, s56, 57344
    s_nop 0
    buffer_load_dwordx4 v8, s[20:23], s47 offen lds
    v_mfma_f32_16x16x32_bf16 v[236:239], v[140:143], v[132:135], v[236:239]
    s_add_u32 m0, s56, 58368
    s_nop 0
    buffer_load_dwordx4 v9, s[20:23], s47 offen lds
    v_mfma_f32_16x16x32_bf16 v[168:171], v[120:123], v[144:147], v[168:171]
    s_add_u32 m0, s56, 59392
    s_nop 0
    buffer_load_dwordx4 v10, s[20:23], s47 offen lds
    v_mfma_f32_16x16x32_bf16 v[192:195], v[124:127], v[144:147], v[192:195]
    s_add_u32 m0, s56, 60416
    s_nop 0
    buffer_load_dwordx4 v11, s[20:23], s47 offen lds
    v_mfma_f32_16x16x32_bf16 v[216:219], v[128:131], v[144:147], v[216:219]
    s_add_u32 m0, s56, 61440
    s_nop 0
    buffer_load_dwordx4 v12, s[20:23], s47 offen lds
    v_mfma_f32_16x16x32_bf16 v[240:243], v[132:135], v[144:147], v[240:243]
    s_add_u32 m0, s56, 62464
    s_nop 0
    buffer_load_dwordx4 v13, s[20:23], s47 offen lds
    v_mfma_f32_16x16x32_bf16 v[172:175], v[148:151], v[120:123], v[172:175]
    v_mfma_f32_16x16x32_bf16 v[196:199], v[148:151], v[124:127], v[196:199]
    v_mfma_f32_16x16x32_bf16 v[220:223], v[148:151], v[128:131], v[220:223]
    v_mfma_f32_16x16x32_bf16 v[244:247], v[148:151], v[132:135], v[244:247]
    v_mfma_f32_16x16x32_bf16 v[176:179], v[152:155], v[120:123], v[176:179]
    v_mfma_f32_16x16x32_bf16 v[200:203], v[152:155], v[124:127], v[200:203]
    v_mfma_f32_16x16x32_bf16 v[224:227], v[152:155], v[128:131], v[224:227]
    v_mfma_f32_16x16x32_bf16 v[248:251], v[152:155], v[132:135], v[248:251]
    v_mfma_f32_16x16x32_bf16 v[180:183], v[120:123], v[156:159], v[180:183]
    v_mfma_f32_16x16x32_bf16 v[204:207], v[124:127], v[156:159], v[204:207]
    v_mfma_f32_16x16x32_bf16 v[228:231], v[128:131], v[156:159], v[228:231]
    v_mfma_f32_16x16x32_bf16 v[252:255], v[132:135], v[156:159], v[252:255]
    s_waitcnt lgkmcnt(0)
    v_mfma_f32_16x16x32_bf16 v[160:163], v[96:99], v[80:83], v[160:163]
    ds_read_b128 v[120:123], v15 offset:16384
    v_mfma_f32_16x16x32_bf16 v[184:187], v[96:99], v[84:87], v[184:187]
    ds_read_b128 v[124:127], v15 offset:18432
    v_mfma_f32_16x16x32_bf16 v[208:211], v[96:99], v[88:91], v[208:211]
    ds_read_b128 v[128:131], v17 offset:16384
    v_mfma_f32_16x16x32_bf16 v[232:235], v[96:99], v[92:95], v[232:235]
    ds_read_b128 v[132:135], v17 offset:18432
    v_mfma_f32_16x16x32_bf16 v[164:167], v[100:103], v[80:83], v[164:167]
    ds_read_b64_tr_b16 v[136:137], v18 offset:36864
    v_mfma_f32_16x16x32_bf16 v[188:191], v[100:103], v[84:87], v[188:191]
    ds_read_b64_tr_b16 v[138:139], v18 offset:38400
    v_mfma_f32_16x16x32_bf16 v[212:215], v[100:103], v[88:91], v[212:215]
    ds_read_b64_tr_b16 v[140:141], v19 offset:36864
    v_mfma_f32_16x16x32_bf16 v[236:239], v[100:103], v[92:95], v[236:239]
    ds_read_b64_tr_b16 v[142:143], v19 offset:38400
    v_mfma_f32_16x16x32_bf16 v[168:171], v[80:83], v[104:107], v[168:171]
    ds_read_b64_tr_b16 v[144:145], v20 offset:36864
    v_mfma_f32_16x16x32_bf16 v[192:195], v[84:87], v[104:107], v[192:195]
    ds_read_b64_tr_b16 v[146:147], v20 offset:38400
    v_mfma_f32_16x16x32_bf16 v[216:219], v[88:91], v[104:107], v[216:219]
    ds_read_b64_tr_b16 v[148:149], v21 offset:36864
    v_mfma_f32_16x16x32_bf16 v[240:243], v[92:95], v[104:107], v[240:243]
    ds_read_b64_tr_b16 v[150:151], v21 offset:38400
    v_mfma_f32_16x16x32_bf16 v[172:175], v[108:111], v[80:83], v[172:175]
    ds_read_b64_tr_b16 v[152:153], v22 offset:36864
    v_mfma_f32_16x16x32_bf16 v[196:199], v[108:111], v[84:87], v[196:199]
    ds_read_b64_tr_b16 v[154:155], v22 offset:38400
    v_mfma_f32_16x16x32_bf16 v[220:223], v[108:111], v[88:91], v[220:223]
    ds_read_b64_tr_b16 v[156:157], v23 offset:36864
    v_mfma_f32_16x16x32_bf16 v[244:247], v[108:111], v[92:95], v[244:247]
    ds_read_b64_tr_b16 v[158:159], v23 offset:38400
    v_mfma_f32_16x16x32_bf16 v[176:179], v[112:115], v[80:83], v[176:179]
    v_mfma_f32_16x16x32_bf16 v[200:203], v[112:115], v[84:87], v[200:203]
    v_mfma_f32_16x16x32_bf16 v[224:227], v[112:115], v[88:91], v[224:227]
    v_mfma_f32_16x16x32_bf16 v[248:251], v[112:115], v[92:95], v[248:251]
    v_mfma_f32_16x16x32_bf16 v[180:183], v[80:83], v[116:119], v[180:183]
    v_mfma_f32_16x16x32_bf16 v[204:207], v[84:87], v[116:119], v[204:207]
    v_mfma_f32_16x16x32_bf16 v[228:231], v[88:91], v[116:119], v[228:231]
    v_mfma_f32_16x16x32_bf16 v[252:255], v[92:95], v[116:119], v[252:255]
    v_mfma_f32_16x16x32_bf16 a[0:3], v[24:27], v[80:83], a[0:3]
    v_mfma_f32_16x16x32_bf16 a[8:11], v[80:83], v[80:83], a[8:11]
    v_mfma_f32_16x16x32_bf16 a[4:7], v[24:27], v[84:87], a[4:7]
    v_mfma_f32_16x16x32_bf16 a[12:15], v[84:87], v[84:87], a[12:15]
    v_mfma_f32_16x16x32_bf16 a[16:19], v[24:27], v[96:99], a[16:19]
    v_mfma_f32_16x16x32_bf16 a[20:23], v[24:27], v[100:103], a[20:23]
    v_mfma_f32_16x16x32_bf16 a[24:27], v[24:27], v[104:107], a[24:27]
    s_waitcnt vmcnt(10) lgkmcnt(0)
    s_barrier
    v_mfma_f32_16x16x32_bf16 a[0:3], v[24:27], v[120:123], a[0:3]
    ds_read_b128 v[80:83], v14 offset:32768
    ds_read_b128 v[84:87], v14 offset:34816
    v_mfma_f32_16x16x32_bf16 a[8:11], v[120:123], v[120:123], a[8:11]
    ds_read_b128 v[88:91], v16 offset:32768
    ds_read_b128 v[92:95], v16 offset:34816
    v_mfma_f32_16x16x32_bf16 a[4:7], v[24:27], v[124:127], a[4:7]
    ds_read_b64_tr_b16 v[96:97], v18 offset:49152
    ds_read_b64_tr_b16 v[98:99], v18 offset:50688
    v_mfma_f32_16x16x32_bf16 a[12:15], v[124:127], v[124:127], a[12:15]
    ds_read_b64_tr_b16 v[100:101], v19 offset:49152
    ds_read_b64_tr_b16 v[102:103], v19 offset:50688
    v_mfma_f32_16x16x32_bf16 a[16:19], v[24:27], v[136:139], a[16:19]
    ds_read_b64_tr_b16 v[104:105], v20 offset:49152
    ds_read_b64_tr_b16 v[106:107], v20 offset:50688
    v_mfma_f32_16x16x32_bf16 a[20:23], v[24:27], v[140:143], a[20:23]
    ds_read_b64_tr_b16 v[108:109], v21 offset:49152
    ds_read_b64_tr_b16 v[110:111], v21 offset:50688
    v_mfma_f32_16x16x32_bf16 a[24:27], v[24:27], v[144:147], a[24:27]
    ds_read_b64_tr_b16 v[112:113], v22 offset:49152
    ds_read_b64_tr_b16 v[114:115], v22 offset:50688
    v_mfma_f32_16x16x32_bf16 v[160:163], v[136:139], v[120:123], v[160:163]
    ds_read_b64_tr_b16 v[116:117], v23 offset:49152
    ds_read_b64_tr_b16 v[118:119], v23 offset:50688
    v_mfma_f32_16x16x32_bf16 v[184:187], v[136:139], v[124:127], v[184:187]
    s_movk_i32 s46, 512
    s_mov_b32 s47, 786432
    v_mfma_f32_16x16x32_bf16 v[208:211], v[136:139], v[128:131], v[208:211]
    s_add_u32 m0, s55, 24576
    s_nop 0
    buffer_load_dwordx4 v4, s[16:19], s46 offen lds
    v_mfma_f32_16x16x32_bf16 v[232:235], v[136:139], v[132:135], v[232:235]
    s_add_u32 m0, s55, 25600
    s_nop 0
    buffer_load_dwordx4 v5, s[16:19], s46 offen lds
    v_mfma_f32_16x16x32_bf16 v[164:167], v[140:143], v[120:123], v[164:167]
    s_add_u32 m0, s55, 26624
    s_nop 0
    buffer_load_dwordx4 v6, s[16:19], s46 offen lds
    v_mfma_f32_16x16x32_bf16 v[188:191], v[140:143], v[124:127], v[188:191]
    s_add_u32 m0, s55, 27648
    s_nop 0
    buffer_load_dwordx4 v7, s[16:19], s46 offen lds
    v_mfma_f32_16x16x32_bf16 v[212:215], v[140:143], v[128:131], v[212:215]
    s_add_u32 m0, s56, 81920
    s_nop 0
    buffer_load_dwordx4 v8, s[20:23], s47 offen lds
    v_mfma_f32_16x16x32_bf16 v[236:239], v[140:143], v[132:135], v[236:239]
    s_add_u32 m0, s56, 82944
    s_nop 0
    buffer_load_dwordx4 v9, s[20:23], s47 offen lds
    v_mfma_f32_16x16x32_bf16 v[168:171], v[120:123], v[144:147], v[168:171]
    s_add_u32 m0, s56, 83968
    s_nop 0
    buffer_load_dwordx4 v10, s[20:23], s47 offen lds
    v_mfma_f32_16x16x32_bf16 v[192:195], v[124:127], v[144:147], v[192:195]
    s_add_u32 m0, s56, 84992
    s_nop 0
    buffer_load_dwordx4 v11, s[20:23], s47 offen lds
    v_mfma_f32_16x16x32_bf16 v[216:219], v[128:131], v[144:147], v[216:219]
    s_add_u32 m0, s56, 86016
    s_nop 0
    buffer_load_dwordx4 v12, s[20:23], s47 offen lds
    v_mfma_f32_16x16x32_bf16 v[240:243], v[132:135], v[144:147], v[240:243]
    s_add_u32 m0, s56, 87040
    s_nop 0
    buffer_load_dwordx4 v13, s[20:23], s47 offen lds
    v_mfma_f32_16x16x32_bf16 v[172:175], v[148:151], v[120:123], v[172:175]
    v_mfma_f32_16x16x32_bf16 v[196:199], v[148:151], v[124:127], v[196:199]
    v_mfma_f32_16x16x32_bf16 v[220:223], v[148:151], v[128:131], v[220:223]
    v_mfma_f32_16x16x32_bf16 v[244:247], v[148:151], v[132:135], v[244:247]
    v_mfma_f32_16x16x32_bf16 v[176:179], v[152:155], v[120:123], v[176:179]
    v_mfma_f32_16x16x32_bf16 v[200:203], v[152:155], v[124:127], v[200:203]
    v_mfma_f32_16x16x32_bf16 v[224:227], v[152:155], v[128:131], v[224:227]
    v_mfma_f32_16x16x32_bf16 v[248:251], v[152:155], v[132:135], v[248:251]
    v_mfma_f32_16x16x32_bf16 v[180:183], v[120:123], v[156:159], v[180:183]
    v_mfma_f32_16x16x32_bf16 v[204:207], v[124:127], v[156:159], v[204:207]
    v_mfma_f32_16x16x32_bf16 v[228:231], v[128:131], v[156:159], v[228:231]
    v_mfma_f32_16x16x32_bf16 v[252:255], v[132:135], v[156:159], v[252:255]
    s_waitcnt lgkmcnt(0)
    v_mfma_f32_16x16x32_bf16 v[160:163], v[96:99], v[80:83], v[160:163]
    ds_read_b128 v[120:123], v15 offset:32768
    v_mfma_f32_16x16x32_bf16 v[184:187], v[96:99], v[84:87], v[184:187]
    ds_read_b128 v[124:127], v15 offset:34816
    v_mfma_f32_16x16x32_bf16 v[208:211], v[96:99], v[88:91], v[208:211]
    ds_read_b128 v[128:131], v17 offset:32768
    v_mfma_f32_16x16x32_bf16 v[232:235], v[96:99], v[92:95], v[232:235]
    ds_read_b128 v[132:135], v17 offset:34816
    v_mfma_f32_16x16x32_bf16 v[164:167], v[100:103], v[80:83], v[164:167]
    ds_read_b64_tr_b16 v[136:137], v18 offset:61440
    v_mfma_f32_16x16x32_bf16 v[188:191], v[100:103], v[84:87], v[188:191]
    ds_read_b64_tr_b16 v[138:139], v18 offset:62976
    v_mfma_f32_16x16x32_bf16 v[212:215], v[100:103], v[88:91], v[212:215]
    ds_read_b64_tr_b16 v[140:141], v19 offset:61440
    v_mfma_f32_16x16x32_bf16 v[236:239], v[100:103], v[92:95], v[236:239]
    ds_read_b64_tr_b16 v[142:143], v19 offset:62976
    v_mfma_f32_16x16x32_bf16 v[168:171], v[80:83], v[104:107], v[168:171]
    ds_read_b64_tr_b16 v[144:145], v20 offset:61440
    v_mfma_f32_16x16x32_bf16 v[192:195], v[84:87], v[104:107], v[192:195]
    ds_read_b64_tr_b16 v[146:147], v20 offset:62976
    v_mfma_f32_16x16x32_bf16 v[216:219], v[88:91], v[104:107], v[216:219]
    ds_read_b64_tr_b16 v[148:149], v21 offset:61440
    v_mfma_f32_16x16x32_bf16 v[240:243], v[92:95], v[104:107], v[240:243]
    ds_read_b64_tr_b16 v[150:151], v21 offset:62976
    v_mfma_f32_16x16x32_bf16 v[172:175], v[108:111], v[80:83], v[172:175]
    ds_read_b64_tr_b16 v[152:153], v22 offset:61440
    v_mfma_f32_16x16x32_bf16 v[196:199], v[108:111], v[84:87], v[196:199]
    ds_read_b64_tr_b16 v[154:155], v22 offset:62976
    v_mfma_f32_16x16x32_bf16 v[220:223], v[108:111], v[88:91], v[220:223]
    ds_read_b64_tr_b16 v[156:157], v23 offset:61440
    v_mfma_f32_16x16x32_bf16 v[244:247], v[108:111], v[92:95], v[244:247]
    ds_read_b64_tr_b16 v[158:159], v23 offset:62976
    v_mfma_f32_16x16x32_bf16 v[176:179], v[112:115], v[80:83], v[176:179]
    v_mfma_f32_16x16x32_bf16 v[200:203], v[112:115], v[84:87], v[200:203]
    v_mfma_f32_16x16x32_bf16 v[224:227], v[112:115], v[88:91], v[224:227]
    v_mfma_f32_16x16x32_bf16 v[248:251], v[112:115], v[92:95], v[248:251]
    v_mfma_f32_16x16x32_bf16 v[180:183], v[80:83], v[116:119], v[180:183]
    v_mfma_f32_16x16x32_bf16 v[204:207], v[84:87], v[116:119], v[204:207]
    v_mfma_f32_16x16x32_bf16 v[228:231], v[88:91], v[116:119], v[228:231]
    v_mfma_f32_16x16x32_bf16 v[252:255], v[92:95], v[116:119], v[252:255]
    v_mfma_f32_16x16x32_bf16 a[0:3], v[24:27], v[80:83], a[0:3]
    v_mfma_f32_16x16x32_bf16 a[8:11], v[80:83], v[80:83], a[8:11]
    v_mfma_f32_16x16x32_bf16 a[4:7], v[24:27], v[84:87], a[4:7]
    v_mfma_f32_16x16x32_bf16 a[12:15], v[84:87], v[84:87], a[12:15]
    v_mfma_f32_16x16x32_bf16 a[16:19], v[24:27], v[96:99], a[16:19]
    v_mfma_f32_16x16x32_bf16 a[20:23], v[24:27], v[100:103], a[20:23]
    v_mfma_f32_16x16x32_bf16 a[24:27], v[24:27], v[104:107], a[24:27]
    s_waitcnt vmcnt(10) lgkmcnt(0)
    s_barrier
    v_mfma_f32_16x16x32_bf16 a[0:3], v[24:27], v[120:123], a[0:3]
    ds_read_b128 v[80:83], v14 offset:0
    ds_read_b128 v[84:87], v14 offset:2048
    v_mfma_f32_16x16x32_bf16 a[8:11], v[120:123], v[120:123], a[8:11]
    ds_read_b128 v[88:91], v16 offset:0
    ds_read_b128 v[92:95], v16 offset:2048
    v_mfma_f32_16x16x32_bf16 a[4:7], v[24:27], v[124:127], a[4:7]
    ds_read_b64_tr_b16 v[96:97], v18 offset:0
    ds_read_b64_tr_b16 v[98:99], v18 offset:1536
    v_mfma_f32_16x16x32_bf16 a[12:15], v[124:127], v[124:127], a[12:15]
    ds_read_b64_tr_b16 v[100:101], v19 offset:0
    ds_read_b64_tr_b16 v[102:103], v19 offset:1536
    v_mfma_f32_16x16x32_bf16 a[16:19], v[24:27], v[136:139], a[16:19]
    ds_read_b64_tr_b16 v[104:105], v20 offset:0
    ds_read_b64_tr_b16 v[106:107], v20 offset:1536
    v_mfma_f32_16x16x32_bf16 a[20:23], v[24:27], v[140:143], a[20:23]
    ds_read_b64_tr_b16 v[108:109], v21 offset:0
    ds_read_b64_tr_b16 v[110:111], v21 offset:1536
    v_mfma_f32_16x16x32_bf16 a[24:27], v[24:27], v[144:147], a[24:27]
    ds_read_b64_tr_b16 v[112:113], v22 offset:0
    ds_read_b64_tr_b16 v[114:115], v22 offset:1536
    v_mfma_f32_16x16x32_bf16 v[160:163], v[136:139], v[120:123], v[160:163]
    ds_read_b64_tr_b16 v[116:117], v23 offset:0
    ds_read_b64_tr_b16 v[118:119], v23 offset:1536
    v_mfma_f32_16x16x32_bf16 v[184:187], v[136:139], v[124:127], v[184:187]
    s_movk_i32 s46, 640
    s_mov_b32 s47, 983040
    v_mfma_f32_16x16x32_bf16 v[208:211], v[136:139], v[128:131], v[208:211]
    s_add_u32 m0, s55, 40960
    s_nop 0
    buffer_load_dwordx4 v4, s[16:19], s46 offen lds
    v_mfma_f32_16x16x32_bf16 v[232:235], v[136:139], v[132:135], v[232:235]
    s_add_u32 m0, s55, 41984
    s_nop 0
    buffer_load_dwordx4 v5, s[16:19], s46 offen lds
    v_mfma_f32_16x16x32_bf16 v[164:167], v[140:143], v[120:123], v[164:167]
    s_add_u32 m0, s55, 43008
    s_nop 0
    buffer_load_dwordx4 v6, s[16:19], s46 offen lds
    v_mfma_f32_16x16x32_bf16 v[188:191], v[140:143], v[124:127], v[188:191]
    s_add_u32 m0, s55, 44032
    s_nop 0
    buffer_load_dwordx4 v7, s[16:19], s46 offen lds
    v_mfma_f32_16x16x32_bf16 v[212:215], v[140:143], v[128:131], v[212:215]
    s_add_u32 m0, s56, 106496
    s_nop 0
    buffer_load_dwordx4 v8, s[20:23], s47 offen lds
    v_mfma_f32_16x16x32_bf16 v[236:239], v[140:143], v[132:135], v[236:239]
    s_add_u32 m0, s56, 107520
    s_nop 0
    buffer_load_dwordx4 v9, s[20:23], s47 offen lds
    v_mfma_f32_16x16x32_bf16 v[168:171], v[120:123], v[144:147], v[168:171]
    s_add_u32 m0, s56, 108544
    s_nop 0
    buffer_load_dwordx4 v10, s[20:23], s47 offen lds
    v_mfma_f32_16x16x32_bf16 v[192:195], v[124:127], v[144:147], v[192:195]
    s_add_u32 m0, s56, 109568
    s_nop 0
    buffer_load_dwordx4 v11, s[20:23], s47 offen lds
    v_mfma_f32_16x16x32_bf16 v[216:219], v[128:131], v[144:147], v[216:219]
    s_add_u32 m0, s56, 110592
    s_nop 0
    buffer_load_dwordx4 v12, s[20:23], s47 offen lds
    v_mfma_f32_16x16x32_bf16 v[240:243], v[132:135], v[144:147], v[240:243]
    s_add_u32 m0, s56, 111616
    s_nop 0
    buffer_load_dwordx4 v13, s[20:23], s47 offen lds
    v_mfma_f32_16x16x32_bf16 v[172:175], v[148:151], v[120:123], v[172:175]
    v_mfma_f32_16x16x32_bf16 v[196:199], v[148:151], v[124:127], v[196:199]
    v_mfma_f32_16x16x32_bf16 v[220:223], v[148:151], v[128:131], v[220:223]
    v_mfma_f32_16x16x32_bf16 v[244:247], v[148:151], v[132:135], v[244:247]
    v_mfma_f32_16x16x32_bf16 v[176:179], v[152:155], v[120:123], v[176:179]
    v_mfma_f32_16x16x32_bf16 v[200:203], v[152:155], v[124:127], v[200:203]
    v_mfma_f32_16x16x32_bf16 v[224:227], v[152:155], v[128:131], v[224:227]
    v_mfma_f32_16x16x32_bf16 v[248:251], v[152:155], v[132:135], v[248:251]
    v_mfma_f32_16x16x32_bf16 v[180:183], v[120:123], v[156:159], v[180:183]
    v_mfma_f32_16x16x32_bf16 v[204:207], v[124:127], v[156:159], v[204:207]
    v_mfma_f32_16x16x32_bf16 v[228:231], v[128:131], v[156:159], v[228:231]
    v_mfma_f32_16x16x32_bf16 v[252:255], v[132:135], v[156:159], v[252:255]
    s_waitcnt lgkmcnt(0)
    v_mfma_f32_16x16x32_bf16 v[160:163], v[96:99], v[80:83], v[160:163]
    ds_read_b128 v[120:123], v15 offset:0
    v_mfma_f32_16x16x32_bf16 v[184:187], v[96:99], v[84:87], v[184:187]
    ds_read_b128 v[124:127], v15 offset:2048
    v_mfma_f32_16x16x32_bf16 v[208:211], v[96:99], v[88:91], v[208:211]
    ds_read_b128 v[128:131], v17 offset:0
    v_mfma_f32_16x16x32_bf16 v[232:235], v[96:99], v[92:95], v[232:235]
    ds_read_b128 v[132:135], v17 offset:2048
    v_mfma_f32_16x16x32_bf16 v[164:167], v[100:103], v[80:83], v[164:167]
    ds_read_b64_tr_b16 v[136:137], v18 offset:12288
    v_mfma_f32_16x16x32_bf16 v[188:191], v[100:103], v[84:87], v[188:191]
    ds_read_b64_tr_b16 v[138:139], v18 offset:13824
    v_mfma_f32_16x16x32_bf16 v[212:215], v[100:103], v[88:91], v[212:215]
    ds_read_b64_tr_b16 v[140:141], v19 offset:12288
    v_mfma_f32_16x16x32_bf16 v[236:239], v[100:103], v[92:95], v[236:239]
    ds_read_b64_tr_b16 v[142:143], v19 offset:13824
    v_mfma_f32_16x16x32_bf16 v[168:171], v[80:83], v[104:107], v[168:171]
    ds_read_b64_tr_b16 v[144:145], v20 offset:12288
    v_mfma_f32_16x16x32_bf16 v[192:195], v[84:87], v[104:107], v[192:195]
    ds_read_b64_tr_b16 v[146:147], v20 offset:13824
    v_mfma_f32_16x16x32_bf16 v[216:219], v[88:91], v[104:107], v[216:219]
    ds_read_b64_tr_b16 v[148:149], v21 offset:12288
    v_mfma_f32_16x16x32_bf16 v[240:243], v[92:95], v[104:107], v[240:243]
    ds_read_b64_tr_b16 v[150:151], v21 offset:13824
    v_mfma_f32_16x16x32_bf16 v[172:175], v[108:111], v[80:83], v[172:175]
    ds_read_b64_tr_b16 v[152:153], v22 offset:12288
    v_mfma_f32_16x16x32_bf16 v[196:199], v[108:111], v[84:87], v[196:199]
    ds_read_b64_tr_b16 v[154:155], v22 offset:13824
    v_mfma_f32_16x16x32_bf16 v[220:223], v[108:111], v[88:91], v[220:223]
    ds_read_b64_tr_b16 v[156:157], v23 offset:12288
    v_mfma_f32_16x16x32_bf16 v[244:247], v[108:111], v[92:95], v[244:247]
    ds_read_b64_tr_b16 v[158:159], v23 offset:13824
    v_mfma_f32_16x16x32_bf16 v[176:179], v[112:115], v[80:83], v[176:179]
    v_mfma_f32_16x16x32_bf16 v[200:203], v[112:115], v[84:87], v[200:203]
    v_mfma_f32_16x16x32_bf16 v[224:227], v[112:115], v[88:91], v[224:227]
    v_mfma_f32_16x16x32_bf16 v[248:251], v[112:115], v[92:95], v[248:251]
    v_mfma_f32_16x16x32_bf16 v[180:183], v[80:83], v[116:119], v[180:183]
    v_mfma_f32_16x16x32_bf16 v[204:207], v[84:87], v[116:119], v[204:207]
    v_mfma_f32_16x16x32_bf16 v[228:231], v[88:91], v[116:119], v[228:231]
    v_mfma_f32_16x16x32_bf16 v[252:255], v[92:95], v[116:119], v[252:255]
    v_mfma_f32_16x16x32_bf16 a[0:3], v[24:27], v[80:83], a[0:3]
    v_mfma_f32_16x16x32_bf16 a[8:11], v[80:83], v[80:83], a[8:11]
    v_mfma_f32_16x16x32_bf16 a[4:7], v[24:27], v[84:87], a[4:7]
    v_mfma_f32_16x16x32_bf16 a[12:15], v[84:87], v[84:87], a[12:15]
    v_mfma_f32_16x16x32_bf16 a[16:19], v[24:27], v[96:99], a[16:19]
    v_mfma_f32_16x16x32_bf16 a[20:23], v[24:27], v[100:103], a[20:23]
    v_mfma_f32_16x16x32_bf16 a[24:27], v[24:27], v[104:107], a[24:27]
    s_waitcnt vmcnt(10) lgkmcnt(0)
    s_barrier
    v_mfma_f32_16x16x32_bf16 a[0:3], v[24:27], v[120:123], a[0:3]
    ds_read_b128 v[80:83], v14 offset:16384
    ds_read_b128 v[84:87], v14 offset:18432
    v_mfma_f32_16x16x32_bf16 a[8:11], v[120:123], v[120:123], a[8:11]
    ds_read_b128 v[88:91], v16 offset:16384
    ds_read_b128 v[92:95], v16 offset:18432
    v_mfma_f32_16x16x32_bf16 a[4:7], v[24:27], v[124:127], a[4:7]
    ds_read_b64_tr_b16 v[96:97], v18 offset:24576
    ds_read_b64_tr_b16 v[98:99], v18 offset:26112
    v_mfma_f32_16x16x32_bf16 a[12:15], v[124:127], v[124:127], a[12:15]
    ds_read_b64_tr_b16 v[100:101], v19 offset:24576
    ds_read_b64_tr_b16 v[102:103], v19 offset:26112
    v_mfma_f32_16x16x32_bf16 a[16:19], v[24:27], v[136:139], a[16:19]
    ds_read_b64_tr_b16 v[104:105], v20 offset:24576
    ds_read_b64_tr_b16 v[106:107], v20 offset:26112
    v_mfma_f32_16x16x32_bf16 a[20:23], v[24:27], v[140:143], a[20:23]
    ds_read_b64_tr_b16 v[108:109], v21 offset:24576
    ds_read_b64_tr_b16 v[110:111], v21 offset:26112
    v_mfma_f32_16x16x32_bf16 a[24:27], v[24:27], v[144:147], a[24:27]
    ds_read_b64_tr_b16 v[112:113], v22 offset:24576
    ds_read_b64_tr_b16 v[114:115], v22 offset:26112
    v_mfma_f32_16x16x32_bf16 v[160:163], v[136:139], v[120:123], v[160:163]
    ds_read_b64_tr_b16 v[116:117], v23 offset:24576
    ds_read_b64_tr_b16 v[118:119], v23 offset:26112
    v_mfma_f32_16x16x32_bf16 v[184:187], v[136:139], v[124:127], v[184:187]
    s_movk_i32 s46, 768
    s_mov_b32 s47, 1179648
    v_mfma_f32_16x16x32_bf16 v[208:211], v[136:139], v[128:131], v[208:211]
    s_add_u32 m0, s55, 8192
    s_nop 0
    buffer_load_dwordx4 v4, s[16:19], s46 offen lds
    v_mfma_f32_16x16x32_bf16 v[232:235], v[136:139], v[132:135], v[232:235]
    s_add_u32 m0, s55, 9216
    s_nop 0
    buffer_load_dwordx4 v5, s[16:19], s46 offen lds
    v_mfma_f32_16x16x32_bf16 v[164:167], v[140:143], v[120:123], v[164:167]
    s_add_u32 m0, s55, 10240
    s_nop 0
    buffer_load_dwordx4 v6, s[16:19], s46 offen lds
    v_mfma_f32_16x16x32_bf16 v[188:191], v[140:143], v[124:127], v[188:191]
    s_add_u32 m0, s55, 11264
    s_nop 0
    buffer_load_dwordx4 v7, s[16:19], s46 offen lds
    v_mfma_f32_16x16x32_bf16 v[212:215], v[140:143], v[128:131], v[212:215]
    s_add_u32 m0, s56, 57344
    s_nop 0
    buffer_load_dwordx4 v8, s[20:23], s47 offen lds
    v_mfma_f32_16x16x32_bf16 v[236:239], v[140:143], v[132:135], v[236:239]
    s_add_u32 m0, s56, 58368
    s_nop 0
    buffer_load_dwordx4 v9, s[20:23], s47 offen lds
    v_mfma_f32_16x16x32_bf16 v[168:171], v[120:123], v[144:147], v[168:171]
    s_add_u32 m0, s56, 59392
    s_nop 0
    buffer_load_dwordx4 v10, s[20:23], s47 offen lds
    v_mfma_f32_16x16x32_bf16 v[192:195], v[124:127], v[144:147], v[192:195]
    s_add_u32 m0, s56, 60416
    s_nop 0
    buffer_load_dwordx4 v11, s[20:23], s47 offen lds
    v_mfma_f32_16x16x32_bf16 v[216:219], v[128:131], v[144:147], v[216:219]
    s_add_u32 m0, s56, 61440
    s_nop 0
    buffer_load_dwordx4 v12, s[20:23], s47 offen lds
    v_mfma_f32_16x16x32_bf16 v[240:243], v[132:135], v[144:147], v[240:243]
    s_add_u32 m0, s56, 62464
    s_nop 0
    buffer_load_dwordx4 v13, s[20:23], s47 offen lds
    v_mfma_f32_16x16x32_bf16 v[172:175], v[148:151], v[120:123], v[172:175]
    v_mfma_f32_16x16x32_bf16 v[196:199], v[148:151], v[124:127], v[196:199]
    v_mfma_f32_16x16x32_bf16 v[220:223], v[148:151], v[128:131], v[220:223]
    v_mfma_f32_16x16x32_bf16 v[244:247], v[148:151], v[132:135], v[244:247]
    v_mfma_f32_16x16x32_bf16 v[176:179], v[152:155], v[120:123], v[176:179]
    v_mfma_f32_16x16x32_bf16 v[200:203], v[152:155], v[124:127], v[200:203]
    v_mfma_f32_16x16x32_bf16 v[224:227], v[152:155], v[128:131], v[224:227]
    v_mfma_f32_16x16x32_bf16 v[248:251], v[152:155], v[132:135], v[248:251]
    v_mfma_f32_16x16x32_bf16 v[180:183], v[120:123], v[156:159], v[180:183]
    v_mfma_f32_16x16x32_bf16 v[204:207], v[124:127], v[156:159], v[204:207]
    v_mfma_f32_16x16x32_bf16 v[228:231], v[128:131], v[156:159], v[228:231]
    v_mfma_f32_16x16x32_bf16 v[252:255], v[132:135], v[156:159], v[252:255]
    s_waitcnt lgkmcnt(0)
    v_mfma_f32_16x16x32_bf16 v[160:163], v[96:99], v[80:83], v[160:163]
    ds_read_b128 v[120:123], v15 offset:16384
    v_mfma_f32_16x16x32_bf16 v[184:187], v[96:99], v[84:87], v[184:187]
    ds_read_b128 v[124:127], v15 offset:18432
    v_mfma_f32_16x16x32_bf16 v[208:211], v[96:99], v[88:91], v[208:211]
    ds_read_b128 v[128:131], v17 offset:16384
    v_mfma_f32_16x16x32_bf16 v[232:235], v[96:99], v[92:95], v[232:235]
    ds_read_b128 v[132:135], v17 offset:18432
    v_mfma_f32_16x16x32_bf16 v[164:167], v[100:103], v[80:83], v[164:167]
    ds_read_b64_tr_b16 v[136:137], v18 offset:36864
    v_mfma_f32_16x16x32_bf16 v[188:191], v[100:103], v[84:87], v[188:191]
    ds_read_b64_tr_b16 v[138:139], v18 offset:38400
    v_mfma_f32_16x16x32_bf16 v[212:215], v[100:103], v[88:91], v[212:215]
    ds_read_b64_tr_b16 v[140:141], v19 offset:36864
    v_mfma_f32_16x16x32_bf16 v[236:239], v[100:103], v[92:95], v[236:239]
    ds_read_b64_tr_b16 v[142:143], v19 offset:38400
    v_mfma_f32_16x16x32_bf16 v[168:171], v[80:83], v[104:107], v[168:171]
    ds_read_b64_tr_b16 v[144:145], v20 offset:36864
    v_mfma_f32_16x16x32_bf16 v[192:195], v[84:87], v[104:107], v[192:195]
    ds_read_b64_tr_b16 v[146:147], v20 offset:38400
    v_mfma_f32_16x16x32_bf16 v[216:219], v[88:91], v[104:107], v[216:219]
    ds_read_b64_tr_b16 v[148:149], v21 offset:36864
    v_mfma_f32_16x16x32_bf16 v[240:243], v[92:95], v[104:107], v[240:243]
    ds_read_b64_tr_b16 v[150:151], v21 offset:38400
    v_mfma_f32_16x16x32_bf16 v[172:175], v[108:111], v[80:83], v[172:175]
    ds_read_b64_tr_b16 v[152:153], v22 offset:36864
    v_mfma_f32_16x16x32_bf16 v[196:199], v[108:111], v[84:87], v[196:199]
    ds_read_b64_tr_b16 v[154:155], v22 offset:38400
    v_mfma_f32_16x16x32_bf16 v[220:223], v[108:111], v[88:91], v[220:223]
    ds_read_b64_tr_b16 v[156:157], v23 offset:36864
    v_mfma_f32_16x16x32_bf16 v[244:247], v[108:111], v[92:95], v[244:247]
    ds_read_b64_tr_b16 v[158:159], v23 offset:38400
    v_mfma_f32_16x16x32_bf16 v[176:179], v[112:115], v[80:83], v[176:179]
    v_mfma_f32_16x16x32_bf16 v[200:203], v[112:115], v[84:87], v[200:203]
    v_mfma_f32_16x16x32_bf16 v[224:227], v[112:115], v[88:91], v[224:227]
    v_mfma_f32_16x16x32_bf16 v[248:251], v[112:115], v[92:95], v[248:251]
    v_mfma_f32_16x16x32_bf16 v[180:183], v[80:83], v[116:119], v[180:183]
    v_mfma_f32_16x16x32_bf16 v[204:207], v[84:87], v[116:119], v[204:207]
    v_mfma_f32_16x16x32_bf16 v[228:231], v[88:91], v[116:119], v[228:231]
    v_mfma_f32_16x16x32_bf16 v[252:255], v[92:95], v[116:119], v[252:255]
    v_mfma_f32_16x16x32_bf16 a[0:3], v[24:27], v[80:83], a[0:3]
    v_mfma_f32_16x16x32_bf16 a[8:11], v[80:83], v[80:83], a[8:11]
    v_mfma_f32_16x16x32_bf16 a[4:7], v[24:27], v[84:87], a[4:7]
    v_mfma_f32_16x16x32_bf16 a[12:15], v[84:87], v[84:87], a[12:15]
    v_mfma_f32_16x16x32_bf16 a[16:19], v[24:27], v[96:99], a[16:19]
    v_mfma_f32_16x16x32_bf16 a[20:23], v[24:27], v[100:103], a[20:23]
    v_mfma_f32_16x16x32_bf16 a[24:27], v[24:27], v[104:107], a[24:27]
    s_waitcnt vmcnt(10) lgkmcnt(0)
    s_barrier
    v_mfma_f32_16x16x32_bf16 a[0:3], v[24:27], v[120:123], a[0:3]
    ds_read_b128 v[80:83], v14 offset:32768
    ds_read_b128 v[84:87], v14 offset:34816
    v_mfma_f32_16x16x32_bf16 a[8:11], v[120:123], v[120:123], a[8:11]
    ds_read_b128 v[88:91], v16 offset:32768
    ds_read_b128 v[92:95], v16 offset:34816
    v_mfma_f32_16x16x32_bf16 a[4:7], v[24:27], v[124:127], a[4:7]
    ds_read_b64_tr_b16 v[96:97], v18 offset:49152
    ds_read_b64_tr_b16 v[98:99], v18 offset:50688
    v_mfma_f32_16x16x32_bf16 a[12:15], v[124:127], v[124:127], a[12:15]
    ds_read_b64_tr_b16 v[100:101], v19 offset:49152
    ds_read_b64_tr_b16 v[102:103], v19 offset:50688
    v_mfma_f32_16x16x32_bf16 a[16:19], v[24:27], v[136:139], a[16:19]
    ds_read_b64_tr_b16 v[104:105], v20 offset:49152
    ds_read_b64_tr_b16 v[106:107], v20 offset:50688
    v_mfma_f32_16x16x32_bf16 a[20:23], v[24:27], v[140:143], a[20:23]
    ds_read_b64_tr_b16 v[108:109], v21 offset:49152
    ds_read_b64_tr_b16 v[110:111], v21 offset:50688
    v_mfma_f32_16x16x32_bf16 a[24:27], v[24:27], v[144:147], a[24:27]
    ds_read_b64_tr_b16 v[112:113], v22 offset:49152
    ds_read_b64_tr_b16 v[114:115], v22 offset:50688
    v_mfma_f32_16x16x32_bf16 v[160:163], v[136:139], v[120:123], v[160:163]
    ds_read_b64_tr_b16 v[116:117], v23 offset:49152
    ds_read_b64_tr_b16 v[118:119], v23 offset:50688
    v_mfma_f32_16x16x32_bf16 v[184:187], v[136:139], v[124:127], v[184:187]
    s_movk_i32 s46, 896
    s_mov_b32 s47, 1376256
    v_mfma_f32_16x16x32_bf16 v[208:211], v[136:139], v[128:131], v[208:211]
    s_add_u32 m0, s55, 24576
    s_nop 0
    buffer_load_dwordx4 v4, s[16:19], s46 offen lds
    v_mfma_f32_16x16x32_bf16 v[232:235], v[136:139], v[132:135], v[232:235]
    s_add_u32 m0, s55, 25600
    s_nop 0
    buffer_load_dwordx4 v5, s[16:19], s46 offen lds
    v_mfma_f32_16x16x32_bf16 v[164:167], v[140:143], v[120:123], v[164:167]
    s_add_u32 m0, s55, 26624
    s_nop 0
    buffer_load_dwordx4 v6, s[16:19], s46 offen lds
    v_mfma_f32_16x16x32_bf16 v[188:191], v[140:143], v[124:127], v[188:191]
    s_add_u32 m0, s55, 27648
    s_nop 0
    buffer_load_dwordx4 v7, s[16:19], s46 offen lds
    v_mfma_f32_16x16x32_bf16 v[212:215], v[140:143], v[128:131], v[212:215]
    s_add_u32 m0, s56, 81920
    s_nop 0
    buffer_load_dwordx4 v8, s[20:23], s47 offen lds
    v_mfma_f32_16x16x32_bf16 v[236:239], v[140:143], v[132:135], v[236:239]
    s_add_u32 m0, s56, 82944
    s_nop 0
    buffer_load_dwordx4 v9, s[20:23], s47 offen lds
    v_mfma_f32_16x16x32_bf16 v[168:171], v[120:123], v[144:147], v[168:171]
    s_add_u32 m0, s56, 83968
    s_nop 0
    buffer_load_dwordx4 v10, s[20:23], s47 offen lds
    v_mfma_f32_16x16x32_bf16 v[192:195], v[124:127], v[144:147], v[192:195]
    s_add_u32 m0, s56, 84992
    s_nop 0
    buffer_load_dwordx4 v11, s[20:23], s47 offen lds
    v_mfma_f32_16x16x32_bf16 v[216:219], v[128:131], v[144:147], v[216:219]
    s_add_u32 m0, s56, 86016
    s_nop 0
    buffer_load_dwordx4 v12, s[20:23], s47 offen lds
    v_mfma_f32_16x16x32_bf16 v[240:243], v[132:135], v[144:147], v[240:243]
    s_add_u32 m0, s56, 87040
    s_nop 0
    buffer_load_dwordx4 v13, s[20:23], s47 offen lds
    v_mfma_f32_16x16x32_bf16 v[172:175], v[148:151], v[120:123], v[172:175]
    v_mfma_f32_16x16x32_bf16 v[196:199], v[148:151], v[124:127], v[196:199]
    v_mfma_f32_16x16x32_bf16 v[220:223], v[148:151], v[128:131], v[220:223]
    v_mfma_f32_16x16x32_bf16 v[244:247], v[148:151], v[132:135], v[244:247]
    v_mfma_f32_16x16x32_bf16 v[176:179], v[152:155], v[120:123], v[176:179]
    v_mfma_f32_16x16x32_bf16 v[200:203], v[152:155], v[124:127], v[200:203]
    v_mfma_f32_16x16x32_bf16 v[224:227], v[152:155], v[128:131], v[224:227]
    v_mfma_f32_16x16x32_bf16 v[248:251], v[152:155], v[132:135], v[248:251]
    v_mfma_f32_16x16x32_bf16 v[180:183], v[120:123], v[156:159], v[180:183]
    v_mfma_f32_16x16x32_bf16 v[204:207], v[124:127], v[156:159], v[204:207]
    v_mfma_f32_16x16x32_bf16 v[228:231], v[128:131], v[156:159], v[228:231]
    v_mfma_f32_16x16x32_bf16 v[252:255], v[132:135], v[156:159], v[252:255]
    s_waitcnt lgkmcnt(0)
    v_mfma_f32_16x16x32_bf16 v[160:163], v[96:99], v[80:83], v[160:163]
    ds_read_b128 v[120:123], v15 offset:32768
    v_mfma_f32_16x16x32_bf16 v[184:187], v[96:99], v[84:87], v[184:187]
    ds_read_b128 v[124:127], v15 offset:34816
    v_mfma_f32_16x16x32_bf16 v[208:211], v[96:99], v[88:91], v[208:211]
    ds_read_b128 v[128:131], v17 offset:32768
    v_mfma_f32_16x16x32_bf16 v[232:235], v[96:99], v[92:95], v[232:235]
    ds_read_b128 v[132:135], v17 offset:34816
    v_mfma_f32_16x16x32_bf16 v[164:167], v[100:103], v[80:83], v[164:167]
    ds_read_b64_tr_b16 v[136:137], v18 offset:61440
    v_mfma_f32_16x16x32_bf16 v[188:191], v[100:103], v[84:87], v[188:191]
    ds_read_b64_tr_b16 v[138:139], v18 offset:62976
    v_mfma_f32_16x16x32_bf16 v[212:215], v[100:103], v[88:91], v[212:215]
    ds_read_b64_tr_b16 v[140:141], v19 offset:61440
    v_mfma_f32_16x16x32_bf16 v[236:239], v[100:103], v[92:95], v[236:239]
    ds_read_b64_tr_b16 v[142:143], v19 offset:62976
    v_mfma_f32_16x16x32_bf16 v[168:171], v[80:83], v[104:107], v[168:171]
    ds_read_b64_tr_b16 v[144:145], v20 offset:61440
    v_mfma_f32_16x16x32_bf16 v[192:195], v[84:87], v[104:107], v[192:195]
    ds_read_b64_tr_b16 v[146:147], v20 offset:62976
    v_mfma_f32_16x16x32_bf16 v[216:219], v[88:91], v[104:107], v[216:219]
    ds_read_b64_tr_b16 v[148:149], v21 offset:61440
    v_mfma_f32_16x16x32_bf16 v[240:243], v[92:95], v[104:107], v[240:243]
    ds_read_b64_tr_b16 v[150:151], v21 offset:62976
    v_mfma_f32_16x16x32_bf16 v[172:175], v[108:111], v[80:83], v[172:175]
    ds_read_b64_tr_b16 v[152:153], v22 offset:61440
    v_mfma_f32_16x16x32_bf16 v[196:199], v[108:111], v[84:87], v[196:199]
    ds_read_b64_tr_b16 v[154:155], v22 offset:62976
    v_mfma_f32_16x16x32_bf16 v[220:223], v[108:111], v[88:91], v[220:223]
    ds_read_b64_tr_b16 v[156:157], v23 offset:61440
    v_mfma_f32_16x16x32_bf16 v[244:247], v[108:111], v[92:95], v[244:247]
    ds_read_b64_tr_b16 v[158:159], v23 offset:62976
    v_mfma_f32_16x16x32_bf16 v[176:179], v[112:115], v[80:83], v[176:179]
    v_mfma_f32_16x16x32_bf16 v[200:203], v[112:115], v[84:87], v[200:203]
    v_mfma_f32_16x16x32_bf16 v[224:227], v[112:115], v[88:91], v[224:227]
    v_mfma_f32_16x16x32_bf16 v[248:251], v[112:115], v[92:95], v[248:251]
    v_mfma_f32_16x16x32_bf16 v[180:183], v[80:83], v[116:119], v[180:183]
    v_mfma_f32_16x16x32_bf16 v[204:207], v[84:87], v[116:119], v[204:207]
    v_mfma_f32_16x16x32_bf16 v[228:231], v[88:91], v[116:119], v[228:231]
    v_mfma_f32_16x16x32_bf16 v[252:255], v[92:95], v[116:119], v[252:255]
    v_mfma_f32_16x16x32_bf16 a[0:3], v[24:27], v[80:83], a[0:3]
    v_mfma_f32_16x16x32_bf16 a[8:11], v[80:83], v[80:83], a[8:11]
    v_mfma_f32_16x16x32_bf16 a[4:7], v[24:27], v[84:87], a[4:7]
    v_mfma_f32_16x16x32_bf16 a[12:15], v[84:87], v[84:87], a[12:15]
    v_mfma_f32_16x16x32_bf16 a[16:19], v[24:27], v[96:99], a[16:19]
    v_mfma_f32_16x16x32_bf16 a[20:23], v[24:27], v[100:103], a[20:23]
    v_mfma_f32_16x16x32_bf16 a[24:27], v[24:27], v[104:107], a[24:27]
    s_waitcnt vmcnt(10) lgkmcnt(0)
    s_barrier
    v_mfma_f32_16x16x32_bf16 a[0:3], v[24:27], v[120:123], a[0:3]
    ds_read_b128 v[80:83], v14 offset:0
    ds_read_b128 v[84:87], v14 offset:2048
    v_mfma_f32_16x16x32_bf16 a[8:11], v[120:123], v[120:123], a[8:11]
    ds_read_b128 v[88:91], v16 offset:0
    ds_read_b128 v[92:95], v16 offset:2048
    v_mfma_f32_16x16x32_bf16 a[4:7], v[24:27], v[124:127], a[4:7]
    ds_read_b64_tr_b16 v[96:97], v18 offset:0
    ds_read_b64_tr_b16 v[98:99], v18 offset:1536
    v_mfma_f32_16x16x32_bf16 a[12:15], v[124:127], v[124:127], a[12:15]
    ds_read_b64_tr_b16 v[100:101], v19 offset:0
    ds_read_b64_tr_b16 v[102:103], v19 offset:1536
    v_mfma_f32_16x16x32_bf16 a[16:19], v[24:27], v[136:139], a[16:19]
    ds_read_b64_tr_b16 v[104:105], v20 offset:0
    ds_read_b64_tr_b16 v[106:107], v20 offset:1536
    v_mfma_f32_16x16x32_bf16 a[20:23], v[24:27], v[140:143], a[20:23]
    ds_read_b64_tr_b16 v[108:109], v21 offset:0
    ds_read_b64_tr_b16 v[110:111], v21 offset:1536
    v_mfma_f32_16x16x32_bf16 a[24:27], v[24:27], v[144:147], a[24:27]
    ds_read_b64_tr_b16 v[112:113], v22 offset:0
    ds_read_b64_tr_b16 v[114:115], v22 offset:1536
    v_mfma_f32_16x16x32_bf16 v[160:163], v[136:139], v[120:123], v[160:163]
    ds_read_b64_tr_b16 v[116:117], v23 offset:0
    ds_read_b64_tr_b16 v[118:119], v23 offset:1536
    v_mfma_f32_16x16x32_bf16 v[184:187], v[136:139], v[124:127], v[184:187]
    v_mfma_f32_16x16x32_bf16 v[208:211], v[136:139], v[128:131], v[208:211]
    v_mfma_f32_16x16x32_bf16 v[232:235], v[136:139], v[132:135], v[232:235]
    v_mfma_f32_16x16x32_bf16 v[164:167], v[140:143], v[120:123], v[164:167]
    v_mfma_f32_16x16x32_bf16 v[188:191], v[140:143], v[124:127], v[188:191]
    v_mfma_f32_16x16x32_bf16 v[212:215], v[140:143], v[128:131], v[212:215]
    v_mfma_f32_16x16x32_bf16 v[236:239], v[140:143], v[132:135], v[236:239]
    v_mfma_f32_16x16x32_bf16 v[168:171], v[120:123], v[144:147], v[168:171]
    v_mfma_f32_16x16x32_bf16 v[192:195], v[124:127], v[144:147], v[192:195]
    v_mfma_f32_16x16x32_bf16 v[216:219], v[128:131], v[144:147], v[216:219]
    v_mfma_f32_16x16x32_bf16 v[240:243], v[132:135], v[144:147], v[240:243]
    v_mfma_f32_16x16x32_bf16 v[172:175], v[148:151], v[120:123], v[172:175]
    v_mfma_f32_16x16x32_bf16 v[196:199], v[148:151], v[124:127], v[196:199]
    v_mfma_f32_16x16x32_bf16 v[220:223], v[148:151], v[128:131], v[220:223]
    v_mfma_f32_16x16x32_bf16 v[244:247], v[148:151], v[132:135], v[244:247]
    v_mfma_f32_16x16x32_bf16 v[176:179], v[152:155], v[120:123], v[176:179]
    v_mfma_f32_16x16x32_bf16 v[200:203], v[152:155], v[124:127], v[200:203]
    v_mfma_f32_16x16x32_bf16 v[224:227], v[152:155], v[128:131], v[224:227]
    v_mfma_f32_16x16x32_bf16 v[248:251], v[152:155], v[132:135], v[248:251]
    v_mfma_f32_16x16x32_bf16 v[180:183], v[120:123], v[156:159], v[180:183]
    v_mfma_f32_16x16x32_bf16 v[204:207], v[124:127], v[156:159], v[204:207]
    v_mfma_f32_16x16x32_bf16 v[228:231], v[128:131], v[156:159], v[228:231]
    v_mfma_f32_16x16x32_bf16 v[252:255], v[132:135], v[156:159], v[252:255]
    s_waitcnt lgkmcnt(0)
    v_mfma_f32_16x16x32_bf16 v[160:163], v[96:99], v[80:83], v[160:163]
    ds_read_b128 v[120:123], v15 offset:0
    v_mfma_f32_16x16x32_bf16 v[184:187], v[96:99], v[84:87], v[184:187]
    ds_read_b128 v[124:127], v15 offset:2048
    v_mfma_f32_16x16x32_bf16 v[208:211], v[96:99], v[88:91], v[208:211]
    ds_read_b128 v[128:131], v17 offset:0
    v_mfma_f32_16x16x32_bf16 v[232:235], v[96:99], v[92:95], v[232:235]
    ds_read_b128 v[132:135], v17 offset:2048
    v_mfma_f32_16x16x32_bf16 v[164:167], v[100:103], v[80:83], v[164:167]
    ds_read_b64_tr_b16 v[136:137], v18 offset:12288
    v_mfma_f32_16x16x32_bf16 v[188:191], v[100:103], v[84:87], v[188:191]
    ds_read_b64_tr_b16 v[138:139], v18 offset:13824
    v_mfma_f32_16x16x32_bf16 v[212:215], v[100:103], v[88:91], v[212:215]
    ds_read_b64_tr_b16 v[140:141], v19 offset:12288
    v_mfma_f32_16x16x32_bf16 v[236:239], v[100:103], v[92:95], v[236:239]
    ds_read_b64_tr_b16 v[142:143], v19 offset:13824
    v_mfma_f32_16x16x32_bf16 v[168:171], v[80:83], v[104:107], v[168:171]
    ds_read_b64_tr_b16 v[144:145], v20 offset:12288
    v_mfma_f32_16x16x32_bf16 v[192:195], v[84:87], v[104:107], v[192:195]
    ds_read_b64_tr_b16 v[146:147], v20 offset:13824
    v_mfma_f32_16x16x32_bf16 v[216:219], v[88:91], v[104:107], v[216:219]
    ds_read_b64_tr_b16 v[148:149], v21 offset:12288
    v_mfma_f32_16x16x32_bf16 v[240:243], v[92:95], v[104:107], v[240:243]
    ds_read_b64_tr_b16 v[150:151], v21 offset:13824
    v_mfma_f32_16x16x32_bf16 v[172:175], v[108:111], v[80:83], v[172:175]
    ds_read_b64_tr_b16 v[152:153], v22 offset:12288
    v_mfma_f32_16x16x32_bf16 v[196:199], v[108:111], v[84:87], v[196:199]
    ds_read_b64_tr_b16 v[154:155], v22 offset:13824
    v_mfma_f32_16x16x32_bf16 v[220:223], v[108:111], v[88:91], v[220:223]
    ds_read_b64_tr_b16 v[156:157], v23 offset:12288
    v_mfma_f32_16x16x32_bf16 v[244:247], v[108:111], v[92:95], v[244:247]
    ds_read_b64_tr_b16 v[158:159], v23 offset:13824
    v_mfma_f32_16x16x32_bf16 v[176:179], v[112:115], v[80:83], v[176:179]
    v_mfma_f32_16x16x32_bf16 v[200:203], v[112:115], v[84:87], v[200:203]
    v_mfma_f32_16x16x32_bf16 v[224:227], v[112:115], v[88:91], v[224:227]
    v_mfma_f32_16x16x32_bf16 v[248:251], v[112:115], v[92:95], v[248:251]
    v_mfma_f32_16x16x32_bf16 v[180:183], v[80:83], v[116:119], v[180:183]
    v_mfma_f32_16x16x32_bf16 v[204:207], v[84:87], v[116:119], v[204:207]
    v_mfma_f32_16x16x32_bf16 v[228:231], v[88:91], v[116:119], v[228:231]
    v_mfma_f32_16x16x32_bf16 v[252:255], v[92:95], v[116:119], v[252:255]
    v_mfma_f32_16x16x32_bf16 a[0:3], v[24:27], v[80:83], a[0:3]
    v_mfma_f32_16x16x32_bf16 a[8:11], v[80:83], v[80:83], a[8:11]
    v_mfma_f32_16x16x32_bf16 a[4:7], v[24:27], v[84:87], a[4:7]
    v_mfma_f32_16x16x32_bf16 a[12:15], v[84:87], v[84:87], a[12:15]
    v_mfma_f32_16x16x32_bf16 a[16:19], v[24:27], v[96:99], a[16:19]
    v_mfma_f32_16x16x32_bf16 a[20:23], v[24:27], v[100:103], a[20:23]
    v_mfma_f32_16x16x32_bf16 a[24:27], v[24:27], v[104:107], a[24:27]
    s_waitcnt vmcnt(0) lgkmcnt(0)
    s_barrier
    v_mfma_f32_16x16x32_bf16 a[0:3], v[24:27], v[120:123], a[0:3]
    ds_read_b128 v[80:83], v14 offset:16384
    ds_read_b128 v[84:87], v14 offset:18432
    v_mfma_f32_16x16x32_bf16 a[8:11], v[120:123], v[120:123], a[8:11]
    ds_read_b128 v[88:91], v16 offset:16384
    ds_read_b128 v[92:95], v16 offset:18432
    v_mfma_f32_16x16x32_bf16 a[4:7], v[24:27], v[124:127], a[4:7]
    ds_read_b64_tr_b16 v[96:97], v18 offset:24576
    ds_read_b64_tr_b16 v[98:99], v18 offset:26112
    v_mfma_f32_16x16x32_bf16 a[12:15], v[124:127], v[124:127], a[12:15]
    ds_read_b64_tr_b16 v[100:101], v19 offset:24576
    ds_read_b64_tr_b16 v[102:103], v19 offset:26112
    v_mfma_f32_16x16x32_bf16 a[16:19], v[24:27], v[136:139], a[16:19]
    ds_read_b64_tr_b16 v[104:105], v20 offset:24576
    ds_read_b64_tr_b16 v[106:107], v20 offset:26112
    v_mfma_f32_16x16x32_bf16 a[20:23], v[24:27], v[140:143], a[20:23]
    ds_read_b64_tr_b16 v[108:109], v21 offset:24576
    ds_read_b64_tr_b16 v[110:111], v21 offset:26112
    v_mfma_f32_16x16x32_bf16 a[24:27], v[24:27], v[144:147], a[24:27]
    ds_read_b64_tr_b16 v[112:113], v22 offset:24576
    ds_read_b64_tr_b16 v[114:115], v22 offset:26112
    v_mfma_f32_16x16x32_bf16 v[160:163], v[136:139], v[120:123], v[160:163]
    ds_read_b64_tr_b16 v[116:117], v23 offset:24576
    ds_read_b64_tr_b16 v[118:119], v23 offset:26112
    v_mfma_f32_16x16x32_bf16 v[184:187], v[136:139], v[124:127], v[184:187]
    v_mfma_f32_16x16x32_bf16 v[208:211], v[136:139], v[128:131], v[208:211]
    v_mfma_f32_16x16x32_bf16 v[232:235], v[136:139], v[132:135], v[232:235]
    v_mfma_f32_16x16x32_bf16 v[164:167], v[140:143], v[120:123], v[164:167]
    v_mfma_f32_16x16x32_bf16 v[188:191], v[140:143], v[124:127], v[188:191]
    v_mfma_f32_16x16x32_bf16 v[212:215], v[140:143], v[128:131], v[212:215]
    v_mfma_f32_16x16x32_bf16 v[236:239], v[140:143], v[132:135], v[236:239]
    v_mfma_f32_16x16x32_bf16 v[168:171], v[120:123], v[144:147], v[168:171]
    v_mfma_f32_16x16x32_bf16 v[192:195], v[124:127], v[144:147], v[192:195]
    v_mfma_f32_16x16x32_bf16 v[216:219], v[128:131], v[144:147], v[216:219]
    v_mfma_f32_16x16x32_bf16 v[240:243], v[132:135], v[144:147], v[240:243]
    v_mfma_f32_16x16x32_bf16 v[172:175], v[148:151], v[120:123], v[172:175]
    v_mfma_f32_16x16x32_bf16 v[196:199], v[148:151], v[124:127], v[196:199]
    v_mfma_f32_16x16x32_bf16 v[220:223], v[148:151], v[128:131], v[220:223]
    v_mfma_f32_16x16x32_bf16 v[244:247], v[148:151], v[132:135], v[244:247]
    v_mfma_f32_16x16x32_bf16 v[176:179], v[152:155], v[120:123], v[176:179]
    v_mfma_f32_16x16x32_bf16 v[200:203], v[152:155], v[124:127], v[200:203]
    v_mfma_f32_16x16x32_bf16 v[224:227], v[152:155], v[128:131], v[224:227]
    v_mfma_f32_16x16x32_bf16 v[248:251], v[152:155], v[132:135], v[248:251]
    v_mfma_f32_16x16x32_bf16 v[180:183], v[120:123], v[156:159], v[180:183]
    v_mfma_f32_16x16x32_bf16 v[204:207], v[124:127], v[156:159], v[204:207]
    v_mfma_f32_16x16x32_bf16 v[228:231], v[128:131], v[156:159], v[228:231]
    v_mfma_f32_16x16x32_bf16 v[252:255], v[132:135], v[156:159], v[252:255]
    s_waitcnt lgkmcnt(0)
    v_mfma_f32_16x16x32_bf16 v[160:163], v[96:99], v[80:83], v[160:163]
    ds_read_b128 v[120:123], v15 offset:16384
    v_mfma_f32_16x16x32_bf16 v[184:187], v[96:99], v[84:87], v[184:187]
    ds_read_b128 v[124:127], v15 offset:18432
    v_mfma_f32_16x16x32_bf16 v[208:211], v[96:99], v[88:91], v[208:211]
    ds_read_b128 v[128:131], v17 offset:16384
    v_mfma_f32_16x16x32_bf16 v[232:235], v[96:99], v[92:95], v[232:235]
    ds_read_b128 v[132:135], v17 offset:18432
    v_mfma_f32_16x16x32_bf16 v[164:167], v[100:103], v[80:83], v[164:167]
    ds_read_b64_tr_b16 v[136:137], v18 offset:36864
    v_mfma_f32_16x16x32_bf16 v[188:191], v[100:103], v[84:87], v[188:191]
    ds_read_b64_tr_b16 v[138:139], v18 offset:38400
    v_mfma_f32_16x16x32_bf16 v[212:215], v[100:103], v[88:91], v[212:215]
    ds_read_b64_tr_b16 v[140:141], v19 offset:36864
    v_mfma_f32_16x16x32_bf16 v[236:239], v[100:103], v[92:95], v[236:239]
    ds_read_b64_tr_b16 v[142:143], v19 offset:38400
    v_mfma_f32_16x16x32_bf16 v[168:171], v[80:83], v[104:107], v[168:171]
    ds_read_b64_tr_b16 v[144:145], v20 offset:36864
    v_mfma_f32_16x16x32_bf16 v[192:195], v[84:87], v[104:107], v[192:195]
    ds_read_b64_tr_b16 v[146:147], v20 offset:38400
    v_mfma_f32_16x16x32_bf16 v[216:219], v[88:91], v[104:107], v[216:219]
    ds_read_b64_tr_b16 v[148:149], v21 offset:36864
    v_mfma_f32_16x16x32_bf16 v[240:243], v[92:95], v[104:107], v[240:243]
    ds_read_b64_tr_b16 v[150:151], v21 offset:38400
    v_mfma_f32_16x16x32_bf16 v[172:175], v[108:111], v[80:83], v[172:175]
    ds_read_b64_tr_b16 v[152:153], v22 offset:36864
    v_mfma_f32_16x16x32_bf16 v[196:199], v[108:111], v[84:87], v[196:199]
    ds_read_b64_tr_b16 v[154:155], v22 offset:38400
    v_mfma_f32_16x16x32_bf16 v[220:223], v[108:111], v[88:91], v[220:223]
    ds_read_b64_tr_b16 v[156:157], v23 offset:36864
    v_mfma_f32_16x16x32_bf16 v[244:247], v[108:111], v[92:95], v[244:247]
    ds_read_b64_tr_b16 v[158:159], v23 offset:38400
    v_mfma_f32_16x16x32_bf16 v[176:179], v[112:115], v[80:83], v[176:179]
    v_mfma_f32_16x16x32_bf16 v[200:203], v[112:115], v[84:87], v[200:203]
    v_mfma_f32_16x16x32_bf16 v[224:227], v[112:115], v[88:91], v[224:227]
    v_mfma_f32_16x16x32_bf16 v[248:251], v[112:115], v[92:95], v[248:251]
    v_mfma_f32_16x16x32_bf16 v[180:183], v[80:83], v[116:119], v[180:183]
    v_mfma_f32_16x16x32_bf16 v[204:207], v[84:87], v[116:119], v[204:207]
    v_mfma_f32_16x16x32_bf16 v[228:231], v[88:91], v[116:119], v[228:231]
    v_mfma_f32_16x16x32_bf16 v[252:255], v[92:95], v[116:119], v[252:255]
    v_mfma_f32_16x16x32_bf16 a[0:3], v[24:27], v[80:83], a[0:3]
    v_mfma_f32_16x16x32_bf16 a[8:11], v[80:83], v[80:83], a[8:11]
    v_mfma_f32_16x16x32_bf16 a[4:7], v[24:27], v[84:87], a[4:7]
    v_mfma_f32_16x16x32_bf16 a[12:15], v[84:87], v[84:87], a[12:15]
    v_mfma_f32_16x16x32_bf16 a[16:19], v[24:27], v[96:99], a[16:19]
    v_mfma_f32_16x16x32_bf16 a[20:23], v[24:27], v[100:103], a[20:23]
    v_mfma_f32_16x16x32_bf16 a[24:27], v[24:27], v[104:107], a[24:27]
    s_waitcnt lgkmcnt(0)
    v_mfma_f32_16x16x32_bf16 a[0:3], v[24:27], v[120:123], a[0:3]
    v_mfma_f32_16x16x32_bf16 a[8:11], v[120:123], v[120:123], a[8:11]
    v_mfma_f32_16x16x32_bf16 a[4:7], v[24:27], v[124:127], a[4:7]
    v_mfma_f32_16x16x32_bf16 a[12:15], v[124:127], v[124:127], a[12:15]
    v_mfma_f32_16x16x32_bf16 a[16:19], v[24:27], v[136:139], a[16:19]
    v_mfma_f32_16x16x32_bf16 a[20:23], v[24:27], v[140:143], a[20:23]
    v_mfma_f32_16x16x32_bf16 a[24:27], v[24:27], v[144:147], a[24:27]
    v_mfma_f32_16x16x32_bf16 v[160:163], v[136:139], v[120:123], v[160:163]
    v_mfma_f32_16x16x32_bf16 v[184:187], v[136:139], v[124:127], v[184:187]
    v_mfma_f32_16x16x32_bf16 v[208:211], v[136:139], v[128:131], v[208:211]
    v_mfma_f32_16x16x32_bf16 v[232:235], v[136:139], v[132:135], v[232:235]
    v_mfma_f32_16x16x32_bf16 v[164:167], v[140:143], v[120:123], v[164:167]
    v_mfma_f32_16x16x32_bf16 v[188:191], v[140:143], v[124:127], v[188:191]
    v_mfma_f32_16x16x32_bf16 v[212:215], v[140:143], v[128:131], v[212:215]
    v_mfma_f32_16x16x32_bf16 v[236:239], v[140:143], v[132:135], v[236:239]
    v_mfma_f32_16x16x32_bf16 v[168:171], v[120:123], v[144:147], v[168:171]
    v_mfma_f32_16x16x32_bf16 v[192:195], v[124:127], v[144:147], v[192:195]
    v_mfma_f32_16x16x32_bf16 v[216:219], v[128:131], v[144:147], v[216:219]
    v_mfma_f32_16x16x32_bf16 v[240:243], v[132:135], v[144:147], v[240:243]
    v_mfma_f32_16x16x32_bf16 v[172:175], v[148:151], v[120:123], v[172:175]
    v_mfma_f32_16x16x32_bf16 v[196:199], v[148:151], v[124:127], v[196:199]
    v_mfma_f32_16x16x32_bf16 v[220:223], v[148:151], v[128:131], v[220:223]
    v_mfma_f32_16x16x32_bf16 v[244:247], v[148:151], v[132:135], v[244:247]
    v_mfma_f32_16x16x32_bf16 v[176:179], v[152:155], v[120:123], v[176:179]
    v_mfma_f32_16x16x32_bf16 v[200:203], v[152:155], v[124:127], v[200:203]
    v_mfma_f32_16x16x32_bf16 v[224:227], v[152:155], v[128:131], v[224:227]
    v_mfma_f32_16x16x32_bf16 v[248:251], v[152:155], v[132:135], v[248:251]
    v_mfma_f32_16x16x32_bf16 v[180:183], v[120:123], v[156:159], v[180:183]
    v_mfma_f32_16x16x32_bf16 v[204:207], v[124:127], v[156:159], v[204:207]
    v_mfma_f32_16x16x32_bf16 v[228:231], v[128:131], v[156:159], v[228:231]
    v_mfma_f32_16x16x32_bf16 v[252:255], v[132:135], v[156:159], v[252:255]
    s_lshl_b32 s48, s39, 8
    s_lshl_b32 s49, s40, 7
    s_add_u32 s48, s48, s49
    v_lshl_add_u32 v40, v2, 2, s48
    s_lshl_b32 s48, s40, 7
    s_lshl_b32 s49, s39, 6
    s_add_u32 s59, s48, s49
    s_xor_b32 s60, s59, 64
    v_lshl_add_u32 v41, v2, 2, s59
    s_mov_b64 exec, 0xffff
    ds_write_b32 v40, a0 offset:0
    ds_write_b32 v40, a4 offset:64
    ds_write_b32 v41, a16 offset:1024
    ds_write_b32 v41, a20 offset:1280
    ds_write_b32 v41, a24 offset:1536
    s_mov_b32 exec_lo, 1048577
    s_mov_b32 exec_hi, 268435712
    ds_write_b32 v40, a8 offset:512
    ds_write_b32 v40, a12 offset:576
    s_mov_b32 exec_lo, 2097154
    s_mov_b32 exec_hi, 536871424
    ds_write_b32 v40, a9 offset:512
    ds_write_b32 v40, a13 offset:576
    s_mov_b32 exec_lo, 4194308
    s_mov_b32 exec_hi, 1073742848
    ds_write_b32 v40, a10 offset:512
    ds_write_b32 v40, a14 offset:576
    s_mov_b32 exec_lo, 8388616
    s_mov_b32 exec_hi, 2147485696
    ds_write_b32 v40, a11 offset:512
    ds_write_b32 v40, a15 offset:576
    s_mov_b64 exec, -1
    s_waitcnt lgkmcnt(0)
    s_barrier
    v_and_b32 v40, 127, v0
    v_lshlrev_b32 v40, 2, v40
    ds_read_b32 v41, v40 offset:0
    ds_read_b32 v42, v40 offset:512
    s_waitcnt lgkmcnt(0)
    v_mul_f32 v41, 0x3b000000, v41
    v_mul_f32 v42, 0x3b000000, v42
    v_fma_f32 v42, -v41, v41, v42
    v_max_f32 v42, 0, v42
    v_add_f32 v42, 0x3727c5ac, v42
    v_rsq_f32 v42, v42
    s_nop 0
    v_mul_f32 v41, v41, v42
    ds_write_b32 v40, v42 offset:2048
    ds_write_b32 v40, v41 offset:2560
    s_waitcnt lgkmcnt(0)
    s_barrier
    s_lshl_b32 s48, s39, 8
    s_lshl_b32 s49, s40, 7
    s_add_u32 s57, s48, s49
    s_xor_b32 s58, s57, 128
    v_lshl_add_u32 v40, v2, 2, s57
    v_lshl_add_u32 v41, v2, 2, s58
    v_lshl_add_u32 v42, v3, 4, s57
    v_lshl_add_u32 v43, v3, 4, s58
    v_lshl_add_u32 v44, v3, 4, s59
    v_lshl_add_u32 v45, v3, 4, s60
    v_lshl_add_u32 v46, v2, 2, s59
    v_lshl_add_u32 v47, v2, 2, s60
    ds_read_b32 v80, v40 offset:2048
    ds_read_b32 v81, v40 offset:2560
    ds_read_b128 v[88:91], v42 offset:2048
    ds_read_b128 v[104:107], v42 offset:2560
    ds_read_b32 v82, v40 offset:2112
    ds_read_b32 v83, v40 offset:2624
    ds_read_b128 v[92:95], v42 offset:2112
    ds_read_b128 v[108:111], v42 offset:2624
    ds_read_b32 v84, v41 offset:2048
    ds_read_b32 v85, v41 offset:2560
    ds_read_b128 v[96:99], v43 offset:2048
    ds_read_b128 v[112:115], v43 offset:2560
    ds_read_b32 v86, v41 offset:2112
    ds_read_b32 v87, v41 offset:2624
    ds_read_b128 v[100:103], v43 offset:2112
    ds_read_b128 v[116:119], v43 offset:2624
    ds_read_b128 v[120:123], v44 offset:1024
    ds_read_b128 v[124:127], v44 offset:1280
    ds_read_b32 v128, v46 offset:1536
    ds_read_b128 v[132:135], v45 offset:1024
    ds_read_b128 v[136:139], v45 offset:1280
    ds_read_b32 v140, v47 offset:1536
    s_waitcnt lgkmcnt(0)
    v_pk_mul_f32 v[144:145], v[120:121], v[80:81] op_sel:[0,1] op_sel_hi:[1,1]
    v_pk_mul_f32 v[148:149], v[120:121], v[82:83] op_sel:[0,1] op_sel_hi:[1,1]
    v_pk_mul_f32 v[152:153], v[120:121], v[84:85] op_sel:[0,1] op_sel_hi:[1,1]
    v_pk_mul_f32 v[156:157], v[120:121], v[86:87] op_sel:[0,1] op_sel_hi:[1,1]
    v_pk_fma_f32 v[160:161], v[160:161], v[80:81], v[144:145] op_sel_hi:[1,0,1] neg_lo:[0,0,1] neg_hi:[0,0,1]
    v_pk_fma_f32 v[184:185], v[184:185], v[82:83], v[148:149] op_sel_hi:[1,0,1] neg_lo:[0,0,1] neg_hi:[0,0,1]
    v_pk_fma_f32 v[208:209], v[208:209], v[84:85], v[152:153] op_sel_hi:[1,0,1] neg_lo:[0,0,1] neg_hi:[0,0,1]
    v_pk_fma_f32 v[232:233], v[232:233], v[86:87], v[156:157] op_sel_hi:[1,0,1] neg_lo:[0,0,1] neg_hi:[0,0,1]
    v_pk_mul_f32 v[146:147], v[122:123], v[80:81] op_sel:[0,1] op_sel_hi:[1,1]
    v_pk_mul_f32 v[150:151], v[122:123], v[82:83] op_sel:[0,1] op_sel_hi:[1,1]
    v_pk_mul_f32 v[154:155], v[122:123], v[84:85] op_sel:[0,1] op_sel_hi:[1,1]
    v_pk_mul_f32 v[158:159], v[122:123], v[86:87] op_sel:[0,1] op_sel_hi:[1,1]
    v_pk_fma_f32 v[162:163], v[162:163], v[80:81], v[146:147] op_sel_hi:[1,0,1] neg_lo:[0,0,1] neg_hi:[0,0,1]
    v_pk_fma_f32 v[186:187], v[186:187], v[82:83], v[150:151] op_sel_hi:[1,0,1] neg_lo:[0,0,1] neg_hi:[0,0,1]
    v_pk_fma_f32 v[210:211], v[210:211], v[84:85], v[154:155] op_sel_hi:[1,0,1] neg_lo:[0,0,1] neg_hi:[0,0,1]
    v_pk_fma_f32 v[234:235], v[234:235], v[86:87], v[158:159] op_sel_hi:[1,0,1] neg_lo:[0,0,1] neg_hi:[0,0,1]
    v_pk_mul_f32 v[144:145], v[124:125], v[80:81] op_sel:[0,1] op_sel_hi:[1,1]
    v_pk_mul_f32 v[148:149], v[124:125], v[82:83] op_sel:[0,1] op_sel_hi:[1,1]
    v_pk_mul_f32 v[152:153], v[124:125], v[84:85] op_sel:[0,1] op_sel_hi:[1,1]
    v_pk_mul_f32 v[156:157], v[124:125], v[86:87] op_sel:[0,1] op_sel_hi:[1,1]
    v_pk_fma_f32 v[164:165], v[164:165], v[80:81], v[144:145] op_sel_hi:[1,0,1] neg_lo:[0,0,1] neg_hi:[0,0,1]
    v_pk_fma_f32 v[188:189], v[188:189], v[82:83], v[148:149] op_sel_hi:[1,0,1] neg_lo:[0,0,1] neg_hi:[0,0,1]
    v_pk_fma_f32 v[212:213], v[212:213], v[84:85], v[152:153] op_sel_hi:[1,0,1] neg_lo:[0,0,1] neg_hi:[0,0,1]
    v_pk_fma_f32 v[236:237], v[236:237], v[86:87], v[156:157] op_sel_hi:[1,0,1] neg_lo:[0,0,1] neg_hi:[0,0,1]
    v_pk_mul_f32 v[146:147], v[126:127], v[80:81] op_sel:[0,1] op_sel_hi:[1,1]
    v_pk_mul_f32 v[150:151], v[126:127], v[82:83] op_sel:[0,1] op_sel_hi:[1,1]
    v_pk_mul_f32 v[154:155], v[126:127], v[84:85] op_sel:[0,1] op_sel_hi:[1,1]
    v_pk_mul_f32 v[158:159], v[126:127], v[86:87] op_sel:[0,1] op_sel_hi:[1,1]
    v_pk_fma_f32 v[166:167], v[166:167], v[80:81], v[146:147] op_sel_hi:[1,0,1] neg_lo:[0,0,1] neg_hi:[0,0,1]
    v_pk_fma_f32 v[190:191], v[190:191], v[82:83], v[150:151] op_sel_hi:[1,0,1] neg_lo:[0,0,1] neg_hi:[0,0,1]
    v_pk_fma_f32 v[214:215], v[214:215], v[84:85], v[154:155] op_sel_hi:[1,0,1] neg_lo:[0,0,1] neg_hi:[0,0,1]
    v_pk_fma_f32 v[238:239], v[238:239], v[86:87], v[158:159] op_sel_hi:[1,0,1] neg_lo:[0,0,1] neg_hi:[0,0,1]
    v_pk_mul_f32 v[144:145], v[104:105], v[128:129] op_sel_hi:[1,0]
    v_pk_mul_f32 v[148:149], v[108:109], v[128:129] op_sel_hi:[1,0]
    v_pk_mul_f32 v[152:153], v[112:113], v[128:129] op_sel_hi:[1,0]
    v_pk_mul_f32 v[156:157], v[116:117], v[128:129] op_sel_hi:[1,0]
    v_pk_fma_f32 v[168:169], v[168:169], v[88:89], v[144:145] neg_lo:[0,0,1] neg_hi:[0,0,1]
    v_pk_fma_f32 v[192:193], v[192:193], v[92:93], v[148:149] neg_lo:[0,0,1] neg_hi:[0,0,1]
    v_pk_fma_f32 v[216:217], v[216:217], v[96:97], v[152:153] neg_lo:[0,0,1] neg_hi:[0,0,1]
    v_pk_fma_f32 v[240:241], v[240:241], v[100:101], v[156:157] neg_lo:[0,0,1] neg_hi:[0,0,1]
    v_pk_mul_f32 v[146:147], v[106:107], v[128:129] op_sel_hi:[1,0]
    v_pk_mul_f32 v[150:151], v[110:111], v[128:129] op_sel_hi:[1,0]
    v_pk_mul_f32 v[154:155], v[114:115], v[128:129] op_sel_hi:[1,0]
    v_pk_mul_f32 v[158:159], v[118:119], v[128:129] op_sel_hi:[1,0]
    v_pk_fma_f32 v[170:171], v[170:171], v[90:91], v[146:147] neg_lo:[0,0,1] neg_hi:[0,0,1]
    v_pk_fma_f32 v[194:195], v[194:195], v[94:95], v[150:151] neg_lo:[0,0,1] neg_hi:[0,0,1]
    v_pk_fma_f32 v[218:219], v[218:219], v[98:99], v[154:155] neg_lo:[0,0,1] neg_hi:[0,0,1]
    v_pk_fma_f32 v[242:243], v[242:243], v[102:103], v[158:159] neg_lo:[0,0,1] neg_hi:[0,0,1]
    v_pk_mul_f32 v[144:145], v[132:133], v[80:81] op_sel:[0,1] op_sel_hi:[1,1]
    v_pk_mul_f32 v[148:149], v[132:133], v[82:83] op_sel:[0,1] op_sel_hi:[1,1]
    v_pk_mul_f32 v[152:153], v[132:133], v[84:85] op_sel:[0,1] op_sel_hi:[1,1]
    v_pk_mul_f32 v[156:157], v[132:133], v[86:87] op_sel:[0,1] op_sel_hi:[1,1]
    v_pk_fma_f32 v[172:173], v[172:173], v[80:81], v[144:145] op_sel_hi:[1,0,1] neg_lo:[0,0,1] neg_hi:[0,0,1]
    v_pk_fma_f32 v[196:197], v[196:197], v[82:83], v[148:149] op_sel_hi:[1,0,1] neg_lo:[0,0,1] neg_hi:[0,0,1]
    v_pk_fma_f32 v[220:221], v[220:221], v[84:85], v[152:153] op_sel_hi:[1,0,1] neg_lo:[0,0,1] neg_hi:[0,0,1]
    v_pk_fma_f32 v[244:245], v[244:245], v[86:87], v[156:157] op_sel_hi:[1,0,1] neg_lo:[0,0,1] neg_hi:[0,0,1]
    v_pk_mul_f32 v[146:147], v[134:135], v[80:81] op_sel:[0,1] op_sel_hi:[1,1]
    v_pk_mul_f32 v[150:151], v[134:135], v[82:83] op_sel:[0,1] op_sel_hi:[1,1]
    v_pk_mul_f32 v[154:155], v[134:135], v[84:85] op_sel:[0,1] op_sel_hi:[1,1]
    v_pk_mul_f32 v[158:159], v[134:135], v[86:87] op_sel:[0,1] op_sel_hi:[1,1]
    v_pk_fma_f32 v[174:175], v[174:175], v[80:81], v[146:147] op_sel_hi:[1,0,1] neg_lo:[0,0,1] neg_hi:[0,0,1]
    v_pk_fma_f32 v[198:199], v[198:199], v[82:83], v[150:151] op_sel_hi:[1,0,1] neg_lo:[0,0,1] neg_hi:[0,0,1]
    v_pk_fma_f32 v[222:223], v[222:223], v[84:85], v[154:155] op_sel_hi:[1,0,1] neg_lo:[0,0,1] neg_hi:[0,0,1]
    v_pk_fma_f32 v[246:247], v[246:247], v[86:87], v[158:159] op_sel_hi:[1,0,1] neg_lo:[0,0,1] neg_hi:[0,0,1]
    v_pk_mul_f32 v[144:145], v[136:137], v[80:81] op_sel:[0,1] op_sel_hi:[1,1]
    v_pk_mul_f32 v[148:149], v[136:137], v[82:83] op_sel:[0,1] op_sel_hi:[1,1]
    v_pk_mul_f32 v[152:153], v[136:137], v[84:85] op_sel:[0,1] op_sel_hi:[1,1]
    v_pk_mul_f32 v[156:157], v[136:137], v[86:87] op_sel:[0,1] op_sel_hi:[1,1]
    v_pk_fma_f32 v[176:177], v[176:177], v[80:81], v[144:145] op_sel_hi:[1,0,1] neg_lo:[0,0,1] neg_hi:[0,0,1]
    v_pk_fma_f32 v[200:201], v[200:201], v[82:83], v[148:149] op_sel_hi:[1,0,1] neg_lo:[0,0,1] neg_hi:[0,0,1]
    v_pk_fma_f32 v[224:225], v[224:225], v[84:85], v[152:153] op_sel_hi:[1,0,1] neg_lo:[0,0,1] neg_hi:[0,0,1]
    v_pk_fma_f32 v[248:249], v[248:249], v[86:87], v[156:157] op_sel_hi:[1,0,1] neg_lo:[0,0,1] neg_hi:[0,0,1]
    v_pk_mul_f32 v[146:147], v[138:139], v[80:81] op_sel:[0,1] op_sel_hi:[1,1]
    v_pk_mul_f32 v[150:151], v[138:139], v[82:83] op_sel:[0,1] op_sel_hi:[1,1]
    v_pk_mul_f32 v[154:155], v[138:139], v[84:85] op_sel:[0,1] op_sel_hi:[1,1]
    v_pk_mul_f32 v[158:159], v[138:139], v[86:87] op_sel:[0,1] op_sel_hi:[1,1]
    v_pk_fma_f32 v[178:179], v[178:179], v[80:81], v[146:147] op_sel_hi:[1,0,1] neg_lo:[0,0,1] neg_hi:[0,0,1]
    v_pk_fma_f32 v[202:203], v[202:203], v[82:83], v[150:151] op_sel_hi:[1,0,1] neg_lo:[0,0,1] neg_hi:[0,0,1]
    v_pk_fma_f32 v[226:227], v[226:227], v[84:85], v[154:155] op_sel_hi:[1,0,1] neg_lo:[0,0,1] neg_hi:[0,0,1]
    v_pk_fma_f32 v[250:251], v[250:251], v[86:87], v[158:159] op_sel_hi:[1,0,1] neg_lo:[0,0,1] neg_hi:[0,0,1]
    v_pk_mul_f32 v[144:145], v[104:105], v[140:141] op_sel_hi:[1,0]
    v_pk_mul_f32 v[148:149], v[108:109], v[140:141] op_sel_hi:[1,0]
    v_pk_mul_f32 v[152:153], v[112:113], v[140:141] op_sel_hi:[1,0]
    v_pk_mul_f32 v[156:157], v[116:117], v[140:141] op_sel_hi:[1,0]
    v_pk_fma_f32 v[180:181], v[180:181], v[88:89], v[144:145] neg_lo:[0,0,1] neg_hi:[0,0,1]
    v_pk_fma_f32 v[204:205], v[204:205], v[92:93], v[148:149] neg_lo:[0,0,1] neg_hi:[0,0,1]
    v_pk_fma_f32 v[228:229], v[228:229], v[96:97], v[152:153] neg_lo:[0,0,1] neg_hi:[0,0,1]
    v_pk_fma_f32 v[252:253], v[252:253], v[100:101], v[156:157] neg_lo:[0,0,1] neg_hi:[0,0,1]
    v_pk_mul_f32 v[146:147], v[106:107], v[140:141] op_sel_hi:[1,0]
    v_pk_mul_f32 v[150:151], v[110:111], v[140:141] op_sel_hi:[1,0]
    v_pk_mul_f32 v[154:155], v[114:115], v[140:141] op_sel_hi:[1,0]
    v_pk_mul_f32 v[158:159], v[118:119], v[140:141] op_sel_hi:[1,0]
    v_pk_fma_f32 v[182:183], v[182:183], v[90:91], v[146:147] neg_lo:[0,0,1] neg_hi:[0,0,1]
    v_pk_fma_f32 v[206:207], v[206:207], v[94:95], v[150:151] neg_lo:[0,0,1] neg_hi:[0,0,1]
    v_pk_fma_f32 v[230:231], v[230:231], v[98:99], v[154:155] neg_lo:[0,0,1] neg_hi:[0,0,1]
    v_pk_fma_f32 v[254:255], v[254:255], v[102:103], v[158:159] neg_lo:[0,0,1] neg_hi:[0,0,1]
    s_lshl_b32 s48, s36, 7
    s_lshr_b32 s61, s57, 2
    s_lshr_b32 s62, s58, 2
    s_add_u32 s61, s61, s48
    s_add_u32 s62, s62, s48
    s_lshl_b32 s48, s61, 11
    v_lshl_add_u32 v48, v1, 4, s48
    s_lshl_b32 s48, s62, 11
    v_lshl_add_u32 v49, v1, 4, s48
    s_waitcnt vmcnt(0)
    v_lshl_or_b32 v32, v68, 16, v32
    v_lshl_or_b32 v33, v69, 16, v33
    v_lshl_or_b32 v34, v70, 16, v34
    v_lshl_or_b32 v35, v71, 16, v35
    s_xor_b32 s48, s39, 0
    s_lshl_b32 s49, s40, 1
    s_add_u32 s48, s48, s49
    s_lshl_b32 s49, s37, 2
    s_add_u32 s63, s48, s49
    s_lshl_b32 s64, s63, 10
    s_add_u32 s65, s64, 32768
    v_cvt_pk_bf16_f32 v80, v160, v161
    v_cvt_pk_bf16_f32 v81, v162, v163
    v_cvt_pk_bf16_f32 v82, v184, v185
    v_cvt_pk_bf16_f32 v83, v186, v187
    v_cvt_pk_bf16_f32 v84, v208, v209
    v_cvt_pk_bf16_f32 v85, v210, v211
    v_cvt_pk_bf16_f32 v86, v232, v233
    v_cvt_pk_bf16_f32 v87, v234, v235
    s_nop 1
    v_mfma_f32_16x16x16_bf16 v[88:91], v[32:33], v[80:81], 0
    v_mfma_f32_16x16x16_bf16 v[92:95], v[32:33], v[82:83], 0
    v_mfma_f32_16x16x16_bf16 v[96:99], v[32:33], v[84:85], 0
    v_mfma_f32_16x16x16_bf16 v[100:103], v[32:33], v[86:87], 0
    s_nop 7
    v_max3_f32 v104, v88, v89, v90
    v_max3_f32 v105, v92, v93, v94
    v_max3_f32 v106, v96, v97, v98
    v_max3_f32 v107, v100, v101, v102
    v_max3_f32 v108, -v88, -v89, -v90
    v_max3_f32 v109, -v92, -v93, -v94
    v_max3_f32 v110, -v96, -v97, -v98
    v_max3_f32 v111, -v100, -v101, -v102
    v_max_f32 v104, v104, v91
    v_max_f32 v105, v105, v95
    v_max_f32 v106, v106, v99
    v_max_f32 v107, v107, v103
    v_max_f32_e64 v108, v108, -v91
    v_max_f32_e64 v109, v109, -v95
    v_max_f32_e64 v110, v110, -v99
    v_max_f32_e64 v111, v111, -v103
    v_permlane32_swap_b32 v104, v108
    v_permlane32_swap_b32 v105, v109
    v_permlane32_swap_b32 v106, v110
    v_permlane32_swap_b32 v107, v111
    v_max_f32 v104, v104, v108
    v_max_f32 v105, v105, v109
    v_max_f32 v106, v106, v110
    v_max_f32 v107, v107, v111
    v_mov_b32 v108, v104
    v_mov_b32 v109, v105
    v_mov_b32 v110, v106
    v_mov_b32 v111, v107
    v_permlane16_swap_b32 v104, v108
    v_permlane16_swap_b32 v105, v109
    v_permlane16_swap_b32 v106, v110
    v_permlane16_swap_b32 v107, v111
    v_max_f32 v104, v104, v108
    v_max_f32 v105, v105, v109
    v_max_f32 v106, v106, v110
    v_max_f32 v107, v107, v111
    v_mov_b32 v108, v104
    v_mov_b32 v109, v105
    v_mov_b32 v110, v106
    v_mov_b32 v111, v107
    v_permlane32_swap_b32 v104, v108
    v_permlane32_swap_b32 v105, v109
    v_permlane32_swap_b32 v106, v110
    v_permlane32_swap_b32 v107, v111
    v_mul_f32 v104, s52, v104
    v_mul_f32 v105, s52, v105
    v_mul_f32 v106, s52, v106
    v_mul_f32 v107, s52, v107
    v_mul_f32 v108, s52, v108
    v_mul_f32 v109, s52, v109
    v_mul_f32 v110, s52, v110
    v_mul_f32 v111, s52, v111
    v_fma_f32 v112, v88, s52, v108
    v_fma_f32 v113, v89, s52, v108
    v_fma_f32 v114, v90, s52, v108
    v_fma_f32 v115, v91, s52, v108
    v_fma_f32 v116, v92, s52, v109
    v_fma_f32 v117, v93, s52, v109
    v_fma_f32 v118, v94, s52, v109
    v_fma_f32 v119, v95, s52, v109
    v_fma_f32 v120, v96, s52, v110
    v_fma_f32 v121, v97, s52, v110
    v_fma_f32 v122, v98, s52, v110
    v_fma_f32 v123, v99, s52, v110
    v_fma_f32 v124, v100, s52, v111
    v_fma_f32 v125, v101, s52, v111
    v_fma_f32 v126, v102, s52, v111
    v_fma_f32 v127, v103, s52, v111
    v_fma_f32 v88, v88, s51, v104
    v_fma_f32 v89, v89, s51, v104
    v_fma_f32 v90, v90, s51, v104
    v_fma_f32 v91, v91, s51, v104
    v_fma_f32 v92, v92, s51, v105
    v_fma_f32 v93, v93, s51, v105
    v_fma_f32 v94, v94, s51, v105
    v_fma_f32 v95, v95, s51, v105
    v_fma_f32 v96, v96, s51, v106
    v_fma_f32 v97, v97, s51, v106
    v_fma_f32 v98, v98, s51, v106
    v_fma_f32 v99, v99, s51, v106
    v_fma_f32 v100, v100, s51, v107
    v_fma_f32 v101, v101, s51, v107
    v_fma_f32 v102, v102, s51, v107
    v_fma_f32 v103, v103, s51, v107
    v_exp_f32 v112, v112
    v_exp_f32 v113, v113
    v_exp_f32 v114, v114
    v_exp_f32 v115, v115
    v_exp_f32 v116, v116
    v_exp_f32 v117, v117
    v_exp_f32 v118, v118
    v_exp_f32 v119, v119
    v_exp_f32 v120, v120
    v_exp_f32 v121, v121
    v_exp_f32 v122, v122
    v_exp_f32 v123, v123
    v_exp_f32 v124, v124
    v_exp_f32 v125, v125
    v_exp_f32 v126, v126
    v_exp_f32 v127, v127
    v_exp_f32 v88, v88
    v_exp_f32 v89, v89
    v_exp_f32 v90, v90
    v_exp_f32 v91, v91
    v_exp_f32 v92, v92
    v_exp_f32 v93, v93
    v_exp_f32 v94, v94
    v_exp_f32 v95, v95
    v_exp_f32 v96, v96
    v_exp_f32 v97, v97
    v_exp_f32 v98, v98
    v_exp_f32 v99, v99
    v_exp_f32 v100, v100
    v_exp_f32 v101, v101
    v_exp_f32 v102, v102
    v_exp_f32 v103, v103
    v_add_f32 v108, v112, v113
    v_add_f32 v109, v116, v117
    v_add_f32 v110, v120, v121
    v_add_f32 v111, v124, v125
    v_add_f32 v104, v88, v89
    v_add_f32 v105, v92, v93
    v_add_f32 v106, v96, v97
    v_add_f32 v107, v100, v101
    v_add_f32 v108, v108, v114
    v_add_f32 v109, v109, v118
    v_add_f32 v110, v110, v122
    v_add_f32 v111, v111, v126
    v_add_f32 v104, v104, v90
    v_add_f32 v105, v105, v94
    v_add_f32 v106, v106, v98
    v_add_f32 v107, v107, v102
    v_add_f32 v108, v108, v115
    v_add_f32 v109, v109, v119
    v_add_f32 v110, v110, v123
    v_add_f32 v111, v111, v127
    v_add_f32 v104, v104, v91
    v_add_f32 v105, v105, v95
    v_add_f32 v106, v106, v99
    v_add_f32 v107, v107, v103
    s_nop 0
    v_permlane32_swap_b32 v104, v108
    v_permlane32_swap_b32 v105, v109
    v_permlane32_swap_b32 v106, v110
    v_permlane32_swap_b32 v107, v111
    v_add_f32 v104, v104, v108
    v_add_f32 v105, v105, v109
    v_add_f32 v106, v106, v110
    v_add_f32 v107, v107, v111
    v_mov_b32 v108, v104
    v_mov_b32 v109, v105
    v_mov_b32 v110, v106
    v_mov_b32 v111, v107
    v_permlane16_swap_b32 v104, v108
    v_permlane16_swap_b32 v105, v109
    v_permlane16_swap_b32 v106, v110
    v_permlane16_swap_b32 v107, v111
    v_add_f32 v104, v104, v108
    v_add_f32 v105, v105, v109
    v_add_f32 v106, v106, v110
    v_add_f32 v107, v107, v111
    v_mov_b32 v108, v104
    v_mov_b32 v109, v105
    v_mov_b32 v110, v106
    v_mov_b32 v111, v107
    v_permlane32_swap_b32 v104, v108
    v_permlane32_swap_b32 v105, v109
    v_permlane32_swap_b32 v106, v110
    v_permlane32_swap_b32 v107, v111
    v_rcp_f32 v104, v104
    v_rcp_f32 v105, v105
    v_rcp_f32 v106, v106
    v_rcp_f32 v107, v107
    v_rcp_f32 v108, v108
    v_rcp_f32 v109, v109
    v_rcp_f32 v110, v110
    v_rcp_f32 v111, v111
    v_mul_f32 v88, v88, v104
    v_mul_f32 v89, v89, v104
    v_mul_f32 v90, v90, v104
    v_mul_f32 v91, v91, v104
    v_mul_f32 v92, v92, v105
    v_mul_f32 v93, v93, v105
    v_mul_f32 v94, v94, v105
    v_mul_f32 v95, v95, v105
    v_mul_f32 v96, v96, v106
    v_mul_f32 v97, v97, v106
    v_mul_f32 v98, v98, v106
    v_mul_f32 v99, v99, v106
    v_mul_f32 v100, v100, v107
    v_mul_f32 v101, v101, v107
    v_mul_f32 v102, v102, v107
    v_mul_f32 v103, v103, v107
    v_mul_f32 v112, v112, v108
    v_mul_f32 v113, v113, v108
    v_mul_f32 v114, v114, v108
    v_mul_f32 v115, v115, v108
    v_mul_f32 v116, v116, v109
    v_mul_f32 v117, v117, v109
    v_mul_f32 v118, v118, v109
    v_mul_f32 v119, v119, v109
    v_mul_f32 v120, v120, v110
    v_mul_f32 v121, v121, v110
    v_mul_f32 v122, v122, v110
    v_mul_f32 v123, v123, v110
    v_mul_f32 v124, v124, v111
    v_mul_f32 v125, v125, v111
    v_mul_f32 v126, v126, v111
    v_mul_f32 v127, v127, v111
    v_cvt_pk_bf16_f32 v160, v88, v89
    v_cvt_pk_bf16_f32 v161, v90, v91
    v_cvt_pk_bf16_f32 v162, v112, v113
    v_cvt_pk_bf16_f32 v163, v114, v115
    v_cvt_pk_bf16_f32 v184, v92, v93
    v_cvt_pk_bf16_f32 v185, v94, v95
    v_cvt_pk_bf16_f32 v186, v116, v117
    v_cvt_pk_bf16_f32 v187, v118, v119
    v_cvt_pk_bf16_f32 v208, v96, v97
    v_cvt_pk_bf16_f32 v209, v98, v99
    v_cvt_pk_bf16_f32 v210, v120, v121
    v_cvt_pk_bf16_f32 v211, v122, v123
    v_cvt_pk_bf16_f32 v232, v100, v101
    v_cvt_pk_bf16_f32 v233, v102, v103
    v_cvt_pk_bf16_f32 v234, v124, v125
    v_cvt_pk_bf16_f32 v235, v126, v127
    buffer_store_dwordx4 v[160:163], v48, s[28:31], s64 offen
    buffer_store_dwordx4 v[184:187], v48, s[28:31], s65 offen
    buffer_store_dwordx4 v[208:211], v49, s[28:31], s64 offen
    buffer_store_dwordx4 v[232:235], v49, s[28:31], s65 offen
    v_cvt_pk_bf16_f32 v80, v164, v165
    v_cvt_pk_bf16_f32 v81, v166, v167
    v_cvt_pk_bf16_f32 v82, v188, v189
    v_cvt_pk_bf16_f32 v83, v190, v191
    v_cvt_pk_bf16_f32 v84, v212, v213
    v_cvt_pk_bf16_f32 v85, v214, v215
    v_cvt_pk_bf16_f32 v86, v236, v237
    v_cvt_pk_bf16_f32 v87, v238, v239
    s_nop 1
    v_mfma_f32_16x16x16_bf16 v[88:91], v[32:33], v[80:81], 0
    v_mfma_f32_16x16x16_bf16 v[92:95], v[32:33], v[82:83], 0
    v_mfma_f32_16x16x16_bf16 v[96:99], v[32:33], v[84:85], 0
    v_mfma_f32_16x16x16_bf16 v[100:103], v[32:33], v[86:87], 0
    s_nop 7
    v_max3_f32 v104, v88, v89, v90
    v_max3_f32 v105, v92, v93, v94
    v_max3_f32 v106, v96, v97, v98
    v_max3_f32 v107, v100, v101, v102
    v_max3_f32 v108, -v88, -v89, -v90
    v_max3_f32 v109, -v92, -v93, -v94
    v_max3_f32 v110, -v96, -v97, -v98
    v_max3_f32 v111, -v100, -v101, -v102
    v_max_f32 v104, v104, v91
    v_max_f32 v105, v105, v95
    v_max_f32 v106, v106, v99
    v_max_f32 v107, v107, v103
    v_max_f32_e64 v108, v108, -v91
    v_max_f32_e64 v109, v109, -v95
    v_max_f32_e64 v110, v110, -v99
    v_max_f32_e64 v111, v111, -v103
    v_permlane32_swap_b32 v104, v108
    v_permlane32_swap_b32 v105, v109
    v_permlane32_swap_b32 v106, v110
    v_permlane32_swap_b32 v107, v111
    v_max_f32 v104, v104, v108
    v_max_f32 v105, v105, v109
    v_max_f32 v106, v106, v110
    v_max_f32 v107, v107, v111
    v_mov_b32 v108, v104
    v_mov_b32 v109, v105
    v_mov_b32 v110, v106
    v_mov_b32 v111, v107
    v_permlane16_swap_b32 v104, v108
    v_permlane16_swap_b32 v105, v109
    v_permlane16_swap_b32 v106, v110
    v_permlane16_swap_b32 v107, v111
    v_max_f32 v104, v104, v108
    v_max_f32 v105, v105, v109
    v_max_f32 v106, v106, v110
    v_max_f32 v107, v107, v111
    v_mov_b32 v108, v104
    v_mov_b32 v109, v105
    v_mov_b32 v110, v106
    v_mov_b32 v111, v107
    v_permlane32_swap_b32 v104, v108
    v_permlane32_swap_b32 v105, v109
    v_permlane32_swap_b32 v106, v110
    v_permlane32_swap_b32 v107, v111
    v_mul_f32 v104, s52, v104
    v_mul_f32 v105, s52, v105
    v_mul_f32 v106, s52, v106
    v_mul_f32 v107, s52, v107
    v_mul_f32 v108, s52, v108
    v_mul_f32 v109, s52, v109
    v_mul_f32 v110, s52, v110
    v_mul_f32 v111, s52, v111
    v_fma_f32 v112, v88, s52, v108
    v_fma_f32 v113, v89, s52, v108
    v_fma_f32 v114, v90, s52, v108
    v_fma_f32 v115, v91, s52, v108
    v_fma_f32 v116, v92, s52, v109
    v_fma_f32 v117, v93, s52, v109
    v_fma_f32 v118, v94, s52, v109
    v_fma_f32 v119, v95, s52, v109
    v_fma_f32 v120, v96, s52, v110
    v_fma_f32 v121, v97, s52, v110
    v_fma_f32 v122, v98, s52, v110
    v_fma_f32 v123, v99, s52, v110
    v_fma_f32 v124, v100, s52, v111
    v_fma_f32 v125, v101, s52, v111
    v_fma_f32 v126, v102, s52, v111
    v_fma_f32 v127, v103, s52, v111
    v_fma_f32 v88, v88, s51, v104
    v_fma_f32 v89, v89, s51, v104
    v_fma_f32 v90, v90, s51, v104
    v_fma_f32 v91, v91, s51, v104
    v_fma_f32 v92, v92, s51, v105
    v_fma_f32 v93, v93, s51, v105
    v_fma_f32 v94, v94, s51, v105
    v_fma_f32 v95, v95, s51, v105
    v_fma_f32 v96, v96, s51, v106
    v_fma_f32 v97, v97, s51, v106
    v_fma_f32 v98, v98, s51, v106
    v_fma_f32 v99, v99, s51, v106
    v_fma_f32 v100, v100, s51, v107
    v_fma_f32 v101, v101, s51, v107
    v_fma_f32 v102, v102, s51, v107
    v_fma_f32 v103, v103, s51, v107
    v_exp_f32 v112, v112
    v_exp_f32 v113, v113
    v_exp_f32 v114, v114
    v_exp_f32 v115, v115
    v_exp_f32 v116, v116
    v_exp_f32 v117, v117
    v_exp_f32 v118, v118
    v_exp_f32 v119, v119
    v_exp_f32 v120, v120
    v_exp_f32 v121, v121
    v_exp_f32 v122, v122
    v_exp_f32 v123, v123
    v_exp_f32 v124, v124
    v_exp_f32 v125, v125
    v_exp_f32 v126, v126
    v_exp_f32 v127, v127
    v_exp_f32 v88, v88
    v_exp_f32 v89, v89
    v_exp_f32 v90, v90
    v_exp_f32 v91, v91
    v_exp_f32 v92, v92
    v_exp_f32 v93, v93
    v_exp_f32 v94, v94
    v_exp_f32 v95, v95
    v_exp_f32 v96, v96
    v_exp_f32 v97, v97
    v_exp_f32 v98, v98
    v_exp_f32 v99, v99
    v_exp_f32 v100, v100
    v_exp_f32 v101, v101
    v_exp_f32 v102, v102
    v_exp_f32 v103, v103
    v_add_f32 v108, v112, v113
    v_add_f32 v109, v116, v117
    v_add_f32 v110, v120, v121
    v_add_f32 v111, v124, v125
    v_add_f32 v104, v88, v89
    v_add_f32 v105, v92, v93
    v_add_f32 v106, v96, v97
    v_add_f32 v107, v100, v101
    v_add_f32 v108, v108, v114
    v_add_f32 v109, v109, v118
    v_add_f32 v110, v110, v122
    v_add_f32 v111, v111, v126
    v_add_f32 v104, v104, v90
    v_add_f32 v105, v105, v94
    v_add_f32 v106, v106, v98
    v_add_f32 v107, v107, v102
    v_add_f32 v108, v108, v115
    v_add_f32 v109, v109, v119
    v_add_f32 v110, v110, v123
    v_add_f32 v111, v111, v127
    v_add_f32 v104, v104, v91
    v_add_f32 v105, v105, v95
    v_add_f32 v106, v106, v99
    v_add_f32 v107, v107, v103
    s_nop 0
    v_permlane32_swap_b32 v104, v108
    v_permlane32_swap_b32 v105, v109
    v_permlane32_swap_b32 v106, v110
    v_permlane32_swap_b32 v107, v111
    v_add_f32 v104, v104, v108
    v_add_f32 v105, v105, v109
    v_add_f32 v106, v106, v110
    v_add_f32 v107, v107, v111
    v_mov_b32 v108, v104
    v_mov_b32 v109, v105
    v_mov_b32 v110, v106
    v_mov_b32 v111, v107
    v_permlane16_swap_b32 v104, v108
    v_permlane16_swap_b32 v105, v109
    v_permlane16_swap_b32 v106, v110
    v_permlane16_swap_b32 v107, v111
    v_add_f32 v104, v104, v108
    v_add_f32 v105, v105, v109
    v_add_f32 v106, v106, v110
    v_add_f32 v107, v107, v111
    v_mov_b32 v108, v104
    v_mov_b32 v109, v105
    v_mov_b32 v110, v106
    v_mov_b32 v111, v107
    v_permlane32_swap_b32 v104, v108
    v_permlane32_swap_b32 v105, v109
    v_permlane32_swap_b32 v106, v110
    v_permlane32_swap_b32 v107, v111
    v_rcp_f32 v104, v104
    v_rcp_f32 v105, v105
    v_rcp_f32 v106, v106
    v_rcp_f32 v107, v107
    v_rcp_f32 v108, v108
    v_rcp_f32 v109, v109
    v_rcp_f32 v110, v110
    v_rcp_f32 v111, v111
    v_mul_f32 v88, v88, v104
    v_mul_f32 v89, v89, v104
    v_mul_f32 v90, v90, v104
    v_mul_f32 v91, v91, v104
    v_mul_f32 v92, v92, v105
    v_mul_f32 v93, v93, v105
    v_mul_f32 v94, v94, v105
    v_mul_f32 v95, v95, v105
    v_mul_f32 v96, v96, v106
    v_mul_f32 v97, v97, v106
    v_mul_f32 v98, v98, v106
    v_mul_f32 v99, v99, v106
    v_mul_f32 v100, v100, v107
    v_mul_f32 v101, v101, v107
    v_mul_f32 v102, v102, v107
    v_mul_f32 v103, v103, v107
    v_mul_f32 v112, v112, v108
    v_mul_f32 v113, v113, v108
    v_mul_f32 v114, v114, v108
    v_mul_f32 v115, v115, v108
    v_mul_f32 v116, v116, v109
    v_mul_f32 v117, v117, v109
    v_mul_f32 v118, v118, v109
    v_mul_f32 v119, v119, v109
    v_mul_f32 v120, v120, v110
    v_mul_f32 v121, v121, v110
    v_mul_f32 v122, v122, v110
    v_mul_f32 v123, v123, v110
    v_mul_f32 v124, v124, v111
    v_mul_f32 v125, v125, v111
    v_mul_f32 v126, v126, v111
    v_mul_f32 v127, v127, v111
    v_cvt_pk_bf16_f32 v164, v88, v89
    v_cvt_pk_bf16_f32 v165, v90, v91
    v_cvt_pk_bf16_f32 v166, v112, v113
    v_cvt_pk_bf16_f32 v167, v114, v115
    v_cvt_pk_bf16_f32 v188, v92, v93
    v_cvt_pk_bf16_f32 v189, v94, v95
    v_cvt_pk_bf16_f32 v190, v116, v117
    v_cvt_pk_bf16_f32 v191, v118, v119
    v_cvt_pk_bf16_f32 v212, v96, v97
    v_cvt_pk_bf16_f32 v213, v98, v99
    v_cvt_pk_bf16_f32 v214, v120, v121
    v_cvt_pk_bf16_f32 v215, v122, v123
    v_cvt_pk_bf16_f32 v236, v100, v101
    v_cvt_pk_bf16_f32 v237, v102, v103
    v_cvt_pk_bf16_f32 v238, v124, v125
    v_cvt_pk_bf16_f32 v239, v126, v127
    s_nop 1
    v_mfma_f32_16x16x16_bf16 v[80:83], v[164:165], v[36:37], 0
    v_mfma_f32_16x16x16_bf16 v[84:87], v[166:167], v[36:37], 0
    v_mfma_f32_16x16x16_bf16 v[88:91], v[188:189], v[36:37], 0
    v_mfma_f32_16x16x16_bf16 v[92:95], v[190:191], v[36:37], 0
    v_mfma_f32_16x16x16_bf16 v[96:99], v[212:213], v[36:37], 0
    v_mfma_f32_16x16x16_bf16 v[100:103], v[214:215], v[36:37], 0
    v_mfma_f32_16x16x16_bf16 v[104:107], v[236:237], v[36:37], 0
    v_mfma_f32_16x16x16_bf16 v[108:111], v[238:239], v[36:37], 0
    v_cvt_pk_bf16_f32 v112, v168, v169
    v_cvt_pk_bf16_f32 v113, v170, v171
    v_cvt_pk_bf16_f32 v114, v192, v193
    v_cvt_pk_bf16_f32 v115, v194, v195
    v_cvt_pk_bf16_f32 v116, v216, v217
    v_cvt_pk_bf16_f32 v117, v218, v219
    v_cvt_pk_bf16_f32 v118, v240, v241
    v_cvt_pk_bf16_f32 v119, v242, v243
    v_cvt_pk_bf16_f32 v164, v80, v81
    v_cvt_pk_bf16_f32 v165, v82, v83
    v_cvt_pk_bf16_f32 v166, v84, v85
    v_cvt_pk_bf16_f32 v167, v86, v87
    v_cvt_pk_bf16_f32 v188, v88, v89
    v_cvt_pk_bf16_f32 v189, v90, v91
    v_cvt_pk_bf16_f32 v190, v92, v93
    v_cvt_pk_bf16_f32 v191, v94, v95
    v_cvt_pk_bf16_f32 v212, v96, v97
    v_cvt_pk_bf16_f32 v213, v98, v99
    v_cvt_pk_bf16_f32 v214, v100, v101
    v_cvt_pk_bf16_f32 v215, v102, v103
    v_cvt_pk_bf16_f32 v236, v104, v105
    v_cvt_pk_bf16_f32 v237, v106, v107
    v_cvt_pk_bf16_f32 v238, v108, v109
    v_cvt_pk_bf16_f32 v239, v110, v111
    s_nop 1
    v_mfma_f32_16x16x16_bf16 v[52:55], v[164:165], v[112:113], 0
    v_mfma_f32_16x16x16_bf16 v[60:63], v[164:165], v[38:39], 0
    v_mfma_f32_16x16x16_bf16 v[56:59], v[166:167], v[112:113], 0
    v_mfma_f32_16x16x16_bf16 v[64:67], v[166:167], v[38:39], 0
    v_mfma_f32_16x16x16_bf16 v[52:55], v[188:189], v[114:115], v[52:55]
    v_mfma_f32_16x16x16_bf16 v[60:63], v[188:189], v[38:39], v[60:63]
    v_mfma_f32_16x16x16_bf16 v[56:59], v[190:191], v[114:115], v[56:59]
    v_mfma_f32_16x16x16_bf16 v[64:67], v[190:191], v[38:39], v[64:67]
    v_mfma_f32_16x16x16_bf16 v[52:55], v[212:213], v[116:117], v[52:55]
    v_mfma_f32_16x16x16_bf16 v[60:63], v[212:213], v[38:39], v[60:63]
    v_mfma_f32_16x16x16_bf16 v[56:59], v[214:215], v[116:117], v[56:59]
    v_mfma_f32_16x16x16_bf16 v[64:67], v[214:215], v[38:39], v[64:67]
    v_mfma_f32_16x16x16_bf16 v[52:55], v[236:237], v[118:119], v[52:55]
    v_mfma_f32_16x16x16_bf16 v[60:63], v[236:237], v[38:39], v[60:63]
    v_mfma_f32_16x16x16_bf16 v[56:59], v[238:239], v[118:119], v[56:59]
    v_mfma_f32_16x16x16_bf16 v[64:67], v[238:239], v[38:39], v[64:67]
    s_nop 7
    s_and_b32 s48, s63, 3
    s_lshl_b32 s48, s48, 13
    s_lshl_b32 s49, s39, 12
    s_add_u32 s48, s48, s49
    v_lshl_add_u32 v50, v1, 4, s48
    ds_write_b128 v50, v[52:55] offset:8192
    ds_write_b128 v50, v[56:59] offset:9216
    ds_write_b128 v50, v[60:63] offset:10240
    ds_write_b128 v50, v[64:67] offset:11264
    s_xor_b32 s48, s39, 1
    s_lshl_b32 s49, s40, 1
    s_add_u32 s48, s48, s49
    s_lshl_b32 s49, s37, 2
    s_add_u32 s63, s48, s49
    s_lshl_b32 s64, s63, 10
    s_add_u32 s65, s64, 32768
    v_cvt_pk_bf16_f32 v80, v172, v173
    v_cvt_pk_bf16_f32 v81, v174, v175
    v_cvt_pk_bf16_f32 v82, v196, v197
    v_cvt_pk_bf16_f32 v83, v198, v199
    v_cvt_pk_bf16_f32 v84, v220, v221
    v_cvt_pk_bf16_f32 v85, v222, v223
    v_cvt_pk_bf16_f32 v86, v244, v245
    v_cvt_pk_bf16_f32 v87, v246, v247
    s_nop 1
    v_mfma_f32_16x16x16_bf16 v[88:91], v[34:35], v[80:81], 0
    v_mfma_f32_16x16x16_bf16 v[92:95], v[34:35], v[82:83], 0
    v_mfma_f32_16x16x16_bf16 v[96:99], v[34:35], v[84:85], 0
    v_mfma_f32_16x16x16_bf16 v[100:103], v[34:35], v[86:87], 0
    s_nop 7
    v_max3_f32 v104, v88, v89, v90
    v_max3_f32 v105, v92, v93, v94
    v_max3_f32 v106, v96, v97, v98
    v_max3_f32 v107, v100, v101, v102
    v_max3_f32 v108, -v88, -v89, -v90
    v_max3_f32 v109, -v92, -v93, -v94
    v_max3_f32 v110, -v96, -v97, -v98
    v_max3_f32 v111, -v100, -v101, -v102
    v_max_f32 v104, v104, v91
    v_max_f32 v105, v105, v95
    v_max_f32 v106, v106, v99
    v_max_f32 v107, v107, v103
    v_max_f32_e64 v108, v108, -v91
    v_max_f32_e64 v109, v109, -v95
    v_max_f32_e64 v110, v110, -v99
    v_max_f32_e64 v111, v111, -v103
    v_permlane32_swap_b32 v104, v108
    v_permlane32_swap_b32 v105, v109
    v_permlane32_swap_b32 v106, v110
    v_permlane32_swap_b32 v107, v111
    v_max_f32 v104, v104, v108
    v_max_f32 v105, v105, v109
    v_max_f32 v106, v106, v110
    v_max_f32 v107, v107, v111
    v_mov_b32 v108, v104
    v_mov_b32 v109, v105
    v_mov_b32 v110, v106
    v_mov_b32 v111, v107
    v_permlane16_swap_b32 v104, v108
    v_permlane16_swap_b32 v105, v109
    v_permlane16_swap_b32 v106, v110
    v_permlane16_swap_b32 v107, v111
    v_max_f32 v104, v104, v108
    v_max_f32 v105, v105, v109
    v_max_f32 v106, v106, v110
    v_max_f32 v107, v107, v111
    v_mov_b32 v108, v104
    v_mov_b32 v109, v105
    v_mov_b32 v110, v106
    v_mov_b32 v111, v107
    v_permlane32_swap_b32 v104, v108
    v_permlane32_swap_b32 v105, v109
    v_permlane32_swap_b32 v106, v110
    v_permlane32_swap_b32 v107, v111
    v_mul_f32 v104, s52, v104
    v_mul_f32 v105, s52, v105
    v_mul_f32 v106, s52, v106
    v_mul_f32 v107, s52, v107
    v_mul_f32 v108, s52, v108
    v_mul_f32 v109, s52, v109
    v_mul_f32 v110, s52, v110
    v_mul_f32 v111, s52, v111
    v_fma_f32 v112, v88, s52, v108
    v_fma_f32 v113, v89, s52, v108
    v_fma_f32 v114, v90, s52, v108
    v_fma_f32 v115, v91, s52, v108
    v_fma_f32 v116, v92, s52, v109
    v_fma_f32 v117, v93, s52, v109
    v_fma_f32 v118, v94, s52, v109
    v_fma_f32 v119, v95, s52, v109
    v_fma_f32 v120, v96, s52, v110
    v_fma_f32 v121, v97, s52, v110
    v_fma_f32 v122, v98, s52, v110
    v_fma_f32 v123, v99, s52, v110
    v_fma_f32 v124, v100, s52, v111
    v_fma_f32 v125, v101, s52, v111
    v_fma_f32 v126, v102, s52, v111
    v_fma_f32 v127, v103, s52, v111
    v_fma_f32 v88, v88, s51, v104
    v_fma_f32 v89, v89, s51, v104
    v_fma_f32 v90, v90, s51, v104
    v_fma_f32 v91, v91, s51, v104
    v_fma_f32 v92, v92, s51, v105
    v_fma_f32 v93, v93, s51, v105
    v_fma_f32 v94, v94, s51, v105
    v_fma_f32 v95, v95, s51, v105
    v_fma_f32 v96, v96, s51, v106
    v_fma_f32 v97, v97, s51, v106
    v_fma_f32 v98, v98, s51, v106
    v_fma_f32 v99, v99, s51, v106
    v_fma_f32 v100, v100, s51, v107
    v_fma_f32 v101, v101, s51, v107
    v_fma_f32 v102, v102, s51, v107
    v_fma_f32 v103, v103, s51, v107
    v_exp_f32 v112, v112
    v_exp_f32 v113, v113
    v_exp_f32 v114, v114
    v_exp_f32 v115, v115
    v_exp_f32 v116, v116
    v_exp_f32 v117, v117
    v_exp_f32 v118, v118
    v_exp_f32 v119, v119
    v_exp_f32 v120, v120
    v_exp_f32 v121, v121
    v_exp_f32 v122, v122
    v_exp_f32 v123, v123
    v_exp_f32 v124, v124
    v_exp_f32 v125, v125
    v_exp_f32 v126, v126
    v_exp_f32 v127, v127
    v_exp_f32 v88, v88
    v_exp_f32 v89, v89
    v_exp_f32 v90, v90
    v_exp_f32 v91, v91
    v_exp_f32 v92, v92
    v_exp_f32 v93, v93
    v_exp_f32 v94, v94
    v_exp_f32 v95, v95
    v_exp_f32 v96, v96
    v_exp_f32 v97, v97
    v_exp_f32 v98, v98
    v_exp_f32 v99, v99
    v_exp_f32 v100, v100
    v_exp_f32 v101, v101
    v_exp_f32 v102, v102
    v_exp_f32 v103, v103
    v_add_f32 v108, v112, v113
    v_add_f32 v109, v116, v117
    v_add_f32 v110, v120, v121
    v_add_f32 v111, v124, v125
    v_add_f32 v104, v88, v89
    v_add_f32 v105, v92, v93
    v_add_f32 v106, v96, v97
    v_add_f32 v107, v100, v101
    v_add_f32 v108, v108, v114
    v_add_f32 v109, v109, v118
    v_add_f32 v110, v110, v122
    v_add_f32 v111, v111, v126
    v_add_f32 v104, v104, v90
    v_add_f32 v105, v105, v94
    v_add_f32 v106, v106, v98
    v_add_f32 v107, v107, v102
    v_add_f32 v108, v108, v115
    v_add_f32 v109, v109, v119
    v_add_f32 v110, v110, v123
    v_add_f32 v111, v111, v127
    v_add_f32 v104, v104, v91
    v_add_f32 v105, v105, v95
    v_add_f32 v106, v106, v99
    v_add_f32 v107, v107, v103
    s_nop 0
    v_permlane32_swap_b32 v104, v108
    v_permlane32_swap_b32 v105, v109
    v_permlane32_swap_b32 v106, v110
    v_permlane32_swap_b32 v107, v111
    v_add_f32 v104, v104, v108
    v_add_f32 v105, v105, v109
    v_add_f32 v106, v106, v110
    v_add_f32 v107, v107, v111
    v_mov_b32 v108, v104
    v_mov_b32 v109, v105
    v_mov_b32 v110, v106
    v_mov_b32 v111, v107
    v_permlane16_swap_b32 v104, v108
    v_permlane16_swap_b32 v105, v109
    v_permlane16_swap_b32 v106, v110
    v_permlane16_swap_b32 v107, v111
    v_add_f32 v104, v104, v108
    v_add_f32 v105, v105, v109
    v_add_f32 v106, v106, v110
    v_add_f32 v107, v107, v111
    v_mov_b32 v108, v104
    v_mov_b32 v109, v105
    v_mov_b32 v110, v106
    v_mov_b32 v111, v107
    v_permlane32_swap_b32 v104, v108
    v_permlane32_swap_b32 v105, v109
    v_permlane32_swap_b32 v106, v110
    v_permlane32_swap_b32 v107, v111
    v_rcp_f32 v104, v104
    v_rcp_f32 v105, v105
    v_rcp_f32 v106, v106
    v_rcp_f32 v107, v107
    v_rcp_f32 v108, v108
    v_rcp_f32 v109, v109
    v_rcp_f32 v110, v110
    v_rcp_f32 v111, v111
    v_mul_f32 v88, v88, v104
    v_mul_f32 v89, v89, v104
    v_mul_f32 v90, v90, v104
    v_mul_f32 v91, v91, v104
    v_mul_f32 v92, v92, v105
    v_mul_f32 v93, v93, v105
    v_mul_f32 v94, v94, v105
    v_mul_f32 v95, v95, v105
    v_mul_f32 v96, v96, v106
    v_mul_f32 v97, v97, v106
    v_mul_f32 v98, v98, v106
    v_mul_f32 v99, v99, v106
    v_mul_f32 v100, v100, v107
    v_mul_f32 v101, v101, v107
    v_mul_f32 v102, v102, v107
    v_mul_f32 v103, v103, v107
    v_mul_f32 v112, v112, v108
    v_mul_f32 v113, v113, v108
    v_mul_f32 v114, v114, v108
    v_mul_f32 v115, v115, v108
    v_mul_f32 v116, v116, v109
    v_mul_f32 v117, v117, v109
    v_mul_f32 v118, v118, v109
    v_mul_f32 v119, v119, v109
    v_mul_f32 v120, v120, v110
    v_mul_f32 v121, v121, v110
    v_mul_f32 v122, v122, v110
    v_mul_f32 v123, v123, v110
    v_mul_f32 v124, v124, v111
    v_mul_f32 v125, v125, v111
    v_mul_f32 v126, v126, v111
    v_mul_f32 v127, v127, v111
    v_cvt_pk_bf16_f32 v172, v88, v89
    v_cvt_pk_bf16_f32 v173, v90, v91
    v_cvt_pk_bf16_f32 v174, v112, v113
    v_cvt_pk_bf16_f32 v175, v114, v115
    v_cvt_pk_bf16_f32 v196, v92, v93
    v_cvt_pk_bf16_f32 v197, v94, v95
    v_cvt_pk_bf16_f32 v198, v116, v117
    v_cvt_pk_bf16_f32 v199, v118, v119
    v_cvt_pk_bf16_f32 v220, v96, v97
    v_cvt_pk_bf16_f32 v221, v98, v99
    v_cvt_pk_bf16_f32 v222, v120, v121
    v_cvt_pk_bf16_f32 v223, v122, v123
    v_cvt_pk_bf16_f32 v244, v100, v101
    v_cvt_pk_bf16_f32 v245, v102, v103
    v_cvt_pk_bf16_f32 v246, v124, v125
    v_cvt_pk_bf16_f32 v247, v126, v127
    buffer_store_dwordx4 v[172:175], v48, s[28:31], s64 offen
    buffer_store_dwordx4 v[196:199], v48, s[28:31], s65 offen
    buffer_store_dwordx4 v[220:223], v49, s[28:31], s64 offen
    buffer_store_dwordx4 v[244:247], v49, s[28:31], s65 offen
    v_cvt_pk_bf16_f32 v80, v176, v177
    v_cvt_pk_bf16_f32 v81, v178, v179
    v_cvt_pk_bf16_f32 v82, v200, v201
    v_cvt_pk_bf16_f32 v83, v202, v203
    v_cvt_pk_bf16_f32 v84, v224, v225
    v_cvt_pk_bf16_f32 v85, v226, v227
    v_cvt_pk_bf16_f32 v86, v248, v249
    v_cvt_pk_bf16_f32 v87, v250, v251
    s_nop 1
    v_mfma_f32_16x16x16_bf16 v[88:91], v[34:35], v[80:81], 0
    v_mfma_f32_16x16x16_bf16 v[92:95], v[34:35], v[82:83], 0
    v_mfma_f32_16x16x16_bf16 v[96:99], v[34:35], v[84:85], 0
    v_mfma_f32_16x16x16_bf16 v[100:103], v[34:35], v[86:87], 0
    s_nop 7
    v_max3_f32 v104, v88, v89, v90
    v_max3_f32 v105, v92, v93, v94
    v_max3_f32 v106, v96, v97, v98
    v_max3_f32 v107, v100, v101, v102
    v_max3_f32 v108, -v88, -v89, -v90
    v_max3_f32 v109, -v92, -v93, -v94
    v_max3_f32 v110, -v96, -v97, -v98
    v_max3_f32 v111, -v100, -v101, -v102
    v_max_f32 v104, v104, v91
    v_max_f32 v105, v105, v95
    v_max_f32 v106, v106, v99
    v_max_f32 v107, v107, v103
    v_max_f32_e64 v108, v108, -v91
    v_max_f32_e64 v109, v109, -v95
    v_max_f32_e64 v110, v110, -v99
    v_max_f32_e64 v111, v111, -v103
    v_permlane32_swap_b32 v104, v108
    v_permlane32_swap_b32 v105, v109
    v_permlane32_swap_b32 v106, v110
    v_permlane32_swap_b32 v107, v111
    v_max_f32 v104, v104, v108
    v_max_f32 v105, v105, v109
    v_max_f32 v106, v106, v110
    v_max_f32 v107, v107, v111
    v_mov_b32 v108, v104
    v_mov_b32 v109, v105
    v_mov_b32 v110, v106
    v_mov_b32 v111, v107
    v_permlane16_swap_b32 v104, v108
    v_permlane16_swap_b32 v105, v109
    v_permlane16_swap_b32 v106, v110
    v_permlane16_swap_b32 v107, v111
    v_max_f32 v104, v104, v108
    v_max_f32 v105, v105, v109
    v_max_f32 v106, v106, v110
    v_max_f32 v107, v107, v111
    v_mov_b32 v108, v104
    v_mov_b32 v109, v105
    v_mov_b32 v110, v106
    v_mov_b32 v111, v107
    v_permlane32_swap_b32 v104, v108
    v_permlane32_swap_b32 v105, v109
    v_permlane32_swap_b32 v106, v110
    v_permlane32_swap_b32 v107, v111
    v_mul_f32 v104, s52, v104
    v_mul_f32 v105, s52, v105
    v_mul_f32 v106, s52, v106
    v_mul_f32 v107, s52, v107
    v_mul_f32 v108, s52, v108
    v_mul_f32 v109, s52, v109
    v_mul_f32 v110, s52, v110
    v_mul_f32 v111, s52, v111
    v_fma_f32 v112, v88, s52, v108
    v_fma_f32 v113, v89, s52, v108
    v_fma_f32 v114, v90, s52, v108
    v_fma_f32 v115, v91, s52, v108
    v_fma_f32 v116, v92, s52, v109
    v_fma_f32 v117, v93, s52, v109
    v_fma_f32 v118, v94, s52, v109
    v_fma_f32 v119, v95, s52, v109
    v_fma_f32 v120, v96, s52, v110
    v_fma_f32 v121, v97, s52, v110
    v_fma_f32 v122, v98, s52, v110
    v_fma_f32 v123, v99, s52, v110
    v_fma_f32 v124, v100, s52, v111
    v_fma_f32 v125, v101, s52, v111
    v_fma_f32 v126, v102, s52, v111
    v_fma_f32 v127, v103, s52, v111
    v_fma_f32 v88, v88, s51, v104
    v_fma_f32 v89, v89, s51, v104
    v_fma_f32 v90, v90, s51, v104
    v_fma_f32 v91, v91, s51, v104
    v_fma_f32 v92, v92, s51, v105
    v_fma_f32 v93, v93, s51, v105
    v_fma_f32 v94, v94, s51, v105
    v_fma_f32 v95, v95, s51, v105
    v_fma_f32 v96, v96, s51, v106
    v_fma_f32 v97, v97, s51, v106
    v_fma_f32 v98, v98, s51, v106
    v_fma_f32 v99, v99, s51, v106
    v_fma_f32 v100, v100, s51, v107
    v_fma_f32 v101, v101, s51, v107
    v_fma_f32 v102, v102, s51, v107
    v_fma_f32 v103, v103, s51, v107
    v_exp_f32 v112, v112
    v_exp_f32 v113, v113
    v_exp_f32 v114, v114
    v_exp_f32 v115, v115
    v_exp_f32 v116, v116
    v_exp_f32 v117, v117
    v_exp_f32 v118, v118
    v_exp_f32 v119, v119
    v_exp_f32 v120, v120
    v_exp_f32 v121, v121
    v_exp_f32 v122, v122
    v_exp_f32 v123, v123
    v_exp_f32 v124, v124
    v_exp_f32 v125, v125
    v_exp_f32 v126, v126
    v_exp_f32 v127, v127
    v_exp_f32 v88, v88
    v_exp_f32 v89, v89
    v_exp_f32 v90, v90
    v_exp_f32 v91, v91
    v_exp_f32 v92, v92
    v_exp_f32 v93, v93
    v_exp_f32 v94, v94
    v_exp_f32 v95, v95
    v_exp_f32 v96, v96
    v_exp_f32 v97, v97
    v_exp_f32 v98, v98
    v_exp_f32 v99, v99
    v_exp_f32 v100, v100
    v_exp_f32 v101, v101
    v_exp_f32 v102, v102
    v_exp_f32 v103, v103
    v_add_f32 v108, v112, v113
    v_add_f32 v109, v116, v117
    v_add_f32 v110, v120, v121
    v_add_f32 v111, v124, v125
    v_add_f32 v104, v88, v89
    v_add_f32 v105, v92, v93
    v_add_f32 v106, v96, v97
    v_add_f32 v107, v100, v101
    v_add_f32 v108, v108, v114
    v_add_f32 v109, v109, v118
    v_add_f32 v110, v110, v122
    v_add_f32 v111, v111, v126
    v_add_f32 v104, v104, v90
    v_add_f32 v105, v105, v94
    v_add_f32 v106, v106, v98
    v_add_f32 v107, v107, v102
    v_add_f32 v108, v108, v115
    v_add_f32 v109, v109, v119
    v_add_f32 v110, v110, v123
    v_add_f32 v111, v111, v127
    v_add_f32 v104, v104, v91
    v_add_f32 v105, v105, v95
    v_add_f32 v106, v106, v99
    v_add_f32 v107, v107, v103
    s_nop 0
    v_permlane32_swap_b32 v104, v108
    v_permlane32_swap_b32 v105, v109
    v_permlane32_swap_b32 v106, v110
    v_permlane32_swap_b32 v107, v111
    v_add_f32 v104, v104, v108
    v_add_f32 v105, v105, v109
    v_add_f32 v106, v106, v110
    v_add_f32 v107, v107, v111
    v_mov_b32 v108, v104
    v_mov_b32 v109, v105
    v_mov_b32 v110, v106
    v_mov_b32 v111, v107
    v_permlane16_swap_b32 v104, v108
    v_permlane16_swap_b32 v105, v109
    v_permlane16_swap_b32 v106, v110
    v_permlane16_swap_b32 v107, v111
    v_add_f32 v104, v104, v108
    v_add_f32 v105, v105, v109
    v_add_f32 v106, v106, v110
    v_add_f32 v107, v107, v111
    v_mov_b32 v108, v104
    v_mov_b32 v109, v105
    v_mov_b32 v110, v106
    v_mov_b32 v111, v107
    v_permlane32_swap_b32 v104, v108
    v_permlane32_swap_b32 v105, v109
    v_permlane32_swap_b32 v106, v110
    v_permlane32_swap_b32 v107, v111
    v_rcp_f32 v104, v104
    v_rcp_f32 v105, v105
    v_rcp_f32 v106, v106
    v_rcp_f32 v107, v107
    v_rcp_f32 v108, v108
    v_rcp_f32 v109, v109
    v_rcp_f32 v110, v110
    v_rcp_f32 v111, v111
    v_mul_f32 v88, v88, v104
    v_mul_f32 v89, v89, v104
    v_mul_f32 v90, v90, v104
    v_mul_f32 v91, v91, v104
    v_mul_f32 v92, v92, v105
    v_mul_f32 v93, v93, v105
    v_mul_f32 v94, v94, v105
    v_mul_f32 v95, v95, v105
    v_mul_f32 v96, v96, v106
    v_mul_f32 v97, v97, v106
    v_mul_f32 v98, v98, v106
    v_mul_f32 v99, v99, v106
    v_mul_f32 v100, v100, v107
    v_mul_f32 v101, v101, v107
    v_mul_f32 v102, v102, v107
    v_mul_f32 v103, v103, v107
    v_mul_f32 v112, v112, v108
    v_mul_f32 v113, v113, v108
    v_mul_f32 v114, v114, v108
    v_mul_f32 v115, v115, v108
    v_mul_f32 v116, v116, v109
    v_mul_f32 v117, v117, v109
    v_mul_f32 v118, v118, v109
    v_mul_f32 v119, v119, v109
    v_mul_f32 v120, v120, v110
    v_mul_f32 v121, v121, v110
    v_mul_f32 v122, v122, v110
    v_mul_f32 v123, v123, v110
    v_mul_f32 v124, v124, v111
    v_mul_f32 v125, v125, v111
    v_mul_f32 v126, v126, v111
    v_mul_f32 v127, v127, v111
    v_cvt_pk_bf16_f32 v176, v88, v89
    v_cvt_pk_bf16_f32 v177, v90, v91
    v_cvt_pk_bf16_f32 v178, v112, v113
    v_cvt_pk_bf16_f32 v179, v114, v115
    v_cvt_pk_bf16_f32 v200, v92, v93
    v_cvt_pk_bf16_f32 v201, v94, v95
    v_cvt_pk_bf16_f32 v202, v116, v117
    v_cvt_pk_bf16_f32 v203, v118, v119
    v_cvt_pk_bf16_f32 v224, v96, v97
    v_cvt_pk_bf16_f32 v225, v98, v99
    v_cvt_pk_bf16_f32 v226, v120, v121
    v_cvt_pk_bf16_f32 v227, v122, v123
    v_cvt_pk_bf16_f32 v248, v100, v101
    v_cvt_pk_bf16_f32 v249, v102, v103
    v_cvt_pk_bf16_f32 v250, v124, v125
    v_cvt_pk_bf16_f32 v251, v126, v127
    s_nop 1
    v_mfma_f32_16x16x16_bf16 v[80:83], v[176:177], v[36:37], 0
    v_mfma_f32_16x16x16_bf16 v[84:87], v[178:179], v[36:37], 0
    v_mfma_f32_16x16x16_bf16 v[88:91], v[200:201], v[36:37], 0
    v_mfma_f32_16x16x16_bf16 v[92:95], v[202:203], v[36:37], 0
    v_mfma_f32_16x16x16_bf16 v[96:99], v[224:225], v[36:37], 0
    v_mfma_f32_16x16x16_bf16 v[100:103], v[226:227], v[36:37], 0
    v_mfma_f32_16x16x16_bf16 v[104:107], v[248:249], v[36:37], 0
    v_mfma_f32_16x16x16_bf16 v[108:111], v[250:251], v[36:37], 0
    v_cvt_pk_bf16_f32 v112, v180, v181
    v_cvt_pk_bf16_f32 v113, v182, v183
    v_cvt_pk_bf16_f32 v114, v204, v205
    v_cvt_pk_bf16_f32 v115, v206, v207
    v_cvt_pk_bf16_f32 v116, v228, v229
    v_cvt_pk_bf16_f32 v117, v230, v231
    v_cvt_pk_bf16_f32 v118, v252, v253
    v_cvt_pk_bf16_f32 v119, v254, v255
    v_cvt_pk_bf16_f32 v176, v80, v81
    v_cvt_pk_bf16_f32 v177, v82, v83
    v_cvt_pk_bf16_f32 v178, v84, v85
    v_cvt_pk_bf16_f32 v179, v86, v87
    v_cvt_pk_bf16_f32 v200, v88, v89
    v_cvt_pk_bf16_f32 v201, v90, v91
    v_cvt_pk_bf16_f32 v202, v92, v93
    v_cvt_pk_bf16_f32 v203, v94, v95
    v_cvt_pk_bf16_f32 v224, v96, v97
    v_cvt_pk_bf16_f32 v225, v98, v99
    v_cvt_pk_bf16_f32 v226, v100, v101
    v_cvt_pk_bf16_f32 v227, v102, v103
    v_cvt_pk_bf16_f32 v248, v104, v105
    v_cvt_pk_bf16_f32 v249, v106, v107
    v_cvt_pk_bf16_f32 v250, v108, v109
    v_cvt_pk_bf16_f32 v251, v110, v111
    s_nop 1
    v_mfma_f32_16x16x16_bf16 v[52:55], v[176:177], v[112:113], 0
    v_mfma_f32_16x16x16_bf16 v[60:63], v[176:177], v[38:39], 0
    v_mfma_f32_16x16x16_bf16 v[56:59], v[178:179], v[112:113], 0
    v_mfma_f32_16x16x16_bf16 v[64:67], v[178:179], v[38:39], 0
    v_mfma_f32_16x16x16_bf16 v[52:55], v[200:201], v[114:115], v[52:55]
    v_mfma_f32_16x16x16_bf16 v[60:63], v[200:201], v[38:39], v[60:63]
    v_mfma_f32_16x16x16_bf16 v[56:59], v[202:203], v[114:115], v[56:59]
    v_mfma_f32_16x16x16_bf16 v[64:67], v[202:203], v[38:39], v[64:67]
    v_mfma_f32_16x16x16_bf16 v[52:55], v[224:225], v[116:117], v[52:55]
    v_mfma_f32_16x16x16_bf16 v[60:63], v[224:225], v[38:39], v[60:63]
    v_mfma_f32_16x16x16_bf16 v[56:59], v[226:227], v[116:117], v[56:59]
    v_mfma_f32_16x16x16_bf16 v[64:67], v[226:227], v[38:39], v[64:67]
    v_mfma_f32_16x16x16_bf16 v[52:55], v[248:249], v[118:119], v[52:55]
    v_mfma_f32_16x16x16_bf16 v[60:63], v[248:249], v[38:39], v[60:63]
    v_mfma_f32_16x16x16_bf16 v[56:59], v[250:251], v[118:119], v[56:59]
    v_mfma_f32_16x16x16_bf16 v[64:67], v[250:251], v[38:39], v[64:67]
    s_nop 7
    s_and_b32 s48, s63, 3
    s_lshl_b32 s48, s48, 13
    s_lshl_b32 s49, s39, 12
    s_add_u32 s48, s48, s49
    v_lshl_add_u32 v50, v1, 4, s48
    ds_write_b128 v50, v[52:55] offset:8192
    ds_write_b128 v50, v[56:59] offset:9216
    ds_write_b128 v50, v[60:63] offset:10240
    ds_write_b128 v50, v[64:67] offset:11264
    s_waitcnt lgkmcnt(0)
    s_barrier
    s_lshl_b32 s48, s38, 13
    v_lshl_add_u32 v50, v1, 4, s48
    ds_read_b128 v[80:83], v50 offset:8192
    ds_read_b128 v[84:87], v50 offset:9216
    ds_read_b128 v[88:91], v50 offset:10240
    ds_read_b128 v[92:95], v50 offset:11264
    ds_read_b128 v[96:99], v50 offset:12288
    ds_read_b128 v[100:103], v50 offset:13312
    ds_read_b128 v[104:107], v50 offset:14336
    ds_read_b128 v[108:111], v50 offset:15360
    s_lshl_b32 s48, s37, 2
    s_add_u32 s48, s48, s38
    s_lshl_b32 s48, s48, 4
    s_add_u32 s48, s48, s36
    s_mul_i32 s48, s48, 2176
    v_lshlrev_b32 v51, 2, v2
    v_lshl_add_u32 v51, v3, 8, v51
    v_lshlrev_b32 v52, 4, v3
    s_waitcnt lgkmcnt(0)
    v_add_f32 v80, v80, v96
    v_add_f32 v81, v81, v97
    v_add_f32 v82, v82, v98
    v_add_f32 v83, v83, v99
    v_add_f32 v84, v84, v100
    v_add_f32 v85, v85, v101
    v_add_f32 v86, v86, v102
    v_add_f32 v87, v87, v103
    v_add_f32 v88, v88, v104
    v_add_f32 v89, v89, v105
    v_add_f32 v90, v90, v106
    v_add_f32 v91, v91, v107
    v_add_f32 v92, v92, v108
    v_add_f32 v93, v93, v109
    v_add_f32 v94, v94, v110
    v_add_f32 v95, v95, v111
    buffer_store_dword v80, v51, s[32:35], s48 offen offset:0
    buffer_store_dword v81, v51, s[32:35], s48 offen offset:64
    buffer_store_dword v82, v51, s[32:35], s48 offen offset:128
    buffer_store_dword v83, v51, s[32:35], s48 offen offset:192
    buffer_store_dword v84, v51, s[32:35], s48 offen offset:1024
    buffer_store_dword v85, v51, s[32:35], s48 offen offset:1088
    buffer_store_dword v86, v51, s[32:35], s48 offen offset:1152
    buffer_store_dword v87, v51, s[32:35], s48 offen offset:1216
    v_cmp_eq_u32 vcc, 0, v2
    s_and_saveexec_b64 s[66:67], vcc
    buffer_store_dwordx4 v[88:91], v52, s[32:35], s48 offen offset:2048
    buffer_store_dwordx4 v[92:95], v52, s[32:35], s48 offen offset:2112
    s_endpgm
P1_z1:
    s_add_u32 s28, s12, 4194304
    s_addc_u32 s29, s13, 0
    s_mov_b32 s30, 2883584
    s_mov_b32 s31, 0x00020000
    s_waitcnt vmcnt(20) lgkmcnt(0)
    s_barrier
    ds_read_b128 v[80:83], v14 offset:0
    ds_read_b128 v[84:87], v14 offset:2048
    ds_read_b128 v[88:91], v16 offset:0
    ds_read_b128 v[92:95], v16 offset:2048
    ds_read_b64_tr_b16 v[96:97], v18 offset:0
    ds_read_b64_tr_b16 v[98:99], v18 offset:1536
    ds_read_b64_tr_b16 v[100:101], v19 offset:0
    ds_read_b64_tr_b16 v[102:103], v19 offset:1536
    ds_read_b64_tr_b16 v[104:105], v20 offset:0
    ds_read_b64_tr_b16 v[106:107], v20 offset:1536
    ds_read_b64_tr_b16 v[108:109], v21 offset:0
    ds_read_b64_tr_b16 v[110:111], v21 offset:1536
    ds_read_b64_tr_b16 v[112:113], v22 offset:0
    ds_read_b64_tr_b16 v[114:115], v22 offset:1536
    ds_read_b64_tr_b16 v[116:117], v23 offset:0
    ds_read_b64_tr_b16 v[118:119], v23 offset:1536
    s_waitcnt lgkmcnt(0)
    v_mfma_f32_16x16x32_bf16 v[160:163], v[96:99], v[80:83], 0
    ds_read_b128 v[120:123], v15 offset:0
    v_mfma_f32_16x16x32_bf16 v[184:187], v[96:99], v[84:87], 0
    ds_read_b128 v[124:127], v15 offset:2048
    v_mfma_f32_16x16x32_bf16 v[208:211], v[96:99], v[88:91], 0
    ds_read_b128 v[128:131], v17 offset:0
    v_mfma_f32_16x16x32_bf16 v[232:235], v[96:99], v[92:95], 0
    ds_read_b128 v[132:135], v17 offset:2048
    v_mfma_f32_16x16x32_bf16 v[164:167], v[100:103], v[80:83], 0
    ds_read_b64_tr_b16 v[136:137], v18 offset:12288
    v_mfma_f32_16x16x32_bf16 v[188:191], v[100:103], v[84:87], 0
    ds_read_b64_tr_b16 v[138:139], v18 offset:13824
    v_mfma_f32_16x16x32_bf16 v[212:215], v[100:103], v[88:91], 0
    ds_read_b64_tr_b16 v[140:141], v19 offset:12288
    v_mfma_f32_16x16x32_bf16 v[236:239], v[100:103], v[92:95], 0
    ds_read_b64_tr_b16 v[142:143], v19 offset:13824
    v_mfma_f32_16x16x32_bf16 v[168:171], v[104:107], v[80:83], 0
    ds_read_b64_tr_b16 v[144:145], v20 offset:12288
    v_mfma_f32_16x16x32_bf16 v[192:195], v[104:107], v[84:87], 0
    ds_read_b64_tr_b16 v[146:147], v20 offset:13824
    v_mfma_f32_16x16x32_bf16 v[216:219], v[104:107], v[88:91], 0
    ds_read_b64_tr_b16 v[148:149], v21 offset:12288
    v_mfma_f32_16x16x32_bf16 v[240:243], v[104:107], v[92:95], 0
    ds_read_b64_tr_b16 v[150:151], v21 offset:13824
    v_mfma_f32_16x16x32_bf16 v[172:175], v[108:111], v[80:83], 0
    ds_read_b64_tr_b16 v[152:153], v22 offset:12288
    v_mfma_f32_16x16x32_bf16 v[196:199], v[108:111], v[84:87], 0
    ds_read_b64_tr_b16 v[154:155], v22 offset:13824
    v_mfma_f32_16x16x32_bf16 v[220:223], v[108:111], v[88:91], 0
    ds_read_b64_tr_b16 v[156:157], v23 offset:12288
    v_mfma_f32_16x16x32_bf16 v[244:247], v[108:111], v[92:95], 0
    ds_read_b64_tr_b16 v[158:159], v23 offset:13824
    v_mfma_f32_16x16x32_bf16 v[176:179], v[112:115], v[80:83], 0
    v_mfma_f32_16x16x32_bf16 v[200:203], v[112:115], v[84:87], 0
    v_mfma_f32_16x16x32_bf16 v[224:227], v[112:115], v[88:91], 0
    v_mfma_f32_16x16x32_bf16 v[248:251], v[112:115], v[92:95], 0
    v_mfma_f32_16x16x32_bf16 v[180:183], v[116:119], v[80:83], 0
    v_mfma_f32_16x16x32_bf16 v[204:207], v[116:119], v[84:87], 0
    v_mfma_f32_16x16x32_bf16 v[228:231], v[116:119], v[88:91], 0
    v_mfma_f32_16x16x32_bf16 v[252:255], v[116:119], v[92:95], 0
    v_mfma_f32_16x16x32_bf16 a[0:3], v[24:27], v[80:83], 0
    v_mfma_f32_16x16x32_bf16 a[8:11], v[80:83], v[80:83], 0
    v_mfma_f32_16x16x32_bf16 a[4:7], v[24:27], v[84:87], 0
    v_mfma_f32_16x16x32_bf16 a[12:15], v[84:87], v[84:87], 0
    v_mfma_f32_16x16x32_bf16 a[16:19], v[24:27], v[96:99], 0
    v_mfma_f32_16x16x32_bf16 a[20:23], v[24:27], v[100:103], 0
    v_mfma_f32_16x16x32_bf16 a[24:27], v[24:27], v[104:107], 0
    s_waitcnt vmcnt(10) lgkmcnt(0)
    s_barrier
    v_mfma_f32_16x16x32_bf16 a[0:3], v[24:27], v[120:123], a[0:3]
    ds_read_b128 v[80:83], v14 offset:16384
    ds_read_b128 v[84:87], v14 offset:18432
    v_mfma_f32_16x16x32_bf16 a[8:11], v[120:123], v[120:123], a[8:11]
    ds_read_b128 v[88:91], v16 offset:16384
    ds_read_b128 v[92:95], v16 offset:18432
    v_mfma_f32_16x16x32_bf16 a[4:7], v[24:27], v[124:127], a[4:7]
    ds_read_b64_tr_b16 v[96:97], v18 offset:24576
    ds_read_b64_tr_b16 v[98:99], v18 offset:26112
    v_mfma_f32_16x16x32_bf16 a[12:15], v[124:127], v[124:127], a[12:15]
    ds_read_b64_tr_b16 v[100:101], v19 offset:24576
    ds_read_b64_tr_b16 v[102:103], v19 offset:26112
    v_mfma_f32_16x16x32_bf16 a[16:19], v[24:27], v[136:139], a[16:19]
    ds_read_b64_tr_b16 v[104:105], v20 offset:24576
    ds_read_b64_tr_b16 v[106:107], v20 offset:26112
    v_mfma_f32_16x16x32_bf16 a[20:23], v[24:27], v[140:143], a[20:23]
    ds_read_b64_tr_b16 v[108:109], v21 offset:24576
    ds_read_b64_tr_b16 v[110:111], v21 offset:26112
    v_mfma_f32_16x16x32_bf16 a[24:27], v[24:27], v[144:147], a[24:27]
    ds_read_b64_tr_b16 v[112:113], v22 offset:24576
    ds_read_b64_tr_b16 v[114:115], v22 offset:26112
    v_mfma_f32_16x16x32_bf16 v[160:163], v[136:139], v[120:123], v[160:163]
    ds_read_b64_tr_b16 v[116:117], v23 offset:24576
    ds_read_b64_tr_b16 v[118:119], v23 offset:26112
    v_mfma_f32_16x16x32_bf16 v[184:187], v[136:139], v[124:127], v[184:187]
    s_movk_i32 s46, 384
    s_mov_b32 s47, 528384
    v_mfma_f32_16x16x32_bf16 v[208:211], v[136:139], v[128:131], v[208:211]
    s_add_u32 m0, s55, 8192
    s_nop 0
    buffer_load_dwordx4 v4, s[16:19], s46 offen lds
    v_mfma_f32_16x16x32_bf16 v[232:235], v[136:139], v[132:135], v[232:235]
    s_add_u32 m0, s55, 9216
    s_nop 0
    buffer_load_dwordx4 v5, s[16:19], s46 offen lds
    v_mfma_f32_16x16x32_bf16 v[164:167], v[140:143], v[120:123], v[164:167]
    s_add_u32 m0, s55, 10240
    s_nop 0
    buffer_load_dwordx4 v6, s[16:19], s46 offen lds
    v_mfma_f32_16x16x32_bf16 v[188:191], v[140:143], v[124:127], v[188:191]
    s_add_u32 m0, s55, 11264
    s_nop 0
    buffer_load_dwordx4 v7, s[16:19], s46 offen lds
    v_mfma_f32_16x16x32_bf16 v[212:215], v[140:143], v[128:131], v[212:215]
    s_add_u32 m0, s56, 57344
    s_nop 0
    buffer_load_dwordx4 v8, s[20:23], s47 offen lds
    v_mfma_f32_16x16x32_bf16 v[236:239], v[140:143], v[132:135], v[236:239]
    s_add_u32 m0, s56, 58368
    s_nop 0
    buffer_load_dwordx4 v9, s[20:23], s47 offen lds
    v_mfma_f32_16x16x32_bf16 v[168:171], v[144:147], v[120:123], v[168:171]
    s_add_u32 m0, s56, 59392
    s_nop 0
    buffer_load_dwordx4 v10, s[20:23], s47 offen lds
    v_mfma_f32_16x16x32_bf16 v[192:195], v[144:147], v[124:127], v[192:195]
    s_add_u32 m0, s56, 60416
    s_nop 0
    buffer_load_dwordx4 v11, s[20:23], s47 offen lds
    v_mfma_f32_16x16x32_bf16 v[216:219], v[144:147], v[128:131], v[216:219]
    s_add_u32 m0, s56, 61440
    s_nop 0
    buffer_load_dwordx4 v12, s[20:23], s47 offen lds
    v_mfma_f32_16x16x32_bf16 v[240:243], v[144:147], v[132:135], v[240:243]
    s_add_u32 m0, s56, 62464
    s_nop 0
    buffer_load_dwordx4 v13, s[20:23], s47 offen lds
    v_mfma_f32_16x16x32_bf16 v[172:175], v[148:151], v[120:123], v[172:175]
    v_mfma_f32_16x16x32_bf16 v[196:199], v[148:151], v[124:127], v[196:199]
    v_mfma_f32_16x16x32_bf16 v[220:223], v[148:151], v[128:131], v[220:223]
    v_mfma_f32_16x16x32_bf16 v[244:247], v[148:151], v[132:135], v[244:247]
    v_mfma_f32_16x16x32_bf16 v[176:179], v[152:155], v[120:123], v[176:179]
    v_mfma_f32_16x16x32_bf16 v[200:203], v[152:155], v[124:127], v[200:203]
    v_mfma_f32_16x16x32_bf16 v[224:227], v[152:155], v[128:131], v[224:227]
    v_mfma_f32_16x16x32_bf16 v[248:251], v[152:155], v[132:135], v[248:251]
    v_mfma_f32_16x16x32_bf16 v[180:183], v[156:159], v[120:123], v[180:183]
    v_mfma_f32_16x16x32_bf16 v[204:207], v[156:159], v[124:127], v[204:207]
    v_mfma_f32_16x16x32_bf16 v[228:231], v[156:159], v[128:131], v[228:231]
    v_mfma_f32_16x16x32_bf16 v[252:255], v[156:159], v[132:135], v[252:255]
    s_waitcnt lgkmcnt(0)
    v_mfma_f32_16x16x32_bf16 v[160:163], v[96:99], v[80:83], v[160:163]
    ds_read_b128 v[120:123], v15 offset:16384
    v_mfma_f32_16x16x32_bf16 v[184:187], v[96:99], v[84:87], v[184:187]
    ds_read_b128 v[124:127], v15 offset:18432
    v_mfma_f32_16x16x32_bf16 v[208:211], v[96:99], v[88:91], v[208:211]
    ds_read_b128 v[128:131], v17 offset:16384
    v_mfma_f32_16x16x32_bf16 v[232:235], v[96:99], v[92:95], v[232:235]
    ds_read_b128 v[132:135], v17 offset:18432
    v_mfma_f32_16x16x32_bf16 v[164:167], v[100:103], v[80:83], v[164:167]
    ds_read_b64_tr_b16 v[136:137], v18 offset:36864
    v_mfma_f32_16x16x32_bf16 v[188:191], v[100:103], v[84:87], v[188:191]
    ds_read_b64_tr_b16 v[138:139], v18 offset:38400
    v_mfma_f32_16x16x32_bf16 v[212:215], v[100:103], v[88:91], v[212:215]
    ds_read_b64_tr_b16 v[140:141], v19 offset:36864
    v_mfma_f32_16x16x32_bf16 v[236:239], v[100:103], v[92:95], v[236:239]
    ds_read_b64_tr_b16 v[142:143], v19 offset:38400
    v_mfma_f32_16x16x32_bf16 v[168:171], v[104:107], v[80:83], v[168:171]
    ds_read_b64_tr_b16 v[144:145], v20 offset:36864
    v_mfma_f32_16x16x32_bf16 v[192:195], v[104:107], v[84:87], v[192:195]
    ds_read_b64_tr_b16 v[146:147], v20 offset:38400
    v_mfma_f32_16x16x32_bf16 v[216:219], v[104:107], v[88:91], v[216:219]
    ds_read_b64_tr_b16 v[148:149], v21 offset:36864
    v_mfma_f32_16x16x32_bf16 v[240:243], v[104:107], v[92:95], v[240:243]
    ds_read_b64_tr_b16 v[150:151], v21 offset:38400
    v_mfma_f32_16x16x32_bf16 v[172:175], v[108:111], v[80:83], v[172:175]
    ds_read_b64_tr_b16 v[152:153], v22 offset:36864
    v_mfma_f32_16x16x32_bf16 v[196:199], v[108:111], v[84:87], v[196:199]
    ds_read_b64_tr_b16 v[154:155], v22 offset:38400
    v_mfma_f32_16x16x32_bf16 v[220:223], v[108:111], v[88:91], v[220:223]
    ds_read_b64_tr_b16 v[156:157], v23 offset:36864
    v_mfma_f32_16x16x32_bf16 v[244:247], v[108:111], v[92:95], v[244:247]
    ds_read_b64_tr_b16 v[158:159], v23 offset:38400
    v_mfma_f32_16x16x32_bf16 v[176:179], v[112:115], v[80:83], v[176:179]
    v_mfma_f32_16x16x32_bf16 v[200:203], v[112:115], v[84:87], v[200:203]
    v_mfma_f32_16x16x32_bf16 v[224:227], v[112:115], v[88:91], v[224:227]
    v_mfma_f32_16x16x32_bf16 v[248:251], v[112:115], v[92:95], v[248:251]
    v_mfma_f32_16x16x32_bf16 v[180:183], v[116:119], v[80:83], v[180:183]
    v_mfma_f32_16x16x32_bf16 v[204:207], v[116:119], v[84:87], v[204:207]
    v_mfma_f32_16x16x32_bf16 v[228:231], v[116:119], v[88:91], v[228:231]
    v_mfma_f32_16x16x32_bf16 v[252:255], v[116:119], v[92:95], v[252:255]
    v_mfma_f32_16x16x32_bf16 a[0:3], v[24:27], v[80:83], a[0:3]
    v_mfma_f32_16x16x32_bf16 a[8:11], v[80:83], v[80:83], a[8:11]
    v_mfma_f32_16x16x32_bf16 a[4:7], v[24:27], v[84:87], a[4:7]
    v_mfma_f32_16x16x32_bf16 a[12:15], v[84:87], v[84:87], a[12:15]
    v_mfma_f32_16x16x32_bf16 a[16:19], v[24:27], v[96:99], a[16:19]
    v_mfma_f32_16x16x32_bf16 a[20:23], v[24:27], v[100:103], a[20:23]
    v_mfma_f32_16x16x32_bf16 a[24:27], v[24:27], v[104:107], a[24:27]
    s_waitcnt vmcnt(10) lgkmcnt(0)
    s_barrier
    v_mfma_f32_16x16x32_bf16 a[0:3], v[24:27], v[120:123], a[0:3]
    ds_read_b128 v[80:83], v14 offset:32768
    ds_read_b128 v[84:87], v14 offset:34816
    v_mfma_f32_16x16x32_bf16 a[8:11], v[120:123], v[120:123], a[8:11]
    ds_read_b128 v[88:91], v16 offset:32768
    ds_read_b128 v[92:95], v16 offset:34816
    v_mfma_f32_16x16x32_bf16 a[4:7], v[24:27], v[124:127], a[4:7]
    ds_read_b64_tr_b16 v[96:97], v18 offset:49152
    ds_read_b64_tr_b16 v[98:99], v18 offset:50688
    v_mfma_f32_16x16x32_bf16 a[12:15], v[124:127], v[124:127], a[12:15]
    ds_read_b64_tr_b16 v[100:101], v19 offset:49152
    ds_read_b64_tr_b16 v[102:103], v19 offset:50688
    v_mfma_f32_16x16x32_bf16 a[16:19], v[24:27], v[136:139], a[16:19]
    ds_read_b64_tr_b16 v[104:105], v20 offset:49152
    ds_read_b64_tr_b16 v[106:107], v20 offset:50688
    v_mfma_f32_16x16x32_bf16 a[20:23], v[24:27], v[140:143], a[20:23]
    ds_read_b64_tr_b16 v[108:109], v21 offset:49152
    ds_read_b64_tr_b16 v[110:111], v21 offset:50688
    v_mfma_f32_16x16x32_bf16 a[24:27], v[24:27], v[144:147], a[24:27]
    ds_read_b64_tr_b16 v[112:113], v22 offset:49152
    ds_read_b64_tr_b16 v[114:115], v22 offset:50688
    v_mfma_f32_16x16x32_bf16 v[160:163], v[136:139], v[120:123], v[160:163]
    ds_read_b64_tr_b16 v[116:117], v23 offset:49152
    ds_read_b64_tr_b16 v[118:119], v23 offset:50688
    v_mfma_f32_16x16x32_bf16 v[184:187], v[136:139], v[124:127], v[184:187]
    s_movk_i32 s46, 512
    s_mov_b32 s47, 704512
    v_mfma_f32_16x16x32_bf16 v[208:211], v[136:139], v[128:131], v[208:211]
    s_add_u32 m0, s55, 24576
    s_nop 0
    buffer_load_dwordx4 v4, s[16:19], s46 offen lds
    v_mfma_f32_16x16x32_bf16 v[232:235], v[136:139], v[132:135], v[232:235]
    s_add_u32 m0, s55, 25600
    s_nop 0
    buffer_load_dwordx4 v5, s[16:19], s46 offen lds
    v_mfma_f32_16x16x32_bf16 v[164:167], v[140:143], v[120:123], v[164:167]
    s_add_u32 m0, s55, 26624
    s_nop 0
    buffer_load_dwordx4 v6, s[16:19], s46 offen lds
    v_mfma_f32_16x16x32_bf16 v[188:191], v[140:143], v[124:127], v[188:191]
    s_add_u32 m0, s55, 27648
    s_nop 0
    buffer_load_dwordx4 v7, s[16:19], s46 offen lds
    v_mfma_f32_16x16x32_bf16 v[212:215], v[140:143], v[128:131], v[212:215]
    s_add_u32 m0, s56, 81920
    s_nop 0
    buffer_load_dwordx4 v8, s[20:23], s47 offen lds
    v_mfma_f32_16x16x32_bf16 v[236:239], v[140:143], v[132:135], v[236:239]
    s_add_u32 m0, s56, 82944
    s_nop 0
    buffer_load_dwordx4 v9, s[20:23], s47 offen lds
    v_mfma_f32_16x16x32_bf16 v[168:171], v[144:147], v[120:123], v[168:171]
    s_add_u32 m0, s56, 83968
    s_nop 0
    buffer_load_dwordx4 v10, s[20:23], s47 offen lds
    v_mfma_f32_16x16x32_bf16 v[192:195], v[144:147], v[124:127], v[192:195]
    s_add_u32 m0, s56, 84992
    s_nop 0
    buffer_load_dwordx4 v11, s[20:23], s47 offen lds
    v_mfma_f32_16x16x32_bf16 v[216:219], v[144:147], v[128:131], v[216:219]
    s_add_u32 m0, s56, 86016
    s_nop 0
    buffer_load_dwordx4 v12, s[20:23], s47 offen lds
    v_mfma_f32_16x16x32_bf16 v[240:243], v[144:147], v[132:135], v[240:243]
    s_add_u32 m0, s56, 87040
    s_nop 0
    buffer_load_dwordx4 v13, s[20:23], s47 offen lds
    v_mfma_f32_16x16x32_bf16 v[172:175], v[148:151], v[120:123], v[172:175]
    v_mfma_f32_16x16x32_bf16 v[196:199], v[148:151], v[124:127], v[196:199]
    v_mfma_f32_16x16x32_bf16 v[220:223], v[148:151], v[128:131], v[220:223]
    v_mfma_f32_16x16x32_bf16 v[244:247], v[148:151], v[132:135], v[244:247]
    v_mfma_f32_16x16x32_bf16 v[176:179], v[152:155], v[120:123], v[176:179]
    v_mfma_f32_16x16x32_bf16 v[200:203], v[152:155], v[124:127], v[200:203]
    v_mfma_f32_16x16x32_bf16 v[224:227], v[152:155], v[128:131], v[224:227]
    v_mfma_f32_16x16x32_bf16 v[248:251], v[152:155], v[132:135], v[248:251]
    v_mfma_f32_16x16x32_bf16 v[180:183], v[156:159], v[120:123], v[180:183]
    v_mfma_f32_16x16x32_bf16 v[204:207], v[156:159], v[124:127], v[204:207]
    v_mfma_f32_16x16x32_bf16 v[228:231], v[156:159], v[128:131], v[228:231]
    v_mfma_f32_16x16x32_bf16 v[252:255], v[156:159], v[132:135], v[252:255]
    s_waitcnt lgkmcnt(0)
    v_mfma_f32_16x16x32_bf16 v[160:163], v[96:99], v[80:83], v[160:163]
    ds_read_b128 v[120:123], v15 offset:32768
    v_mfma_f32_16x16x32_bf16 v[184:187], v[96:99], v[84:87], v[184:187]
    ds_read_b128 v[124:127], v15 offset:34816
    v_mfma_f32_16x16x32_bf16 v[208:211], v[96:99], v[88:91], v[208:211]
    ds_read_b128 v[128:131], v17 offset:32768
    v_mfma_f32_16x16x32_bf16 v[232:235], v[96:99], v[92:95], v[232:235]
    ds_read_b128 v[132:135], v17 offset:34816
    v_mfma_f32_16x16x32_bf16 v[164:167], v[100:103], v[80:83], v[164:167]
    ds_read_b64_tr_b16 v[136:137], v18 offset:61440
    v_mfma_f32_16x16x32_bf16 v[188:191], v[100:103], v[84:87], v[188:191]
    ds_read_b64_tr_b16 v[138:139], v18 offset:62976
    v_mfma_f32_16x16x32_bf16 v[212:215], v[100:103], v[88:91], v[212:215]
    ds_read_b64_tr_b16 v[140:141], v19 offset:61440
    v_mfma_f32_16x16x32_bf16 v[236:239], v[100:103], v[92:95], v[236:239]
    ds_read_b64_tr_b16 v[142:143], v19 offset:62976
    v_mfma_f32_16x16x32_bf16 v[168:171], v[104:107], v[80:83], v[168:171]
    ds_read_b64_tr_b16 v[144:145], v20 offset:61440
    v_mfma_f32_16x16x32_bf16 v[192:195], v[104:107], v[84:87], v[192:195]
    ds_read_b64_tr_b16 v[146:147], v20 offset:62976
    v_mfma_f32_16x16x32_bf16 v[216:219], v[104:107], v[88:91], v[216:219]
    ds_read_b64_tr_b16 v[148:149], v21 offset:61440
    v_mfma_f32_16x16x32_bf16 v[240:243], v[104:107], v[92:95], v[240:243]
    ds_read_b64_tr_b16 v[150:151], v21 offset:62976
    v_mfma_f32_16x16x32_bf16 v[172:175], v[108:111], v[80:83], v[172:175]
    ds_read_b64_tr_b16 v[152:153], v22 offset:61440
    v_mfma_f32_16x16x32_bf16 v[196:199], v[108:111], v[84:87], v[196:199]
    ds_read_b64_tr_b16 v[154:155], v22 offset:62976
    v_mfma_f32_16x16x32_bf16 v[220:223], v[108:111], v[88:91], v[220:223]
    ds_read_b64_tr_b16 v[156:157], v23 offset:61440
    v_mfma_f32_16x16x32_bf16 v[244:247], v[108:111], v[92:95], v[244:247]
    ds_read_b64_tr_b16 v[158:159], v23 offset:62976
    v_mfma_f32_16x16x32_bf16 v[176:179], v[112:115], v[80:83], v[176:179]
    v_mfma_f32_16x16x32_bf16 v[200:203], v[112:115], v[84:87], v[200:203]
    v_mfma_f32_16x16x32_bf16 v[224:227], v[112:115], v[88:91], v[224:227]
    v_mfma_f32_16x16x32_bf16 v[248:251], v[112:115], v[92:95], v[248:251]
    v_mfma_f32_16x16x32_bf16 v[180:183], v[116:119], v[80:83], v[180:183]
    v_mfma_f32_16x16x32_bf16 v[204:207], v[116:119], v[84:87], v[204:207]
    v_mfma_f32_16x16x32_bf16 v[228:231], v[116:119], v[88:91], v[228:231]
    v_mfma_f32_16x16x32_bf16 v[252:255], v[116:119], v[92:95], v[252:255]
    v_mfma_f32_16x16x32_bf16 a[0:3], v[24:27], v[80:83], a[0:3]
    v_mfma_f32_16x16x32_bf16 a[8:11], v[80:83], v[80:83], a[8:11]
    v_mfma_f32_16x16x32_bf16 a[4:7], v[24:27], v[84:87], a[4:7]
    v_mfma_f32_16x16x32_bf16 a[12:15], v[84:87], v[84:87], a[12:15]
    v_mfma_f32_16x16x32_bf16 a[16:19], v[24:27], v[96:99], a[16:19]
    v_mfma_f32_16x16x32_bf16 a[20:23], v[24:27], v[100:103], a[20:23]
    v_mfma_f32_16x16x32_bf16 a[24:27], v[24:27], v[104:107], a[24:27]
    s_waitcnt vmcnt(10) lgkmcnt(0)
    s_barrier
    v_mfma_f32_16x16x32_bf16 a[0:3], v[24:27], v[120:123], a[0:3]
    ds_read_b128 v[80:83], v14 offset:0
    ds_read_b128 v[84:87], v14 offset:2048
    v_mfma_f32_16x16x32_bf16 a[8:11], v[120:123], v[120:123], a[8:11]
    ds_read_b128 v[88:91], v16 offset:0
    ds_read_b128 v[92:95], v16 offset:2048
    v_mfma_f32_16x16x32_bf16 a[4:7], v[24:27], v[124:127], a[4:7]
    ds_read_b64_tr_b16 v[96:97], v18 offset:0
    ds_read_b64_tr_b16 v[98:99], v18 offset:1536
    v_mfma_f32_16x16x32_bf16 a[12:15], v[124:127], v[124:127], a[12:15]
    ds_read_b64_tr_b16 v[100:101], v19 offset:0
    ds_read_b64_tr_b16 v[102:103], v19 offset:1536
    v_mfma_f32_16x16x32_bf16 a[16:19], v[24:27], v[136:139], a[16:19]
    ds_read_b64_tr_b16 v[104:105], v20 offset:0
    ds_read_b64_tr_b16 v[106:107], v20 offset:1536
    v_mfma_f32_16x16x32_bf16 a[20:23], v[24:27], v[140:143], a[20:23]
    ds_read_b64_tr_b16 v[108:109], v21 offset:0
    ds_read_b64_tr_b16 v[110:111], v21 offset:1536
    v_mfma_f32_16x16x32_bf16 a[24:27], v[24:27], v[144:147], a[24:27]
    ds_read_b64_tr_b16 v[112:113], v22 offset:0
    ds_read_b64_tr_b16 v[114:115], v22 offset:1536
    v_mfma_f32_16x16x32_bf16 v[160:163], v[136:139], v[120:123], v[160:163]
    ds_read_b64_tr_b16 v[116:117], v23 offset:0
    ds_read_b64_tr_b16 v[118:119], v23 offset:1536
    v_mfma_f32_16x16x32_bf16 v[184:187], v[136:139], v[124:127], v[184:187]
    s_movk_i32 s46, 640
    s_mov_b32 s47, 880640
    v_mfma_f32_16x16x32_bf16 v[208:211], v[136:139], v[128:131], v[208:211]
    s_add_u32 m0, s55, 40960
    s_nop 0
    buffer_load_dwordx4 v4, s[16:19], s46 offen lds
    v_mfma_f32_16x16x32_bf16 v[232:235], v[136:139], v[132:135], v[232:235]
    s_add_u32 m0, s55, 41984
    s_nop 0
    buffer_load_dwordx4 v5, s[16:19], s46 offen lds
    v_mfma_f32_16x16x32_bf16 v[164:167], v[140:143], v[120:123], v[164:167]
    s_add_u32 m0, s55, 43008
    s_nop 0
    buffer_load_dwordx4 v6, s[16:19], s46 offen lds
    v_mfma_f32_16x16x32_bf16 v[188:191], v[140:143], v[124:127], v[188:191]
    s_add_u32 m0, s55, 44032
    s_nop 0
    buffer_load_dwordx4 v7, s[16:19], s46 offen lds
    v_mfma_f32_16x16x32_bf16 v[212:215], v[140:143], v[128:131], v[212:215]
    s_add_u32 m0, s56, 106496
    s_nop 0
    buffer_load_dwordx4 v8, s[20:23], s47 offen lds
    v_mfma_f32_16x16x32_bf16 v[236:239], v[140:143], v[132:135], v[236:239]
    s_add_u32 m0, s56, 107520
    s_nop 0
    buffer_load_dwordx4 v9, s[20:23], s47 offen lds
    v_mfma_f32_16x16x32_bf16 v[168:171], v[144:147], v[120:123], v[168:171]
    s_add_u32 m0, s56, 108544
    s_nop 0
    buffer_load_dwordx4 v10, s[20:23], s47 offen lds
    v_mfma_f32_16x16x32_bf16 v[192:195], v[144:147], v[124:127], v[192:195]
    s_add_u32 m0, s56, 109568
    s_nop 0
    buffer_load_dwordx4 v11, s[20:23], s47 offen lds
    v_mfma_f32_16x16x32_bf16 v[216:219], v[144:147], v[128:131], v[216:219]
    s_add_u32 m0, s56, 110592
    s_nop 0
    buffer_load_dwordx4 v12, s[20:23], s47 offen lds
    v_mfma_f32_16x16x32_bf16 v[240:243], v[144:147], v[132:135], v[240:243]
    s_add_u32 m0, s56, 111616
    s_nop 0
    buffer_load_dwordx4 v13, s[20:23], s47 offen lds
    v_mfma_f32_16x16x32_bf16 v[172:175], v[148:151], v[120:123], v[172:175]
    v_mfma_f32_16x16x32_bf16 v[196:199], v[148:151], v[124:127], v[196:199]
    v_mfma_f32_16x16x32_bf16 v[220:223], v[148:151], v[128:131], v[220:223]
    v_mfma_f32_16x16x32_bf16 v[244:247], v[148:151], v[132:135], v[244:247]
    v_mfma_f32_16x16x32_bf16 v[176:179], v[152:155], v[120:123], v[176:179]
    v_mfma_f32_16x16x32_bf16 v[200:203], v[152:155], v[124:127], v[200:203]
    v_mfma_f32_16x16x32_bf16 v[224:227], v[152:155], v[128:131], v[224:227]
    v_mfma_f32_16x16x32_bf16 v[248:251], v[152:155], v[132:135], v[248:251]
    v_mfma_f32_16x16x32_bf16 v[180:183], v[156:159], v[120:123], v[180:183]
    v_mfma_f32_16x16x32_bf16 v[204:207], v[156:159], v[124:127], v[204:207]
    v_mfma_f32_16x16x32_bf16 v[228:231], v[156:159], v[128:131], v[228:231]
    v_mfma_f32_16x16x32_bf16 v[252:255], v[156:159], v[132:135], v[252:255]
    s_waitcnt lgkmcnt(0)
    v_mfma_f32_16x16x32_bf16 v[160:163], v[96:99], v[80:83], v[160:163]
    ds_read_b128 v[120:123], v15 offset:0
    v_mfma_f32_16x16x32_bf16 v[184:187], v[96:99], v[84:87], v[184:187]
    ds_read_b128 v[124:127], v15 offset:2048
    v_mfma_f32_16x16x32_bf16 v[208:211], v[96:99], v[88:91], v[208:211]
    ds_read_b128 v[128:131], v17 offset:0
    v_mfma_f32_16x16x32_bf16 v[232:235], v[96:99], v[92:95], v[232:235]
    ds_read_b128 v[132:135], v17 offset:2048
    v_mfma_f32_16x16x32_bf16 v[164:167], v[100:103], v[80:83], v[164:167]
    ds_read_b64_tr_b16 v[136:137], v18 offset:12288
    v_mfma_f32_16x16x32_bf16 v[188:191], v[100:103], v[84:87], v[188:191]
    ds_read_b64_tr_b16 v[138:139], v18 offset:13824
    v_mfma_f32_16x16x32_bf16 v[212:215], v[100:103], v[88:91], v[212:215]
    ds_read_b64_tr_b16 v[140:141], v19 offset:12288
    v_mfma_f32_16x16x32_bf16 v[236:239], v[100:103], v[92:95], v[236:239]
    ds_read_b64_tr_b16 v[142:143], v19 offset:13824
    v_mfma_f32_16x16x32_bf16 v[168:171], v[104:107], v[80:83], v[168:171]
    ds_read_b64_tr_b16 v[144:145], v20 offset:12288
    v_mfma_f32_16x16x32_bf16 v[192:195], v[104:107], v[84:87], v[192:195]
    ds_read_b64_tr_b16 v[146:147], v20 offset:13824
    v_mfma_f32_16x16x32_bf16 v[216:219], v[104:107], v[88:91], v[216:219]
    ds_read_b64_tr_b16 v[148:149], v21 offset:12288
    v_mfma_f32_16x16x32_bf16 v[240:243], v[104:107], v[92:95], v[240:243]
    ds_read_b64_tr_b16 v[150:151], v21 offset:13824
    v_mfma_f32_16x16x32_bf16 v[172:175], v[108:111], v[80:83], v[172:175]
    ds_read_b64_tr_b16 v[152:153], v22 offset:12288
    v_mfma_f32_16x16x32_bf16 v[196:199], v[108:111], v[84:87], v[196:199]
    ds_read_b64_tr_b16 v[154:155], v22 offset:13824
    v_mfma_f32_16x16x32_bf16 v[220:223], v[108:111], v[88:91], v[220:223]
    ds_read_b64_tr_b16 v[156:157], v23 offset:12288
    v_mfma_f32_16x16x32_bf16 v[244:247], v[108:111], v[92:95], v[244:247]
    ds_read_b64_tr_b16 v[158:159], v23 offset:13824
    v_mfma_f32_16x16x32_bf16 v[176:179], v[112:115], v[80:83], v[176:179]
    v_mfma_f32_16x16x32_bf16 v[200:203], v[112:115], v[84:87], v[200:203]
    v_mfma_f32_16x16x32_bf16 v[224:227], v[112:115], v[88:91], v[224:227]
    v_mfma_f32_16x16x32_bf16 v[248:251], v[112:115], v[92:95], v[248:251]
    v_mfma_f32_16x16x32_bf16 v[180:183], v[116:119], v[80:83], v[180:183]
    v_mfma_f32_16x16x32_bf16 v[204:207], v[116:119], v[84:87], v[204:207]
    v_mfma_f32_16x16x32_bf16 v[228:231], v[116:119], v[88:91], v[228:231]
    v_mfma_f32_16x16x32_bf16 v[252:255], v[116:119], v[92:95], v[252:255]
    v_mfma_f32_16x16x32_bf16 a[0:3], v[24:27], v[80:83], a[0:3]
    v_mfma_f32_16x16x32_bf16 a[8:11], v[80:83], v[80:83], a[8:11]
    v_mfma_f32_16x16x32_bf16 a[4:7], v[24:27], v[84:87], a[4:7]
    v_mfma_f32_16x16x32_bf16 a[12:15], v[84:87], v[84:87], a[12:15]
    v_mfma_f32_16x16x32_bf16 a[16:19], v[24:27], v[96:99], a[16:19]
    v_mfma_f32_16x16x32_bf16 a[20:23], v[24:27], v[100:103], a[20:23]
    v_mfma_f32_16x16x32_bf16 a[24:27], v[24:27], v[104:107], a[24:27]
    s_waitcnt vmcnt(10) lgkmcnt(0)
    s_barrier
    v_mfma_f32_16x16x32_bf16 a[0:3], v[24:27], v[120:123], a[0:3]
    ds_read_b128 v[80:83], v14 offset:16384
    ds_read_b128 v[84:87], v14 offset:18432
    v_mfma_f32_16x16x32_bf16 a[8:11], v[120:123], v[120:123], a[8:11]
    ds_read_b128 v[88:91], v16 offset:16384
    ds_read_b128 v[92:95], v16 offset:18432
    v_mfma_f32_16x16x32_bf16 a[4:7], v[24:27], v[124:127], a[4:7]
    ds_read_b64_tr_b16 v[96:97], v18 offset:24576
    ds_read_b64_tr_b16 v[98:99], v18 offset:26112
    v_mfma_f32_16x16x32_bf16 a[12:15], v[124:127], v[124:127], a[12:15]
    ds_read_b64_tr_b16 v[100:101], v19 offset:24576
    ds_read_b64_tr_b16 v[102:103], v19 offset:26112
    v_mfma_f32_16x16x32_bf16 a[16:19], v[24:27], v[136:139], a[16:19]
    ds_read_b64_tr_b16 v[104:105], v20 offset:24576
    ds_read_b64_tr_b16 v[106:107], v20 offset:26112
    v_mfma_f32_16x16x32_bf16 a[20:23], v[24:27], v[140:143], a[20:23]
    ds_read_b64_tr_b16 v[108:109], v21 offset:24576
    ds_read_b64_tr_b16 v[110:111], v21 offset:26112
    v_mfma_f32_16x16x32_bf16 a[24:27], v[24:27], v[144:147], a[24:27]
    ds_read_b64_tr_b16 v[112:113], v22 offset:24576
    ds_read_b64_tr_b16 v[114:115], v22 offset:26112
    v_mfma_f32_16x16x32_bf16 v[160:163], v[136:139], v[120:123], v[160:163]
    ds_read_b64_tr_b16 v[116:117], v23 offset:24576
    ds_read_b64_tr_b16 v[118:119], v23 offset:26112
    v_mfma_f32_16x16x32_bf16 v[184:187], v[136:139], v[124:127], v[184:187]
    s_movk_i32 s46, 768
    s_mov_b32 s47, 1056768
    v_mfma_f32_16x16x32_bf16 v[208:211], v[136:139], v[128:131], v[208:211]
    s_add_u32 m0, s55, 8192
    s_nop 0
    buffer_load_dwordx4 v4, s[16:19], s46 offen lds
    v_mfma_f32_16x16x32_bf16 v[232:235], v[136:139], v[132:135], v[232:235]
    s_add_u32 m0, s55, 9216
    s_nop 0
    buffer_load_dwordx4 v5, s[16:19], s46 offen lds
    v_mfma_f32_16x16x32_bf16 v[164:167], v[140:143], v[120:123], v[164:167]
    s_add_u32 m0, s55, 10240
    s_nop 0
    buffer_load_dwordx4 v6, s[16:19], s46 offen lds
    v_mfma_f32_16x16x32_bf16 v[188:191], v[140:143], v[124:127], v[188:191]
    s_add_u32 m0, s55, 11264
    s_nop 0
    buffer_load_dwordx4 v7, s[16:19], s46 offen lds
    v_mfma_f32_16x16x32_bf16 v[212:215], v[140:143], v[128:131], v[212:215]
    s_add_u32 m0, s56, 57344
    s_nop 0
    buffer_load_dwordx4 v8, s[20:23], s47 offen lds
    v_mfma_f32_16x16x32_bf16 v[236:239], v[140:143], v[132:135], v[236:239]
    s_add_u32 m0, s56, 58368
    s_nop 0
    buffer_load_dwordx4 v9, s[20:23], s47 offen lds
    v_mfma_f32_16x16x32_bf16 v[168:171], v[144:147], v[120:123], v[168:171]
    s_add_u32 m0, s56, 59392
    s_nop 0
    buffer_load_dwordx4 v10, s[20:23], s47 offen lds
    v_mfma_f32_16x16x32_bf16 v[192:195], v[144:147], v[124:127], v[192:195]
    s_add_u32 m0, s56, 60416
    s_nop 0
    buffer_load_dwordx4 v11, s[20:23], s47 offen lds
    v_mfma_f32_16x16x32_bf16 v[216:219], v[144:147], v[128:131], v[216:219]
    s_add_u32 m0, s56, 61440
    s_nop 0
    buffer_load_dwordx4 v12, s[20:23], s47 offen lds
    v_mfma_f32_16x16x32_bf16 v[240:243], v[144:147], v[132:135], v[240:243]
    s_add_u32 m0, s56, 62464
    s_nop 0
    buffer_load_dwordx4 v13, s[20:23], s47 offen lds
    v_mfma_f32_16x16x32_bf16 v[172:175], v[148:151], v[120:123], v[172:175]
    v_mfma_f32_16x16x32_bf16 v[196:199], v[148:151], v[124:127], v[196:199]
    v_mfma_f32_16x16x32_bf16 v[220:223], v[148:151], v[128:131], v[220:223]
    v_mfma_f32_16x16x32_bf16 v[244:247], v[148:151], v[132:135], v[244:247]
    v_mfma_f32_16x16x32_bf16 v[176:179], v[152:155], v[120:123], v[176:179]
    v_mfma_f32_16x16x32_bf16 v[200:203], v[152:155], v[124:127], v[200:203]
    v_mfma_f32_16x16x32_bf16 v[224:227], v[152:155], v[128:131], v[224:227]
    v_mfma_f32_16x16x32_bf16 v[248:251], v[152:155], v[132:135], v[248:251]
    v_mfma_f32_16x16x32_bf16 v[180:183], v[156:159], v[120:123], v[180:183]
    v_mfma_f32_16x16x32_bf16 v[204:207], v[156:159], v[124:127], v[204:207]
    v_mfma_f32_16x16x32_bf16 v[228:231], v[156:159], v[128:131], v[228:231]
    v_mfma_f32_16x16x32_bf16 v[252:255], v[156:159], v[132:135], v[252:255]
    s_waitcnt lgkmcnt(0)
    v_mfma_f32_16x16x32_bf16 v[160:163], v[96:99], v[80:83], v[160:163]
    ds_read_b128 v[120:123], v15 offset:16384
    v_mfma_f32_16x16x32_bf16 v[184:187], v[96:99], v[84:87], v[184:187]
    ds_read_b128 v[124:127], v15 offset:18432
    v_mfma_f32_16x16x32_bf16 v[208:211], v[96:99], v[88:91], v[208:211]
    ds_read_b128 v[128:131], v17 offset:16384
    v_mfma_f32_16x16x32_bf16 v[232:235], v[96:99], v[92:95], v[232:235]
    ds_read_b128 v[132:135], v17 offset:18432
    v_mfma_f32_16x16x32_bf16 v[164:167], v[100:103], v[80:83], v[164:167]
    ds_read_b64_tr_b16 v[136:137], v18 offset:36864
    v_mfma_f32_16x16x32_bf16 v[188:191], v[100:103], v[84:87], v[188:191]
    ds_read_b64_tr_b16 v[138:139], v18 offset:38400
    v_mfma_f32_16x16x32_bf16 v[212:215], v[100:103], v[88:91], v[212:215]
    ds_read_b64_tr_b16 v[140:141], v19 offset:36864
    v_mfma_f32_16x16x32_bf16 v[236:239], v[100:103], v[92:95], v[236:239]
    ds_read_b64_tr_b16 v[142:143], v19 offset:38400
    v_mfma_f32_16x16x32_bf16 v[168:171], v[104:107], v[80:83], v[168:171]
    ds_read_b64_tr_b16 v[144:145], v20 offset:36864
    v_mfma_f32_16x16x32_bf16 v[192:195], v[104:107], v[84:87], v[192:195]
    ds_read_b64_tr_b16 v[146:147], v20 offset:38400
    v_mfma_f32_16x16x32_bf16 v[216:219], v[104:107], v[88:91], v[216:219]
    ds_read_b64_tr_b16 v[148:149], v21 offset:36864
    v_mfma_f32_16x16x32_bf16 v[240:243], v[104:107], v[92:95], v[240:243]
    ds_read_b64_tr_b16 v[150:151], v21 offset:38400
    v_mfma_f32_16x16x32_bf16 v[172:175], v[108:111], v[80:83], v[172:175]
    ds_read_b64_tr_b16 v[152:153], v22 offset:36864
    v_mfma_f32_16x16x32_bf16 v[196:199], v[108:111], v[84:87], v[196:199]
    ds_read_b64_tr_b16 v[154:155], v22 offset:38400
    v_mfma_f32_16x16x32_bf16 v[220:223], v[108:111], v[88:91], v[220:223]
    ds_read_b64_tr_b16 v[156:157], v23 offset:36864
    v_mfma_f32_16x16x32_bf16 v[244:247], v[108:111], v[92:95], v[244:247]
    ds_read_b64_tr_b16 v[158:159], v23 offset:38400
    v_mfma_f32_16x16x32_bf16 v[176:179], v[112:115], v[80:83], v[176:179]
    v_mfma_f32_16x16x32_bf16 v[200:203], v[112:115], v[84:87], v[200:203]
    v_mfma_f32_16x16x32_bf16 v[224:227], v[112:115], v[88:91], v[224:227]
    v_mfma_f32_16x16x32_bf16 v[248:251], v[112:115], v[92:95], v[248:251]
    v_mfma_f32_16x16x32_bf16 v[180:183], v[116:119], v[80:83], v[180:183]
    v_mfma_f32_16x16x32_bf16 v[204:207], v[116:119], v[84:87], v[204:207]
    v_mfma_f32_16x16x32_bf16 v[228:231], v[116:119], v[88:91], v[228:231]
    v_mfma_f32_16x16x32_bf16 v[252:255], v[116:119], v[92:95], v[252:255]
    v_mfma_f32_16x16x32_bf16 a[0:3], v[24:27], v[80:83], a[0:3]
    v_mfma_f32_16x16x32_bf16 a[8:11], v[80:83], v[80:83], a[8:11]
    v_mfma_f32_16x16x32_bf16 a[4:7], v[24:27], v[84:87], a[4:7]
    v_mfma_f32_16x16x32_bf16 a[12:15], v[84:87], v[84:87], a[12:15]
    v_mfma_f32_16x16x32_bf16 a[16:19], v[24:27], v[96:99], a[16:19]
    v_mfma_f32_16x16x32_bf16 a[20:23], v[24:27], v[100:103], a[20:23]
    v_mfma_f32_16x16x32_bf16 a[24:27], v[24:27], v[104:107], a[24:27]
    s_waitcnt vmcnt(10) lgkmcnt(0)
    s_barrier
    v_mfma_f32_16x16x32_bf16 a[0:3], v[24:27], v[120:123], a[0:3]
    ds_read_b128 v[80:83], v14 offset:32768
    ds_read_b128 v[84:87], v14 offset:34816
    v_mfma_f32_16x16x32_bf16 a[8:11], v[120:123], v[120:123], a[8:11]
    ds_read_b128 v[88:91], v16 offset:32768
    ds_read_b128 v[92:95], v16 offset:34816
    v_mfma_f32_16x16x32_bf16 a[4:7], v[24:27], v[124:127], a[4:7]
    ds_read_b64_tr_b16 v[96:97], v18 offset:49152
    ds_read_b64_tr_b16 v[98:99], v18 offset:50688
    v_mfma_f32_16x16x32_bf16 a[12:15], v[124:127], v[124:127], a[12:15]
    ds_read_b64_tr_b16 v[100:101], v19 offset:49152
    ds_read_b64_tr_b16 v[102:103], v19 offset:50688
    v_mfma_f32_16x16x32_bf16 a[16:19], v[24:27], v[136:139], a[16:19]
    ds_read_b64_tr_b16 v[104:105], v20 offset:49152
    ds_read_b64_tr_b16 v[106:107], v20 offset:50688
    v_mfma_f32_16x16x32_bf16 a[20:23], v[24:27], v[140:143], a[20:23]
    ds_read_b64_tr_b16 v[108:109], v21 offset:49152
    ds_read_b64_tr_b16 v[110:111], v21 offset:50688
    v_mfma_f32_16x16x32_bf16 a[24:27], v[24:27], v[144:147], a[24:27]
    ds_read_b64_tr_b16 v[112:113], v22 offset:49152
    ds_read_b64_tr_b16 v[114:115], v22 offset:50688
    v_mfma_f32_16x16x32_bf16 v[160:163], v[136:139], v[120:123], v[160:163]
    ds_read_b64_tr_b16 v[116:117], v23 offset:49152
    ds_read_b64_tr_b16 v[118:119], v23 offset:50688
    v_mfma_f32_16x16x32_bf16 v[184:187], v[136:139], v[124:127], v[184:187]
    s_movk_i32 s46, 896
    s_mov_b32 s47, 1232896
    v_mfma_f32_16x16x32_bf16 v[208:211], v[136:139], v[128:131], v[208:211]
    s_add_u32 m0, s55, 24576
    s_nop 0
    buffer_load_dwordx4 v4, s[16:19], s46 offen lds
    v_mfma_f32_16x16x32_bf16 v[232:235], v[136:139], v[132:135], v[232:235]
    s_add_u32 m0, s55, 25600
    s_nop 0
    buffer_load_dwordx4 v5, s[16:19], s46 offen lds
    v_mfma_f32_16x16x32_bf16 v[164:167], v[140:143], v[120:123], v[164:167]
    s_add_u32 m0, s55, 26624
    s_nop 0
    buffer_load_dwordx4 v6, s[16:19], s46 offen lds
    v_mfma_f32_16x16x32_bf16 v[188:191], v[140:143], v[124:127], v[188:191]
    s_add_u32 m0, s55, 27648
    s_nop 0
    buffer_load_dwordx4 v7, s[16:19], s46 offen lds
    v_mfma_f32_16x16x32_bf16 v[212:215], v[140:143], v[128:131], v[212:215]
    s_add_u32 m0, s56, 81920
    s_nop 0
    buffer_load_dwordx4 v8, s[20:23], s47 offen lds
    v_mfma_f32_16x16x32_bf16 v[236:239], v[140:143], v[132:135], v[236:239]
    s_add_u32 m0, s56, 82944
    s_nop 0
    buffer_load_dwordx4 v9, s[20:23], s47 offen lds
    v_mfma_f32_16x16x32_bf16 v[168:171], v[144:147], v[120:123], v[168:171]
    s_add_u32 m0, s56, 83968
    s_nop 0
    buffer_load_dwordx4 v10, s[20:23], s47 offen lds
    v_mfma_f32_16x16x32_bf16 v[192:195], v[144:147], v[124:127], v[192:195]
    s_add_u32 m0, s56, 84992
    s_nop 0
    buffer_load_dwordx4 v11, s[20:23], s47 offen lds
    v_mfma_f32_16x16x32_bf16 v[216:219], v[144:147], v[128:131], v[216:219]
    s_add_u32 m0, s56, 86016
    s_nop 0
    buffer_load_dwordx4 v12, s[20:23], s47 offen lds
    v_mfma_f32_16x16x32_bf16 v[240:243], v[144:147], v[132:135], v[240:243]
    s_add_u32 m0, s56, 87040
    s_nop 0
    buffer_load_dwordx4 v13, s[20:23], s47 offen lds
    v_mfma_f32_16x16x32_bf16 v[172:175], v[148:151], v[120:123], v[172:175]
    v_mfma_f32_16x16x32_bf16 v[196:199], v[148:151], v[124:127], v[196:199]
    v_mfma_f32_16x16x32_bf16 v[220:223], v[148:151], v[128:131], v[220:223]
    v_mfma_f32_16x16x32_bf16 v[244:247], v[148:151], v[132:135], v[244:247]
    v_mfma_f32_16x16x32_bf16 v[176:179], v[152:155], v[120:123], v[176:179]
    v_mfma_f32_16x16x32_bf16 v[200:203], v[152:155], v[124:127], v[200:203]
    v_mfma_f32_16x16x32_bf16 v[224:227], v[152:155], v[128:131], v[224:227]
    v_mfma_f32_16x16x32_bf16 v[248:251], v[152:155], v[132:135], v[248:251]
    v_mfma_f32_16x16x32_bf16 v[180:183], v[156:159], v[120:123], v[180:183]
    v_mfma_f32_16x16x32_bf16 v[204:207], v[156:159], v[124:127], v[204:207]
    v_mfma_f32_16x16x32_bf16 v[228:231], v[156:159], v[128:131], v[228:231]
    v_mfma_f32_16x16x32_bf16 v[252:255], v[156:159], v[132:135], v[252:255]
    s_waitcnt lgkmcnt(0)
    v_mfma_f32_16x16x32_bf16 v[160:163], v[96:99], v[80:83], v[160:163]
    ds_read_b128 v[120:123], v15 offset:32768
    v_mfma_f32_16x16x32_bf16 v[184:187], v[96:99], v[84:87], v[184:187]
    ds_read_b128 v[124:127], v15 offset:34816
    v_mfma_f32_16x16x32_bf16 v[208:211], v[96:99], v[88:91], v[208:211]
    ds_read_b128 v[128:131], v17 offset:32768
    v_mfma_f32_16x16x32_bf16 v[232:235], v[96:99], v[92:95], v[232:235]
    ds_read_b128 v[132:135], v17 offset:34816
    v_mfma_f32_16x16x32_bf16 v[164:167], v[100:103], v[80:83], v[164:167]
    ds_read_b64_tr_b16 v[136:137], v18 offset:61440
    v_mfma_f32_16x16x32_bf16 v[188:191], v[100:103], v[84:87], v[188:191]
    ds_read_b64_tr_b16 v[138:139], v18 offset:62976
    v_mfma_f32_16x16x32_bf16 v[212:215], v[100:103], v[88:91], v[212:215]
    ds_read_b64_tr_b16 v[140:141], v19 offset:61440
    v_mfma_f32_16x16x32_bf16 v[236:239], v[100:103], v[92:95], v[236:239]
    ds_read_b64_tr_b16 v[142:143], v19 offset:62976
    v_mfma_f32_16x16x32_bf16 v[168:171], v[104:107], v[80:83], v[168:171]
    ds_read_b64_tr_b16 v[144:145], v20 offset:61440
    v_mfma_f32_16x16x32_bf16 v[192:195], v[104:107], v[84:87], v[192:195]
    ds_read_b64_tr_b16 v[146:147], v20 offset:62976
    v_mfma_f32_16x16x32_bf16 v[216:219], v[104:107], v[88:91], v[216:219]
    ds_read_b64_tr_b16 v[148:149], v21 offset:61440
    v_mfma_f32_16x16x32_bf16 v[240:243], v[104:107], v[92:95], v[240:243]
    ds_read_b64_tr_b16 v[150:151], v21 offset:62976
    v_mfma_f32_16x16x32_bf16 v[172:175], v[108:111], v[80:83], v[172:175]
    ds_read_b64_tr_b16 v[152:153], v22 offset:61440
    v_mfma_f32_16x16x32_bf16 v[196:199], v[108:111], v[84:87], v[196:199]
    ds_read_b64_tr_b16 v[154:155], v22 offset:62976
    v_mfma_f32_16x16x32_bf16 v[220:223], v[108:111], v[88:91], v[220:223]
    ds_read_b64_tr_b16 v[156:157], v23 offset:61440
    v_mfma_f32_16x16x32_bf16 v[244:247], v[108:111], v[92:95], v[244:247]
    ds_read_b64_tr_b16 v[158:159], v23 offset:62976
    v_mfma_f32_16x16x32_bf16 v[176:179], v[112:115], v[80:83], v[176:179]
    v_mfma_f32_16x16x32_bf16 v[200:203], v[112:115], v[84:87], v[200:203]
    v_mfma_f32_16x16x32_bf16 v[224:227], v[112:115], v[88:91], v[224:227]
    v_mfma_f32_16x16x32_bf16 v[248:251], v[112:115], v[92:95], v[248:251]
    v_mfma_f32_16x16x32_bf16 v[180:183], v[116:119], v[80:83], v[180:183]
    v_mfma_f32_16x16x32_bf16 v[204:207], v[116:119], v[84:87], v[204:207]
    v_mfma_f32_16x16x32_bf16 v[228:231], v[116:119], v[88:91], v[228:231]
    v_mfma_f32_16x16x32_bf16 v[252:255], v[116:119], v[92:95], v[252:255]
    v_mfma_f32_16x16x32_bf16 a[0:3], v[24:27], v[80:83], a[0:3]
    v_mfma_f32_16x16x32_bf16 a[8:11], v[80:83], v[80:83], a[8:11]
    v_mfma_f32_16x16x32_bf16 a[4:7], v[24:27], v[84:87], a[4:7]
    v_mfma_f32_16x16x32_bf16 a[12:15], v[84:87], v[84:87], a[12:15]
    v_mfma_f32_16x16x32_bf16 a[16:19], v[24:27], v[96:99], a[16:19]
    v_mfma_f32_16x16x32_bf16 a[20:23], v[24:27], v[100:103], a[20:23]
    v_mfma_f32_16x16x32_bf16 a[24:27], v[24:27], v[104:107], a[24:27]
    s_waitcnt vmcnt(10) lgkmcnt(0)
    s_barrier
    v_mfma_f32_16x16x32_bf16 a[0:3], v[24:27], v[120:123], a[0:3]
    ds_read_b128 v[80:83], v14 offset:0
    ds_read_b128 v[84:87], v14 offset:2048
    v_mfma_f32_16x16x32_bf16 a[8:11], v[120:123], v[120:123], a[8:11]
    ds_read_b128 v[88:91], v16 offset:0
    ds_read_b128 v[92:95], v16 offset:2048
    v_mfma_f32_16x16x32_bf16 a[4:7], v[24:27], v[124:127], a[4:7]
    ds_read_b64_tr_b16 v[96:97], v18 offset:0
    ds_read_b64_tr_b16 v[98:99], v18 offset:1536
    v_mfma_f32_16x16x32_bf16 a[12:15], v[124:127], v[124:127], a[12:15]
    ds_read_b64_tr_b16 v[100:101], v19 offset:0
    ds_read_b64_tr_b16 v[102:103], v19 offset:1536
    v_mfma_f32_16x16x32_bf16 a[16:19], v[24:27], v[136:139], a[16:19]
    ds_read_b64_tr_b16 v[104:105], v20 offset:0
    ds_read_b64_tr_b16 v[106:107], v20 offset:1536
    v_mfma_f32_16x16x32_bf16 a[20:23], v[24:27], v[140:143], a[20:23]
    ds_read_b64_tr_b16 v[108:109], v21 offset:0
    ds_read_b64_tr_b16 v[110:111], v21 offset:1536
    v_mfma_f32_16x16x32_bf16 a[24:27], v[24:27], v[144:147], a[24:27]
    ds_read_b64_tr_b16 v[112:113], v22 offset:0
    ds_read_b64_tr_b16 v[114:115], v22 offset:1536
    v_mfma_f32_16x16x32_bf16 v[160:163], v[136:139], v[120:123], v[160:163]
    ds_read_b64_tr_b16 v[116:117], v23 offset:0
    ds_read_b64_tr_b16 v[118:119], v23 offset:1536
    v_mfma_f32_16x16x32_bf16 v[184:187], v[136:139], v[124:127], v[184:187]
    v_mfma_f32_16x16x32_bf16 v[208:211], v[136:139], v[128:131], v[208:211]
    v_mfma_f32_16x16x32_bf16 v[232:235], v[136:139], v[132:135], v[232:235]
    v_mfma_f32_16x16x32_bf16 v[164:167], v[140:143], v[120:123], v[164:167]
    v_mfma_f32_16x16x32_bf16 v[188:191], v[140:143], v[124:127], v[188:191]
    v_mfma_f32_16x16x32_bf16 v[212:215], v[140:143], v[128:131], v[212:215]
    v_mfma_f32_16x16x32_bf16 v[236:239], v[140:143], v[132:135], v[236:239]
    v_mfma_f32_16x16x32_bf16 v[168:171], v[144:147], v[120:123], v[168:171]
    v_mfma_f32_16x16x32_bf16 v[192:195], v[144:147], v[124:127], v[192:195]
    v_mfma_f32_16x16x32_bf16 v[216:219], v[144:147], v[128:131], v[216:219]
    v_mfma_f32_16x16x32_bf16 v[240:243], v[144:147], v[132:135], v[240:243]
    v_mfma_f32_16x16x32_bf16 v[172:175], v[148:151], v[120:123], v[172:175]
    v_mfma_f32_16x16x32_bf16 v[196:199], v[148:151], v[124:127], v[196:199]
    v_mfma_f32_16x16x32_bf16 v[220:223], v[148:151], v[128:131], v[220:223]
    v_mfma_f32_16x16x32_bf16 v[244:247], v[148:151], v[132:135], v[244:247]
    v_mfma_f32_16x16x32_bf16 v[176:179], v[152:155], v[120:123], v[176:179]
    v_mfma_f32_16x16x32_bf16 v[200:203], v[152:155], v[124:127], v[200:203]
    v_mfma_f32_16x16x32_bf16 v[224:227], v[152:155], v[128:131], v[224:227]
    v_mfma_f32_16x16x32_bf16 v[248:251], v[152:155], v[132:135], v[248:251]
    v_mfma_f32_16x16x32_bf16 v[180:183], v[156:159], v[120:123], v[180:183]
    v_mfma_f32_16x16x32_bf16 v[204:207], v[156:159], v[124:127], v[204:207]
    v_mfma_f32_16x16x32_bf16 v[228:231], v[156:159], v[128:131], v[228:231]
    v_mfma_f32_16x16x32_bf16 v[252:255], v[156:159], v[132:135], v[252:255]
    s_waitcnt lgkmcnt(0)
    v_mfma_f32_16x16x32_bf16 v[160:163], v[96:99], v[80:83], v[160:163]
    ds_read_b128 v[120:123], v15 offset:0
    v_mfma_f32_16x16x32_bf16 v[184:187], v[96:99], v[84:87], v[184:187]
    ds_read_b128 v[124:127], v15 offset:2048
    v_mfma_f32_16x16x32_bf16 v[208:211], v[96:99], v[88:91], v[208:211]
    ds_read_b128 v[128:131], v17 offset:0
    v_mfma_f32_16x16x32_bf16 v[232:235], v[96:99], v[92:95], v[232:235]
    ds_read_b128 v[132:135], v17 offset:2048
    v_mfma_f32_16x16x32_bf16 v[164:167], v[100:103], v[80:83], v[164:167]
    ds_read_b64_tr_b16 v[136:137], v18 offset:12288
    v_mfma_f32_16x16x32_bf16 v[188:191], v[100:103], v[84:87], v[188:191]
    ds_read_b64_tr_b16 v[138:139], v18 offset:13824
    v_mfma_f32_16x16x32_bf16 v[212:215], v[100:103], v[88:91], v[212:215]
    ds_read_b64_tr_b16 v[140:141], v19 offset:12288
    v_mfma_f32_16x16x32_bf16 v[236:239], v[100:103], v[92:95], v[236:239]
    ds_read_b64_tr_b16 v[142:143], v19 offset:13824
    v_mfma_f32_16x16x32_bf16 v[168:171], v[104:107], v[80:83], v[168:171]
    ds_read_b64_tr_b16 v[144:145], v20 offset:12288
    v_mfma_f32_16x16x32_bf16 v[192:195], v[104:107], v[84:87], v[192:195]
    ds_read_b64_tr_b16 v[146:147], v20 offset:13824
    v_mfma_f32_16x16x32_bf16 v[216:219], v[104:107], v[88:91], v[216:219]
    ds_read_b64_tr_b16 v[148:149], v21 offset:12288
    v_mfma_f32_16x16x32_bf16 v[240:243], v[104:107], v[92:95], v[240:243]
    ds_read_b64_tr_b16 v[150:151], v21 offset:13824
    v_mfma_f32_16x16x32_bf16 v[172:175], v[108:111], v[80:83], v[172:175]
    ds_read_b64_tr_b16 v[152:153], v22 offset:12288
    v_mfma_f32_16x16x32_bf16 v[196:199], v[108:111], v[84:87], v[196:199]
    ds_read_b64_tr_b16 v[154:155], v22 offset:13824
    v_mfma_f32_16x16x32_bf16 v[220:223], v[108:111], v[88:91], v[220:223]
    ds_read_b64_tr_b16 v[156:157], v23 offset:12288
    v_mfma_f32_16x16x32_bf16 v[244:247], v[108:111], v[92:95], v[244:247]
    ds_read_b64_tr_b16 v[158:159], v23 offset:13824
    v_mfma_f32_16x16x32_bf16 v[176:179], v[112:115], v[80:83], v[176:179]
    v_mfma_f32_16x16x32_bf16 v[200:203], v[112:115], v[84:87], v[200:203]
    v_mfma_f32_16x16x32_bf16 v[224:227], v[112:115], v[88:91], v[224:227]
    v_mfma_f32_16x16x32_bf16 v[248:251], v[112:115], v[92:95], v[248:251]
    v_mfma_f32_16x16x32_bf16 v[180:183], v[116:119], v[80:83], v[180:183]
    v_mfma_f32_16x16x32_bf16 v[204:207], v[116:119], v[84:87], v[204:207]
    v_mfma_f32_16x16x32_bf16 v[228:231], v[116:119], v[88:91], v[228:231]
    v_mfma_f32_16x16x32_bf16 v[252:255], v[116:119], v[92:95], v[252:255]
    v_mfma_f32_16x16x32_bf16 a[0:3], v[24:27], v[80:83], a[0:3]
    v_mfma_f32_16x16x32_bf16 a[8:11], v[80:83], v[80:83], a[8:11]
    v_mfma_f32_16x16x32_bf16 a[4:7], v[24:27], v[84:87], a[4:7]
    v_mfma_f32_16x16x32_bf16 a[12:15], v[84:87], v[84:87], a[12:15]
    v_mfma_f32_16x16x32_bf16 a[16:19], v[24:27], v[96:99], a[16:19]
    v_mfma_f32_16x16x32_bf16 a[20:23], v[24:27], v[100:103], a[20:23]
    v_mfma_f32_16x16x32_bf16 a[24:27], v[24:27], v[104:107], a[24:27]
    s_waitcnt vmcnt(0) lgkmcnt(0)
    s_barrier
    v_mfma_f32_16x16x32_bf16 a[0:3], v[24:27], v[120:123], a[0:3]
    ds_read_b128 v[80:83], v14 offset:16384
    ds_read_b128 v[84:87], v14 offset:18432
    v_mfma_f32_16x16x32_bf16 a[8:11], v[120:123], v[120:123], a[8:11]
    ds_read_b128 v[88:91], v16 offset:16384
    ds_read_b128 v[92:95], v16 offset:18432
    v_mfma_f32_16x16x32_bf16 a[4:7], v[24:27], v[124:127], a[4:7]
    ds_read_b64_tr_b16 v[96:97], v18 offset:24576
    ds_read_b64_tr_b16 v[98:99], v18 offset:26112
    v_mfma_f32_16x16x32_bf16 a[12:15], v[124:127], v[124:127], a[12:15]
    ds_read_b64_tr_b16 v[100:101], v19 offset:24576
    ds_read_b64_tr_b16 v[102:103], v19 offset:26112
    v_mfma_f32_16x16x32_bf16 a[16:19], v[24:27], v[136:139], a[16:19]
    ds_read_b64_tr_b16 v[104:105], v20 offset:24576
    ds_read_b64_tr_b16 v[106:107], v20 offset:26112
    v_mfma_f32_16x16x32_bf16 a[20:23], v[24:27], v[140:143], a[20:23]
    ds_read_b64_tr_b16 v[108:109], v21 offset:24576
    ds_read_b64_tr_b16 v[110:111], v21 offset:26112
    v_mfma_f32_16x16x32_bf16 a[24:27], v[24:27], v[144:147], a[24:27]
    ds_read_b64_tr_b16 v[112:113], v22 offset:24576
    ds_read_b64_tr_b16 v[114:115], v22 offset:26112
    v_mfma_f32_16x16x32_bf16 v[160:163], v[136:139], v[120:123], v[160:163]
    ds_read_b64_tr_b16 v[116:117], v23 offset:24576
    ds_read_b64_tr_b16 v[118:119], v23 offset:26112
    v_mfma_f32_16x16x32_bf16 v[184:187], v[136:139], v[124:127], v[184:187]
    v_mfma_f32_16x16x32_bf16 v[208:211], v[136:139], v[128:131], v[208:211]
    v_mfma_f32_16x16x32_bf16 v[232:235], v[136:139], v[132:135], v[232:235]
    v_mfma_f32_16x16x32_bf16 v[164:167], v[140:143], v[120:123], v[164:167]
    v_mfma_f32_16x16x32_bf16 v[188:191], v[140:143], v[124:127], v[188:191]
    v_mfma_f32_16x16x32_bf16 v[212:215], v[140:143], v[128:131], v[212:215]
    v_mfma_f32_16x16x32_bf16 v[236:239], v[140:143], v[132:135], v[236:239]
    v_mfma_f32_16x16x32_bf16 v[168:171], v[144:147], v[120:123], v[168:171]
    v_mfma_f32_16x16x32_bf16 v[192:195], v[144:147], v[124:127], v[192:195]
    v_mfma_f32_16x16x32_bf16 v[216:219], v[144:147], v[128:131], v[216:219]
    v_mfma_f32_16x16x32_bf16 v[240:243], v[144:147], v[132:135], v[240:243]
    v_mfma_f32_16x16x32_bf16 v[172:175], v[148:151], v[120:123], v[172:175]
    v_mfma_f32_16x16x32_bf16 v[196:199], v[148:151], v[124:127], v[196:199]
    v_mfma_f32_16x16x32_bf16 v[220:223], v[148:151], v[128:131], v[220:223]
    v_mfma_f32_16x16x32_bf16 v[244:247], v[148:151], v[132:135], v[244:247]
    v_mfma_f32_16x16x32_bf16 v[176:179], v[152:155], v[120:123], v[176:179]
    v_mfma_f32_16x16x32_bf16 v[200:203], v[152:155], v[124:127], v[200:203]
    v_mfma_f32_16x16x32_bf16 v[224:227], v[152:155], v[128:131], v[224:227]
    v_mfma_f32_16x16x32_bf16 v[248:251], v[152:155], v[132:135], v[248:251]
    v_mfma_f32_16x16x32_bf16 v[180:183], v[156:159], v[120:123], v[180:183]
    v_mfma_f32_16x16x32_bf16 v[204:207], v[156:159], v[124:127], v[204:207]
    v_mfma_f32_16x16x32_bf16 v[228:231], v[156:159], v[128:131], v[228:231]
    v_mfma_f32_16x16x32_bf16 v[252:255], v[156:159], v[132:135], v[252:255]
    s_waitcnt lgkmcnt(0)
    v_mfma_f32_16x16x32_bf16 v[160:163], v[96:99], v[80:83], v[160:163]
    ds_read_b128 v[120:123], v15 offset:16384
    v_mfma_f32_16x16x32_bf16 v[184:187], v[96:99], v[84:87], v[184:187]
    ds_read_b128 v[124:127], v15 offset:18432
    v_mfma_f32_16x16x32_bf16 v[208:211], v[96:99], v[88:91], v[208:211]
    ds_read_b128 v[128:131], v17 offset:16384
    v_mfma_f32_16x16x32_bf16 v[232:235], v[96:99], v[92:95], v[232:235]
    ds_read_b128 v[132:135], v17 offset:18432
    v_mfma_f32_16x16x32_bf16 v[164:167], v[100:103], v[80:83], v[164:167]
    ds_read_b64_tr_b16 v[136:137], v18 offset:36864
    v_mfma_f32_16x16x32_bf16 v[188:191], v[100:103], v[84:87], v[188:191]
    ds_read_b64_tr_b16 v[138:139], v18 offset:38400
    v_mfma_f32_16x16x32_bf16 v[212:215], v[100:103], v[88:91], v[212:215]
    ds_read_b64_tr_b16 v[140:141], v19 offset:36864
    v_mfma_f32_16x16x32_bf16 v[236:239], v[100:103], v[92:95], v[236:239]
    ds_read_b64_tr_b16 v[142:143], v19 offset:38400
    v_mfma_f32_16x16x32_bf16 v[168:171], v[104:107], v[80:83], v[168:171]
    ds_read_b64_tr_b16 v[144:145], v20 offset:36864
    v_mfma_f32_16x16x32_bf16 v[192:195], v[104:107], v[84:87], v[192:195]
    ds_read_b64_tr_b16 v[146:147], v20 offset:38400
    v_mfma_f32_16x16x32_bf16 v[216:219], v[104:107], v[88:91], v[216:219]
    ds_read_b64_tr_b16 v[148:149], v21 offset:36864
    v_mfma_f32_16x16x32_bf16 v[240:243], v[104:107], v[92:95], v[240:243]
    ds_read_b64_tr_b16 v[150:151], v21 offset:38400
    v_mfma_f32_16x16x32_bf16 v[172:175], v[108:111], v[80:83], v[172:175]
    ds_read_b64_tr_b16 v[152:153], v22 offset:36864
    v_mfma_f32_16x16x32_bf16 v[196:199], v[108:111], v[84:87], v[196:199]
    ds_read_b64_tr_b16 v[154:155], v22 offset:38400
    v_mfma_f32_16x16x32_bf16 v[220:223], v[108:111], v[88:91], v[220:223]
    ds_read_b64_tr_b16 v[156:157], v23 offset:36864
    v_mfma_f32_16x16x32_bf16 v[244:247], v[108:111], v[92:95], v[244:247]
    ds_read_b64_tr_b16 v[158:159], v23 offset:38400
    v_mfma_f32_16x16x32_bf16 v[176:179], v[112:115], v[80:83], v[176:179]
    v_mfma_f32_16x16x32_bf16 v[200:203], v[112:115], v[84:87], v[200:203]
    v_mfma_f32_16x16x32_bf16 v[224:227], v[112:115], v[88:91], v[224:227]
    v_mfma_f32_16x16x32_bf16 v[248:251], v[112:115], v[92:95], v[248:251]
    v_mfma_f32_16x16x32_bf16 v[180:183], v[116:119], v[80:83], v[180:183]
    v_mfma_f32_16x16x32_bf16 v[204:207], v[116:119], v[84:87], v[204:207]
    v_mfma_f32_16x16x32_bf16 v[228:231], v[116:119], v[88:91], v[228:231]
    v_mfma_f32_16x16x32_bf16 v[252:255], v[116:119], v[92:95], v[252:255]
    v_mfma_f32_16x16x32_bf16 a[0:3], v[24:27], v[80:83], a[0:3]
    v_mfma_f32_16x16x32_bf16 a[8:11], v[80:83], v[80:83], a[8:11]
    v_mfma_f32_16x16x32_bf16 a[4:7], v[24:27], v[84:87], a[4:7]
    v_mfma_f32_16x16x32_bf16 a[12:15], v[84:87], v[84:87], a[12:15]
    v_mfma_f32_16x16x32_bf16 a[16:19], v[24:27], v[96:99], a[16:19]
    v_mfma_f32_16x16x32_bf16 a[20:23], v[24:27], v[100:103], a[20:23]
    v_mfma_f32_16x16x32_bf16 a[24:27], v[24:27], v[104:107], a[24:27]
    s_waitcnt lgkmcnt(0)
    v_mfma_f32_16x16x32_bf16 a[0:3], v[24:27], v[120:123], a[0:3]
    v_mfma_f32_16x16x32_bf16 a[8:11], v[120:123], v[120:123], a[8:11]
    v_mfma_f32_16x16x32_bf16 a[4:7], v[24:27], v[124:127], a[4:7]
    v_mfma_f32_16x16x32_bf16 a[12:15], v[124:127], v[124:127], a[12:15]
    v_mfma_f32_16x16x32_bf16 a[16:19], v[24:27], v[136:139], a[16:19]
    v_mfma_f32_16x16x32_bf16 a[20:23], v[24:27], v[140:143], a[20:23]
    v_mfma_f32_16x16x32_bf16 a[24:27], v[24:27], v[144:147], a[24:27]
    v_mfma_f32_16x16x32_bf16 v[160:163], v[136:139], v[120:123], v[160:163]
    v_mfma_f32_16x16x32_bf16 v[184:187], v[136:139], v[124:127], v[184:187]
    v_mfma_f32_16x16x32_bf16 v[208:211], v[136:139], v[128:131], v[208:211]
    v_mfma_f32_16x16x32_bf16 v[232:235], v[136:139], v[132:135], v[232:235]
    v_mfma_f32_16x16x32_bf16 v[164:167], v[140:143], v[120:123], v[164:167]
    v_mfma_f32_16x16x32_bf16 v[188:191], v[140:143], v[124:127], v[188:191]
    v_mfma_f32_16x16x32_bf16 v[212:215], v[140:143], v[128:131], v[212:215]
    v_mfma_f32_16x16x32_bf16 v[236:239], v[140:143], v[132:135], v[236:239]
    v_mfma_f32_16x16x32_bf16 v[168:171], v[144:147], v[120:123], v[168:171]
    v_mfma_f32_16x16x32_bf16 v[192:195], v[144:147], v[124:127], v[192:195]
    v_mfma_f32_16x16x32_bf16 v[216:219], v[144:147], v[128:131], v[216:219]
    v_mfma_f32_16x16x32_bf16 v[240:243], v[144:147], v[132:135], v[240:243]
    v_mfma_f32_16x16x32_bf16 v[172:175], v[148:151], v[120:123], v[172:175]
    v_mfma_f32_16x16x32_bf16 v[196:199], v[148:151], v[124:127], v[196:199]
    v_mfma_f32_16x16x32_bf16 v[220:223], v[148:151], v[128:131], v[220:223]
    v_mfma_f32_16x16x32_bf16 v[244:247], v[148:151], v[132:135], v[244:247]
    v_mfma_f32_16x16x32_bf16 v[176:179], v[152:155], v[120:123], v[176:179]
    v_mfma_f32_16x16x32_bf16 v[200:203], v[152:155], v[124:127], v[200:203]
    v_mfma_f32_16x16x32_bf16 v[224:227], v[152:155], v[128:131], v[224:227]
    v_mfma_f32_16x16x32_bf16 v[248:251], v[152:155], v[132:135], v[248:251]
    v_mfma_f32_16x16x32_bf16 v[180:183], v[156:159], v[120:123], v[180:183]
    v_mfma_f32_16x16x32_bf16 v[204:207], v[156:159], v[124:127], v[204:207]
    v_mfma_f32_16x16x32_bf16 v[228:231], v[156:159], v[128:131], v[228:231]
    v_mfma_f32_16x16x32_bf16 v[252:255], v[156:159], v[132:135], v[252:255]
    s_lshl_b32 s48, s39, 8
    s_lshl_b32 s49, s40, 7
    s_add_u32 s48, s48, s49
    v_lshl_add_u32 v40, v2, 2, s48
    s_lshl_b32 s48, s40, 7
    s_lshl_b32 s49, s39, 6
    s_add_u32 s59, s48, s49
    s_xor_b32 s60, s59, 64
    v_lshl_add_u32 v41, v2, 2, s59
    s_mov_b64 exec, 0xffff
    ds_write_b32 v40, a0 offset:0
    ds_write_b32 v40, a4 offset:64
    ds_write_b32 v41, a16 offset:1024
    ds_write_b32 v41, a20 offset:1280
    ds_write_b32 v41, a24 offset:1536
    s_mov_b32 exec_lo, 1048577
    s_mov_b32 exec_hi, 268435712
    ds_write_b32 v40, a8 offset:512
    ds_write_b32 v40, a12 offset:576
    s_mov_b32 exec_lo, 2097154
    s_mov_b32 exec_hi, 536871424
    ds_write_b32 v40, a9 offset:512
    ds_write_b32 v40, a13 offset:576
    s_mov_b32 exec_lo, 4194308
    s_mov_b32 exec_hi, 1073742848
    ds_write_b32 v40, a10 offset:512
    ds_write_b32 v40, a14 offset:576
    s_mov_b32 exec_lo, 8388616
    s_mov_b32 exec_hi, 2147485696
    ds_write_b32 v40, a11 offset:512
    ds_write_b32 v40, a15 offset:576
    s_mov_b64 exec, -1
    s_waitcnt lgkmcnt(0)
    s_barrier
    v_and_b32 v40, 127, v0
    v_lshlrev_b32 v40, 2, v40
    ds_read_b32 v41, v40 offset:0
    ds_read_b32 v42, v40 offset:512
    s_waitcnt lgkmcnt(0)
    v_mul_f32 v41, 0x3b000000, v41
    v_mul_f32 v42, 0x3b000000, v42
    v_fma_f32 v42, -v41, v41, v42
    v_max_f32 v42, 0, v42
    v_add_f32 v42, 0x3727c5ac, v42
    v_rsq_f32 v42, v42
    s_nop 0
    v_mul_f32 v41, v41, v42
    ds_write_b32 v40, v42 offset:2048
    ds_write_b32 v40, v41 offset:2560
    s_waitcnt lgkmcnt(0)
    s_barrier
    s_lshl_b32 s48, s39, 8
    s_lshl_b32 s49, s40, 7
    s_add_u32 s57, s48, s49
    s_xor_b32 s58, s57, 128
    v_lshl_add_u32 v40, v2, 2, s57
    v_lshl_add_u32 v41, v2, 2, s58
    v_lshl_add_u32 v42, v3, 4, s57
    v_lshl_add_u32 v43, v3, 4, s58
    v_lshl_add_u32 v44, v3, 4, s59
    v_lshl_add_u32 v45, v3, 4, s60
    v_lshl_add_u32 v46, v2, 2, s59
    v_lshl_add_u32 v47, v2, 2, s60
    ds_read_b32 v80, v40 offset:2048
    ds_read_b32 v81, v40 offset:2560
    ds_read_b32 v82, v40 offset:2112
    ds_read_b32 v83, v40 offset:2624
    ds_read_b32 v84, v41 offset:2048
    ds_read_b32 v85, v41 offset:2560
    ds_read_b32 v86, v41 offset:2112
    ds_read_b32 v87, v41 offset:2624
    ds_read_b128 v[120:123], v44 offset:1024
    ds_read_b128 v[124:127], v44 offset:1280
    ds_read_b128 v[128:131], v44 offset:1536
    ds_read_b128 v[132:135], v45 offset:1024
    ds_read_b128 v[136:139], v45 offset:1280
    ds_read_b128 v[140:143], v45 offset:1536
    s_waitcnt lgkmcnt(0)
    v_pk_mul_f32 v[144:145], v[120:121], v[80:81] op_sel:[0,1] op_sel_hi:[1,1]
    v_pk_mul_f32 v[148:149], v[120:121], v[82:83] op_sel:[0,1] op_sel_hi:[1,1]
    v_pk_mul_f32 v[152:153], v[120:121], v[84:85] op_sel:[0,1] op_sel_hi:[1,1]
    v_pk_mul_f32 v[156:157], v[120:121], v[86:87] op_sel:[0,1] op_sel_hi:[1,1]
    v_pk_fma_f32 v[160:161], v[160:161], v[80:81], v[144:145] op_sel_hi:[1,0,1] neg_lo:[0,0,1] neg_hi:[0,0,1]
    v_pk_fma_f32 v[184:185], v[184:185], v[82:83], v[148:149] op_sel_hi:[1,0,1] neg_lo:[0,0,1] neg_hi:[0,0,1]
    v_pk_fma_f32 v[208:209], v[208:209], v[84:85], v[152:153] op_sel_hi:[1,0,1] neg_lo:[0,0,1] neg_hi:[0,0,1]
    v_pk_fma_f32 v[232:233], v[232:233], v[86:87], v[156:157] op_sel_hi:[1,0,1] neg_lo:[0,0,1] neg_hi:[0,0,1]
    v_pk_mul_f32 v[146:147], v[122:123], v[80:81] op_sel:[0,1] op_sel_hi:[1,1]
    v_pk_mul_f32 v[150:151], v[122:123], v[82:83] op_sel:[0,1] op_sel_hi:[1,1]
    v_pk_mul_f32 v[154:155], v[122:123], v[84:85] op_sel:[0,1] op_sel_hi:[1,1]
    v_pk_mul_f32 v[158:159], v[122:123], v[86:87] op_sel:[0,1] op_sel_hi:[1,1]
    v_pk_fma_f32 v[162:163], v[162:163], v[80:81], v[146:147] op_sel_hi:[1,0,1] neg_lo:[0,0,1] neg_hi:[0,0,1]
    v_pk_fma_f32 v[186:187], v[186:187], v[82:83], v[150:151] op_sel_hi:[1,0,1] neg_lo:[0,0,1] neg_hi:[0,0,1]
    v_pk_fma_f32 v[210:211], v[210:211], v[84:85], v[154:155] op_sel_hi:[1,0,1] neg_lo:[0,0,1] neg_hi:[0,0,1]
    v_pk_fma_f32 v[234:235], v[234:235], v[86:87], v[158:159] op_sel_hi:[1,0,1] neg_lo:[0,0,1] neg_hi:[0,0,1]
    v_pk_mul_f32 v[144:145], v[124:125], v[80:81] op_sel:[0,1] op_sel_hi:[1,1]
    v_pk_mul_f32 v[148:149], v[124:125], v[82:83] op_sel:[0,1] op_sel_hi:[1,1]
    v_pk_mul_f32 v[152:153], v[124:125], v[84:85] op_sel:[0,1] op_sel_hi:[1,1]
    v_pk_mul_f32 v[156:157], v[124:125], v[86:87] op_sel:[0,1] op_sel_hi:[1,1]
    v_pk_fma_f32 v[164:165], v[164:165], v[80:81], v[144:145] op_sel_hi:[1,0,1] neg_lo:[0,0,1] neg_hi:[0,0,1]
    v_pk_fma_f32 v[188:189], v[188:189], v[82:83], v[148:149] op_sel_hi:[1,0,1] neg_lo:[0,0,1] neg_hi:[0,0,1]
    v_pk_fma_f32 v[212:213], v[212:213], v[84:85], v[152:153] op_sel_hi:[1,0,1] neg_lo:[0,0,1] neg_hi:[0,0,1]
    v_pk_fma_f32 v[236:237], v[236:237], v[86:87], v[156:157] op_sel_hi:[1,0,1] neg_lo:[0,0,1] neg_hi:[0,0,1]
    v_pk_mul_f32 v[146:147], v[126:127], v[80:81] op_sel:[0,1] op_sel_hi:[1,1]
    v_pk_mul_f32 v[150:151], v[126:127], v[82:83] op_sel:[0,1] op_sel_hi:[1,1]
    v_pk_mul_f32 v[154:155], v[126:127], v[84:85] op_sel:[0,1] op_sel_hi:[1,1]
    v_pk_mul_f32 v[158:159], v[126:127], v[86:87] op_sel:[0,1] op_sel_hi:[1,1]
    v_pk_fma_f32 v[166:167], v[166:167], v[80:81], v[146:147] op_sel_hi:[1,0,1] neg_lo:[0,0,1] neg_hi:[0,0,1]
    v_pk_fma_f32 v[190:191], v[190:191], v[82:83], v[150:151] op_sel_hi:[1,0,1] neg_lo:[0,0,1] neg_hi:[0,0,1]
    v_pk_fma_f32 v[214:215], v[214:215], v[84:85], v[154:155] op_sel_hi:[1,0,1] neg_lo:[0,0,1] neg_hi:[0,0,1]
    v_pk_fma_f32 v[238:239], v[238:239], v[86:87], v[158:159] op_sel_hi:[1,0,1] neg_lo:[0,0,1] neg_hi:[0,0,1]
    v_pk_mul_f32 v[144:145], v[128:129], v[80:81] op_sel:[0,1] op_sel_hi:[1,1]
    v_pk_mul_f32 v[148:149], v[128:129], v[82:83] op_sel:[0,1] op_sel_hi:[1,1]
    v_pk_mul_f32 v[152:153], v[128:129], v[84:85] op_sel:[0,1] op_sel_hi:[1,1]
    v_pk_mul_f32 v[156:157], v[128:129], v[86:87] op_sel:[0,1] op_sel_hi:[1,1]
    v_pk_fma_f32 v[168:169], v[168:169], v[80:81], v[144:145] op_sel_hi:[1,0,1] neg_lo:[0,0,1] neg_hi:[0,0,1]
    v_pk_fma_f32 v[192:193], v[192:193], v[82:83], v[148:149] op_sel_hi:[1,0,1] neg_lo:[0,0,1] neg_hi:[0,0,1]
    v_pk_fma_f32 v[216:217], v[216:217], v[84:85], v[152:153] op_sel_hi:[1,0,1] neg_lo:[0,0,1] neg_hi:[0,0,1]
    v_pk_fma_f32 v[240:241], v[240:241], v[86:87], v[156:157] op_sel_hi:[1,0,1] neg_lo:[0,0,1] neg_hi:[0,0,1]
    v_pk_mul_f32 v[146:147], v[130:131], v[80:81] op_sel:[0,1] op_sel_hi:[1,1]
    v_pk_mul_f32 v[150:151], v[130:131], v[82:83] op_sel:[0,1] op_sel_hi:[1,1]
    v_pk_mul_f32 v[154:155], v[130:131], v[84:85] op_sel:[0,1] op_sel_hi:[1,1]
    v_pk_mul_f32 v[158:159], v[130:131], v[86:87] op_sel:[0,1] op_sel_hi:[1,1]
    v_pk_fma_f32 v[170:171], v[170:171], v[80:81], v[146:147] op_sel_hi:[1,0,1] neg_lo:[0,0,1] neg_hi:[0,0,1]
    v_pk_fma_f32 v[194:195], v[194:195], v[82:83], v[150:151] op_sel_hi:[1,0,1] neg_lo:[0,0,1] neg_hi:[0,0,1]
    v_pk_fma_f32 v[218:219], v[218:219], v[84:85], v[154:155] op_sel_hi:[1,0,1] neg_lo:[0,0,1] neg_hi:[0,0,1]
    v_pk_fma_f32 v[242:243], v[242:243], v[86:87], v[158:159] op_sel_hi:[1,0,1] neg_lo:[0,0,1] neg_hi:[0,0,1]
    v_pk_mul_f32 v[144:145], v[132:133], v[80:81] op_sel:[0,1] op_sel_hi:[1,1]
    v_pk_mul_f32 v[148:149], v[132:133], v[82:83] op_sel:[0,1] op_sel_hi:[1,1]
    v_pk_mul_f32 v[152:153], v[132:133], v[84:85] op_sel:[0,1] op_sel_hi:[1,1]
    v_pk_mul_f32 v[156:157], v[132:133], v[86:87] op_sel:[0,1] op_sel_hi:[1,1]
    v_pk_fma_f32 v[172:173], v[172:173], v[80:81], v[144:145] op_sel_hi:[1,0,1] neg_lo:[0,0,1] neg_hi:[0,0,1]
    v_pk_fma_f32 v[196:197], v[196:197], v[82:83], v[148:149] op_sel_hi:[1,0,1] neg_lo:[0,0,1] neg_hi:[0,0,1]
    v_pk_fma_f32 v[220:221], v[220:221], v[84:85], v[152:153] op_sel_hi:[1,0,1] neg_lo:[0,0,1] neg_hi:[0,0,1]
    v_pk_fma_f32 v[244:245], v[244:245], v[86:87], v[156:157] op_sel_hi:[1,0,1] neg_lo:[0,0,1] neg_hi:[0,0,1]
    v_pk_mul_f32 v[146:147], v[134:135], v[80:81] op_sel:[0,1] op_sel_hi:[1,1]
    v_pk_mul_f32 v[150:151], v[134:135], v[82:83] op_sel:[0,1] op_sel_hi:[1,1]
    v_pk_mul_f32 v[154:155], v[134:135], v[84:85] op_sel:[0,1] op_sel_hi:[1,1]
    v_pk_mul_f32 v[158:159], v[134:135], v[86:87] op_sel:[0,1] op_sel_hi:[1,1]
    v_pk_fma_f32 v[174:175], v[174:175], v[80:81], v[146:147] op_sel_hi:[1,0,1] neg_lo:[0,0,1] neg_hi:[0,0,1]
    v_pk_fma_f32 v[198:199], v[198:199], v[82:83], v[150:151] op_sel_hi:[1,0,1] neg_lo:[0,0,1] neg_hi:[0,0,1]
    v_pk_fma_f32 v[222:223], v[222:223], v[84:85], v[154:155] op_sel_hi:[1,0,1] neg_lo:[0,0,1] neg_hi:[0,0,1]
    v_pk_fma_f32 v[246:247], v[246:247], v[86:87], v[158:159] op_sel_hi:[1,0,1] neg_lo:[0,0,1] neg_hi:[0,0,1]
    v_pk_mul_f32 v[144:145], v[136:137], v[80:81] op_sel:[0,1] op_sel_hi:[1,1]
    v_pk_mul_f32 v[148:149], v[136:137], v[82:83] op_sel:[0,1] op_sel_hi:[1,1]
    v_pk_mul_f32 v[152:153], v[136:137], v[84:85] op_sel:[0,1] op_sel_hi:[1,1]
    v_pk_mul_f32 v[156:157], v[136:137], v[86:87] op_sel:[0,1] op_sel_hi:[1,1]
    v_pk_fma_f32 v[176:177], v[176:177], v[80:81], v[144:145] op_sel_hi:[1,0,1] neg_lo:[0,0,1] neg_hi:[0,0,1]
    v_pk_fma_f32 v[200:201], v[200:201], v[82:83], v[148:149] op_sel_hi:[1,0,1] neg_lo:[0,0,1] neg_hi:[0,0,1]
    v_pk_fma_f32 v[224:225], v[224:225], v[84:85], v[152:153] op_sel_hi:[1,0,1] neg_lo:[0,0,1] neg_hi:[0,0,1]
    v_pk_fma_f32 v[248:249], v[248:249], v[86:87], v[156:157] op_sel_hi:[1,0,1] neg_lo:[0,0,1] neg_hi:[0,0,1]
    v_pk_mul_f32 v[146:147], v[138:139], v[80:81] op_sel:[0,1] op_sel_hi:[1,1]
    v_pk_mul_f32 v[150:151], v[138:139], v[82:83] op_sel:[0,1] op_sel_hi:[1,1]
    v_pk_mul_f32 v[154:155], v[138:139], v[84:85] op_sel:[0,1] op_sel_hi:[1,1]
    v_pk_mul_f32 v[158:159], v[138:139], v[86:87] op_sel:[0,1] op_sel_hi:[1,1]
    v_pk_fma_f32 v[178:179], v[178:179], v[80:81], v[146:147] op_sel_hi:[1,0,1] neg_lo:[0,0,1] neg_hi:[0,0,1]
    v_pk_fma_f32 v[202:203], v[202:203], v[82:83], v[150:151] op_sel_hi:[1,0,1] neg_lo:[0,0,1] neg_hi:[0,0,1]
    v_pk_fma_f32 v[226:227], v[226:227], v[84:85], v[154:155] op_sel_hi:[1,0,1] neg_lo:[0,0,1] neg_hi:[0,0,1]
    v_pk_fma_f32 v[250:251], v[250:251], v[86:87], v[158:159] op_sel_hi:[1,0,1] neg_lo:[0,0,1] neg_hi:[0,0,1]
    v_pk_mul_f32 v[144:145], v[140:141], v[80:81] op_sel:[0,1] op_sel_hi:[1,1]
    v_pk_mul_f32 v[148:149], v[140:141], v[82:83] op_sel:[0,1] op_sel_hi:[1,1]
    v_pk_mul_f32 v[152:153], v[140:141], v[84:85] op_sel:[0,1] op_sel_hi:[1,1]
    v_pk_mul_f32 v[156:157], v[140:141], v[86:87] op_sel:[0,1] op_sel_hi:[1,1]
    v_pk_fma_f32 v[180:181], v[180:181], v[80:81], v[144:145] op_sel_hi:[1,0,1] neg_lo:[0,0,1] neg_hi:[0,0,1]
    v_pk_fma_f32 v[204:205], v[204:205], v[82:83], v[148:149] op_sel_hi:[1,0,1] neg_lo:[0,0,1] neg_hi:[0,0,1]
    v_pk_fma_f32 v[228:229], v[228:229], v[84:85], v[152:153] op_sel_hi:[1,0,1] neg_lo:[0,0,1] neg_hi:[0,0,1]
    v_pk_fma_f32 v[252:253], v[252:253], v[86:87], v[156:157] op_sel_hi:[1,0,1] neg_lo:[0,0,1] neg_hi:[0,0,1]
    v_pk_mul_f32 v[146:147], v[142:143], v[80:81] op_sel:[0,1] op_sel_hi:[1,1]
    v_pk_mul_f32 v[150:151], v[142:143], v[82:83] op_sel:[0,1] op_sel_hi:[1,1]
    v_pk_mul_f32 v[154:155], v[142:143], v[84:85] op_sel:[0,1] op_sel_hi:[1,1]
    v_pk_mul_f32 v[158:159], v[142:143], v[86:87] op_sel:[0,1] op_sel_hi:[1,1]
    v_pk_fma_f32 v[182:183], v[182:183], v[80:81], v[146:147] op_sel_hi:[1,0,1] neg_lo:[0,0,1] neg_hi:[0,0,1]
    v_pk_fma_f32 v[206:207], v[206:207], v[82:83], v[150:151] op_sel_hi:[1,0,1] neg_lo:[0,0,1] neg_hi:[0,0,1]
    v_pk_fma_f32 v[230:231], v[230:231], v[84:85], v[154:155] op_sel_hi:[1,0,1] neg_lo:[0,0,1] neg_hi:[0,0,1]
    v_pk_fma_f32 v[254:255], v[254:255], v[86:87], v[158:159] op_sel_hi:[1,0,1] neg_lo:[0,0,1] neg_hi:[0,0,1]
    s_lshl_b32 s48, s36, 7
    s_lshr_b32 s61, s57, 2
    s_lshr_b32 s62, s58, 2
    s_add_u32 s61, s61, s48
    s_add_u32 s62, s62, s48
    v_mov_b32 v79, 0xc0135761
    s_cmp_eq_u32 s53, 3
    s_cselect_b32 s63, 10, 11
    s_mul_i32 s48, s61, 1408
    v_lshl_add_u32 v48, v1, 3, s48
    s_mul_i32 s48, s62, 1408
    v_lshl_add_u32 v49, v1, 3, s48
    s_lshr_b32 s48, s59, 6
    s_add_u32 s48, s48, 0
    s_cmp_ge_u32 s48, s63
    s_cbranch_scc1 P1_z1_skip0
    s_mul_i32 s49, s53, 11
    s_add_u32 s48, s48, s49
    v_mul_f32 v80, v160, v160
    v_mul_f32 v81, v161, v161
    v_mul_f32 v82, v162, v162
    v_mul_f32 v83, v163, v163
    v_mul_f32 v84, v184, v184
    v_mul_f32 v85, v185, v185
    v_mul_f32 v86, v186, v186
    v_mul_f32 v87, v187, v187
    v_mul_f32 v88, v208, v208
    v_mul_f32 v89, v209, v209
    v_mul_f32 v90, v210, v210
    v_mul_f32 v91, v211, v211
    v_mul_f32 v92, v232, v232
    v_mul_f32 v93, v233, v233
    v_mul_f32 v94, v234, v234
    v_mul_f32 v95, v235, v235
    v_fma_f32 v80, v80, s54, v79
    v_fma_f32 v81, v81, s54, v79
    v_fma_f32 v82, v82, s54, v79
    v_fma_f32 v83, v83, s54, v79
    v_fma_f32 v84, v84, s54, v79
    v_fma_f32 v85, v85, s54, v79
    v_fma_f32 v86, v86, s54, v79
    v_fma_f32 v87, v87, s54, v79
    v_fma_f32 v88, v88, s54, v79
    v_fma_f32 v89, v89, s54, v79
    v_fma_f32 v90, v90, s54, v79
    v_fma_f32 v91, v91, s54, v79
    v_fma_f32 v92, v92, s54, v79
    v_fma_f32 v93, v93, s54, v79
    v_fma_f32 v94, v94, s54, v79
    v_fma_f32 v95, v95, s54, v79
    v_mul_f32 v80, v80, v160
    v_mul_f32 v81, v81, v161
    v_mul_f32 v82, v82, v162
    v_mul_f32 v83, v83, v163
    v_mul_f32 v84, v84, v184
    v_mul_f32 v85, v85, v185
    v_mul_f32 v86, v86, v186
    v_mul_f32 v87, v87, v187
    v_mul_f32 v88, v88, v208
    v_mul_f32 v89, v89, v209
    v_mul_f32 v90, v90, v210
    v_mul_f32 v91, v91, v211
    v_mul_f32 v92, v92, v232
    v_mul_f32 v93, v93, v233
    v_mul_f32 v94, v94, v234
    v_mul_f32 v95, v95, v235
    v_exp_f32 v80, v80
    v_exp_f32 v81, v81
    v_exp_f32 v82, v82
    v_exp_f32 v83, v83
    v_exp_f32 v84, v84
    v_exp_f32 v85, v85
    v_exp_f32 v86, v86
    v_exp_f32 v87, v87
    v_exp_f32 v88, v88
    v_exp_f32 v89, v89
    v_exp_f32 v90, v90
    v_exp_f32 v91, v91
    v_exp_f32 v92, v92
    v_exp_f32 v93, v93
    v_exp_f32 v94, v94
    v_exp_f32 v95, v95
    v_add_f32 v80, 1.0, v80
    v_add_f32 v81, 1.0, v81
    v_add_f32 v82, 1.0, v82
    v_add_f32 v83, 1.0, v83
    v_add_f32 v84, 1.0, v84
    v_add_f32 v85, 1.0, v85
    v_add_f32 v86, 1.0, v86
    v_add_f32 v87, 1.0, v87
    v_add_f32 v88, 1.0, v88
    v_add_f32 v89, 1.0, v89
    v_add_f32 v90, 1.0, v90
    v_add_f32 v91, 1.0, v91
    v_add_f32 v92, 1.0, v92
    v_add_f32 v93, 1.0, v93
    v_add_f32 v94, 1.0, v94
    v_add_f32 v95, 1.0, v95
    v_rcp_f32 v80, v80
    v_rcp_f32 v81, v81
    v_rcp_f32 v82, v82
    v_rcp_f32 v83, v83
    v_rcp_f32 v84, v84
    v_rcp_f32 v85, v85
    v_rcp_f32 v86, v86
    v_rcp_f32 v87, v87
    v_rcp_f32 v88, v88
    v_rcp_f32 v89, v89
    v_rcp_f32 v90, v90
    v_rcp_f32 v91, v91
    v_rcp_f32 v92, v92
    v_rcp_f32 v93, v93
    v_rcp_f32 v94, v94
    v_rcp_f32 v95, v95
    v_mul_f32 v160, v160, v80
    v_mul_f32 v161, v161, v81
    v_mul_f32 v162, v162, v82
    v_mul_f32 v163, v163, v83
    v_mul_f32 v184, v184, v84
    v_mul_f32 v185, v185, v85
    v_mul_f32 v186, v186, v86
    v_mul_f32 v187, v187, v87
    v_mul_f32 v208, v208, v88
    v_mul_f32 v209, v209, v89
    v_mul_f32 v210, v210, v90
    v_mul_f32 v211, v211, v91
    v_mul_f32 v232, v232, v92
    v_mul_f32 v233, v233, v93
    v_mul_f32 v234, v234, v94
    v_mul_f32 v235, v235, v95
    v_cvt_pk_bf16_f32 v96, v160, v161
    v_cvt_pk_bf16_f32 v97, v162, v163
    v_cvt_pk_bf16_f32 v98, v184, v185
    v_cvt_pk_bf16_f32 v99, v186, v187
    v_cvt_pk_bf16_f32 v100, v208, v209
    v_cvt_pk_bf16_f32 v101, v210, v211
    v_cvt_pk_bf16_f32 v102, v232, v233
    v_cvt_pk_bf16_f32 v103, v234, v235
    s_lshl_b32 s64, s48, 9
    s_add_u32 s65, s64, 22528
    buffer_store_dwordx2 v[96:97], v48, s[28:31], s64 offen
    buffer_store_dwordx2 v[98:99], v48, s[28:31], s65 offen
    buffer_store_dwordx2 v[100:101], v49, s[28:31], s64 offen
    buffer_store_dwordx2 v[102:103], v49, s[28:31], s65 offen
P1_z1_skip0:
    s_lshr_b32 s48, s59, 6
    s_add_u32 s48, s48, 4
    s_cmp_ge_u32 s48, s63
    s_cbranch_scc1 P1_z1_skip1
    s_mul_i32 s49, s53, 11
    s_add_u32 s48, s48, s49
    v_mul_f32 v80, v164, v164
    v_mul_f32 v81, v165, v165
    v_mul_f32 v82, v166, v166
    v_mul_f32 v83, v167, v167
    v_mul_f32 v84, v188, v188
    v_mul_f32 v85, v189, v189
    v_mul_f32 v86, v190, v190
    v_mul_f32 v87, v191, v191
    v_mul_f32 v88, v212, v212
    v_mul_f32 v89, v213, v213
    v_mul_f32 v90, v214, v214
    v_mul_f32 v91, v215, v215
    v_mul_f32 v92, v236, v236
    v_mul_f32 v93, v237, v237
    v_mul_f32 v94, v238, v238
    v_mul_f32 v95, v239, v239
    v_fma_f32 v80, v80, s54, v79
    v_fma_f32 v81, v81, s54, v79
    v_fma_f32 v82, v82, s54, v79
    v_fma_f32 v83, v83, s54, v79
    v_fma_f32 v84, v84, s54, v79
    v_fma_f32 v85, v85, s54, v79
    v_fma_f32 v86, v86, s54, v79
    v_fma_f32 v87, v87, s54, v79
    v_fma_f32 v88, v88, s54, v79
    v_fma_f32 v89, v89, s54, v79
    v_fma_f32 v90, v90, s54, v79
    v_fma_f32 v91, v91, s54, v79
    v_fma_f32 v92, v92, s54, v79
    v_fma_f32 v93, v93, s54, v79
    v_fma_f32 v94, v94, s54, v79
    v_fma_f32 v95, v95, s54, v79
    v_mul_f32 v80, v80, v164
    v_mul_f32 v81, v81, v165
    v_mul_f32 v82, v82, v166
    v_mul_f32 v83, v83, v167
    v_mul_f32 v84, v84, v188
    v_mul_f32 v85, v85, v189
    v_mul_f32 v86, v86, v190
    v_mul_f32 v87, v87, v191
    v_mul_f32 v88, v88, v212
    v_mul_f32 v89, v89, v213
    v_mul_f32 v90, v90, v214
    v_mul_f32 v91, v91, v215
    v_mul_f32 v92, v92, v236
    v_mul_f32 v93, v93, v237
    v_mul_f32 v94, v94, v238
    v_mul_f32 v95, v95, v239
    v_exp_f32 v80, v80
    v_exp_f32 v81, v81
    v_exp_f32 v82, v82
    v_exp_f32 v83, v83
    v_exp_f32 v84, v84
    v_exp_f32 v85, v85
    v_exp_f32 v86, v86
    v_exp_f32 v87, v87
    v_exp_f32 v88, v88
    v_exp_f32 v89, v89
    v_exp_f32 v90, v90
    v_exp_f32 v91, v91
    v_exp_f32 v92, v92
    v_exp_f32 v93, v93
    v_exp_f32 v94, v94
    v_exp_f32 v95, v95
    v_add_f32 v80, 1.0, v80
    v_add_f32 v81, 1.0, v81
    v_add_f32 v82, 1.0, v82
    v_add_f32 v83, 1.0, v83
    v_add_f32 v84, 1.0, v84
    v_add_f32 v85, 1.0, v85
    v_add_f32 v86, 1.0, v86
    v_add_f32 v87, 1.0, v87
    v_add_f32 v88, 1.0, v88
    v_add_f32 v89, 1.0, v89
    v_add_f32 v90, 1.0, v90
    v_add_f32 v91, 1.0, v91
    v_add_f32 v92, 1.0, v92
    v_add_f32 v93, 1.0, v93
    v_add_f32 v94, 1.0, v94
    v_add_f32 v95, 1.0, v95
    v_rcp_f32 v80, v80
    v_rcp_f32 v81, v81
    v_rcp_f32 v82, v82
    v_rcp_f32 v83, v83
    v_rcp_f32 v84, v84
    v_rcp_f32 v85, v85
    v_rcp_f32 v86, v86
    v_rcp_f32 v87, v87
    v_rcp_f32 v88, v88
    v_rcp_f32 v89, v89
    v_rcp_f32 v90, v90
    v_rcp_f32 v91, v91
    v_rcp_f32 v92, v92
    v_rcp_f32 v93, v93
    v_rcp_f32 v94, v94
    v_rcp_f32 v95, v95
    v_mul_f32 v164, v164, v80
    v_mul_f32 v165, v165, v81
    v_mul_f32 v166, v166, v82
    v_mul_f32 v167, v167, v83
    v_mul_f32 v188, v188, v84
    v_mul_f32 v189, v189, v85
    v_mul_f32 v190, v190, v86
    v_mul_f32 v191, v191, v87
    v_mul_f32 v212, v212, v88
    v_mul_f32 v213, v213, v89
    v_mul_f32 v214, v214, v90
    v_mul_f32 v215, v215, v91
    v_mul_f32 v236, v236, v92
    v_mul_f32 v237, v237, v93
    v_mul_f32 v238, v238, v94
    v_mul_f32 v239, v239, v95
    v_cvt_pk_bf16_f32 v96, v164, v165
    v_cvt_pk_bf16_f32 v97, v166, v167
    v_cvt_pk_bf16_f32 v98, v188, v189
    v_cvt_pk_bf16_f32 v99, v190, v191
    v_cvt_pk_bf16_f32 v100, v212, v213
    v_cvt_pk_bf16_f32 v101, v214, v215
    v_cvt_pk_bf16_f32 v102, v236, v237
    v_cvt_pk_bf16_f32 v103, v238, v239
    s_lshl_b32 s64, s48, 9
    s_add_u32 s65, s64, 22528
    buffer_store_dwordx2 v[96:97], v48, s[28:31], s64 offen
    buffer_store_dwordx2 v[98:99], v48, s[28:31], s65 offen
    buffer_store_dwordx2 v[100:101], v49, s[28:31], s64 offen
    buffer_store_dwordx2 v[102:103], v49, s[28:31], s65 offen
P1_z1_skip1:
    s_lshr_b32 s48, s59, 6
    s_add_u32 s48, s48, 8
    s_cmp_ge_u32 s48, s63
    s_cbranch_scc1 P1_z1_skip2
    s_mul_i32 s49, s53, 11
    s_add_u32 s48, s48, s49
    v_mul_f32 v80, v168, v168
    v_mul_f32 v81, v169, v169
    v_mul_f32 v82, v170, v170
    v_mul_f32 v83, v171, v171
    v_mul_f32 v84, v192, v192
    v_mul_f32 v85, v193, v193
    v_mul_f32 v86, v194, v194
    v_mul_f32 v87, v195, v195
    v_mul_f32 v88, v216, v216
    v_mul_f32 v89, v217, v217
    v_mul_f32 v90, v218, v218
    v_mul_f32 v91, v219, v219
    v_mul_f32 v92, v240, v240
    v_mul_f32 v93, v241, v241
    v_mul_f32 v94, v242, v242
    v_mul_f32 v95, v243, v243
    v_fma_f32 v80, v80, s54, v79
    v_fma_f32 v81, v81, s54, v79
    v_fma_f32 v82, v82, s54, v79
    v_fma_f32 v83, v83, s54, v79
    v_fma_f32 v84, v84, s54, v79
    v_fma_f32 v85, v85, s54, v79
    v_fma_f32 v86, v86, s54, v79
    v_fma_f32 v87, v87, s54, v79
    v_fma_f32 v88, v88, s54, v79
    v_fma_f32 v89, v89, s54, v79
    v_fma_f32 v90, v90, s54, v79
    v_fma_f32 v91, v91, s54, v79
    v_fma_f32 v92, v92, s54, v79
    v_fma_f32 v93, v93, s54, v79
    v_fma_f32 v94, v94, s54, v79
    v_fma_f32 v95, v95, s54, v79
    v_mul_f32 v80, v80, v168
    v_mul_f32 v81, v81, v169
    v_mul_f32 v82, v82, v170
    v_mul_f32 v83, v83, v171
    v_mul_f32 v84, v84, v192
    v_mul_f32 v85, v85, v193
    v_mul_f32 v86, v86, v194
    v_mul_f32 v87, v87, v195
    v_mul_f32 v88, v88, v216
    v_mul_f32 v89, v89, v217
    v_mul_f32 v90, v90, v218
    v_mul_f32 v91, v91, v219
    v_mul_f32 v92, v92, v240
    v_mul_f32 v93, v93, v241
    v_mul_f32 v94, v94, v242
    v_mul_f32 v95, v95, v243
    v_exp_f32 v80, v80
    v_exp_f32 v81, v81
    v_exp_f32 v82, v82
    v_exp_f32 v83, v83
    v_exp_f32 v84, v84
    v_exp_f32 v85, v85
    v_exp_f32 v86, v86
    v_exp_f32 v87, v87
    v_exp_f32 v88, v88
    v_exp_f32 v89, v89
    v_exp_f32 v90, v90
    v_exp_f32 v91, v91
    v_exp_f32 v92, v92
    v_exp_f32 v93, v93
    v_exp_f32 v94, v94
    v_exp_f32 v95, v95
    v_add_f32 v80, 1.0, v80
    v_add_f32 v81, 1.0, v81
    v_add_f32 v82, 1.0, v82
    v_add_f32 v83, 1.0, v83
    v_add_f32 v84, 1.0, v84
    v_add_f32 v85, 1.0, v85
    v_add_f32 v86, 1.0, v86
    v_add_f32 v87, 1.0, v87
    v_add_f32 v88, 1.0, v88
    v_add_f32 v89, 1.0, v89
    v_add_f32 v90, 1.0, v90
    v_add_f32 v91, 1.0, v91
    v_add_f32 v92, 1.0, v92
    v_add_f32 v93, 1.0, v93
    v_add_f32 v94, 1.0, v94
    v_add_f32 v95, 1.0, v95
    v_rcp_f32 v80, v80
    v_rcp_f32 v81, v81
    v_rcp_f32 v82, v82
    v_rcp_f32 v83, v83
    v_rcp_f32 v84, v84
    v_rcp_f32 v85, v85
    v_rcp_f32 v86, v86
    v_rcp_f32 v87, v87
    v_rcp_f32 v88, v88
    v_rcp_f32 v89, v89
    v_rcp_f32 v90, v90
    v_rcp_f32 v91, v91
    v_rcp_f32 v92, v92
    v_rcp_f32 v93, v93
    v_rcp_f32 v94, v94
    v_rcp_f32 v95, v95
    v_mul_f32 v168, v168, v80
    v_mul_f32 v169, v169, v81
    v_mul_f32 v170, v170, v82
    v_mul_f32 v171, v171, v83
    v_mul_f32 v192, v192, v84
    v_mul_f32 v193, v193, v85
    v_mul_f32 v194, v194, v86
    v_mul_f32 v195, v195, v87
    v_mul_f32 v216, v216, v88
    v_mul_f32 v217, v217, v89
    v_mul_f32 v218, v218, v90
    v_mul_f32 v219, v219, v91
    v_mul_f32 v240, v240, v92
    v_mul_f32 v241, v241, v93
    v_mul_f32 v242, v242, v94
    v_mul_f32 v243, v243, v95
    v_cvt_pk_bf16_f32 v96, v168, v169
    v_cvt_pk_bf16_f32 v97, v170, v171
    v_cvt_pk_bf16_f32 v98, v192, v193
    v_cvt_pk_bf16_f32 v99, v194, v195
    v_cvt_pk_bf16_f32 v100, v216, v217
    v_cvt_pk_bf16_f32 v101, v218, v219
    v_cvt_pk_bf16_f32 v102, v240, v241
    v_cvt_pk_bf16_f32 v103, v242, v243
    s_lshl_b32 s64, s48, 9
    s_add_u32 s65, s64, 22528
    buffer_store_dwordx2 v[96:97], v48, s[28:31], s64 offen
    buffer_store_dwordx2 v[98:99], v48, s[28:31], s65 offen
    buffer_store_dwordx2 v[100:101], v49, s[28:31], s64 offen
    buffer_store_dwordx2 v[102:103], v49, s[28:31], s65 offen
P1_z1_skip2:
    s_lshr_b32 s48, s60, 6
    s_add_u32 s48, s48, 0
    s_cmp_ge_u32 s48, s63
    s_cbranch_scc1 P1_z1_skip3
    s_mul_i32 s49, s53, 11
    s_add_u32 s48, s48, s49
    v_mul_f32 v80, v172, v172
    v_mul_f32 v81, v173, v173
    v_mul_f32 v82, v174, v174
    v_mul_f32 v83, v175, v175
    v_mul_f32 v84, v196, v196
    v_mul_f32 v85, v197, v197
    v_mul_f32 v86, v198, v198
    v_mul_f32 v87, v199, v199
    v_mul_f32 v88, v220, v220
    v_mul_f32 v89, v221, v221
    v_mul_f32 v90, v222, v222
    v_mul_f32 v91, v223, v223
    v_mul_f32 v92, v244, v244
    v_mul_f32 v93, v245, v245
    v_mul_f32 v94, v246, v246
    v_mul_f32 v95, v247, v247
    v_fma_f32 v80, v80, s54, v79
    v_fma_f32 v81, v81, s54, v79
    v_fma_f32 v82, v82, s54, v79
    v_fma_f32 v83, v83, s54, v79
    v_fma_f32 v84, v84, s54, v79
    v_fma_f32 v85, v85, s54, v79
    v_fma_f32 v86, v86, s54, v79
    v_fma_f32 v87, v87, s54, v79
    v_fma_f32 v88, v88, s54, v79
    v_fma_f32 v89, v89, s54, v79
    v_fma_f32 v90, v90, s54, v79
    v_fma_f32 v91, v91, s54, v79
    v_fma_f32 v92, v92, s54, v79
    v_fma_f32 v93, v93, s54, v79
    v_fma_f32 v94, v94, s54, v79
    v_fma_f32 v95, v95, s54, v79
    v_mul_f32 v80, v80, v172
    v_mul_f32 v81, v81, v173
    v_mul_f32 v82, v82, v174
    v_mul_f32 v83, v83, v175
    v_mul_f32 v84, v84, v196
    v_mul_f32 v85, v85, v197
    v_mul_f32 v86, v86, v198
    v_mul_f32 v87, v87, v199
    v_mul_f32 v88, v88, v220
    v_mul_f32 v89, v89, v221
    v_mul_f32 v90, v90, v222
    v_mul_f32 v91, v91, v223
    v_mul_f32 v92, v92, v244
    v_mul_f32 v93, v93, v245
    v_mul_f32 v94, v94, v246
    v_mul_f32 v95, v95, v247
    v_exp_f32 v80, v80
    v_exp_f32 v81, v81
    v_exp_f32 v82, v82
    v_exp_f32 v83, v83
    v_exp_f32 v84, v84
    v_exp_f32 v85, v85
    v_exp_f32 v86, v86
    v_exp_f32 v87, v87
    v_exp_f32 v88, v88
    v_exp_f32 v89, v89
    v_exp_f32 v90, v90
    v_exp_f32 v91, v91
    v_exp_f32 v92, v92
    v_exp_f32 v93, v93
    v_exp_f32 v94, v94
    v_exp_f32 v95, v95
    v_add_f32 v80, 1.0, v80
    v_add_f32 v81, 1.0, v81
    v_add_f32 v82, 1.0, v82
    v_add_f32 v83, 1.0, v83
    v_add_f32 v84, 1.0, v84
    v_add_f32 v85, 1.0, v85
    v_add_f32 v86, 1.0, v86
    v_add_f32 v87, 1.0, v87
    v_add_f32 v88, 1.0, v88
    v_add_f32 v89, 1.0, v89
    v_add_f32 v90, 1.0, v90
    v_add_f32 v91, 1.0, v91
    v_add_f32 v92, 1.0, v92
    v_add_f32 v93, 1.0, v93
    v_add_f32 v94, 1.0, v94
    v_add_f32 v95, 1.0, v95
    v_rcp_f32 v80, v80
    v_rcp_f32 v81, v81
    v_rcp_f32 v82, v82
    v_rcp_f32 v83, v83
    v_rcp_f32 v84, v84
    v_rcp_f32 v85, v85
    v_rcp_f32 v86, v86
    v_rcp_f32 v87, v87
    v_rcp_f32 v88, v88
    v_rcp_f32 v89, v89
    v_rcp_f32 v90, v90
    v_rcp_f32 v91, v91
    v_rcp_f32 v92, v92
    v_rcp_f32 v93, v93
    v_rcp_f32 v94, v94
    v_rcp_f32 v95, v95
    v_mul_f32 v172, v172, v80
    v_mul_f32 v173, v173, v81
    v_mul_f32 v174, v174, v82
    v_mul_f32 v175, v175, v83
    v_mul_f32 v196, v196, v84
    v_mul_f32 v197, v197, v85
    v_mul_f32 v198, v198, v86
    v_mul_f32 v199, v199, v87
    v_mul_f32 v220, v220, v88
    v_mul_f32 v221, v221, v89
    v_mul_f32 v222, v222, v90
    v_mul_f32 v223, v223, v91
    v_mul_f32 v244, v244, v92
    v_mul_f32 v245, v245, v93
    v_mul_f32 v246, v246, v94
    v_mul_f32 v247, v247, v95
    v_cvt_pk_bf16_f32 v96, v172, v173
    v_cvt_pk_bf16_f32 v97, v174, v175
    v_cvt_pk_bf16_f32 v98, v196, v197
    v_cvt_pk_bf16_f32 v99, v198, v199
    v_cvt_pk_bf16_f32 v100, v220, v221
    v_cvt_pk_bf16_f32 v101, v222, v223
    v_cvt_pk_bf16_f32 v102, v244, v245
    v_cvt_pk_bf16_f32 v103, v246, v247
    s_lshl_b32 s64, s48, 9
    s_add_u32 s65, s64, 22528
    buffer_store_dwordx2 v[96:97], v48, s[28:31], s64 offen
    buffer_store_dwordx2 v[98:99], v48, s[28:31], s65 offen
    buffer_store_dwordx2 v[100:101], v49, s[28:31], s64 offen
    buffer_store_dwordx2 v[102:103], v49, s[28:31], s65 offen
P1_z1_skip3:
    s_lshr_b32 s48, s60, 6
    s_add_u32 s48, s48, 4
    s_cmp_ge_u32 s48, s63
    s_cbranch_scc1 P1_z1_skip4
    s_mul_i32 s49, s53, 11
    s_add_u32 s48, s48, s49
    v_mul_f32 v80, v176, v176
    v_mul_f32 v81, v177, v177
    v_mul_f32 v82, v178, v178
    v_mul_f32 v83, v179, v179
    v_mul_f32 v84, v200, v200
    v_mul_f32 v85, v201, v201
    v_mul_f32 v86, v202, v202
    v_mul_f32 v87, v203, v203
    v_mul_f32 v88, v224, v224
    v_mul_f32 v89, v225, v225
    v_mul_f32 v90, v226, v226
    v_mul_f32 v91, v227, v227
    v_mul_f32 v92, v248, v248
    v_mul_f32 v93, v249, v249
    v_mul_f32 v94, v250, v250
    v_mul_f32 v95, v251, v251
    v_fma_f32 v80, v80, s54, v79
    v_fma_f32 v81, v81, s54, v79
    v_fma_f32 v82, v82, s54, v79
    v_fma_f32 v83, v83, s54, v79
    v_fma_f32 v84, v84, s54, v79
    v_fma_f32 v85, v85, s54, v79
    v_fma_f32 v86, v86, s54, v79
    v_fma_f32 v87, v87, s54, v79
    v_fma_f32 v88, v88, s54, v79
    v_fma_f32 v89, v89, s54, v79
    v_fma_f32 v90, v90, s54, v79
    v_fma_f32 v91, v91, s54, v79
    v_fma_f32 v92, v92, s54, v79
    v_fma_f32 v93, v93, s54, v79
    v_fma_f32 v94, v94, s54, v79
    v_fma_f32 v95, v95, s54, v79
    v_mul_f32 v80, v80, v176
    v_mul_f32 v81, v81, v177
    v_mul_f32 v82, v82, v178
    v_mul_f32 v83, v83, v179
    v_mul_f32 v84, v84, v200
    v_mul_f32 v85, v85, v201
    v_mul_f32 v86, v86, v202
    v_mul_f32 v87, v87, v203
    v_mul_f32 v88, v88, v224
    v_mul_f32 v89, v89, v225
    v_mul_f32 v90, v90, v226
    v_mul_f32 v91, v91, v227
    v_mul_f32 v92, v92, v248
    v_mul_f32 v93, v93, v249
    v_mul_f32 v94, v94, v250
    v_mul_f32 v95, v95, v251
    v_exp_f32 v80, v80
    v_exp_f32 v81, v81
    v_exp_f32 v82, v82
    v_exp_f32 v83, v83
    v_exp_f32 v84, v84
    v_exp_f32 v85, v85
    v_exp_f32 v86, v86
    v_exp_f32 v87, v87
    v_exp_f32 v88, v88
    v_exp_f32 v89, v89
    v_exp_f32 v90, v90
    v_exp_f32 v91, v91
    v_exp_f32 v92, v92
    v_exp_f32 v93, v93
    v_exp_f32 v94, v94
    v_exp_f32 v95, v95
    v_add_f32 v80, 1.0, v80
    v_add_f32 v81, 1.0, v81
    v_add_f32 v82, 1.0, v82
    v_add_f32 v83, 1.0, v83
    v_add_f32 v84, 1.0, v84
    v_add_f32 v85, 1.0, v85
    v_add_f32 v86, 1.0, v86
    v_add_f32 v87, 1.0, v87
    v_add_f32 v88, 1.0, v88
    v_add_f32 v89, 1.0, v89
    v_add_f32 v90, 1.0, v90
    v_add_f32 v91, 1.0, v91
    v_add_f32 v92, 1.0, v92
    v_add_f32 v93, 1.0, v93
    v_add_f32 v94, 1.0, v94
    v_add_f32 v95, 1.0, v95
    v_rcp_f32 v80, v80
    v_rcp_f32 v81, v81
    v_rcp_f32 v82, v82
    v_rcp_f32 v83, v83
    v_rcp_f32 v84, v84
    v_rcp_f32 v85, v85
    v_rcp_f32 v86, v86
    v_rcp_f32 v87, v87
    v_rcp_f32 v88, v88
    v_rcp_f32 v89, v89
    v_rcp_f32 v90, v90
    v_rcp_f32 v91, v91
    v_rcp_f32 v92, v92
    v_rcp_f32 v93, v93
    v_rcp_f32 v94, v94
    v_rcp_f32 v95, v95
    v_mul_f32 v176, v176, v80
    v_mul_f32 v177, v177, v81
    v_mul_f32 v178, v178, v82
    v_mul_f32 v179, v179, v83
    v_mul_f32 v200, v200, v84
    v_mul_f32 v201, v201, v85
    v_mul_f32 v202, v202, v86
    v_mul_f32 v203, v203, v87
    v_mul_f32 v224, v224, v88
    v_mul_f32 v225, v225, v89
    v_mul_f32 v226, v226, v90
    v_mul_f32 v227, v227, v91
    v_mul_f32 v248, v248, v92
    v_mul_f32 v249, v249, v93
    v_mul_f32 v250, v250, v94
    v_mul_f32 v251, v251, v95
    v_cvt_pk_bf16_f32 v96, v176, v177
    v_cvt_pk_bf16_f32 v97, v178, v179
    v_cvt_pk_bf16_f32 v98, v200, v201
    v_cvt_pk_bf16_f32 v99, v202, v203
    v_cvt_pk_bf16_f32 v100, v224, v225
    v_cvt_pk_bf16_f32 v101, v226, v227
    v_cvt_pk_bf16_f32 v102, v248, v249
    v_cvt_pk_bf16_f32 v103, v250, v251
    s_lshl_b32 s64, s48, 9
    s_add_u32 s65, s64, 22528
    buffer_store_dwordx2 v[96:97], v48, s[28:31], s64 offen
    buffer_store_dwordx2 v[98:99], v48, s[28:31], s65 offen
    buffer_store_dwordx2 v[100:101], v49, s[28:31], s64 offen
    buffer_store_dwordx2 v[102:103], v49, s[28:31], s65 offen
P1_z1_skip4:
    s_lshr_b32 s48, s60, 6
    s_add_u32 s48, s48, 8
    s_cmp_ge_u32 s48, s63
    s_cbranch_scc1 P1_z1_skip5
    s_mul_i32 s49, s53, 11
    s_add_u32 s48, s48, s49
    v_mul_f32 v80, v180, v180
    v_mul_f32 v81, v181, v181
    v_mul_f32 v82, v182, v182
    v_mul_f32 v83, v183, v183
    v_mul_f32 v84, v204, v204
    v_mul_f32 v85, v205, v205
    v_mul_f32 v86, v206, v206
    v_mul_f32 v87, v207, v207
    v_mul_f32 v88, v228, v228
    v_mul_f32 v89, v229, v229
    v_mul_f32 v90, v230, v230
    v_mul_f32 v91, v231, v231
    v_mul_f32 v92, v252, v252
    v_mul_f32 v93, v253, v253
    v_mul_f32 v94, v254, v254
    v_mul_f32 v95, v255, v255
    v_fma_f32 v80, v80, s54, v79
    v_fma_f32 v81, v81, s54, v79
    v_fma_f32 v82, v82, s54, v79
    v_fma_f32 v83, v83, s54, v79
    v_fma_f32 v84, v84, s54, v79
    v_fma_f32 v85, v85, s54, v79
    v_fma_f32 v86, v86, s54, v79
    v_fma_f32 v87, v87, s54, v79
    v_fma_f32 v88, v88, s54, v79
    v_fma_f32 v89, v89, s54, v79
    v_fma_f32 v90, v90, s54, v79
    v_fma_f32 v91, v91, s54, v79
    v_fma_f32 v92, v92, s54, v79
    v_fma_f32 v93, v93, s54, v79
    v_fma_f32 v94, v94, s54, v79
    v_fma_f32 v95, v95, s54, v79
    v_mul_f32 v80, v80, v180
    v_mul_f32 v81, v81, v181
    v_mul_f32 v82, v82, v182
    v_mul_f32 v83, v83, v183
    v_mul_f32 v84, v84, v204
    v_mul_f32 v85, v85, v205
    v_mul_f32 v86, v86, v206
    v_mul_f32 v87, v87, v207
    v_mul_f32 v88, v88, v228
    v_mul_f32 v89, v89, v229
    v_mul_f32 v90, v90, v230
    v_mul_f32 v91, v91, v231
    v_mul_f32 v92, v92, v252
    v_mul_f32 v93, v93, v253
    v_mul_f32 v94, v94, v254
    v_mul_f32 v95, v95, v255
    v_exp_f32 v80, v80
    v_exp_f32 v81, v81
    v_exp_f32 v82, v82
    v_exp_f32 v83, v83
    v_exp_f32 v84, v84
    v_exp_f32 v85, v85
    v_exp_f32 v86, v86
    v_exp_f32 v87, v87
    v_exp_f32 v88, v88
    v_exp_f32 v89, v89
    v_exp_f32 v90, v90
    v_exp_f32 v91, v91
    v_exp_f32 v92, v92
    v_exp_f32 v93, v93
    v_exp_f32 v94, v94
    v_exp_f32 v95, v95
    v_add_f32 v80, 1.0, v80
    v_add_f32 v81, 1.0, v81
    v_add_f32 v82, 1.0, v82
    v_add_f32 v83, 1.0, v83
    v_add_f32 v84, 1.0, v84
    v_add_f32 v85, 1.0, v85
    v_add_f32 v86, 1.0, v86
    v_add_f32 v87, 1.0, v87
    v_add_f32 v88, 1.0, v88
    v_add_f32 v89, 1.0, v89
    v_add_f32 v90, 1.0, v90
    v_add_f32 v91, 1.0, v91
    v_add_f32 v92, 1.0, v92
    v_add_f32 v93, 1.0, v93
    v_add_f32 v94, 1.0, v94
    v_add_f32 v95, 1.0, v95
    v_rcp_f32 v80, v80
    v_rcp_f32 v81, v81
    v_rcp_f32 v82, v82
    v_rcp_f32 v83, v83
    v_rcp_f32 v84, v84
    v_rcp_f32 v85, v85
    v_rcp_f32 v86, v86
    v_rcp_f32 v87, v87
    v_rcp_f32 v88, v88
    v_rcp_f32 v89, v89
    v_rcp_f32 v90, v90
    v_rcp_f32 v91, v91
    v_rcp_f32 v92, v92
    v_rcp_f32 v93, v93
    v_rcp_f32 v94, v94
    v_rcp_f32 v95, v95
    v_mul_f32 v180, v180, v80
    v_mul_f32 v181, v181, v81
    v_mul_f32 v182, v182, v82
    v_mul_f32 v183, v183, v83
    v_mul_f32 v204, v204, v84
    v_mul_f32 v205, v205, v85
    v_mul_f32 v206, v206, v86
    v_mul_f32 v207, v207, v87
    v_mul_f32 v228, v228, v88
    v_mul_f32 v229, v229, v89
    v_mul_f32 v230, v230, v90
    v_mul_f32 v231, v231, v91
    v_mul_f32 v252, v252, v92
    v_mul_f32 v253, v253, v93
    v_mul_f32 v254, v254, v94
    v_mul_f32 v255, v255, v95
    v_cvt_pk_bf16_f32 v96, v180, v181
    v_cvt_pk_bf16_f32 v97, v182, v183
    v_cvt_pk_bf16_f32 v98, v204, v205
    v_cvt_pk_bf16_f32 v99, v206, v207
    v_cvt_pk_bf16_f32 v100, v228, v229
    v_cvt_pk_bf16_f32 v101, v230, v231
    v_cvt_pk_bf16_f32 v102, v252, v253
    v_cvt_pk_bf16_f32 v103, v254, v255
    s_lshl_b32 s64, s48, 9
    s_add_u32 s65, s64, 22528
    buffer_store_dwordx2 v[96:97], v48, s[28:31], s64 offen
    buffer_store_dwordx2 v[98:99], v48, s[28:31], s65 offen
    buffer_store_dwordx2 v[100:101], v49, s[28:31], s64 offen
    buffer_store_dwordx2 v[102:103], v49, s[28:31], s65 offen
P1_z1_skip5:
    s_endpgm
P1_z2:
    s_add_u32 s28, s12, 8388608
    s_addc_u32 s29, s13, 0
    s_mov_b32 s30, 2818048
    s_mov_b32 s31, 0x00020000
    s_add_u32 s32, s12, 12582912
    s_addc_u32 s33, s13, 0
    s_mov_b32 s34, 65536
    s_mov_b32 s35, 0x00020000
    s_waitcnt vmcnt(20) lgkmcnt(0)
    s_barrier
    ds_read_b128 v[80:83], v14 offset:0
    ds_read_b128 v[84:87], v14 offset:2048
    ds_read_b128 v[88:91], v16 offset:0
    ds_read_b128 v[92:95], v16 offset:2048
    ds_read_b64_tr_b16 v[96:97], v18 offset:0
    ds_read_b64_tr_b16 v[98:99], v18 offset:1536
    ds_read_b64_tr_b16 v[100:101], v19 offset:0
    ds_read_b64_tr_b16 v[102:103], v19 offset:1536
    ds_read_b64_tr_b16 v[104:105], v20 offset:0
    ds_read_b64_tr_b16 v[106:107], v20 offset:1536
    ds_read_b64_tr_b16 v[108:109], v21 offset:0
    ds_read_b64_tr_b16 v[110:111], v21 offset:1536
    ds_read_b64_tr_b16 v[112:113], v22 offset:0
    ds_read_b64_tr_b16 v[114:115], v22 offset:1536
    ds_read_b64_tr_b16 v[116:117], v23 offset:0
    ds_read_b64_tr_b16 v[118:119], v23 offset:1536
    s_waitcnt lgkmcnt(0)
    v_mfma_f32_16x16x32_bf16 v[160:163], v[80:83], v[96:99], 0
    ds_read_b128 v[120:123], v15 offset:0
    v_mfma_f32_16x16x32_bf16 v[184:187], v[84:87], v[96:99], 0
    ds_read_b128 v[124:127], v15 offset:2048
    v_mfma_f32_16x16x32_bf16 v[208:211], v[88:91], v[96:99], 0
    ds_read_b128 v[128:131], v17 offset:0
    v_mfma_f32_16x16x32_bf16 v[232:235], v[92:95], v[96:99], 0
    ds_read_b128 v[132:135], v17 offset:2048
    v_mfma_f32_16x16x32_bf16 v[164:167], v[80:83], v[100:103], 0
    ds_read_b64_tr_b16 v[136:137], v18 offset:12288
    v_mfma_f32_16x16x32_bf16 v[188:191], v[84:87], v[100:103], 0
    ds_read_b64_tr_b16 v[138:139], v18 offset:13824
    v_mfma_f32_16x16x32_bf16 v[212:215], v[88:91], v[100:103], 0
    ds_read_b64_tr_b16 v[140:141], v19 offset:12288
    v_mfma_f32_16x16x32_bf16 v[236:239], v[92:95], v[100:103], 0
    ds_read_b64_tr_b16 v[142:143], v19 offset:13824
    v_mfma_f32_16x16x32_bf16 v[168:171], v[80:83], v[104:107], 0
    ds_read_b64_tr_b16 v[144:145], v20 offset:12288
    v_mfma_f32_16x16x32_bf16 v[192:195], v[84:87], v[104:107], 0
    ds_read_b64_tr_b16 v[146:147], v20 offset:13824
    v_mfma_f32_16x16x32_bf16 v[216:219], v[88:91], v[104:107], 0
    ds_read_b64_tr_b16 v[148:149], v21 offset:12288
    v_mfma_f32_16x16x32_bf16 v[240:243], v[92:95], v[104:107], 0
    ds_read_b64_tr_b16 v[150:151], v21 offset:13824
    v_mfma_f32_16x16x32_bf16 v[172:175], v[80:83], v[108:111], 0
    ds_read_b64_tr_b16 v[152:153], v22 offset:12288
    v_mfma_f32_16x16x32_bf16 v[196:199], v[84:87], v[108:111], 0
    ds_read_b64_tr_b16 v[154:155], v22 offset:13824
    v_mfma_f32_16x16x32_bf16 v[220:223], v[88:91], v[108:111], 0
    ds_read_b64_tr_b16 v[156:157], v23 offset:12288
    v_mfma_f32_16x16x32_bf16 v[244:247], v[92:95], v[108:111], 0
    ds_read_b64_tr_b16 v[158:159], v23 offset:13824
    v_mfma_f32_16x16x32_bf16 v[176:179], v[80:83], v[112:115], 0
    v_mfma_f32_16x16x32_bf16 v[200:203], v[84:87], v[112:115], 0
    v_mfma_f32_16x16x32_bf16 v[224:227], v[88:91], v[112:115], 0
    v_mfma_f32_16x16x32_bf16 v[248:251], v[92:95], v[112:115], 0
    v_mfma_f32_16x16x32_bf16 v[180:183], v[80:83], v[116:119], 0
    v_mfma_f32_16x16x32_bf16 v[204:207], v[84:87], v[116:119], 0
    v_mfma_f32_16x16x32_bf16 v[228:231], v[88:91], v[116:119], 0
    v_mfma_f32_16x16x32_bf16 v[252:255], v[92:95], v[116:119], 0
    v_mfma_f32_16x16x32_bf16 a[0:3], v[24:27], v[80:83], 0
    v_mfma_f32_16x16x32_bf16 a[8:11], v[80:83], v[80:83], 0
    v_mfma_f32_16x16x32_bf16 a[4:7], v[24:27], v[84:87], 0
    v_mfma_f32_16x16x32_bf16 a[12:15], v[84:87], v[84:87], 0
    v_mfma_f32_16x16x32_bf16 a[16:19], v[24:27], v[96:99], 0
    v_mfma_f32_16x16x32_bf16 a[20:23], v[24:27], v[100:103], 0
    v_mfma_f32_16x16x32_bf16 a[24:27], v[24:27], v[104:107], 0
    s_waitcnt vmcnt(10) lgkmcnt(0)
    s_barrier
    v_mfma_f32_16x16x32_bf16 a[0:3], v[24:27], v[120:123], a[0:3]
    ds_read_b128 v[80:83], v14 offset:16384
    ds_read_b128 v[84:87], v14 offset:18432
    v_mfma_f32_16x16x32_bf16 a[8:11], v[120:123], v[120:123], a[8:11]
    ds_read_b128 v[88:91], v16 offset:16384
    ds_read_b128 v[92:95], v16 offset:18432
    v_mfma_f32_16x16x32_bf16 a[4:7], v[24:27], v[124:127], a[4:7]
    ds_read_b64_tr_b16 v[96:97], v18 offset:24576
    ds_read_b64_tr_b16 v[98:99], v18 offset:26112
    v_mfma_f32_16x16x32_bf16 a[12:15], v[124:127], v[124:127], a[12:15]
    ds_read_b64_tr_b16 v[100:101], v19 offset:24576
    ds_read_b64_tr_b16 v[102:103], v19 offset:26112
    v_mfma_f32_16x16x32_bf16 a[16:19], v[24:27], v[136:139], a[16:19]
    ds_read_b64_tr_b16 v[104:105], v20 offset:24576
    ds_read_b64_tr_b16 v[106:107], v20 offset:26112
    v_mfma_f32_16x16x32_bf16 a[20:23], v[24:27], v[140:143], a[20:23]
    ds_read_b64_tr_b16 v[108:109], v21 offset:24576
    ds_read_b64_tr_b16 v[110:111], v21 offset:26112
    v_mfma_f32_16x16x32_bf16 a[24:27], v[24:27], v[144:147], a[24:27]
    ds_read_b64_tr_b16 v[112:113], v22 offset:24576
    ds_read_b64_tr_b16 v[114:115], v22 offset:26112
    v_mfma_f32_16x16x32_bf16 v[160:163], v[120:123], v[136:139], v[160:163]
    ds_read_b64_tr_b16 v[116:117], v23 offset:24576
    ds_read_b64_tr_b16 v[118:119], v23 offset:26112
    v_mfma_f32_16x16x32_bf16 v[184:187], v[124:127], v[136:139], v[184:187]
    s_movk_i32 s46, 384
    s_mov_b32 s47, 528384
    v_mfma_f32_16x16x32_bf16 v[208:211], v[128:131], v[136:139], v[208:211]
    s_add_u32 m0, s55, 8192
    s_nop 0
    buffer_load_dwordx4 v4, s[16:19], s46 offen lds
    v_mfma_f32_16x16x32_bf16 v[232:235], v[132:135], v[136:139], v[232:235]
    s_add_u32 m0, s55, 9216
    s_nop 0
    buffer_load_dwordx4 v5, s[16:19], s46 offen lds
    v_mfma_f32_16x16x32_bf16 v[164:167], v[120:123], v[140:143], v[164:167]
    s_add_u32 m0, s55, 10240
    s_nop 0
    buffer_load_dwordx4 v6, s[16:19], s46 offen lds
    v_mfma_f32_16x16x32_bf16 v[188:191], v[124:127], v[140:143], v[188:191]
    s_add_u32 m0, s55, 11264
    s_nop 0
    buffer_load_dwordx4 v7, s[16:19], s46 offen lds
    v_mfma_f32_16x16x32_bf16 v[212:215], v[128:131], v[140:143], v[212:215]
    s_add_u32 m0, s56, 57344
    s_nop 0
    buffer_load_dwordx4 v8, s[20:23], s47 offen lds
    v_mfma_f32_16x16x32_bf16 v[236:239], v[132:135], v[140:143], v[236:239]
    s_add_u32 m0, s56, 58368
    s_nop 0
    buffer_load_dwordx4 v9, s[20:23], s47 offen lds
    v_mfma_f32_16x16x32_bf16 v[168:171], v[120:123], v[144:147], v[168:171]
    s_add_u32 m0, s56, 59392
    s_nop 0
    buffer_load_dwordx4 v10, s[20:23], s47 offen lds
    v_mfma_f32_16x16x32_bf16 v[192:195], v[124:127], v[144:147], v[192:195]
    s_add_u32 m0, s56, 60416
    s_nop 0
    buffer_load_dwordx4 v11, s[20:23], s47 offen lds
    v_mfma_f32_16x16x32_bf16 v[216:219], v[128:131], v[144:147], v[216:219]
    s_add_u32 m0, s56, 61440
    s_nop 0
    buffer_load_dwordx4 v12, s[20:23], s47 offen lds
    v_mfma_f32_16x16x32_bf16 v[240:243], v[132:135], v[144:147], v[240:243]
    s_add_u32 m0, s56, 62464
    s_nop 0
    buffer_load_dwordx4 v13, s[20:23], s47 offen lds
    v_mfma_f32_16x16x32_bf16 v[172:175], v[120:123], v[148:151], v[172:175]
    v_mfma_f32_16x16x32_bf16 v[196:199], v[124:127], v[148:151], v[196:199]
    v_mfma_f32_16x16x32_bf16 v[220:223], v[128:131], v[148:151], v[220:223]
    v_mfma_f32_16x16x32_bf16 v[244:247], v[132:135], v[148:151], v[244:247]
    v_mfma_f32_16x16x32_bf16 v[176:179], v[120:123], v[152:155], v[176:179]
    v_mfma_f32_16x16x32_bf16 v[200:203], v[124:127], v[152:155], v[200:203]
    v_mfma_f32_16x16x32_bf16 v[224:227], v[128:131], v[152:155], v[224:227]
    v_mfma_f32_16x16x32_bf16 v[248:251], v[132:135], v[152:155], v[248:251]
    v_mfma_f32_16x16x32_bf16 v[180:183], v[120:123], v[156:159], v[180:183]
    v_mfma_f32_16x16x32_bf16 v[204:207], v[124:127], v[156:159], v[204:207]
    v_mfma_f32_16x16x32_bf16 v[228:231], v[128:131], v[156:159], v[228:231]
    v_mfma_f32_16x16x32_bf16 v[252:255], v[132:135], v[156:159], v[252:255]
    s_waitcnt lgkmcnt(0)
    v_mfma_f32_16x16x32_bf16 v[160:163], v[80:83], v[96:99], v[160:163]
    ds_read_b128 v[120:123], v15 offset:16384
    v_mfma_f32_16x16x32_bf16 v[184:187], v[84:87], v[96:99], v[184:187]
    ds_read_b128 v[124:127], v15 offset:18432
    v_mfma_f32_16x16x32_bf16 v[208:211], v[88:91], v[96:99], v[208:211]
    ds_read_b128 v[128:131], v17 offset:16384
    v_mfma_f32_16x16x32_bf16 v[232:235], v[92:95], v[96:99], v[232:235]
    ds_read_b128 v[132:135], v17 offset:18432
    v_mfma_f32_16x16x32_bf16 v[164:167], v[80:83], v[100:103], v[164:167]
    ds_read_b64_tr_b16 v[136:137], v18 offset:36864
    v_mfma_f32_16x16x32_bf16 v[188:191], v[84:87], v[100:103], v[188:191]
    ds_read_b64_tr_b16 v[138:139], v18 offset:38400
    v_mfma_f32_16x16x32_bf16 v[212:215], v[88:91], v[100:103], v[212:215]
    ds_read_b64_tr_b16 v[140:141], v19 offset:36864
    v_mfma_f32_16x16x32_bf16 v[236:239], v[92:95], v[100:103], v[236:239]
    ds_read_b64_tr_b16 v[142:143], v19 offset:38400
    v_mfma_f32_16x16x32_bf16 v[168:171], v[80:83], v[104:107], v[168:171]
    ds_read_b64_tr_b16 v[144:145], v20 offset:36864
    v_mfma_f32_16x16x32_bf16 v[192:195], v[84:87], v[104:107], v[192:195]
    ds_read_b64_tr_b16 v[146:147], v20 offset:38400
    v_mfma_f32_16x16x32_bf16 v[216:219], v[88:91], v[104:107], v[216:219]
    ds_read_b64_tr_b16 v[148:149], v21 offset:36864
    v_mfma_f32_16x16x32_bf16 v[240:243], v[92:95], v[104:107], v[240:243]
    ds_read_b64_tr_b16 v[150:151], v21 offset:38400
    v_mfma_f32_16x16x32_bf16 v[172:175], v[80:83], v[108:111], v[172:175]
    ds_read_b64_tr_b16 v[152:153], v22 offset:36864
    v_mfma_f32_16x16x32_bf16 v[196:199], v[84:87], v[108:111], v[196:199]
    ds_read_b64_tr_b16 v[154:155], v22 offset:38400
    v_mfma_f32_16x16x32_bf16 v[220:223], v[88:91], v[108:111], v[220:223]
    ds_read_b64_tr_b16 v[156:157], v23 offset:36864
    v_mfma_f32_16x16x32_bf16 v[244:247], v[92:95], v[108:111], v[244:247]
    ds_read_b64_tr_b16 v[158:159], v23 offset:38400
    v_mfma_f32_16x16x32_bf16 v[176:179], v[80:83], v[112:115], v[176:179]
    v_mfma_f32_16x16x32_bf16 v[200:203], v[84:87], v[112:115], v[200:203]
    v_mfma_f32_16x16x32_bf16 v[224:227], v[88:91], v[112:115], v[224:227]
    v_mfma_f32_16x16x32_bf16 v[248:251], v[92:95], v[112:115], v[248:251]
    v_mfma_f32_16x16x32_bf16 v[180:183], v[80:83], v[116:119], v[180:183]
    v_mfma_f32_16x16x32_bf16 v[204:207], v[84:87], v[116:119], v[204:207]
    v_mfma_f32_16x16x32_bf16 v[228:231], v[88:91], v[116:119], v[228:231]
    v_mfma_f32_16x16x32_bf16 v[252:255], v[92:95], v[116:119], v[252:255]
    v_mfma_f32_16x16x32_bf16 a[0:3], v[24:27], v[80:83], a[0:3]
    v_mfma_f32_16x16x32_bf16 a[8:11], v[80:83], v[80:83], a[8:11]
    v_mfma_f32_16x16x32_bf16 a[4:7], v[24:27], v[84:87], a[4:7]
    v_mfma_f32_16x16x32_bf16 a[12:15], v[84:87], v[84:87], a[12:15]
    v_mfma_f32_16x16x32_bf16 a[16:19], v[24:27], v[96:99], a[16:19]
    v_mfma_f32_16x16x32_bf16 a[20:23], v[24:27], v[100:103], a[20:23]
    v_mfma_f32_16x16x32_bf16 a[24:27], v[24:27], v[104:107], a[24:27]
    s_waitcnt vmcnt(10) lgkmcnt(0)
    s_barrier
    v_mfma_f32_16x16x32_bf16 a[0:3], v[24:27], v[120:123], a[0:3]
    ds_read_b128 v[80:83], v14 offset:32768
    ds_read_b128 v[84:87], v14 offset:34816
    v_mfma_f32_16x16x32_bf16 a[8:11], v[120:123], v[120:123], a[8:11]
    ds_read_b128 v[88:91], v16 offset:32768
    ds_read_b128 v[92:95], v16 offset:34816
    v_mfma_f32_16x16x32_bf16 a[4:7], v[24:27], v[124:127], a[4:7]
    ds_read_b64_tr_b16 v[96:97], v18 offset:49152
    ds_read_b64_tr_b16 v[98:99], v18 offset:50688
    v_mfma_f32_16x16x32_bf16 a[12:15], v[124:127], v[124:127], a[12:15]
    ds_read_b64_tr_b16 v[100:101], v19 offset:49152
    ds_read_b64_tr_b16 v[102:103], v19 offset:50688
    v_mfma_f32_16x16x32_bf16 a[16:19], v[24:27], v[136:139], a[16:19]
    ds_read_b64_tr_b16 v[104:105], v20 offset:49152
    ds_read_b64_tr_b16 v[106:107], v20 offset:50688
    v_mfma_f32_16x16x32_bf16 a[20:23], v[24:27], v[140:143], a[20:23]
    ds_read_b64_tr_b16 v[108:109], v21 offset:49152
    ds_read_b64_tr_b16 v[110:111], v21 offset:50688
    v_mfma_f32_16x16x32_bf16 a[24:27], v[24:27], v[144:147], a[24:27]
    ds_read_b64_tr_b16 v[112:113], v22 offset:49152
    ds_read_b64_tr_b16 v[114:115], v22 offset:50688
    v_mfma_f32_16x16x32_bf16 v[160:163], v[120:123], v[136:139], v[160:163]
    ds_read_b64_tr_b16 v[116:117], v23 offset:49152
    ds_read_b64_tr_b16 v[118:119], v23 offset:50688
    v_mfma_f32_16x16x32_bf16 v[184:187], v[124:127], v[136:139], v[184:187]
    s_movk_i32 s46, 512
    s_mov_b32 s47, 704512
    v_mfma_f32_16x16x32_bf16 v[208:211], v[128:131], v[136:139], v[208:211]
    s_add_u32 m0, s55, 24576
    s_nop 0
    buffer_load_dwordx4 v4, s[16:19], s46 offen lds
    v_mfma_f32_16x16x32_bf16 v[232:235], v[132:135], v[136:139], v[232:235]
    s_add_u32 m0, s55, 25600
    s_nop 0
    buffer_load_dwordx4 v5, s[16:19], s46 offen lds
    v_mfma_f32_16x16x32_bf16 v[164:167], v[120:123], v[140:143], v[164:167]
    s_add_u32 m0, s55, 26624
    s_nop 0
    buffer_load_dwordx4 v6, s[16:19], s46 offen lds
    v_mfma_f32_16x16x32_bf16 v[188:191], v[124:127], v[140:143], v[188:191]
    s_add_u32 m0, s55, 27648
    s_nop 0
    buffer_load_dwordx4 v7, s[16:19], s46 offen lds
    v_mfma_f32_16x16x32_bf16 v[212:215], v[128:131], v[140:143], v[212:215]
    s_add_u32 m0, s56, 81920
    s_nop 0
    buffer_load_dwordx4 v8, s[20:23], s47 offen lds
    v_mfma_f32_16x16x32_bf16 v[236:239], v[132:135], v[140:143], v[236:239]
    s_add_u32 m0, s56, 82944
    s_nop 0
    buffer_load_dwordx4 v9, s[20:23], s47 offen lds
    v_mfma_f32_16x16x32_bf16 v[168:171], v[120:123], v[144:147], v[168:171]
    s_add_u32 m0, s56, 83968
    s_nop 0
    buffer_load_dwordx4 v10, s[20:23], s47 offen lds
    v_mfma_f32_16x16x32_bf16 v[192:195], v[124:127], v[144:147], v[192:195]
    s_add_u32 m0, s56, 84992
    s_nop 0
    buffer_load_dwordx4 v11, s[20:23], s47 offen lds
    v_mfma_f32_16x16x32_bf16 v[216:219], v[128:131], v[144:147], v[216:219]
    s_add_u32 m0, s56, 86016
    s_nop 0
    buffer_load_dwordx4 v12, s[20:23], s47 offen lds
    v_mfma_f32_16x16x32_bf16 v[240:243], v[132:135], v[144:147], v[240:243]
    s_add_u32 m0, s56, 87040
    s_nop 0
    buffer_load_dwordx4 v13, s[20:23], s47 offen lds
    v_mfma_f32_16x16x32_bf16 v[172:175], v[120:123], v[148:151], v[172:175]
    v_mfma_f32_16x16x32_bf16 v[196:199], v[124:127], v[148:151], v[196:199]
    v_mfma_f32_16x16x32_bf16 v[220:223], v[128:131], v[148:151], v[220:223]
    v_mfma_f32_16x16x32_bf16 v[244:247], v[132:135], v[148:151], v[244:247]
    v_mfma_f32_16x16x32_bf16 v[176:179], v[120:123], v[152:155], v[176:179]
    v_mfma_f32_16x16x32_bf16 v[200:203], v[124:127], v[152:155], v[200:203]
    v_mfma_f32_16x16x32_bf16 v[224:227], v[128:131], v[152:155], v[224:227]
    v_mfma_f32_16x16x32_bf16 v[248:251], v[132:135], v[152:155], v[248:251]
    v_mfma_f32_16x16x32_bf16 v[180:183], v[120:123], v[156:159], v[180:183]
    v_mfma_f32_16x16x32_bf16 v[204:207], v[124:127], v[156:159], v[204:207]
    v_mfma_f32_16x16x32_bf16 v[228:231], v[128:131], v[156:159], v[228:231]
    v_mfma_f32_16x16x32_bf16 v[252:255], v[132:135], v[156:159], v[252:255]
    s_waitcnt lgkmcnt(0)
    v_mfma_f32_16x16x32_bf16 v[160:163], v[80:83], v[96:99], v[160:163]
    ds_read_b128 v[120:123], v15 offset:32768
    v_mfma_f32_16x16x32_bf16 v[184:187], v[84:87], v[96:99], v[184:187]
    ds_read_b128 v[124:127], v15 offset:34816
    v_mfma_f32_16x16x32_bf16 v[208:211], v[88:91], v[96:99], v[208:211]
    ds_read_b128 v[128:131], v17 offset:32768
    v_mfma_f32_16x16x32_bf16 v[232:235], v[92:95], v[96:99], v[232:235]
    ds_read_b128 v[132:135], v17 offset:34816
    v_mfma_f32_16x16x32_bf16 v[164:167], v[80:83], v[100:103], v[164:167]
    ds_read_b64_tr_b16 v[136:137], v18 offset:61440
    v_mfma_f32_16x16x32_bf16 v[188:191], v[84:87], v[100:103], v[188:191]
    ds_read_b64_tr_b16 v[138:139], v18 offset:62976
    v_mfma_f32_16x16x32_bf16 v[212:215], v[88:91], v[100:103], v[212:215]
    ds_read_b64_tr_b16 v[140:141], v19 offset:61440
    v_mfma_f32_16x16x32_bf16 v[236:239], v[92:95], v[100:103], v[236:239]
    ds_read_b64_tr_b16 v[142:143], v19 offset:62976
    v_mfma_f32_16x16x32_bf16 v[168:171], v[80:83], v[104:107], v[168:171]
    ds_read_b64_tr_b16 v[144:145], v20 offset:61440
    v_mfma_f32_16x16x32_bf16 v[192:195], v[84:87], v[104:107], v[192:195]
    ds_read_b64_tr_b16 v[146:147], v20 offset:62976
    v_mfma_f32_16x16x32_bf16 v[216:219], v[88:91], v[104:107], v[216:219]
    ds_read_b64_tr_b16 v[148:149], v21 offset:61440
    v_mfma_f32_16x16x32_bf16 v[240:243], v[92:95], v[104:107], v[240:243]
    ds_read_b64_tr_b16 v[150:151], v21 offset:62976
    v_mfma_f32_16x16x32_bf16 v[172:175], v[80:83], v[108:111], v[172:175]
    ds_read_b64_tr_b16 v[152:153], v22 offset:61440
    v_mfma_f32_16x16x32_bf16 v[196:199], v[84:87], v[108:111], v[196:199]
    ds_read_b64_tr_b16 v[154:155], v22 offset:62976
    v_mfma_f32_16x16x32_bf16 v[220:223], v[88:91], v[108:111], v[220:223]
    ds_read_b64_tr_b16 v[156:157], v23 offset:61440
    v_mfma_f32_16x16x32_bf16 v[244:247], v[92:95], v[108:111], v[244:247]
    ds_read_b64_tr_b16 v[158:159], v23 offset:62976
    v_mfma_f32_16x16x32_bf16 v[176:179], v[80:83], v[112:115], v[176:179]
    v_mfma_f32_16x16x32_bf16 v[200:203], v[84:87], v[112:115], v[200:203]
    v_mfma_f32_16x16x32_bf16 v[224:227], v[88:91], v[112:115], v[224:227]
    v_mfma_f32_16x16x32_bf16 v[248:251], v[92:95], v[112:115], v[248:251]
    v_mfma_f32_16x16x32_bf16 v[180:183], v[80:83], v[116:119], v[180:183]
    v_mfma_f32_16x16x32_bf16 v[204:207], v[84:87], v[116:119], v[204:207]
    v_mfma_f32_16x16x32_bf16 v[228:231], v[88:91], v[116:119], v[228:231]
    v_mfma_f32_16x16x32_bf16 v[252:255], v[92:95], v[116:119], v[252:255]
    v_mfma_f32_16x16x32_bf16 a[0:3], v[24:27], v[80:83], a[0:3]
    v_mfma_f32_16x16x32_bf16 a[8:11], v[80:83], v[80:83], a[8:11]
    v_mfma_f32_16x16x32_bf16 a[4:7], v[24:27], v[84:87], a[4:7]
    v_mfma_f32_16x16x32_bf16 a[12:15], v[84:87], v[84:87], a[12:15]
    v_mfma_f32_16x16x32_bf16 a[16:19], v[24:27], v[96:99], a[16:19]
    v_mfma_f32_16x16x32_bf16 a[20:23], v[24:27], v[100:103], a[20:23]
    v_mfma_f32_16x16x32_bf16 a[24:27], v[24:27], v[104:107], a[24:27]
    s_waitcnt vmcnt(10) lgkmcnt(0)
    s_barrier
    v_mfma_f32_16x16x32_bf16 a[0:3], v[24:27], v[120:123], a[0:3]
    ds_read_b128 v[80:83], v14 offset:0
    ds_read_b128 v[84:87], v14 offset:2048
    v_mfma_f32_16x16x32_bf16 a[8:11], v[120:123], v[120:123], a[8:11]
    ds_read_b128 v[88:91], v16 offset:0
    ds_read_b128 v[92:95], v16 offset:2048
    v_mfma_f32_16x16x32_bf16 a[4:7], v[24:27], v[124:127], a[4:7]
    ds_read_b64_tr_b16 v[96:97], v18 offset:0
    ds_read_b64_tr_b16 v[98:99], v18 offset:1536
    v_mfma_f32_16x16x32_bf16 a[12:15], v[124:127], v[124:127], a[12:15]
    ds_read_b64_tr_b16 v[100:101], v19 offset:0
    ds_read_b64_tr_b16 v[102:103], v19 offset:1536
    v_mfma_f32_16x16x32_bf16 a[16:19], v[24:27], v[136:139], a[16:19]
    ds_read_b64_tr_b16 v[104:105], v20 offset:0
    ds_read_b64_tr_b16 v[106:107], v20 offset:1536
    v_mfma_f32_16x16x32_bf16 a[20:23], v[24:27], v[140:143], a[20:23]
    ds_read_b64_tr_b16 v[108:109], v21 offset:0
    ds_read_b64_tr_b16 v[110:111], v21 offset:1536
    v_mfma_f32_16x16x32_bf16 a[24:27], v[24:27], v[144:147], a[24:27]
    ds_read_b64_tr_b16 v[112:113], v22 offset:0
    ds_read_b64_tr_b16 v[114:115], v22 offset:1536
    v_mfma_f32_16x16x32_bf16 v[160:163], v[120:123], v[136:139], v[160:163]
    ds_read_b64_tr_b16 v[116:117], v23 offset:0
    ds_read_b64_tr_b16 v[118:119], v23 offset:1536
    v_mfma_f32_16x16x32_bf16 v[184:187], v[124:127], v[136:139], v[184:187]
    s_movk_i32 s46, 640
    s_mov_b32 s47, 880640
    v_mfma_f32_16x16x32_bf16 v[208:211], v[128:131], v[136:139], v[208:211]
    s_add_u32 m0, s55, 40960
    s_nop 0
    buffer_load_dwordx4 v4, s[16:19], s46 offen lds
    v_mfma_f32_16x16x32_bf16 v[232:235], v[132:135], v[136:139], v[232:235]
    s_add_u32 m0, s55, 41984
    s_nop 0
    buffer_load_dwordx4 v5, s[16:19], s46 offen lds
    v_mfma_f32_16x16x32_bf16 v[164:167], v[120:123], v[140:143], v[164:167]
    s_add_u32 m0, s55, 43008
    s_nop 0
    buffer_load_dwordx4 v6, s[16:19], s46 offen lds
    v_mfma_f32_16x16x32_bf16 v[188:191], v[124:127], v[140:143], v[188:191]
    s_add_u32 m0, s55, 44032
    s_nop 0
    buffer_load_dwordx4 v7, s[16:19], s46 offen lds
    v_mfma_f32_16x16x32_bf16 v[212:215], v[128:131], v[140:143], v[212:215]
    s_add_u32 m0, s56, 106496
    s_nop 0
    buffer_load_dwordx4 v8, s[20:23], s47 offen lds
    v_mfma_f32_16x16x32_bf16 v[236:239], v[132:135], v[140:143], v[236:239]
    s_add_u32 m0, s56, 107520
    s_nop 0
    buffer_load_dwordx4 v9, s[20:23], s47 offen lds
    v_mfma_f32_16x16x32_bf16 v[168:171], v[120:123], v[144:147], v[168:171]
    s_add_u32 m0, s56, 108544
    s_nop 0
    buffer_load_dwordx4 v10, s[20:23], s47 offen lds
    v_mfma_f32_16x16x32_bf16 v[192:195], v[124:127], v[144:147], v[192:195]
    s_add_u32 m0, s56, 109568
    s_nop 0
    buffer_load_dwordx4 v11, s[20:23], s47 offen lds
    v_mfma_f32_16x16x32_bf16 v[216:219], v[128:131], v[144:147], v[216:219]
    s_add_u32 m0, s56, 110592
    s_nop 0
    buffer_load_dwordx4 v12, s[20:23], s47 offen lds
    v_mfma_f32_16x16x32_bf16 v[240:243], v[132:135], v[144:147], v[240:243]
    s_add_u32 m0, s56, 111616
    s_nop 0
    buffer_load_dwordx4 v13, s[20:23], s47 offen lds
    v_mfma_f32_16x16x32_bf16 v[172:175], v[120:123], v[148:151], v[172:175]
    v_mfma_f32_16x16x32_bf16 v[196:199], v[124:127], v[148:151], v[196:199]
    v_mfma_f32_16x16x32_bf16 v[220:223], v[128:131], v[148:151], v[220:223]
    v_mfma_f32_16x16x32_bf16 v[244:247], v[132:135], v[148:151], v[244:247]
    v_mfma_f32_16x16x32_bf16 v[176:179], v[120:123], v[152:155], v[176:179]
    v_mfma_f32_16x16x32_bf16 v[200:203], v[124:127], v[152:155], v[200:203]
    v_mfma_f32_16x16x32_bf16 v[224:227], v[128:131], v[152:155], v[224:227]
    v_mfma_f32_16x16x32_bf16 v[248:251], v[132:135], v[152:155], v[248:251]
    v_mfma_f32_16x16x32_bf16 v[180:183], v[120:123], v[156:159], v[180:183]
    v_mfma_f32_16x16x32_bf16 v[204:207], v[124:127], v[156:159], v[204:207]
    v_mfma_f32_16x16x32_bf16 v[228:231], v[128:131], v[156:159], v[228:231]
    v_mfma_f32_16x16x32_bf16 v[252:255], v[132:135], v[156:159], v[252:255]
    s_waitcnt lgkmcnt(0)
    v_mfma_f32_16x16x32_bf16 v[160:163], v[80:83], v[96:99], v[160:163]
    ds_read_b128 v[120:123], v15 offset:0
    v_mfma_f32_16x16x32_bf16 v[184:187], v[84:87], v[96:99], v[184:187]
    ds_read_b128 v[124:127], v15 offset:2048
    v_mfma_f32_16x16x32_bf16 v[208:211], v[88:91], v[96:99], v[208:211]
    ds_read_b128 v[128:131], v17 offset:0
    v_mfma_f32_16x16x32_bf16 v[232:235], v[92:95], v[96:99], v[232:235]
    ds_read_b128 v[132:135], v17 offset:2048
    v_mfma_f32_16x16x32_bf16 v[164:167], v[80:83], v[100:103], v[164:167]
    ds_read_b64_tr_b16 v[136:137], v18 offset:12288
    v_mfma_f32_16x16x32_bf16 v[188:191], v[84:87], v[100:103], v[188:191]
    ds_read_b64_tr_b16 v[138:139], v18 offset:13824
    v_mfma_f32_16x16x32_bf16 v[212:215], v[88:91], v[100:103], v[212:215]
    ds_read_b64_tr_b16 v[140:141], v19 offset:12288
    v_mfma_f32_16x16x32_bf16 v[236:239], v[92:95], v[100:103], v[236:239]
    ds_read_b64_tr_b16 v[142:143], v19 offset:13824
    v_mfma_f32_16x16x32_bf16 v[168:171], v[80:83], v[104:107], v[168:171]
    ds_read_b64_tr_b16 v[144:145], v20 offset:12288
    v_mfma_f32_16x16x32_bf16 v[192:195], v[84:87], v[104:107], v[192:195]
    ds_read_b64_tr_b16 v[146:147], v20 offset:13824
    v_mfma_f32_16x16x32_bf16 v[216:219], v[88:91], v[104:107], v[216:219]
    ds_read_b64_tr_b16 v[148:149], v21 offset:12288
    v_mfma_f32_16x16x32_bf16 v[240:243], v[92:95], v[104:107], v[240:243]
    ds_read_b64_tr_b16 v[150:151], v21 offset:13824
    v_mfma_f32_16x16x32_bf16 v[172:175], v[80:83], v[108:111], v[172:175]
    ds_read_b64_tr_b16 v[152:153], v22 offset:12288
    v_mfma_f32_16x16x32_bf16 v[196:199], v[84:87], v[108:111], v[196:199]
    ds_read_b64_tr_b16 v[154:155], v22 offset:13824
    v_mfma_f32_16x16x32_bf16 v[220:223], v[88:91], v[108:111], v[220:223]
    ds_read_b64_tr_b16 v[156:157], v23 offset:12288
    v_mfma_f32_16x16x32_bf16 v[244:247], v[92:95], v[108:111], v[244:247]
    ds_read_b64_tr_b16 v[158:159], v23 offset:13824
    v_mfma_f32_16x16x32_bf16 v[176:179], v[80:83], v[112:115], v[176:179]
    v_mfma_f32_16x16x32_bf16 v[200:203], v[84:87], v[112:115], v[200:203]
    v_mfma_f32_16x16x32_bf16 v[224:227], v[88:91], v[112:115], v[224:227]
    v_mfma_f32_16x16x32_bf16 v[248:251], v[92:95], v[112:115], v[248:251]
    v_mfma_f32_16x16x32_bf16 v[180:183], v[80:83], v[116:119], v[180:183]
    v_mfma_f32_16x16x32_bf16 v[204:207], v[84:87], v[116:119], v[204:207]
    v_mfma_f32_16x16x32_bf16 v[228:231], v[88:91], v[116:119], v[228:231]
    v_mfma_f32_16x16x32_bf16 v[252:255], v[92:95], v[116:119], v[252:255]
    v_mfma_f32_16x16x32_bf16 a[0:3], v[24:27], v[80:83], a[0:3]
    v_mfma_f32_16x16x32_bf16 a[8:11], v[80:83], v[80:83], a[8:11]
    v_mfma_f32_16x16x32_bf16 a[4:7], v[24:27], v[84:87], a[4:7]
    v_mfma_f32_16x16x32_bf16 a[12:15], v[84:87], v[84:87], a[12:15]
    v_mfma_f32_16x16x32_bf16 a[16:19], v[24:27], v[96:99], a[16:19]
    v_mfma_f32_16x16x32_bf16 a[20:23], v[24:27], v[100:103], a[20:23]
    v_mfma_f32_16x16x32_bf16 a[24:27], v[24:27], v[104:107], a[24:27]
    s_waitcnt vmcnt(10) lgkmcnt(0)
    s_barrier
    v_mfma_f32_16x16x32_bf16 a[0:3], v[24:27], v[120:123], a[0:3]
    ds_read_b128 v[80:83], v14 offset:16384
    ds_read_b128 v[84:87], v14 offset:18432
    v_mfma_f32_16x16x32_bf16 a[8:11], v[120:123], v[120:123], a[8:11]
    ds_read_b128 v[88:91], v16 offset:16384
    ds_read_b128 v[92:95], v16 offset:18432
    v_mfma_f32_16x16x32_bf16 a[4:7], v[24:27], v[124:127], a[4:7]
    ds_read_b64_tr_b16 v[96:97], v18 offset:24576
    ds_read_b64_tr_b16 v[98:99], v18 offset:26112
    v_mfma_f32_16x16x32_bf16 a[12:15], v[124:127], v[124:127], a[12:15]
    ds_read_b64_tr_b16 v[100:101], v19 offset:24576
    ds_read_b64_tr_b16 v[102:103], v19 offset:26112
    v_mfma_f32_16x16x32_bf16 a[16:19], v[24:27], v[136:139], a[16:19]
    ds_read_b64_tr_b16 v[104:105], v20 offset:24576
    ds_read_b64_tr_b16 v[106:107], v20 offset:26112
    v_mfma_f32_16x16x32_bf16 a[20:23], v[24:27], v[140:143], a[20:23]
    ds_read_b64_tr_b16 v[108:109], v21 offset:24576
    ds_read_b64_tr_b16 v[110:111], v21 offset:26112
    v_mfma_f32_16x16x32_bf16 a[24:27], v[24:27], v[144:147], a[24:27]
    ds_read_b64_tr_b16 v[112:113], v22 offset:24576
    ds_read_b64_tr_b16 v[114:115], v22 offset:26112
    v_mfma_f32_16x16x32_bf16 v[160:163], v[120:123], v[136:139], v[160:163]
    ds_read_b64_tr_b16 v[116:117], v23 offset:24576
    ds_read_b64_tr_b16 v[118:119], v23 offset:26112
    v_mfma_f32_16x16x32_bf16 v[184:187], v[124:127], v[136:139], v[184:187]
    s_movk_i32 s46, 768
    s_mov_b32 s47, 1056768
    v_mfma_f32_16x16x32_bf16 v[208:211], v[128:131], v[136:139], v[208:211]
    s_add_u32 m0, s55, 8192
    s_nop 0
    buffer_load_dwordx4 v4, s[16:19], s46 offen lds
    v_mfma_f32_16x16x32_bf16 v[232:235], v[132:135], v[136:139], v[232:235]
    s_add_u32 m0, s55, 9216
    s_nop 0
    buffer_load_dwordx4 v5, s[16:19], s46 offen lds
    v_mfma_f32_16x16x32_bf16 v[164:167], v[120:123], v[140:143], v[164:167]
    s_add_u32 m0, s55, 10240
    s_nop 0
    buffer_load_dwordx4 v6, s[16:19], s46 offen lds
    v_mfma_f32_16x16x32_bf16 v[188:191], v[124:127], v[140:143], v[188:191]
    s_add_u32 m0, s55, 11264
    s_nop 0
    buffer_load_dwordx4 v7, s[16:19], s46 offen lds
    v_mfma_f32_16x16x32_bf16 v[212:215], v[128:131], v[140:143], v[212:215]
    s_add_u32 m0, s56, 57344
    s_nop 0
    buffer_load_dwordx4 v8, s[20:23], s47 offen lds
    v_mfma_f32_16x16x32_bf16 v[236:239], v[132:135], v[140:143], v[236:239]
    s_add_u32 m0, s56, 58368
    s_nop 0
    buffer_load_dwordx4 v9, s[20:23], s47 offen lds
    v_mfma_f32_16x16x32_bf16 v[168:171], v[120:123], v[144:147], v[168:171]
    s_add_u32 m0, s56, 59392
    s_nop 0
    buffer_load_dwordx4 v10, s[20:23], s47 offen lds
    v_mfma_f32_16x16x32_bf16 v[192:195], v[124:127], v[144:147], v[192:195]
    s_add_u32 m0, s56, 60416
    s_nop 0
    buffer_load_dwordx4 v11, s[20:23], s47 offen lds
    v_mfma_f32_16x16x32_bf16 v[216:219], v[128:131], v[144:147], v[216:219]
    s_add_u32 m0, s56, 61440
    s_nop 0
    buffer_load_dwordx4 v12, s[20:23], s47 offen lds
    v_mfma_f32_16x16x32_bf16 v[240:243], v[132:135], v[144:147], v[240:243]
    s_add_u32 m0, s56, 62464
    s_nop 0
    buffer_load_dwordx4 v13, s[20:23], s47 offen lds
    v_mfma_f32_16x16x32_bf16 v[172:175], v[120:123], v[148:151], v[172:175]
    v_mfma_f32_16x16x32_bf16 v[196:199], v[124:127], v[148:151], v[196:199]
    v_mfma_f32_16x16x32_bf16 v[220:223], v[128:131], v[148:151], v[220:223]
    v_mfma_f32_16x16x32_bf16 v[244:247], v[132:135], v[148:151], v[244:247]
    v_mfma_f32_16x16x32_bf16 v[176:179], v[120:123], v[152:155], v[176:179]
    v_mfma_f32_16x16x32_bf16 v[200:203], v[124:127], v[152:155], v[200:203]
    v_mfma_f32_16x16x32_bf16 v[224:227], v[128:131], v[152:155], v[224:227]
    v_mfma_f32_16x16x32_bf16 v[248:251], v[132:135], v[152:155], v[248:251]
    v_mfma_f32_16x16x32_bf16 v[180:183], v[120:123], v[156:159], v[180:183]
    v_mfma_f32_16x16x32_bf16 v[204:207], v[124:127], v[156:159], v[204:207]
    v_mfma_f32_16x16x32_bf16 v[228:231], v[128:131], v[156:159], v[228:231]
    v_mfma_f32_16x16x32_bf16 v[252:255], v[132:135], v[156:159], v[252:255]
    s_waitcnt lgkmcnt(0)
    v_mfma_f32_16x16x32_bf16 v[160:163], v[80:83], v[96:99], v[160:163]
    ds_read_b128 v[120:123], v15 offset:16384
    v_mfma_f32_16x16x32_bf16 v[184:187], v[84:87], v[96:99], v[184:187]
    ds_read_b128 v[124:127], v15 offset:18432
    v_mfma_f32_16x16x32_bf16 v[208:211], v[88:91], v[96:99], v[208:211]
    ds_read_b128 v[128:131], v17 offset:16384
    v_mfma_f32_16x16x32_bf16 v[232:235], v[92:95], v[96:99], v[232:235]
    ds_read_b128 v[132:135], v17 offset:18432
    v_mfma_f32_16x16x32_bf16 v[164:167], v[80:83], v[100:103], v[164:167]
    ds_read_b64_tr_b16 v[136:137], v18 offset:36864
    v_mfma_f32_16x16x32_bf16 v[188:191], v[84:87], v[100:103], v[188:191]
    ds_read_b64_tr_b16 v[138:139], v18 offset:38400
    v_mfma_f32_16x16x32_bf16 v[212:215], v[88:91], v[100:103], v[212:215]
    ds_read_b64_tr_b16 v[140:141], v19 offset:36864
    v_mfma_f32_16x16x32_bf16 v[236:239], v[92:95], v[100:103], v[236:239]
    ds_read_b64_tr_b16 v[142:143], v19 offset:38400
    v_mfma_f32_16x16x32_bf16 v[168:171], v[80:83], v[104:107], v[168:171]
    ds_read_b64_tr_b16 v[144:145], v20 offset:36864
    v_mfma_f32_16x16x32_bf16 v[192:195], v[84:87], v[104:107], v[192:195]
    ds_read_b64_tr_b16 v[146:147], v20 offset:38400
    v_mfma_f32_16x16x32_bf16 v[216:219], v[88:91], v[104:107], v[216:219]
    ds_read_b64_tr_b16 v[148:149], v21 offset:36864
    v_mfma_f32_16x16x32_bf16 v[240:243], v[92:95], v[104:107], v[240:243]
    ds_read_b64_tr_b16 v[150:151], v21 offset:38400
    v_mfma_f32_16x16x32_bf16 v[172:175], v[80:83], v[108:111], v[172:175]
    ds_read_b64_tr_b16 v[152:153], v22 offset:36864
    v_mfma_f32_16x16x32_bf16 v[196:199], v[84:87], v[108:111], v[196:199]
    ds_read_b64_tr_b16 v[154:155], v22 offset:38400
    v_mfma_f32_16x16x32_bf16 v[220:223], v[88:91], v[108:111], v[220:223]
    ds_read_b64_tr_b16 v[156:157], v23 offset:36864
    v_mfma_f32_16x16x32_bf16 v[244:247], v[92:95], v[108:111], v[244:247]
    ds_read_b64_tr_b16 v[158:159], v23 offset:38400
    v_mfma_f32_16x16x32_bf16 v[176:179], v[80:83], v[112:115], v[176:179]
    v_mfma_f32_16x16x32_bf16 v[200:203], v[84:87], v[112:115], v[200:203]
    v_mfma_f32_16x16x32_bf16 v[224:227], v[88:91], v[112:115], v[224:227]
    v_mfma_f32_16x16x32_bf16 v[248:251], v[92:95], v[112:115], v[248:251]
    v_mfma_f32_16x16x32_bf16 v[180:183], v[80:83], v[116:119], v[180:183]
    v_mfma_f32_16x16x32_bf16 v[204:207], v[84:87], v[116:119], v[204:207]
    v_mfma_f32_16x16x32_bf16 v[228:231], v[88:91], v[116:119], v[228:231]
    v_mfma_f32_16x16x32_bf16 v[252:255], v[92:95], v[116:119], v[252:255]
    v_mfma_f32_16x16x32_bf16 a[0:3], v[24:27], v[80:83], a[0:3]
    v_mfma_f32_16x16x32_bf16 a[8:11], v[80:83], v[80:83], a[8:11]
    v_mfma_f32_16x16x32_bf16 a[4:7], v[24:27], v[84:87], a[4:7]
    v_mfma_f32_16x16x32_bf16 a[12:15], v[84:87], v[84:87], a[12:15]
    v_mfma_f32_16x16x32_bf16 a[16:19], v[24:27], v[96:99], a[16:19]
    v_mfma_f32_16x16x32_bf16 a[20:23], v[24:27], v[100:103], a[20:23]
    v_mfma_f32_16x16x32_bf16 a[24:27], v[24:27], v[104:107], a[24:27]
    s_waitcnt vmcnt(10) lgkmcnt(0)
    s_barrier
    v_mfma_f32_16x16x32_bf16 a[0:3], v[24:27], v[120:123], a[0:3]
    ds_read_b128 v[80:83], v14 offset:32768
    ds_read_b128 v[84:87], v14 offset:34816
    v_mfma_f32_16x16x32_bf16 a[8:11], v[120:123], v[120:123], a[8:11]
    ds_read_b128 v[88:91], v16 offset:32768
    ds_read_b128 v[92:95], v16 offset:34816
    v_mfma_f32_16x16x32_bf16 a[4:7], v[24:27], v[124:127], a[4:7]
    ds_read_b64_tr_b16 v[96:97], v18 offset:49152
    ds_read_b64_tr_b16 v[98:99], v18 offset:50688
    v_mfma_f32_16x16x32_bf16 a[12:15], v[124:127], v[124:127], a[12:15]
    ds_read_b64_tr_b16 v[100:101], v19 offset:49152
    ds_read_b64_tr_b16 v[102:103], v19 offset:50688
    v_mfma_f32_16x16x32_bf16 a[16:19], v[24:27], v[136:139], a[16:19]
    ds_read_b64_tr_b16 v[104:105], v20 offset:49152
    ds_read_b64_tr_b16 v[106:107], v20 offset:50688
    v_mfma_f32_16x16x32_bf16 a[20:23], v[24:27], v[140:143], a[20:23]
    ds_read_b64_tr_b16 v[108:109], v21 offset:49152
    ds_read_b64_tr_b16 v[110:111], v21 offset:50688
    v_mfma_f32_16x16x32_bf16 a[24:27], v[24:27], v[144:147], a[24:27]
    ds_read_b64_tr_b16 v[112:113], v22 offset:49152
    ds_read_b64_tr_b16 v[114:115], v22 offset:50688
    v_mfma_f32_16x16x32_bf16 v[160:163], v[120:123], v[136:139], v[160:163]
    ds_read_b64_tr_b16 v[116:117], v23 offset:49152
    ds_read_b64_tr_b16 v[118:119], v23 offset:50688
    v_mfma_f32_16x16x32_bf16 v[184:187], v[124:127], v[136:139], v[184:187]
    s_movk_i32 s46, 896
    s_mov_b32 s47, 1232896
    v_mfma_f32_16x16x32_bf16 v[208:211], v[128:131], v[136:139], v[208:211]
    s_add_u32 m0, s55, 24576
    s_nop 0
    buffer_load_dwordx4 v4, s[16:19], s46 offen lds
    v_mfma_f32_16x16x32_bf16 v[232:235], v[132:135], v[136:139], v[232:235]
    s_add_u32 m0, s55, 25600
    s_nop 0
    buffer_load_dwordx4 v5, s[16:19], s46 offen lds
    v_mfma_f32_16x16x32_bf16 v[164:167], v[120:123], v[140:143], v[164:167]
    s_add_u32 m0, s55, 26624
    s_nop 0
    buffer_load_dwordx4 v6, s[16:19], s46 offen lds
    v_mfma_f32_16x16x32_bf16 v[188:191], v[124:127], v[140:143], v[188:191]
    s_add_u32 m0, s55, 27648
    s_nop 0
    buffer_load_dwordx4 v7, s[16:19], s46 offen lds
    v_mfma_f32_16x16x32_bf16 v[212:215], v[128:131], v[140:143], v[212:215]
    s_add_u32 m0, s56, 81920
    s_nop 0
    buffer_load_dwordx4 v8, s[20:23], s47 offen lds
    v_mfma_f32_16x16x32_bf16 v[236:239], v[132:135], v[140:143], v[236:239]
    s_add_u32 m0, s56, 82944
    s_nop 0
    buffer_load_dwordx4 v9, s[20:23], s47 offen lds
    v_mfma_f32_16x16x32_bf16 v[168:171], v[120:123], v[144:147], v[168:171]
    s_add_u32 m0, s56, 83968
    s_nop 0
    buffer_load_dwordx4 v10, s[20:23], s47 offen lds
    v_mfma_f32_16x16x32_bf16 v[192:195], v[124:127], v[144:147], v[192:195]
    s_add_u32 m0, s56, 84992
    s_nop 0
    buffer_load_dwordx4 v11, s[20:23], s47 offen lds
    v_mfma_f32_16x16x32_bf16 v[216:219], v[128:131], v[144:147], v[216:219]
    s_add_u32 m0, s56, 86016
    s_nop 0
    buffer_load_dwordx4 v12, s[20:23], s47 offen lds
    v_mfma_f32_16x16x32_bf16 v[240:243], v[132:135], v[144:147], v[240:243]
    s_add_u32 m0, s56, 87040
    s_nop 0
    buffer_load_dwordx4 v13, s[20:23], s47 offen lds
    v_mfma_f32_16x16x32_bf16 v[172:175], v[120:123], v[148:151], v[172:175]
    v_mfma_f32_16x16x32_bf16 v[196:199], v[124:127], v[148:151], v[196:199]
    v_mfma_f32_16x16x32_bf16 v[220:223], v[128:131], v[148:151], v[220:223]
    v_mfma_f32_16x16x32_bf16 v[244:247], v[132:135], v[148:151], v[244:247]
    v_mfma_f32_16x16x32_bf16 v[176:179], v[120:123], v[152:155], v[176:179]
    v_mfma_f32_16x16x32_bf16 v[200:203], v[124:127], v[152:155], v[200:203]
    v_mfma_f32_16x16x32_bf16 v[224:227], v[128:131], v[152:155], v[224:227]
    v_mfma_f32_16x16x32_bf16 v[248:251], v[132:135], v[152:155], v[248:251]
    v_mfma_f32_16x16x32_bf16 v[180:183], v[120:123], v[156:159], v[180:183]
    v_mfma_f32_16x16x32_bf16 v[204:207], v[124:127], v[156:159], v[204:207]
    v_mfma_f32_16x16x32_bf16 v[228:231], v[128:131], v[156:159], v[228:231]
    v_mfma_f32_16x16x32_bf16 v[252:255], v[132:135], v[156:159], v[252:255]
    s_waitcnt lgkmcnt(0)
    v_mfma_f32_16x16x32_bf16 v[160:163], v[80:83], v[96:99], v[160:163]
    ds_read_b128 v[120:123], v15 offset:32768
    v_mfma_f32_16x16x32_bf16 v[184:187], v[84:87], v[96:99], v[184:187]
    ds_read_b128 v[124:127], v15 offset:34816
    v_mfma_f32_16x16x32_bf16 v[208:211], v[88:91], v[96:99], v[208:211]
    ds_read_b128 v[128:131], v17 offset:32768
    v_mfma_f32_16x16x32_bf16 v[232:235], v[92:95], v[96:99], v[232:235]
    ds_read_b128 v[132:135], v17 offset:34816
    v_mfma_f32_16x16x32_bf16 v[164:167], v[80:83], v[100:103], v[164:167]
    ds_read_b64_tr_b16 v[136:137], v18 offset:61440
    v_mfma_f32_16x16x32_bf16 v[188:191], v[84:87], v[100:103], v[188:191]
    ds_read_b64_tr_b16 v[138:139], v18 offset:62976
    v_mfma_f32_16x16x32_bf16 v[212:215], v[88:91], v[100:103], v[212:215]
    ds_read_b64_tr_b16 v[140:141], v19 offset:61440
    v_mfma_f32_16x16x32_bf16 v[236:239], v[92:95], v[100:103], v[236:239]
    ds_read_b64_tr_b16 v[142:143], v19 offset:62976
    v_mfma_f32_16x16x32_bf16 v[168:171], v[80:83], v[104:107], v[168:171]
    ds_read_b64_tr_b16 v[144:145], v20 offset:61440
    v_mfma_f32_16x16x32_bf16 v[192:195], v[84:87], v[104:107], v[192:195]
    ds_read_b64_tr_b16 v[146:147], v20 offset:62976
    v_mfma_f32_16x16x32_bf16 v[216:219], v[88:91], v[104:107], v[216:219]
    ds_read_b64_tr_b16 v[148:149], v21 offset:61440
    v_mfma_f32_16x16x32_bf16 v[240:243], v[92:95], v[104:107], v[240:243]
    ds_read_b64_tr_b16 v[150:151], v21 offset:62976
    v_mfma_f32_16x16x32_bf16 v[172:175], v[80:83], v[108:111], v[172:175]
    ds_read_b64_tr_b16 v[152:153], v22 offset:61440
    v_mfma_f32_16x16x32_bf16 v[196:199], v[84:87], v[108:111], v[196:199]
    ds_read_b64_tr_b16 v[154:155], v22 offset:62976
    v_mfma_f32_16x16x32_bf16 v[220:223], v[88:91], v[108:111], v[220:223]
    ds_read_b64_tr_b16 v[156:157], v23 offset:61440
    v_mfma_f32_16x16x32_bf16 v[244:247], v[92:95], v[108:111], v[244:247]
    ds_read_b64_tr_b16 v[158:159], v23 offset:62976
    v_mfma_f32_16x16x32_bf16 v[176:179], v[80:83], v[112:115], v[176:179]
    v_mfma_f32_16x16x32_bf16 v[200:203], v[84:87], v[112:115], v[200:203]
    v_mfma_f32_16x16x32_bf16 v[224:227], v[88:91], v[112:115], v[224:227]
    v_mfma_f32_16x16x32_bf16 v[248:251], v[92:95], v[112:115], v[248:251]
    v_mfma_f32_16x16x32_bf16 v[180:183], v[80:83], v[116:119], v[180:183]
    v_mfma_f32_16x16x32_bf16 v[204:207], v[84:87], v[116:119], v[204:207]
    v_mfma_f32_16x16x32_bf16 v[228:231], v[88:91], v[116:119], v[228:231]
    v_mfma_f32_16x16x32_bf16 v[252:255], v[92:95], v[116:119], v[252:255]
    v_mfma_f32_16x16x32_bf16 a[0:3], v[24:27], v[80:83], a[0:3]
    v_mfma_f32_16x16x32_bf16 a[8:11], v[80:83], v[80:83], a[8:11]
    v_mfma_f32_16x16x32_bf16 a[4:7], v[24:27], v[84:87], a[4:7]
    v_mfma_f32_16x16x32_bf16 a[12:15], v[84:87], v[84:87], a[12:15]
    v_mfma_f32_16x16x32_bf16 a[16:19], v[24:27], v[96:99], a[16:19]
    v_mfma_f32_16x16x32_bf16 a[20:23], v[24:27], v[100:103], a[20:23]
    v_mfma_f32_16x16x32_bf16 a[24:27], v[24:27], v[104:107], a[24:27]
    s_waitcnt vmcnt(10) lgkmcnt(0)
    s_barrier
    v_mfma_f32_16x16x32_bf16 a[0:3], v[24:27], v[120:123], a[0:3]
    ds_read_b128 v[80:83], v14 offset:0
    ds_read_b128 v[84:87], v14 offset:2048
    v_mfma_f32_16x16x32_bf16 a[8:11], v[120:123], v[120:123], a[8:11]
    ds_read_b128 v[88:91], v16 offset:0
    ds_read_b128 v[92:95], v16 offset:2048
    v_mfma_f32_16x16x32_bf16 a[4:7], v[24:27], v[124:127], a[4:7]
    ds_read_b64_tr_b16 v[96:97], v18 offset:0
    ds_read_b64_tr_b16 v[98:99], v18 offset:1536
    v_mfma_f32_16x16x32_bf16 a[12:15], v[124:127], v[124:127], a[12:15]
    ds_read_b64_tr_b16 v[100:101], v19 offset:0
    ds_read_b64_tr_b16 v[102:103], v19 offset:1536
    v_mfma_f32_16x16x32_bf16 a[16:19], v[24:27], v[136:139], a[16:19]
    ds_read_b64_tr_b16 v[104:105], v20 offset:0
    ds_read_b64_tr_b16 v[106:107], v20 offset:1536
    v_mfma_f32_16x16x32_bf16 a[20:23], v[24:27], v[140:143], a[20:23]
    ds_read_b64_tr_b16 v[108:109], v21 offset:0
    ds_read_b64_tr_b16 v[110:111], v21 offset:1536
    v_mfma_f32_16x16x32_bf16 a[24:27], v[24:27], v[144:147], a[24:27]
    ds_read_b64_tr_b16 v[112:113], v22 offset:0
    ds_read_b64_tr_b16 v[114:115], v22 offset:1536
    v_mfma_f32_16x16x32_bf16 v[160:163], v[120:123], v[136:139], v[160:163]
    ds_read_b64_tr_b16 v[116:117], v23 offset:0
    ds_read_b64_tr_b16 v[118:119], v23 offset:1536
    v_mfma_f32_16x16x32_bf16 v[184:187], v[124:127], v[136:139], v[184:187]
    v_mfma_f32_16x16x32_bf16 v[208:211], v[128:131], v[136:139], v[208:211]
    v_mfma_f32_16x16x32_bf16 v[232:235], v[132:135], v[136:139], v[232:235]
    v_mfma_f32_16x16x32_bf16 v[164:167], v[120:123], v[140:143], v[164:167]
    v_mfma_f32_16x16x32_bf16 v[188:191], v[124:127], v[140:143], v[188:191]
    v_mfma_f32_16x16x32_bf16 v[212:215], v[128:131], v[140:143], v[212:215]
    v_mfma_f32_16x16x32_bf16 v[236:239], v[132:135], v[140:143], v[236:239]
    v_mfma_f32_16x16x32_bf16 v[168:171], v[120:123], v[144:147], v[168:171]
    v_mfma_f32_16x16x32_bf16 v[192:195], v[124:127], v[144:147], v[192:195]
    v_mfma_f32_16x16x32_bf16 v[216:219], v[128:131], v[144:147], v[216:219]
    v_mfma_f32_16x16x32_bf16 v[240:243], v[132:135], v[144:147], v[240:243]
    v_mfma_f32_16x16x32_bf16 v[172:175], v[120:123], v[148:151], v[172:175]
    v_mfma_f32_16x16x32_bf16 v[196:199], v[124:127], v[148:151], v[196:199]
    v_mfma_f32_16x16x32_bf16 v[220:223], v[128:131], v[148:151], v[220:223]
    v_mfma_f32_16x16x32_bf16 v[244:247], v[132:135], v[148:151], v[244:247]
    v_mfma_f32_16x16x32_bf16 v[176:179], v[120:123], v[152:155], v[176:179]
    v_mfma_f32_16x16x32_bf16 v[200:203], v[124:127], v[152:155], v[200:203]
    v_mfma_f32_16x16x32_bf16 v[224:227], v[128:131], v[152:155], v[224:227]
    v_mfma_f32_16x16x32_bf16 v[248:251], v[132:135], v[152:155], v[248:251]
    v_mfma_f32_16x16x32_bf16 v[180:183], v[120:123], v[156:159], v[180:183]
    v_mfma_f32_16x16x32_bf16 v[204:207], v[124:127], v[156:159], v[204:207]
    v_mfma_f32_16x16x32_bf16 v[228:231], v[128:131], v[156:159], v[228:231]
    v_mfma_f32_16x16x32_bf16 v[252:255], v[132:135], v[156:159], v[252:255]
    s_waitcnt lgkmcnt(0)
    v_mfma_f32_16x16x32_bf16 v[160:163], v[80:83], v[96:99], v[160:163]
    ds_read_b128 v[120:123], v15 offset:0
    v_mfma_f32_16x16x32_bf16 v[184:187], v[84:87], v[96:99], v[184:187]
    ds_read_b128 v[124:127], v15 offset:2048
    v_mfma_f32_16x16x32_bf16 v[208:211], v[88:91], v[96:99], v[208:211]
    ds_read_b128 v[128:131], v17 offset:0
    v_mfma_f32_16x16x32_bf16 v[232:235], v[92:95], v[96:99], v[232:235]
    ds_read_b128 v[132:135], v17 offset:2048
    v_mfma_f32_16x16x32_bf16 v[164:167], v[80:83], v[100:103], v[164:167]
    ds_read_b64_tr_b16 v[136:137], v18 offset:12288
    v_mfma_f32_16x16x32_bf16 v[188:191], v[84:87], v[100:103], v[188:191]
    ds_read_b64_tr_b16 v[138:139], v18 offset:13824
    v_mfma_f32_16x16x32_bf16 v[212:215], v[88:91], v[100:103], v[212:215]
    ds_read_b64_tr_b16 v[140:141], v19 offset:12288
    v_mfma_f32_16x16x32_bf16 v[236:239], v[92:95], v[100:103], v[236:239]
    ds_read_b64_tr_b16 v[142:143], v19 offset:13824
    v_mfma_f32_16x16x32_bf16 v[168:171], v[80:83], v[104:107], v[168:171]
    ds_read_b64_tr_b16 v[144:145], v20 offset:12288
    v_mfma_f32_16x16x32_bf16 v[192:195], v[84:87], v[104:107], v[192:195]
    ds_read_b64_tr_b16 v[146:147], v20 offset:13824
    v_mfma_f32_16x16x32_bf16 v[216:219], v[88:91], v[104:107], v[216:219]
    ds_read_b64_tr_b16 v[148:149], v21 offset:12288
    v_mfma_f32_16x16x32_bf16 v[240:243], v[92:95], v[104:107], v[240:243]
    ds_read_b64_tr_b16 v[150:151], v21 offset:13824
    v_mfma_f32_16x16x32_bf16 v[172:175], v[80:83], v[108:111], v[172:175]
    ds_read_b64_tr_b16 v[152:153], v22 offset:12288
    v_mfma_f32_16x16x32_bf16 v[196:199], v[84:87], v[108:111], v[196:199]
    ds_read_b64_tr_b16 v[154:155], v22 offset:13824
    v_mfma_f32_16x16x32_bf16 v[220:223], v[88:91], v[108:111], v[220:223]
    ds_read_b64_tr_b16 v[156:157], v23 offset:12288
    v_mfma_f32_16x16x32_bf16 v[244:247], v[92:95], v[108:111], v[244:247]
    ds_read_b64_tr_b16 v[158:159], v23 offset:13824
    v_mfma_f32_16x16x32_bf16 v[176:179], v[80:83], v[112:115], v[176:179]
    v_mfma_f32_16x16x32_bf16 v[200:203], v[84:87], v[112:115], v[200:203]
    v_mfma_f32_16x16x32_bf16 v[224:227], v[88:91], v[112:115], v[224:227]
    v_mfma_f32_16x16x32_bf16 v[248:251], v[92:95], v[112:115], v[248:251]
    v_mfma_f32_16x16x32_bf16 v[180:183], v[80:83], v[116:119], v[180:183]
    v_mfma_f32_16x16x32_bf16 v[204:207], v[84:87], v[116:119], v[204:207]
    v_mfma_f32_16x16x32_bf16 v[228:231], v[88:91], v[116:119], v[228:231]
    v_mfma_f32_16x16x32_bf16 v[252:255], v[92:95], v[116:119], v[252:255]
    v_mfma_f32_16x16x32_bf16 a[0:3], v[24:27], v[80:83], a[0:3]
    v_mfma_f32_16x16x32_bf16 a[8:11], v[80:83], v[80:83], a[8:11]
    v_mfma_f32_16x16x32_bf16 a[4:7], v[24:27], v[84:87], a[4:7]
    v_mfma_f32_16x16x32_bf16 a[12:15], v[84:87], v[84:87], a[12:15]
    v_mfma_f32_16x16x32_bf16 a[16:19], v[24:27], v[96:99], a[16:19]
    v_mfma_f32_16x16x32_bf16 a[20:23], v[24:27], v[100:103], a[20:23]
    v_mfma_f32_16x16x32_bf16 a[24:27], v[24:27], v[104:107], a[24:27]
    s_waitcnt vmcnt(0) lgkmcnt(0)
    s_barrier
    v_mfma_f32_16x16x32_bf16 a[0:3], v[24:27], v[120:123], a[0:3]
    ds_read_b128 v[80:83], v14 offset:16384
    ds_read_b128 v[84:87], v14 offset:18432
    v_mfma_f32_16x16x32_bf16 a[8:11], v[120:123], v[120:123], a[8:11]
    ds_read_b128 v[88:91], v16 offset:16384
    ds_read_b128 v[92:95], v16 offset:18432
    v_mfma_f32_16x16x32_bf16 a[4:7], v[24:27], v[124:127], a[4:7]
    ds_read_b64_tr_b16 v[96:97], v18 offset:24576
    ds_read_b64_tr_b16 v[98:99], v18 offset:26112
    v_mfma_f32_16x16x32_bf16 a[12:15], v[124:127], v[124:127], a[12:15]
    ds_read_b64_tr_b16 v[100:101], v19 offset:24576
    ds_read_b64_tr_b16 v[102:103], v19 offset:26112
    v_mfma_f32_16x16x32_bf16 a[16:19], v[24:27], v[136:139], a[16:19]
    ds_read_b64_tr_b16 v[104:105], v20 offset:24576
    ds_read_b64_tr_b16 v[106:107], v20 offset:26112
    v_mfma_f32_16x16x32_bf16 a[20:23], v[24:27], v[140:143], a[20:23]
    ds_read_b64_tr_b16 v[108:109], v21 offset:24576
    ds_read_b64_tr_b16 v[110:111], v21 offset:26112
    v_mfma_f32_16x16x32_bf16 a[24:27], v[24:27], v[144:147], a[24:27]
    ds_read_b64_tr_b16 v[112:113], v22 offset:24576
    ds_read_b64_tr_b16 v[114:115], v22 offset:26112
    v_mfma_f32_16x16x32_bf16 v[160:163], v[120:123], v[136:139], v[160:163]
    ds_read_b64_tr_b16 v[116:117], v23 offset:24576
    ds_read_b64_tr_b16 v[118:119], v23 offset:26112
    v_mfma_f32_16x16x32_bf16 v[184:187], v[124:127], v[136:139], v[184:187]
    v_mfma_f32_16x16x32_bf16 v[208:211], v[128:131], v[136:139], v[208:211]
    v_mfma_f32_16x16x32_bf16 v[232:235], v[132:135], v[136:139], v[232:235]
    v_mfma_f32_16x16x32_bf16 v[164:167], v[120:123], v[140:143], v[164:167]
    v_mfma_f32_16x16x32_bf16 v[188:191], v[124:127], v[140:143], v[188:191]
    v_mfma_f32_16x16x32_bf16 v[212:215], v[128:131], v[140:143], v[212:215]
    v_mfma_f32_16x16x32_bf16 v[236:239], v[132:135], v[140:143], v[236:239]
    v_mfma_f32_16x16x32_bf16 v[168:171], v[120:123], v[144:147], v[168:171]
    v_mfma_f32_16x16x32_bf16 v[192:195], v[124:127], v[144:147], v[192:195]
    v_mfma_f32_16x16x32_bf16 v[216:219], v[128:131], v[144:147], v[216:219]
    v_mfma_f32_16x16x32_bf16 v[240:243], v[132:135], v[144:147], v[240:243]
    v_mfma_f32_16x16x32_bf16 v[172:175], v[120:123], v[148:151], v[172:175]
    v_mfma_f32_16x16x32_bf16 v[196:199], v[124:127], v[148:151], v[196:199]
    v_mfma_f32_16x16x32_bf16 v[220:223], v[128:131], v[148:151], v[220:223]
    v_mfma_f32_16x16x32_bf16 v[244:247], v[132:135], v[148:151], v[244:247]
    v_mfma_f32_16x16x32_bf16 v[176:179], v[120:123], v[152:155], v[176:179]
    v_mfma_f32_16x16x32_bf16 v[200:203], v[124:127], v[152:155], v[200:203]
    v_mfma_f32_16x16x32_bf16 v[224:227], v[128:131], v[152:155], v[224:227]
    v_mfma_f32_16x16x32_bf16 v[248:251], v[132:135], v[152:155], v[248:251]
    v_mfma_f32_16x16x32_bf16 v[180:183], v[120:123], v[156:159], v[180:183]
    v_mfma_f32_16x16x32_bf16 v[204:207], v[124:127], v[156:159], v[204:207]
    v_mfma_f32_16x16x32_bf16 v[228:231], v[128:131], v[156:159], v[228:231]
    v_mfma_f32_16x16x32_bf16 v[252:255], v[132:135], v[156:159], v[252:255]
    s_waitcnt lgkmcnt(0)
    v_mfma_f32_16x16x32_bf16 v[160:163], v[80:83], v[96:99], v[160:163]
    ds_read_b128 v[120:123], v15 offset:16384
    v_mfma_f32_16x16x32_bf16 v[184:187], v[84:87], v[96:99], v[184:187]
    ds_read_b128 v[124:127], v15 offset:18432
    v_mfma_f32_16x16x32_bf16 v[208:211], v[88:91], v[96:99], v[208:211]
    ds_read_b128 v[128:131], v17 offset:16384
    v_mfma_f32_16x16x32_bf16 v[232:235], v[92:95], v[96:99], v[232:235]
    ds_read_b128 v[132:135], v17 offset:18432
    v_mfma_f32_16x16x32_bf16 v[164:167], v[80:83], v[100:103], v[164:167]
    ds_read_b64_tr_b16 v[136:137], v18 offset:36864
    v_mfma_f32_16x16x32_bf16 v[188:191], v[84:87], v[100:103], v[188:191]
    ds_read_b64_tr_b16 v[138:139], v18 offset:38400
    v_mfma_f32_16x16x32_bf16 v[212:215], v[88:91], v[100:103], v[212:215]
    ds_read_b64_tr_b16 v[140:141], v19 offset:36864
    v_mfma_f32_16x16x32_bf16 v[236:239], v[92:95], v[100:103], v[236:239]
    ds_read_b64_tr_b16 v[142:143], v19 offset:38400
    v_mfma_f32_16x16x32_bf16 v[168:171], v[80:83], v[104:107], v[168:171]
    ds_read_b64_tr_b16 v[144:145], v20 offset:36864
    v_mfma_f32_16x16x32_bf16 v[192:195], v[84:87], v[104:107], v[192:195]
    ds_read_b64_tr_b16 v[146:147], v20 offset:38400
    v_mfma_f32_16x16x32_bf16 v[216:219], v[88:91], v[104:107], v[216:219]
    ds_read_b64_tr_b16 v[148:149], v21 offset:36864
    v_mfma_f32_16x16x32_bf16 v[240:243], v[92:95], v[104:107], v[240:243]
    ds_read_b64_tr_b16 v[150:151], v21 offset:38400
    v_mfma_f32_16x16x32_bf16 v[172:175], v[80:83], v[108:111], v[172:175]
    ds_read_b64_tr_b16 v[152:153], v22 offset:36864
    v_mfma_f32_16x16x32_bf16 v[196:199], v[84:87], v[108:111], v[196:199]
    ds_read_b64_tr_b16 v[154:155], v22 offset:38400
    v_mfma_f32_16x16x32_bf16 v[220:223], v[88:91], v[108:111], v[220:223]
    ds_read_b64_tr_b16 v[156:157], v23 offset:36864
    v_mfma_f32_16x16x32_bf16 v[244:247], v[92:95], v[108:111], v[244:247]
    ds_read_b64_tr_b16 v[158:159], v23 offset:38400
    v_mfma_f32_16x16x32_bf16 v[176:179], v[80:83], v[112:115], v[176:179]
    v_mfma_f32_16x16x32_bf16 v[200:203], v[84:87], v[112:115], v[200:203]
    v_mfma_f32_16x16x32_bf16 v[224:227], v[88:91], v[112:115], v[224:227]
    v_mfma_f32_16x16x32_bf16 v[248:251], v[92:95], v[112:115], v[248:251]
    v_mfma_f32_16x16x32_bf16 v[180:183], v[80:83], v[116:119], v[180:183]
    v_mfma_f32_16x16x32_bf16 v[204:207], v[84:87], v[116:119], v[204:207]
    v_mfma_f32_16x16x32_bf16 v[228:231], v[88:91], v[116:119], v[228:231]
    v_mfma_f32_16x16x32_bf16 v[252:255], v[92:95], v[116:119], v[252:255]
    v_mfma_f32_16x16x32_bf16 a[0:3], v[24:27], v[80:83], a[0:3]
    v_mfma_f32_16x16x32_bf16 a[8:11], v[80:83], v[80:83], a[8:11]
    v_mfma_f32_16x16x32_bf16 a[4:7], v[24:27], v[84:87], a[4:7]
    v_mfma_f32_16x16x32_bf16 a[12:15], v[84:87], v[84:87], a[12:15]
    v_mfma_f32_16x16x32_bf16 a[16:19], v[24:27], v[96:99], a[16:19]
    v_mfma_f32_16x16x32_bf16 a[20:23], v[24:27], v[100:103], a[20:23]
    v_mfma_f32_16x16x32_bf16 a[24:27], v[24:27], v[104:107], a[24:27]
    s_waitcnt lgkmcnt(0)
    v_mfma_f32_16x16x32_bf16 a[0:3], v[24:27], v[120:123], a[0:3]
    v_mfma_f32_16x16x32_bf16 a[8:11], v[120:123], v[120:123], a[8:11]
    v_mfma_f32_16x16x32_bf16 a[4:7], v[24:27], v[124:127], a[4:7]
    v_mfma_f32_16x16x32_bf16 a[12:15], v[124:127], v[124:127], a[12:15]
    v_mfma_f32_16x16x32_bf16 a[16:19], v[24:27], v[136:139], a[16:19]
    v_mfma_f32_16x16x32_bf16 a[20:23], v[24:27], v[140:143], a[20:23]
    v_mfma_f32_16x16x32_bf16 a[24:27], v[24:27], v[144:147], a[24:27]
    v_mfma_f32_16x16x32_bf16 v[160:163], v[120:123], v[136:139], v[160:163]
    v_mfma_f32_16x16x32_bf16 v[184:187], v[124:127], v[136:139], v[184:187]
    v_mfma_f32_16x16x32_bf16 v[208:211], v[128:131], v[136:139], v[208:211]
    v_mfma_f32_16x16x32_bf16 v[232:235], v[132:135], v[136:139], v[232:235]
    v_mfma_f32_16x16x32_bf16 v[164:167], v[120:123], v[140:143], v[164:167]
    v_mfma_f32_16x16x32_bf16 v[188:191], v[124:127], v[140:143], v[188:191]
    v_mfma_f32_16x16x32_bf16 v[212:215], v[128:131], v[140:143], v[212:215]
    v_mfma_f32_16x16x32_bf16 v[236:239], v[132:135], v[140:143], v[236:239]
    v_mfma_f32_16x16x32_bf16 v[168:171], v[120:123], v[144:147], v[168:171]
    v_mfma_f32_16x16x32_bf16 v[192:195], v[124:127], v[144:147], v[192:195]
    v_mfma_f32_16x16x32_bf16 v[216:219], v[128:131], v[144:147], v[216:219]
    v_mfma_f32_16x16x32_bf16 v[240:243], v[132:135], v[144:147], v[240:243]
    v_mfma_f32_16x16x32_bf16 v[172:175], v[120:123], v[148:151], v[172:175]
    v_mfma_f32_16x16x32_bf16 v[196:199], v[124:127], v[148:151], v[196:199]
    v_mfma_f32_16x16x32_bf16 v[220:223], v[128:131], v[148:151], v[220:223]
    v_mfma_f32_16x16x32_bf16 v[244:247], v[132:135], v[148:151], v[244:247]
    v_mfma_f32_16x16x32_bf16 v[176:179], v[120:123], v[152:155], v[176:179]
    v_mfma_f32_16x16x32_bf16 v[200:203], v[124:127], v[152:155], v[200:203]
    v_mfma_f32_16x16x32_bf16 v[224:227], v[128:131], v[152:155], v[224:227]
    v_mfma_f32_16x16x32_bf16 v[248:251], v[132:135], v[152:155], v[248:251]
    v_mfma_f32_16x16x32_bf16 v[180:183], v[120:123], v[156:159], v[180:183]
    v_mfma_f32_16x16x32_bf16 v[204:207], v[124:127], v[156:159], v[204:207]
    v_mfma_f32_16x16x32_bf16 v[228:231], v[128:131], v[156:159], v[228:231]
    v_mfma_f32_16x16x32_bf16 v[252:255], v[132:135], v[156:159], v[252:255]
    s_lshl_b32 s48, s39, 8
    s_lshl_b32 s49, s40, 7
    s_add_u32 s48, s48, s49
    v_lshl_add_u32 v40, v2, 2, s48
    s_lshl_b32 s48, s40, 7
    s_lshl_b32 s49, s39, 6
    s_add_u32 s59, s48, s49
    s_xor_b32 s60, s59, 64
    v_lshl_add_u32 v41, v2, 2, s59
    s_mov_b64 exec, 0xffff
    ds_write_b32 v40, a0 offset:0
    ds_write_b32 v40, a4 offset:64
    ds_write_b32 v41, a16 offset:1024
    ds_write_b32 v41, a20 offset:1280
    ds_write_b32 v41, a24 offset:1536
    s_mov_b32 exec_lo, 1048577
    s_mov_b32 exec_hi, 268435712
    ds_write_b32 v40, a8 offset:512
    ds_write_b32 v40, a12 offset:576
    s_mov_b32 exec_lo, 2097154
    s_mov_b32 exec_hi, 536871424
    ds_write_b32 v40, a9 offset:512
    ds_write_b32 v40, a13 offset:576
    s_mov_b32 exec_lo, 4194308
    s_mov_b32 exec_hi, 1073742848
    ds_write_b32 v40, a10 offset:512
    ds_write_b32 v40, a14 offset:576
    s_mov_b32 exec_lo, 8388616
    s_mov_b32 exec_hi, 2147485696
    ds_write_b32 v40, a11 offset:512
    ds_write_b32 v40, a15 offset:576
    s_mov_b64 exec, -1
    s_waitcnt lgkmcnt(0)
    s_barrier
    v_and_b32 v40, 127, v0
    v_lshlrev_b32 v40, 2, v40
    ds_read_b32 v41, v40 offset:0
    ds_read_b32 v42, v40 offset:512
    s_waitcnt lgkmcnt(0)
    v_mul_f32 v41, 0x3b000000, v41
    v_mul_f32 v42, 0x3b000000, v42
    v_fma_f32 v42, -v41, v41, v42
    v_max_f32 v42, 0, v42
    v_add_f32 v42, 0x3727c5ac, v42
    v_rsq_f32 v42, v42
    s_nop 0
    v_mul_f32 v41, v41, v42
    ds_write_b32 v40, v42 offset:2048
    ds_write_b32 v40, v41 offset:2560
    s_waitcnt lgkmcnt(0)
    s_barrier
    s_lshl_b32 s48, s39, 8
    s_lshl_b32 s49, s40, 7
    s_add_u32 s57, s48, s49
    s_xor_b32 s58, s57, 128
    v_lshl_add_u32 v40, v2, 2, s57
    v_lshl_add_u32 v41, v2, 2, s58
    v_lshl_add_u32 v42, v3, 4, s57
    v_lshl_add_u32 v43, v3, 4, s58
    v_lshl_add_u32 v44, v3, 4, s59
    v_lshl_add_u32 v45, v3, 4, s60
    v_lshl_add_u32 v46, v2, 2, s59
    v_lshl_add_u32 v47, v2, 2, s60
    ds_read_b128 v[88:91], v42 offset:2048
    ds_read_b128 v[104:107], v42 offset:2560
    ds_read_b128 v[92:95], v42 offset:2112
    ds_read_b128 v[108:111], v42 offset:2624
    ds_read_b128 v[96:99], v43 offset:2048
    ds_read_b128 v[112:115], v43 offset:2560
    ds_read_b128 v[100:103], v43 offset:2112
    ds_read_b128 v[116:119], v43 offset:2624
    ds_read_b32 v120, v46 offset:1024
    ds_read_b32 v124, v46 offset:1280
    ds_read_b32 v128, v46 offset:1536
    ds_read_b32 v132, v47 offset:1024
    ds_read_b32 v136, v47 offset:1280
    ds_read_b32 v140, v47 offset:1536
    s_waitcnt lgkmcnt(0)
    v_pk_mul_f32 v[144:145], v[104:105], v[120:121] op_sel_hi:[1,0]
    v_pk_mul_f32 v[148:149], v[108:109], v[120:121] op_sel_hi:[1,0]
    v_pk_mul_f32 v[152:153], v[112:113], v[120:121] op_sel_hi:[1,0]
    v_pk_mul_f32 v[156:157], v[116:117], v[120:121] op_sel_hi:[1,0]
    v_pk_fma_f32 v[160:161], v[160:161], v[88:89], v[144:145] neg_lo:[0,0,1] neg_hi:[0,0,1]
    v_pk_fma_f32 v[184:185], v[184:185], v[92:93], v[148:149] neg_lo:[0,0,1] neg_hi:[0,0,1]
    v_pk_fma_f32 v[208:209], v[208:209], v[96:97], v[152:153] neg_lo:[0,0,1] neg_hi:[0,0,1]
    v_pk_fma_f32 v[232:233], v[232:233], v[100:101], v[156:157] neg_lo:[0,0,1] neg_hi:[0,0,1]
    v_pk_mul_f32 v[146:147], v[106:107], v[120:121] op_sel_hi:[1,0]
    v_pk_mul_f32 v[150:151], v[110:111], v[120:121] op_sel_hi:[1,0]
    v_pk_mul_f32 v[154:155], v[114:115], v[120:121] op_sel_hi:[1,0]
    v_pk_mul_f32 v[158:159], v[118:119], v[120:121] op_sel_hi:[1,0]
    v_pk_fma_f32 v[162:163], v[162:163], v[90:91], v[146:147] neg_lo:[0,0,1] neg_hi:[0,0,1]
    v_pk_fma_f32 v[186:187], v[186:187], v[94:95], v[150:151] neg_lo:[0,0,1] neg_hi:[0,0,1]
    v_pk_fma_f32 v[210:211], v[210:211], v[98:99], v[154:155] neg_lo:[0,0,1] neg_hi:[0,0,1]
    v_pk_fma_f32 v[234:235], v[234:235], v[102:103], v[158:159] neg_lo:[0,0,1] neg_hi:[0,0,1]
    v_pk_mul_f32 v[144:145], v[104:105], v[124:125] op_sel_hi:[1,0]
    v_pk_mul_f32 v[148:149], v[108:109], v[124:125] op_sel_hi:[1,0]
    v_pk_mul_f32 v[152:153], v[112:113], v[124:125] op_sel_hi:[1,0]
    v_pk_mul_f32 v[156:157], v[116:117], v[124:125] op_sel_hi:[1,0]
    v_pk_fma_f32 v[164:165], v[164:165], v[88:89], v[144:145] neg_lo:[0,0,1] neg_hi:[0,0,1]
    v_pk_fma_f32 v[188:189], v[188:189], v[92:93], v[148:149] neg_lo:[0,0,1] neg_hi:[0,0,1]
    v_pk_fma_f32 v[212:213], v[212:213], v[96:97], v[152:153] neg_lo:[0,0,1] neg_hi:[0,0,1]
    v_pk_fma_f32 v[236:237], v[236:237], v[100:101], v[156:157] neg_lo:[0,0,1] neg_hi:[0,0,1]
    v_pk_mul_f32 v[146:147], v[106:107], v[124:125] op_sel_hi:[1,0]
    v_pk_mul_f32 v[150:151], v[110:111], v[124:125] op_sel_hi:[1,0]
    v_pk_mul_f32 v[154:155], v[114:115], v[124:125] op_sel_hi:[1,0]
    v_pk_mul_f32 v[158:159], v[118:119], v[124:125] op_sel_hi:[1,0]
    v_pk_fma_f32 v[166:167], v[166:167], v[90:91], v[146:147] neg_lo:[0,0,1] neg_hi:[0,0,1]
    v_pk_fma_f32 v[190:191], v[190:191], v[94:95], v[150:151] neg_lo:[0,0,1] neg_hi:[0,0,1]
    v_pk_fma_f32 v[214:215], v[214:215], v[98:99], v[154:155] neg_lo:[0,0,1] neg_hi:[0,0,1]
    v_pk_fma_f32 v[238:239], v[238:239], v[102:103], v[158:159] neg_lo:[0,0,1] neg_hi:[0,0,1]
    v_pk_mul_f32 v[144:145], v[104:105], v[128:129] op_sel_hi:[1,0]
    v_pk_mul_f32 v[148:149], v[108:109], v[128:129] op_sel_hi:[1,0]
    v_pk_mul_f32 v[152:153], v[112:113], v[128:129] op_sel_hi:[1,0]
    v_pk_mul_f32 v[156:157], v[116:117], v[128:129] op_sel_hi:[1,0]
    v_pk_fma_f32 v[168:169], v[168:169], v[88:89], v[144:145] neg_lo:[0,0,1] neg_hi:[0,0,1]
    v_pk_fma_f32 v[192:193], v[192:193], v[92:93], v[148:149] neg_lo:[0,0,1] neg_hi:[0,0,1]
    v_pk_fma_f32 v[216:217], v[216:217], v[96:97], v[152:153] neg_lo:[0,0,1] neg_hi:[0,0,1]
    v_pk_fma_f32 v[240:241], v[240:241], v[100:101], v[156:157] neg_lo:[0,0,1] neg_hi:[0,0,1]
    v_pk_mul_f32 v[146:147], v[106:107], v[128:129] op_sel_hi:[1,0]
    v_pk_mul_f32 v[150:151], v[110:111], v[128:129] op_sel_hi:[1,0]
    v_pk_mul_f32 v[154:155], v[114:115], v[128:129] op_sel_hi:[1,0]
    v_pk_mul_f32 v[158:159], v[118:119], v[128:129] op_sel_hi:[1,0]
    v_pk_fma_f32 v[170:171], v[170:171], v[90:91], v[146:147] neg_lo:[0,0,1] neg_hi:[0,0,1]
    v_pk_fma_f32 v[194:195], v[194:195], v[94:95], v[150:151] neg_lo:[0,0,1] neg_hi:[0,0,1]
    v_pk_fma_f32 v[218:219], v[218:219], v[98:99], v[154:155] neg_lo:[0,0,1] neg_hi:[0,0,1]
    v_pk_fma_f32 v[242:243], v[242:243], v[102:103], v[158:159] neg_lo:[0,0,1] neg_hi:[0,0,1]
    v_pk_mul_f32 v[144:145], v[104:105], v[132:133] op_sel_hi:[1,0]
    v_pk_mul_f32 v[148:149], v[108:109], v[132:133] op_sel_hi:[1,0]
    v_pk_mul_f32 v[152:153], v[112:113], v[132:133] op_sel_hi:[1,0]
    v_pk_mul_f32 v[156:157], v[116:117], v[132:133] op_sel_hi:[1,0]
    v_pk_fma_f32 v[172:173], v[172:173], v[88:89], v[144:145] neg_lo:[0,0,1] neg_hi:[0,0,1]
    v_pk_fma_f32 v[196:197], v[196:197], v[92:93], v[148:149] neg_lo:[0,0,1] neg_hi:[0,0,1]
    v_pk_fma_f32 v[220:221], v[220:221], v[96:97], v[152:153] neg_lo:[0,0,1] neg_hi:[0,0,1]
    v_pk_fma_f32 v[244:245], v[244:245], v[100:101], v[156:157] neg_lo:[0,0,1] neg_hi:[0,0,1]
    v_pk_mul_f32 v[146:147], v[106:107], v[132:133] op_sel_hi:[1,0]
    v_pk_mul_f32 v[150:151], v[110:111], v[132:133] op_sel_hi:[1,0]
    v_pk_mul_f32 v[154:155], v[114:115], v[132:133] op_sel_hi:[1,0]
    v_pk_mul_f32 v[158:159], v[118:119], v[132:133] op_sel_hi:[1,0]
    v_pk_fma_f32 v[174:175], v[174:175], v[90:91], v[146:147] neg_lo:[0,0,1] neg_hi:[0,0,1]
    v_pk_fma_f32 v[198:199], v[198:199], v[94:95], v[150:151] neg_lo:[0,0,1] neg_hi:[0,0,1]
    v_pk_fma_f32 v[222:223], v[222:223], v[98:99], v[154:155] neg_lo:[0,0,1] neg_hi:[0,0,1]
    v_pk_fma_f32 v[246:247], v[246:247], v[102:103], v[158:159] neg_lo:[0,0,1] neg_hi:[0,0,1]
    v_pk_mul_f32 v[144:145], v[104:105], v[136:137] op_sel_hi:[1,0]
    v_pk_mul_f32 v[148:149], v[108:109], v[136:137] op_sel_hi:[1,0]
    v_pk_mul_f32 v[152:153], v[112:113], v[136:137] op_sel_hi:[1,0]
    v_pk_mul_f32 v[156:157], v[116:117], v[136:137] op_sel_hi:[1,0]
    v_pk_fma_f32 v[176:177], v[176:177], v[88:89], v[144:145] neg_lo:[0,0,1] neg_hi:[0,0,1]
    v_pk_fma_f32 v[200:201], v[200:201], v[92:93], v[148:149] neg_lo:[0,0,1] neg_hi:[0,0,1]
    v_pk_fma_f32 v[224:225], v[224:225], v[96:97], v[152:153] neg_lo:[0,0,1] neg_hi:[0,0,1]
    v_pk_fma_f32 v[248:249], v[248:249], v[100:101], v[156:157] neg_lo:[0,0,1] neg_hi:[0,0,1]
    v_pk_mul_f32 v[146:147], v[106:107], v[136:137] op_sel_hi:[1,0]
    v_pk_mul_f32 v[150:151], v[110:111], v[136:137] op_sel_hi:[1,0]
    v_pk_mul_f32 v[154:155], v[114:115], v[136:137] op_sel_hi:[1,0]
    v_pk_mul_f32 v[158:159], v[118:119], v[136:137] op_sel_hi:[1,0]
    v_pk_fma_f32 v[178:179], v[178:179], v[90:91], v[146:147] neg_lo:[0,0,1] neg_hi:[0,0,1]
    v_pk_fma_f32 v[202:203], v[202:203], v[94:95], v[150:151] neg_lo:[0,0,1] neg_hi:[0,0,1]
    v_pk_fma_f32 v[226:227], v[226:227], v[98:99], v[154:155] neg_lo:[0,0,1] neg_hi:[0,0,1]
    v_pk_fma_f32 v[250:251], v[250:251], v[102:103], v[158:159] neg_lo:[0,0,1] neg_hi:[0,0,1]
    v_pk_mul_f32 v[144:145], v[104:105], v[140:141] op_sel_hi:[1,0]
    v_pk_mul_f32 v[148:149], v[108:109], v[140:141] op_sel_hi:[1,0]
    v_pk_mul_f32 v[152:153], v[112:113], v[140:141] op_sel_hi:[1,0]
    v_pk_mul_f32 v[156:157], v[116:117], v[140:141] op_sel_hi:[1,0]
    v_pk_fma_f32 v[180:181], v[180:181], v[88:89], v[144:145] neg_lo:[0,0,1] neg_hi:[0,0,1]
    v_pk_fma_f32 v[204:205], v[204:205], v[92:93], v[148:149] neg_lo:[0,0,1] neg_hi:[0,0,1]
    v_pk_fma_f32 v[228:229], v[228:229], v[96:97], v[152:153] neg_lo:[0,0,1] neg_hi:[0,0,1]
    v_pk_fma_f32 v[252:253], v[252:253], v[100:101], v[156:157] neg_lo:[0,0,1] neg_hi:[0,0,1]
    v_pk_mul_f32 v[146:147], v[106:107], v[140:141] op_sel_hi:[1,0]
    v_pk_mul_f32 v[150:151], v[110:111], v[140:141] op_sel_hi:[1,0]
    v_pk_mul_f32 v[154:155], v[114:115], v[140:141] op_sel_hi:[1,0]
    v_pk_mul_f32 v[158:159], v[118:119], v[140:141] op_sel_hi:[1,0]
    v_pk_fma_f32 v[182:183], v[182:183], v[90:91], v[146:147] neg_lo:[0,0,1] neg_hi:[0,0,1]
    v_pk_fma_f32 v[206:207], v[206:207], v[94:95], v[150:151] neg_lo:[0,0,1] neg_hi:[0,0,1]
    v_pk_fma_f32 v[230:231], v[230:231], v[98:99], v[154:155] neg_lo:[0,0,1] neg_hi:[0,0,1]
    v_pk_fma_f32 v[254:255], v[254:255], v[102:103], v[158:159] neg_lo:[0,0,1] neg_hi:[0,0,1]
    s_lshl_b32 s48, s36, 7
    s_lshr_b32 s61, s57, 2
    s_lshr_b32 s62, s58, 2
    s_add_u32 s61, s61, s48
    s_add_u32 s62, s62, s48
    v_mov_b32 v79, 0xc0135761
    s_cmp_eq_u32 s53, 3
    s_cselect_b32 s63, 10, 11
    s_lshl_b32 s48, s61, 5
    v_lshl_add_u32 v48, v1, 4, s48
    s_lshl_b32 s48, s62, 5
    v_lshl_add_u32 v49, v1, 4, s48
    v_mov_b32 v112, 0
    v_mov_b32 v113, 0
    v_mov_b32 v114, 0
    v_mov_b32 v115, 0
    v_mov_b32 v116, 0
    v_mov_b32 v117, 0
    v_mov_b32 v118, 0
    v_mov_b32 v119, 0
    v_mov_b32 v120, 0
    v_mov_b32 v121, 0
    v_mov_b32 v122, 0
    v_mov_b32 v123, 0
    v_mov_b32 v124, 0
    v_mov_b32 v125, 0
    v_mov_b32 v126, 0
    v_mov_b32 v127, 0
    v_mov_b32 v128, 0
    v_mov_b32 v129, 0
    v_mov_b32 v130, 0
    v_mov_b32 v131, 0
    v_mov_b32 v132, 0
    v_mov_b32 v133, 0
    v_mov_b32 v134, 0
    v_mov_b32 v135, 0
    v_mov_b32 v136, 0
    v_mov_b32 v137, 0
    v_mov_b32 v138, 0
    v_mov_b32 v139, 0
    v_mov_b32 v140, 0
    v_mov_b32 v141, 0
    v_mov_b32 v142, 0
    v_mov_b32 v143, 0
    s_lshr_b32 s48, s59, 6
    s_add_u32 s48, s48, 0
    s_cmp_ge_u32 s48, s63
    s_cbranch_scc1 P1_z2_skip0
    s_mul_i32 s49, s53, 11
    s_add_u32 s48, s48, s49
    v_mul_f32 v80, v160, v160
    v_mul_f32 v81, v161, v161
    v_mul_f32 v82, v162, v162
    v_mul_f32 v83, v163, v163
    v_mul_f32 v84, v184, v184
    v_mul_f32 v85, v185, v185
    v_mul_f32 v86, v186, v186
    v_mul_f32 v87, v187, v187
    v_mul_f32 v88, v208, v208
    v_mul_f32 v89, v209, v209
    v_mul_f32 v90, v210, v210
    v_mul_f32 v91, v211, v211
    v_mul_f32 v92, v232, v232
    v_mul_f32 v93, v233, v233
    v_mul_f32 v94, v234, v234
    v_mul_f32 v95, v235, v235
    v_fma_f32 v80, v80, s54, v79
    v_fma_f32 v81, v81, s54, v79
    v_fma_f32 v82, v82, s54, v79
    v_fma_f32 v83, v83, s54, v79
    v_fma_f32 v84, v84, s54, v79
    v_fma_f32 v85, v85, s54, v79
    v_fma_f32 v86, v86, s54, v79
    v_fma_f32 v87, v87, s54, v79
    v_fma_f32 v88, v88, s54, v79
    v_fma_f32 v89, v89, s54, v79
    v_fma_f32 v90, v90, s54, v79
    v_fma_f32 v91, v91, s54, v79
    v_fma_f32 v92, v92, s54, v79
    v_fma_f32 v93, v93, s54, v79
    v_fma_f32 v94, v94, s54, v79
    v_fma_f32 v95, v95, s54, v79
    v_mul_f32 v80, v80, v160
    v_mul_f32 v81, v81, v161
    v_mul_f32 v82, v82, v162
    v_mul_f32 v83, v83, v163
    v_mul_f32 v84, v84, v184
    v_mul_f32 v85, v85, v185
    v_mul_f32 v86, v86, v186
    v_mul_f32 v87, v87, v187
    v_mul_f32 v88, v88, v208
    v_mul_f32 v89, v89, v209
    v_mul_f32 v90, v90, v210
    v_mul_f32 v91, v91, v211
    v_mul_f32 v92, v92, v232
    v_mul_f32 v93, v93, v233
    v_mul_f32 v94, v94, v234
    v_mul_f32 v95, v95, v235
    v_exp_f32 v80, v80
    v_exp_f32 v81, v81
    v_exp_f32 v82, v82
    v_exp_f32 v83, v83
    v_exp_f32 v84, v84
    v_exp_f32 v85, v85
    v_exp_f32 v86, v86
    v_exp_f32 v87, v87
    v_exp_f32 v88, v88
    v_exp_f32 v89, v89
    v_exp_f32 v90, v90
    v_exp_f32 v91, v91
    v_exp_f32 v92, v92
    v_exp_f32 v93, v93
    v_exp_f32 v94, v94
    v_exp_f32 v95, v95
    v_add_f32 v80, 1.0, v80
    v_add_f32 v81, 1.0, v81
    v_add_f32 v82, 1.0, v82
    v_add_f32 v83, 1.0, v83
    v_add_f32 v84, 1.0, v84
    v_add_f32 v85, 1.0, v85
    v_add_f32 v86, 1.0, v86
    v_add_f32 v87, 1.0, v87
    v_add_f32 v88, 1.0, v88
    v_add_f32 v89, 1.0, v89
    v_add_f32 v90, 1.0, v90
    v_add_f32 v91, 1.0, v91
    v_add_f32 v92, 1.0, v92
    v_add_f32 v93, 1.0, v93
    v_add_f32 v94, 1.0, v94
    v_add_f32 v95, 1.0, v95
    v_rcp_f32 v80, v80
    v_rcp_f32 v81, v81
    v_rcp_f32 v82, v82
    v_rcp_f32 v83, v83
    v_rcp_f32 v84, v84
    v_rcp_f32 v85, v85
    v_rcp_f32 v86, v86
    v_rcp_f32 v87, v87
    v_rcp_f32 v88, v88
    v_rcp_f32 v89, v89
    v_rcp_f32 v90, v90
    v_rcp_f32 v91, v91
    v_rcp_f32 v92, v92
    v_rcp_f32 v93, v93
    v_rcp_f32 v94, v94
    v_rcp_f32 v95, v95
    v_mul_f32 v160, v160, v80
    v_mul_f32 v161, v161, v81
    v_mul_f32 v162, v162, v82
    v_mul_f32 v163, v163, v83
    v_mul_f32 v184, v184, v84
    v_mul_f32 v185, v185, v85
    v_mul_f32 v186, v186, v86
    v_mul_f32 v187, v187, v87
    v_mul_f32 v208, v208, v88
    v_mul_f32 v209, v209, v89
    v_mul_f32 v210, v210, v90
    v_mul_f32 v211, v211, v91
    v_mul_f32 v232, v232, v92
    v_mul_f32 v233, v233, v93
    v_mul_f32 v234, v234, v94
    v_mul_f32 v235, v235, v95
    v_cvt_pk_bf16_f32 v96, v160, v161
    v_cvt_pk_bf16_f32 v97, v162, v163
    v_cvt_pk_bf16_f32 v98, v184, v185
    v_cvt_pk_bf16_f32 v99, v186, v187
    v_cvt_pk_bf16_f32 v100, v208, v209
    v_cvt_pk_bf16_f32 v101, v210, v211
    v_cvt_pk_bf16_f32 v102, v232, v233
    v_cvt_pk_bf16_f32 v103, v234, v235
    s_lshl_b32 s64, s48, 16
    buffer_store_dwordx4 v[96:99], v48, s[28:31], s64 offen
    buffer_store_dwordx4 v[100:103], v49, s[28:31], s64 offen
    v_lshlrev_b32 v80, 16, v96
    v_and_b32 v81, 0xffff0000, v96
    v_lshlrev_b32 v82, 16, v97
    v_and_b32 v83, 0xffff0000, v97
    v_lshlrev_b32 v84, 16, v98
    v_and_b32 v85, 0xffff0000, v98
    v_lshlrev_b32 v86, 16, v99
    v_and_b32 v87, 0xffff0000, v99
    v_lshlrev_b32 v88, 16, v100
    v_and_b32 v89, 0xffff0000, v100
    v_lshlrev_b32 v90, 16, v101
    v_and_b32 v91, 0xffff0000, v101
    v_lshlrev_b32 v92, 16, v102
    v_and_b32 v93, 0xffff0000, v102
    v_lshlrev_b32 v94, 16, v103
    v_and_b32 v95, 0xffff0000, v103
    v_pk_add_f32 v[112:113], v[112:113], v[80:81]
    v_pk_fma_f32 v[128:129], v[80:81], v[80:81], v[128:129]
    v_pk_add_f32 v[114:115], v[114:115], v[82:83]
    v_pk_fma_f32 v[130:131], v[82:83], v[82:83], v[130:131]
    v_pk_add_f32 v[116:117], v[116:117], v[84:85]
    v_pk_fma_f32 v[132:133], v[84:85], v[84:85], v[132:133]
    v_pk_add_f32 v[118:119], v[118:119], v[86:87]
    v_pk_fma_f32 v[134:135], v[86:87], v[86:87], v[134:135]
    v_pk_add_f32 v[120:121], v[120:121], v[88:89]
    v_pk_fma_f32 v[136:137], v[88:89], v[88:89], v[136:137]
    v_pk_add_f32 v[122:123], v[122:123], v[90:91]
    v_pk_fma_f32 v[138:139], v[90:91], v[90:91], v[138:139]
    v_pk_add_f32 v[124:125], v[124:125], v[92:93]
    v_pk_fma_f32 v[140:141], v[92:93], v[92:93], v[140:141]
    v_pk_add_f32 v[126:127], v[126:127], v[94:95]
    v_pk_fma_f32 v[142:143], v[94:95], v[94:95], v[142:143]
P1_z2_skip0:
    s_lshr_b32 s48, s59, 6
    s_add_u32 s48, s48, 4
    s_cmp_ge_u32 s48, s63
    s_cbranch_scc1 P1_z2_skip1
    s_mul_i32 s49, s53, 11
    s_add_u32 s48, s48, s49
    v_mul_f32 v80, v164, v164
    v_mul_f32 v81, v165, v165
    v_mul_f32 v82, v166, v166
    v_mul_f32 v83, v167, v167
    v_mul_f32 v84, v188, v188
    v_mul_f32 v85, v189, v189
    v_mul_f32 v86, v190, v190
    v_mul_f32 v87, v191, v191
    v_mul_f32 v88, v212, v212
    v_mul_f32 v89, v213, v213
    v_mul_f32 v90, v214, v214
    v_mul_f32 v91, v215, v215
    v_mul_f32 v92, v236, v236
    v_mul_f32 v93, v237, v237
    v_mul_f32 v94, v238, v238
    v_mul_f32 v95, v239, v239
    v_fma_f32 v80, v80, s54, v79
    v_fma_f32 v81, v81, s54, v79
    v_fma_f32 v82, v82, s54, v79
    v_fma_f32 v83, v83, s54, v79
    v_fma_f32 v84, v84, s54, v79
    v_fma_f32 v85, v85, s54, v79
    v_fma_f32 v86, v86, s54, v79
    v_fma_f32 v87, v87, s54, v79
    v_fma_f32 v88, v88, s54, v79
    v_fma_f32 v89, v89, s54, v79
    v_fma_f32 v90, v90, s54, v79
    v_fma_f32 v91, v91, s54, v79
    v_fma_f32 v92, v92, s54, v79
    v_fma_f32 v93, v93, s54, v79
    v_fma_f32 v94, v94, s54, v79
    v_fma_f32 v95, v95, s54, v79
    v_mul_f32 v80, v80, v164
    v_mul_f32 v81, v81, v165
    v_mul_f32 v82, v82, v166
    v_mul_f32 v83, v83, v167
    v_mul_f32 v84, v84, v188
    v_mul_f32 v85, v85, v189
    v_mul_f32 v86, v86, v190
    v_mul_f32 v87, v87, v191
    v_mul_f32 v88, v88, v212
    v_mul_f32 v89, v89, v213
    v_mul_f32 v90, v90, v214
    v_mul_f32 v91, v91, v215
    v_mul_f32 v92, v92, v236
    v_mul_f32 v93, v93, v237
    v_mul_f32 v94, v94, v238
    v_mul_f32 v95, v95, v239
    v_exp_f32 v80, v80
    v_exp_f32 v81, v81
    v_exp_f32 v82, v82
    v_exp_f32 v83, v83
    v_exp_f32 v84, v84
    v_exp_f32 v85, v85
    v_exp_f32 v86, v86
    v_exp_f32 v87, v87
    v_exp_f32 v88, v88
    v_exp_f32 v89, v89
    v_exp_f32 v90, v90
    v_exp_f32 v91, v91
    v_exp_f32 v92, v92
    v_exp_f32 v93, v93
    v_exp_f32 v94, v94
    v_exp_f32 v95, v95
    v_add_f32 v80, 1.0, v80
    v_add_f32 v81, 1.0, v81
    v_add_f32 v82, 1.0, v82
    v_add_f32 v83, 1.0, v83
    v_add_f32 v84, 1.0, v84
    v_add_f32 v85, 1.0, v85
    v_add_f32 v86, 1.0, v86
    v_add_f32 v87, 1.0, v87
    v_add_f32 v88, 1.0, v88
    v_add_f32 v89, 1.0, v89
    v_add_f32 v90, 1.0, v90
    v_add_f32 v91, 1.0, v91
    v_add_f32 v92, 1.0, v92
    v_add_f32 v93, 1.0, v93
    v_add_f32 v94, 1.0, v94
    v_add_f32 v95, 1.0, v95
    v_rcp_f32 v80, v80
    v_rcp_f32 v81, v81
    v_rcp_f32 v82, v82
    v_rcp_f32 v83, v83
    v_rcp_f32 v84, v84
    v_rcp_f32 v85, v85
    v_rcp_f32 v86, v86
    v_rcp_f32 v87, v87
    v_rcp_f32 v88, v88
    v_rcp_f32 v89, v89
    v_rcp_f32 v90, v90
    v_rcp_f32 v91, v91
    v_rcp_f32 v92, v92
    v_rcp_f32 v93, v93
    v_rcp_f32 v94, v94
    v_rcp_f32 v95, v95
    v_mul_f32 v164, v164, v80
    v_mul_f32 v165, v165, v81
    v_mul_f32 v166, v166, v82
    v_mul_f32 v167, v167, v83
    v_mul_f32 v188, v188, v84
    v_mul_f32 v189, v189, v85
    v_mul_f32 v190, v190, v86
    v_mul_f32 v191, v191, v87
    v_mul_f32 v212, v212, v88
    v_mul_f32 v213, v213, v89
    v_mul_f32 v214, v214, v90
    v_mul_f32 v215, v215, v91
    v_mul_f32 v236, v236, v92
    v_mul_f32 v237, v237, v93
    v_mul_f32 v238, v238, v94
    v_mul_f32 v239, v239, v95
    v_cvt_pk_bf16_f32 v96, v164, v165
    v_cvt_pk_bf16_f32 v97, v166, v167
    v_cvt_pk_bf16_f32 v98, v188, v189
    v_cvt_pk_bf16_f32 v99, v190, v191
    v_cvt_pk_bf16_f32 v100, v212, v213
    v_cvt_pk_bf16_f32 v101, v214, v215
    v_cvt_pk_bf16_f32 v102, v236, v237
    v_cvt_pk_bf16_f32 v103, v238, v239
    s_lshl_b32 s64, s48, 16
    buffer_store_dwordx4 v[96:99], v48, s[28:31], s64 offen
    buffer_store_dwordx4 v[100:103], v49, s[28:31], s64 offen
    v_lshlrev_b32 v80, 16, v96
    v_and_b32 v81, 0xffff0000, v96
    v_lshlrev_b32 v82, 16, v97
    v_and_b32 v83, 0xffff0000, v97
    v_lshlrev_b32 v84, 16, v98
    v_and_b32 v85, 0xffff0000, v98
    v_lshlrev_b32 v86, 16, v99
    v_and_b32 v87, 0xffff0000, v99
    v_lshlrev_b32 v88, 16, v100
    v_and_b32 v89, 0xffff0000, v100
    v_lshlrev_b32 v90, 16, v101
    v_and_b32 v91, 0xffff0000, v101
    v_lshlrev_b32 v92, 16, v102
    v_and_b32 v93, 0xffff0000, v102
    v_lshlrev_b32 v94, 16, v103
    v_and_b32 v95, 0xffff0000, v103
    v_pk_add_f32 v[112:113], v[112:113], v[80:81]
    v_pk_fma_f32 v[128:129], v[80:81], v[80:81], v[128:129]
    v_pk_add_f32 v[114:115], v[114:115], v[82:83]
    v_pk_fma_f32 v[130:131], v[82:83], v[82:83], v[130:131]
    v_pk_add_f32 v[116:117], v[116:117], v[84:85]
    v_pk_fma_f32 v[132:133], v[84:85], v[84:85], v[132:133]
    v_pk_add_f32 v[118:119], v[118:119], v[86:87]
    v_pk_fma_f32 v[134:135], v[86:87], v[86:87], v[134:135]
    v_pk_add_f32 v[120:121], v[120:121], v[88:89]
    v_pk_fma_f32 v[136:137], v[88:89], v[88:89], v[136:137]
    v_pk_add_f32 v[122:123], v[122:123], v[90:91]
    v_pk_fma_f32 v[138:139], v[90:91], v[90:91], v[138:139]
    v_pk_add_f32 v[124:125], v[124:125], v[92:93]
    v_pk_fma_f32 v[140:141], v[92:93], v[92:93], v[140:141]
    v_pk_add_f32 v[126:127], v[126:127], v[94:95]
    v_pk_fma_f32 v[142:143], v[94:95], v[94:95], v[142:143]
P1_z2_skip1:
    s_lshr_b32 s48, s59, 6
    s_add_u32 s48, s48, 8
    s_cmp_ge_u32 s48, s63
    s_cbranch_scc1 P1_z2_skip2
    s_mul_i32 s49, s53, 11
    s_add_u32 s48, s48, s49
    v_mul_f32 v80, v168, v168
    v_mul_f32 v81, v169, v169
    v_mul_f32 v82, v170, v170
    v_mul_f32 v83, v171, v171
    v_mul_f32 v84, v192, v192
    v_mul_f32 v85, v193, v193
    v_mul_f32 v86, v194, v194
    v_mul_f32 v87, v195, v195
    v_mul_f32 v88, v216, v216
    v_mul_f32 v89, v217, v217
    v_mul_f32 v90, v218, v218
    v_mul_f32 v91, v219, v219
    v_mul_f32 v92, v240, v240
    v_mul_f32 v93, v241, v241
    v_mul_f32 v94, v242, v242
    v_mul_f32 v95, v243, v243
    v_fma_f32 v80, v80, s54, v79
    v_fma_f32 v81, v81, s54, v79
    v_fma_f32 v82, v82, s54, v79
    v_fma_f32 v83, v83, s54, v79
    v_fma_f32 v84, v84, s54, v79
    v_fma_f32 v85, v85, s54, v79
    v_fma_f32 v86, v86, s54, v79
    v_fma_f32 v87, v87, s54, v79
    v_fma_f32 v88, v88, s54, v79
    v_fma_f32 v89, v89, s54, v79
    v_fma_f32 v90, v90, s54, v79
    v_fma_f32 v91, v91, s54, v79
    v_fma_f32 v92, v92, s54, v79
    v_fma_f32 v93, v93, s54, v79
    v_fma_f32 v94, v94, s54, v79
    v_fma_f32 v95, v95, s54, v79
    v_mul_f32 v80, v80, v168
    v_mul_f32 v81, v81, v169
    v_mul_f32 v82, v82, v170
    v_mul_f32 v83, v83, v171
    v_mul_f32 v84, v84, v192
    v_mul_f32 v85, v85, v193
    v_mul_f32 v86, v86, v194
    v_mul_f32 v87, v87, v195
    v_mul_f32 v88, v88, v216
    v_mul_f32 v89, v89, v217
    v_mul_f32 v90, v90, v218
    v_mul_f32 v91, v91, v219
    v_mul_f32 v92, v92, v240
    v_mul_f32 v93, v93, v241
    v_mul_f32 v94, v94, v242
    v_mul_f32 v95, v95, v243
    v_exp_f32 v80, v80
    v_exp_f32 v81, v81
    v_exp_f32 v82, v82
    v_exp_f32 v83, v83
    v_exp_f32 v84, v84
    v_exp_f32 v85, v85
    v_exp_f32 v86, v86
    v_exp_f32 v87, v87
    v_exp_f32 v88, v88
    v_exp_f32 v89, v89
    v_exp_f32 v90, v90
    v_exp_f32 v91, v91
    v_exp_f32 v92, v92
    v_exp_f32 v93, v93
    v_exp_f32 v94, v94
    v_exp_f32 v95, v95
    v_add_f32 v80, 1.0, v80
    v_add_f32 v81, 1.0, v81
    v_add_f32 v82, 1.0, v82
    v_add_f32 v83, 1.0, v83
    v_add_f32 v84, 1.0, v84
    v_add_f32 v85, 1.0, v85
    v_add_f32 v86, 1.0, v86
    v_add_f32 v87, 1.0, v87
    v_add_f32 v88, 1.0, v88
    v_add_f32 v89, 1.0, v89
    v_add_f32 v90, 1.0, v90
    v_add_f32 v91, 1.0, v91
    v_add_f32 v92, 1.0, v92
    v_add_f32 v93, 1.0, v93
    v_add_f32 v94, 1.0, v94
    v_add_f32 v95, 1.0, v95
    v_rcp_f32 v80, v80
    v_rcp_f32 v81, v81
    v_rcp_f32 v82, v82
    v_rcp_f32 v83, v83
    v_rcp_f32 v84, v84
    v_rcp_f32 v85, v85
    v_rcp_f32 v86, v86
    v_rcp_f32 v87, v87
    v_rcp_f32 v88, v88
    v_rcp_f32 v89, v89
    v_rcp_f32 v90, v90
    v_rcp_f32 v91, v91
    v_rcp_f32 v92, v92
    v_rcp_f32 v93, v93
    v_rcp_f32 v94, v94
    v_rcp_f32 v95, v95
    v_mul_f32 v168, v168, v80
    v_mul_f32 v169, v169, v81
    v_mul_f32 v170, v170, v82
    v_mul_f32 v171, v171, v83
    v_mul_f32 v192, v192, v84
    v_mul_f32 v193, v193, v85
    v_mul_f32 v194, v194, v86
    v_mul_f32 v195, v195, v87
    v_mul_f32 v216, v216, v88
    v_mul_f32 v217, v217, v89
    v_mul_f32 v218, v218, v90
    v_mul_f32 v219, v219, v91
    v_mul_f32 v240, v240, v92
    v_mul_f32 v241, v241, v93
    v_mul_f32 v242, v242, v94
    v_mul_f32 v243, v243, v95
    v_cvt_pk_bf16_f32 v96, v168, v169
    v_cvt_pk_bf16_f32 v97, v170, v171
    v_cvt_pk_bf16_f32 v98, v192, v193
    v_cvt_pk_bf16_f32 v99, v194, v195
    v_cvt_pk_bf16_f32 v100, v216, v217
    v_cvt_pk_bf16_f32 v101, v218, v219
    v_cvt_pk_bf16_f32 v102, v240, v241
    v_cvt_pk_bf16_f32 v103, v242, v243
    s_lshl_b32 s64, s48, 16
    buffer_store_dwordx4 v[96:99], v48, s[28:31], s64 offen
    buffer_store_dwordx4 v[100:103], v49, s[28:31], s64 offen
    v_lshlrev_b32 v80, 16, v96
    v_and_b32 v81, 0xffff0000, v96
    v_lshlrev_b32 v82, 16, v97
    v_and_b32 v83, 0xffff0000, v97
    v_lshlrev_b32 v84, 16, v98
    v_and_b32 v85, 0xffff0000, v98
    v_lshlrev_b32 v86, 16, v99
    v_and_b32 v87, 0xffff0000, v99
    v_lshlrev_b32 v88, 16, v100
    v_and_b32 v89, 0xffff0000, v100
    v_lshlrev_b32 v90, 16, v101
    v_and_b32 v91, 0xffff0000, v101
    v_lshlrev_b32 v92, 16, v102
    v_and_b32 v93, 0xffff0000, v102
    v_lshlrev_b32 v94, 16, v103
    v_and_b32 v95, 0xffff0000, v103
    v_pk_add_f32 v[112:113], v[112:113], v[80:81]
    v_pk_fma_f32 v[128:129], v[80:81], v[80:81], v[128:129]
    v_pk_add_f32 v[114:115], v[114:115], v[82:83]
    v_pk_fma_f32 v[130:131], v[82:83], v[82:83], v[130:131]
    v_pk_add_f32 v[116:117], v[116:117], v[84:85]
    v_pk_fma_f32 v[132:133], v[84:85], v[84:85], v[132:133]
    v_pk_add_f32 v[118:119], v[118:119], v[86:87]
    v_pk_fma_f32 v[134:135], v[86:87], v[86:87], v[134:135]
    v_pk_add_f32 v[120:121], v[120:121], v[88:89]
    v_pk_fma_f32 v[136:137], v[88:89], v[88:89], v[136:137]
    v_pk_add_f32 v[122:123], v[122:123], v[90:91]
    v_pk_fma_f32 v[138:139], v[90:91], v[90:91], v[138:139]
    v_pk_add_f32 v[124:125], v[124:125], v[92:93]
    v_pk_fma_f32 v[140:141], v[92:93], v[92:93], v[140:141]
    v_pk_add_f32 v[126:127], v[126:127], v[94:95]
    v_pk_fma_f32 v[142:143], v[94:95], v[94:95], v[142:143]
P1_z2_skip2:
    s_lshr_b32 s48, s60, 6
    s_add_u32 s48, s48, 0
    s_cmp_ge_u32 s48, s63
    s_cbranch_scc1 P1_z2_skip3
    s_mul_i32 s49, s53, 11
    s_add_u32 s48, s48, s49
    v_mul_f32 v80, v172, v172
    v_mul_f32 v81, v173, v173
    v_mul_f32 v82, v174, v174
    v_mul_f32 v83, v175, v175
    v_mul_f32 v84, v196, v196
    v_mul_f32 v85, v197, v197
    v_mul_f32 v86, v198, v198
    v_mul_f32 v87, v199, v199
    v_mul_f32 v88, v220, v220
    v_mul_f32 v89, v221, v221
    v_mul_f32 v90, v222, v222
    v_mul_f32 v91, v223, v223
    v_mul_f32 v92, v244, v244
    v_mul_f32 v93, v245, v245
    v_mul_f32 v94, v246, v246
    v_mul_f32 v95, v247, v247
    v_fma_f32 v80, v80, s54, v79
    v_fma_f32 v81, v81, s54, v79
    v_fma_f32 v82, v82, s54, v79
    v_fma_f32 v83, v83, s54, v79
    v_fma_f32 v84, v84, s54, v79
    v_fma_f32 v85, v85, s54, v79
    v_fma_f32 v86, v86, s54, v79
    v_fma_f32 v87, v87, s54, v79
    v_fma_f32 v88, v88, s54, v79
    v_fma_f32 v89, v89, s54, v79
    v_fma_f32 v90, v90, s54, v79
    v_fma_f32 v91, v91, s54, v79
    v_fma_f32 v92, v92, s54, v79
    v_fma_f32 v93, v93, s54, v79
    v_fma_f32 v94, v94, s54, v79
    v_fma_f32 v95, v95, s54, v79
    v_mul_f32 v80, v80, v172
    v_mul_f32 v81, v81, v173
    v_mul_f32 v82, v82, v174
    v_mul_f32 v83, v83, v175
    v_mul_f32 v84, v84, v196
    v_mul_f32 v85, v85, v197
    v_mul_f32 v86, v86, v198
    v_mul_f32 v87, v87, v199
    v_mul_f32 v88, v88, v220
    v_mul_f32 v89, v89, v221
    v_mul_f32 v90, v90, v222
    v_mul_f32 v91, v91, v223
    v_mul_f32 v92, v92, v244
    v_mul_f32 v93, v93, v245
    v_mul_f32 v94, v94, v246
    v_mul_f32 v95, v95, v247
    v_exp_f32 v80, v80
    v_exp_f32 v81, v81
    v_exp_f32 v82, v82
    v_exp_f32 v83, v83
    v_exp_f32 v84, v84
    v_exp_f32 v85, v85
    v_exp_f32 v86, v86
    v_exp_f32 v87, v87
    v_exp_f32 v88, v88
    v_exp_f32 v89, v89
    v_exp_f32 v90, v90
    v_exp_f32 v91, v91
    v_exp_f32 v92, v92
    v_exp_f32 v93, v93
    v_exp_f32 v94, v94
    v_exp_f32 v95, v95
    v_add_f32 v80, 1.0, v80
    v_add_f32 v81, 1.0, v81
    v_add_f32 v82, 1.0, v82
    v_add_f32 v83, 1.0, v83
    v_add_f32 v84, 1.0, v84
    v_add_f32 v85, 1.0, v85
    v_add_f32 v86, 1.0, v86
    v_add_f32 v87, 1.0, v87
    v_add_f32 v88, 1.0, v88
    v_add_f32 v89, 1.0, v89
    v_add_f32 v90, 1.0, v90
    v_add_f32 v91, 1.0, v91
    v_add_f32 v92, 1.0, v92
    v_add_f32 v93, 1.0, v93
    v_add_f32 v94, 1.0, v94
    v_add_f32 v95, 1.0, v95
    v_rcp_f32 v80, v80
    v_rcp_f32 v81, v81
    v_rcp_f32 v82, v82
    v_rcp_f32 v83, v83
    v_rcp_f32 v84, v84
    v_rcp_f32 v85, v85
    v_rcp_f32 v86, v86
    v_rcp_f32 v87, v87
    v_rcp_f32 v88, v88
    v_rcp_f32 v89, v89
    v_rcp_f32 v90, v90
    v_rcp_f32 v91, v91
    v_rcp_f32 v92, v92
    v_rcp_f32 v93, v93
    v_rcp_f32 v94, v94
    v_rcp_f32 v95, v95
    v_mul_f32 v172, v172, v80
    v_mul_f32 v173, v173, v81
    v_mul_f32 v174, v174, v82
    v_mul_f32 v175, v175, v83
    v_mul_f32 v196, v196, v84
    v_mul_f32 v197, v197, v85
    v_mul_f32 v198, v198, v86
    v_mul_f32 v199, v199, v87
    v_mul_f32 v220, v220, v88
    v_mul_f32 v221, v221, v89
    v_mul_f32 v222, v222, v90
    v_mul_f32 v223, v223, v91
    v_mul_f32 v244, v244, v92
    v_mul_f32 v245, v245, v93
    v_mul_f32 v246, v246, v94
    v_mul_f32 v247, v247, v95
    v_cvt_pk_bf16_f32 v96, v172, v173
    v_cvt_pk_bf16_f32 v97, v174, v175
    v_cvt_pk_bf16_f32 v98, v196, v197
    v_cvt_pk_bf16_f32 v99, v198, v199
    v_cvt_pk_bf16_f32 v100, v220, v221
    v_cvt_pk_bf16_f32 v101, v222, v223
    v_cvt_pk_bf16_f32 v102, v244, v245
    v_cvt_pk_bf16_f32 v103, v246, v247
    s_lshl_b32 s64, s48, 16
    buffer_store_dwordx4 v[96:99], v48, s[28:31], s64 offen
    buffer_store_dwordx4 v[100:103], v49, s[28:31], s64 offen
    v_lshlrev_b32 v80, 16, v96
    v_and_b32 v81, 0xffff0000, v96
    v_lshlrev_b32 v82, 16, v97
    v_and_b32 v83, 0xffff0000, v97
    v_lshlrev_b32 v84, 16, v98
    v_and_b32 v85, 0xffff0000, v98
    v_lshlrev_b32 v86, 16, v99
    v_and_b32 v87, 0xffff0000, v99
    v_lshlrev_b32 v88, 16, v100
    v_and_b32 v89, 0xffff0000, v100
    v_lshlrev_b32 v90, 16, v101
    v_and_b32 v91, 0xffff0000, v101
    v_lshlrev_b32 v92, 16, v102
    v_and_b32 v93, 0xffff0000, v102
    v_lshlrev_b32 v94, 16, v103
    v_and_b32 v95, 0xffff0000, v103
    v_pk_add_f32 v[112:113], v[112:113], v[80:81]
    v_pk_fma_f32 v[128:129], v[80:81], v[80:81], v[128:129]
    v_pk_add_f32 v[114:115], v[114:115], v[82:83]
    v_pk_fma_f32 v[130:131], v[82:83], v[82:83], v[130:131]
    v_pk_add_f32 v[116:117], v[116:117], v[84:85]
    v_pk_fma_f32 v[132:133], v[84:85], v[84:85], v[132:133]
    v_pk_add_f32 v[118:119], v[118:119], v[86:87]
    v_pk_fma_f32 v[134:135], v[86:87], v[86:87], v[134:135]
    v_pk_add_f32 v[120:121], v[120:121], v[88:89]
    v_pk_fma_f32 v[136:137], v[88:89], v[88:89], v[136:137]
    v_pk_add_f32 v[122:123], v[122:123], v[90:91]
    v_pk_fma_f32 v[138:139], v[90:91], v[90:91], v[138:139]
    v_pk_add_f32 v[124:125], v[124:125], v[92:93]
    v_pk_fma_f32 v[140:141], v[92:93], v[92:93], v[140:141]
    v_pk_add_f32 v[126:127], v[126:127], v[94:95]
    v_pk_fma_f32 v[142:143], v[94:95], v[94:95], v[142:143]
P1_z2_skip3:
    s_lshr_b32 s48, s60, 6
    s_add_u32 s48, s48, 4
    s_cmp_ge_u32 s48, s63
    s_cbranch_scc1 P1_z2_skip4
    s_mul_i32 s49, s53, 11
    s_add_u32 s48, s48, s49
    v_mul_f32 v80, v176, v176
    v_mul_f32 v81, v177, v177
    v_mul_f32 v82, v178, v178
    v_mul_f32 v83, v179, v179
    v_mul_f32 v84, v200, v200
    v_mul_f32 v85, v201, v201
    v_mul_f32 v86, v202, v202
    v_mul_f32 v87, v203, v203
    v_mul_f32 v88, v224, v224
    v_mul_f32 v89, v225, v225
    v_mul_f32 v90, v226, v226
    v_mul_f32 v91, v227, v227
    v_mul_f32 v92, v248, v248
    v_mul_f32 v93, v249, v249
    v_mul_f32 v94, v250, v250
    v_mul_f32 v95, v251, v251
    v_fma_f32 v80, v80, s54, v79
    v_fma_f32 v81, v81, s54, v79
    v_fma_f32 v82, v82, s54, v79
    v_fma_f32 v83, v83, s54, v79
    v_fma_f32 v84, v84, s54, v79
    v_fma_f32 v85, v85, s54, v79
    v_fma_f32 v86, v86, s54, v79
    v_fma_f32 v87, v87, s54, v79
    v_fma_f32 v88, v88, s54, v79
    v_fma_f32 v89, v89, s54, v79
    v_fma_f32 v90, v90, s54, v79
    v_fma_f32 v91, v91, s54, v79
    v_fma_f32 v92, v92, s54, v79
    v_fma_f32 v93, v93, s54, v79
    v_fma_f32 v94, v94, s54, v79
    v_fma_f32 v95, v95, s54, v79
    v_mul_f32 v80, v80, v176
    v_mul_f32 v81, v81, v177
    v_mul_f32 v82, v82, v178
    v_mul_f32 v83, v83, v179
    v_mul_f32 v84, v84, v200
    v_mul_f32 v85, v85, v201
    v_mul_f32 v86, v86, v202
    v_mul_f32 v87, v87, v203
    v_mul_f32 v88, v88, v224
    v_mul_f32 v89, v89, v225
    v_mul_f32 v90, v90, v226
    v_mul_f32 v91, v91, v227
    v_mul_f32 v92, v92, v248
    v_mul_f32 v93, v93, v249
    v_mul_f32 v94, v94, v250
    v_mul_f32 v95, v95, v251
    v_exp_f32 v80, v80
    v_exp_f32 v81, v81
    v_exp_f32 v82, v82
    v_exp_f32 v83, v83
    v_exp_f32 v84, v84
    v_exp_f32 v85, v85
    v_exp_f32 v86, v86
    v_exp_f32 v87, v87
    v_exp_f32 v88, v88
    v_exp_f32 v89, v89
    v_exp_f32 v90, v90
    v_exp_f32 v91, v91
    v_exp_f32 v92, v92
    v_exp_f32 v93, v93
    v_exp_f32 v94, v94
    v_exp_f32 v95, v95
    v_add_f32 v80, 1.0, v80
    v_add_f32 v81, 1.0, v81
    v_add_f32 v82, 1.0, v82
    v_add_f32 v83, 1.0, v83
    v_add_f32 v84, 1.0, v84
    v_add_f32 v85, 1.0, v85
    v_add_f32 v86, 1.0, v86
    v_add_f32 v87, 1.0, v87
    v_add_f32 v88, 1.0, v88
    v_add_f32 v89, 1.0, v89
    v_add_f32 v90, 1.0, v90
    v_add_f32 v91, 1.0, v91
    v_add_f32 v92, 1.0, v92
    v_add_f32 v93, 1.0, v93
    v_add_f32 v94, 1.0, v94
    v_add_f32 v95, 1.0, v95
    v_rcp_f32 v80, v80
    v_rcp_f32 v81, v81
    v_rcp_f32 v82, v82
    v_rcp_f32 v83, v83
    v_rcp_f32 v84, v84
    v_rcp_f32 v85, v85
    v_rcp_f32 v86, v86
    v_rcp_f32 v87, v87
    v_rcp_f32 v88, v88
    v_rcp_f32 v89, v89
    v_rcp_f32 v90, v90
    v_rcp_f32 v91, v91
    v_rcp_f32 v92, v92
    v_rcp_f32 v93, v93
    v_rcp_f32 v94, v94
    v_rcp_f32 v95, v95
    v_mul_f32 v176, v176, v80
    v_mul_f32 v177, v177, v81
    v_mul_f32 v178, v178, v82
    v_mul_f32 v179, v179, v83
    v_mul_f32 v200, v200, v84
    v_mul_f32 v201, v201, v85
    v_mul_f32 v202, v202, v86
    v_mul_f32 v203, v203, v87
    v_mul_f32 v224, v224, v88
    v_mul_f32 v225, v225, v89
    v_mul_f32 v226, v226, v90
    v_mul_f32 v227, v227, v91
    v_mul_f32 v248, v248, v92
    v_mul_f32 v249, v249, v93
    v_mul_f32 v250, v250, v94
    v_mul_f32 v251, v251, v95
    v_cvt_pk_bf16_f32 v96, v176, v177
    v_cvt_pk_bf16_f32 v97, v178, v179
    v_cvt_pk_bf16_f32 v98, v200, v201
    v_cvt_pk_bf16_f32 v99, v202, v203
    v_cvt_pk_bf16_f32 v100, v224, v225
    v_cvt_pk_bf16_f32 v101, v226, v227
    v_cvt_pk_bf16_f32 v102, v248, v249
    v_cvt_pk_bf16_f32 v103, v250, v251
    s_lshl_b32 s64, s48, 16
    buffer_store_dwordx4 v[96:99], v48, s[28:31], s64 offen
    buffer_store_dwordx4 v[100:103], v49, s[28:31], s64 offen
    v_lshlrev_b32 v80, 16, v96
    v_and_b32 v81, 0xffff0000, v96
    v_lshlrev_b32 v82, 16, v97
    v_and_b32 v83, 0xffff0000, v97
    v_lshlrev_b32 v84, 16, v98
    v_and_b32 v85, 0xffff0000, v98
    v_lshlrev_b32 v86, 16, v99
    v_and_b32 v87, 0xffff0000, v99
    v_lshlrev_b32 v88, 16, v100
    v_and_b32 v89, 0xffff0000, v100
    v_lshlrev_b32 v90, 16, v101
    v_and_b32 v91, 0xffff0000, v101
    v_lshlrev_b32 v92, 16, v102
    v_and_b32 v93, 0xffff0000, v102
    v_lshlrev_b32 v94, 16, v103
    v_and_b32 v95, 0xffff0000, v103
    v_pk_add_f32 v[112:113], v[112:113], v[80:81]
    v_pk_fma_f32 v[128:129], v[80:81], v[80:81], v[128:129]
    v_pk_add_f32 v[114:115], v[114:115], v[82:83]
    v_pk_fma_f32 v[130:131], v[82:83], v[82:83], v[130:131]
    v_pk_add_f32 v[116:117], v[116:117], v[84:85]
    v_pk_fma_f32 v[132:133], v[84:85], v[84:85], v[132:133]
    v_pk_add_f32 v[118:119], v[118:119], v[86:87]
    v_pk_fma_f32 v[134:135], v[86:87], v[86:87], v[134:135]
    v_pk_add_f32 v[120:121], v[120:121], v[88:89]
    v_pk_fma_f32 v[136:137], v[88:89], v[88:89], v[136:137]
    v_pk_add_f32 v[122:123], v[122:123], v[90:91]
    v_pk_fma_f32 v[138:139], v[90:91], v[90:91], v[138:139]
    v_pk_add_f32 v[124:125], v[124:125], v[92:93]
    v_pk_fma_f32 v[140:141], v[92:93], v[92:93], v[140:141]
    v_pk_add_f32 v[126:127], v[126:127], v[94:95]
    v_pk_fma_f32 v[142:143], v[94:95], v[94:95], v[142:143]
P1_z2_skip4:
    s_lshr_b32 s48, s60, 6
    s_add_u32 s48, s48, 8
    s_cmp_ge_u32 s48, s63
    s_cbranch_scc1 P1_z2_skip5
    s_mul_i32 s49, s53, 11
    s_add_u32 s48, s48, s49
    v_mul_f32 v80, v180, v180
    v_mul_f32 v81, v181, v181
    v_mul_f32 v82, v182, v182
    v_mul_f32 v83, v183, v183
    v_mul_f32 v84, v204, v204
    v_mul_f32 v85, v205, v205
    v_mul_f32 v86, v206, v206
    v_mul_f32 v87, v207, v207
    v_mul_f32 v88, v228, v228
    v_mul_f32 v89, v229, v229
    v_mul_f32 v90, v230, v230
    v_mul_f32 v91, v231, v231
    v_mul_f32 v92, v252, v252
    v_mul_f32 v93, v253, v253
    v_mul_f32 v94, v254, v254
    v_mul_f32 v95, v255, v255
    v_fma_f32 v80, v80, s54, v79
    v_fma_f32 v81, v81, s54, v79
    v_fma_f32 v82, v82, s54, v79
    v_fma_f32 v83, v83, s54, v79
    v_fma_f32 v84, v84, s54, v79
    v_fma_f32 v85, v85, s54, v79
    v_fma_f32 v86, v86, s54, v79
    v_fma_f32 v87, v87, s54, v79
    v_fma_f32 v88, v88, s54, v79
    v_fma_f32 v89, v89, s54, v79
    v_fma_f32 v90, v90, s54, v79
    v_fma_f32 v91, v91, s54, v79
    v_fma_f32 v92, v92, s54, v79
    v_fma_f32 v93, v93, s54, v79
    v_fma_f32 v94, v94, s54, v79
    v_fma_f32 v95, v95, s54, v79
    v_mul_f32 v80, v80, v180
    v_mul_f32 v81, v81, v181
    v_mul_f32 v82, v82, v182
    v_mul_f32 v83, v83, v183
    v_mul_f32 v84, v84, v204
    v_mul_f32 v85, v85, v205
    v_mul_f32 v86, v86, v206
    v_mul_f32 v87, v87, v207
    v_mul_f32 v88, v88, v228
    v_mul_f32 v89, v89, v229
    v_mul_f32 v90, v90, v230
    v_mul_f32 v91, v91, v231
    v_mul_f32 v92, v92, v252
    v_mul_f32 v93, v93, v253
    v_mul_f32 v94, v94, v254
    v_mul_f32 v95, v95, v255
    v_exp_f32 v80, v80
    v_exp_f32 v81, v81
    v_exp_f32 v82, v82
    v_exp_f32 v83, v83
    v_exp_f32 v84, v84
    v_exp_f32 v85, v85
    v_exp_f32 v86, v86
    v_exp_f32 v87, v87
    v_exp_f32 v88, v88
    v_exp_f32 v89, v89
    v_exp_f32 v90, v90
    v_exp_f32 v91, v91
    v_exp_f32 v92, v92
    v_exp_f32 v93, v93
    v_exp_f32 v94, v94
    v_exp_f32 v95, v95
    v_add_f32 v80, 1.0, v80
    v_add_f32 v81, 1.0, v81
    v_add_f32 v82, 1.0, v82
    v_add_f32 v83, 1.0, v83
    v_add_f32 v84, 1.0, v84
    v_add_f32 v85, 1.0, v85
    v_add_f32 v86, 1.0, v86
    v_add_f32 v87, 1.0, v87
    v_add_f32 v88, 1.0, v88
    v_add_f32 v89, 1.0, v89
    v_add_f32 v90, 1.0, v90
    v_add_f32 v91, 1.0, v91
    v_add_f32 v92, 1.0, v92
    v_add_f32 v93, 1.0, v93
    v_add_f32 v94, 1.0, v94
    v_add_f32 v95, 1.0, v95
    v_rcp_f32 v80, v80
    v_rcp_f32 v81, v81
    v_rcp_f32 v82, v82
    v_rcp_f32 v83, v83
    v_rcp_f32 v84, v84
    v_rcp_f32 v85, v85
    v_rcp_f32 v86, v86
    v_rcp_f32 v87, v87
    v_rcp_f32 v88, v88
    v_rcp_f32 v89, v89
    v_rcp_f32 v90, v90
    v_rcp_f32 v91, v91
    v_rcp_f32 v92, v92
    v_rcp_f32 v93, v93
    v_rcp_f32 v94, v94
    v_rcp_f32 v95, v95
    v_mul_f32 v180, v180, v80
    v_mul_f32 v181, v181, v81
    v_mul_f32 v182, v182, v82
    v_mul_f32 v183, v183, v83
    v_mul_f32 v204, v204, v84
    v_mul_f32 v205, v205, v85
    v_mul_f32 v206, v206, v86
    v_mul_f32 v207, v207, v87
    v_mul_f32 v228, v228, v88
    v_mul_f32 v229, v229, v89
    v_mul_f32 v230, v230, v90
    v_mul_f32 v231, v231, v91
    v_mul_f32 v252, v252, v92
    v_mul_f32 v253, v253, v93
    v_mul_f32 v254, v254, v94
    v_mul_f32 v255, v255, v95
    v_cvt_pk_bf16_f32 v96, v180, v181
    v_cvt_pk_bf16_f32 v97, v182, v183
    v_cvt_pk_bf16_f32 v98, v204, v205
    v_cvt_pk_bf16_f32 v99, v206, v207
    v_cvt_pk_bf16_f32 v100, v228, v229
    v_cvt_pk_bf16_f32 v101, v230, v231
    v_cvt_pk_bf16_f32 v102, v252, v253
    v_cvt_pk_bf16_f32 v103, v254, v255
    s_lshl_b32 s64, s48, 16
    buffer_store_dwordx4 v[96:99], v48, s[28:31], s64 offen
    buffer_store_dwordx4 v[100:103], v49, s[28:31], s64 offen
    v_lshlrev_b32 v80, 16, v96
    v_and_b32 v81, 0xffff0000, v96
    v_lshlrev_b32 v82, 16, v97
    v_and_b32 v83, 0xffff0000, v97
    v_lshlrev_b32 v84, 16, v98
    v_and_b32 v85, 0xffff0000, v98
    v_lshlrev_b32 v86, 16, v99
    v_and_b32 v87, 0xffff0000, v99
    v_lshlrev_b32 v88, 16, v100
    v_and_b32 v89, 0xffff0000, v100
    v_lshlrev_b32 v90, 16, v101
    v_and_b32 v91, 0xffff0000, v101
    v_lshlrev_b32 v92, 16, v102
    v_and_b32 v93, 0xffff0000, v102
    v_lshlrev_b32 v94, 16, v103
    v_and_b32 v95, 0xffff0000, v103
    v_pk_add_f32 v[112:113], v[112:113], v[80:81]
    v_pk_fma_f32 v[128:129], v[80:81], v[80:81], v[128:129]
    v_pk_add_f32 v[114:115], v[114:115], v[82:83]
    v_pk_fma_f32 v[130:131], v[82:83], v[82:83], v[130:131]
    v_pk_add_f32 v[116:117], v[116:117], v[84:85]
    v_pk_fma_f32 v[132:133], v[84:85], v[84:85], v[132:133]
    v_pk_add_f32 v[118:119], v[118:119], v[86:87]
    v_pk_fma_f32 v[134:135], v[86:87], v[86:87], v[134:135]
    v_pk_add_f32 v[120:121], v[120:121], v[88:89]
    v_pk_fma_f32 v[136:137], v[88:89], v[88:89], v[136:137]
    v_pk_add_f32 v[122:123], v[122:123], v[90:91]
    v_pk_fma_f32 v[138:139], v[90:91], v[90:91], v[138:139]
    v_pk_add_f32 v[124:125], v[124:125], v[92:93]
    v_pk_fma_f32 v[140:141], v[92:93], v[92:93], v[140:141]
    v_pk_add_f32 v[126:127], v[126:127], v[94:95]
    v_pk_fma_f32 v[142:143], v[94:95], v[94:95], v[142:143]
P1_z2_skip5:
    s_nop 1
    v_add_f32_dpp v112, v112, v112 row_ror:8 row_mask:0xf bank_mask:0xf
    v_add_f32_dpp v113, v113, v113 row_ror:8 row_mask:0xf bank_mask:0xf
    v_add_f32_dpp v114, v114, v114 row_ror:8 row_mask:0xf bank_mask:0xf
    v_add_f32_dpp v115, v115, v115 row_ror:8 row_mask:0xf bank_mask:0xf
    v_add_f32_dpp v116, v116, v116 row_ror:8 row_mask:0xf bank_mask:0xf
    v_add_f32_dpp v117, v117, v117 row_ror:8 row_mask:0xf bank_mask:0xf
    v_add_f32_dpp v118, v118, v118 row_ror:8 row_mask:0xf bank_mask:0xf
    v_add_f32_dpp v119, v119, v119 row_ror:8 row_mask:0xf bank_mask:0xf
    v_add_f32_dpp v120, v120, v120 row_ror:8 row_mask:0xf bank_mask:0xf
    v_add_f32_dpp v121, v121, v121 row_ror:8 row_mask:0xf bank_mask:0xf
    v_add_f32_dpp v122, v122, v122 row_ror:8 row_mask:0xf bank_mask:0xf
    v_add_f32_dpp v123, v123, v123 row_ror:8 row_mask:0xf bank_mask:0xf
    v_add_f32_dpp v124, v124, v124 row_ror:8 row_mask:0xf bank_mask:0xf
    v_add_f32_dpp v125, v125, v125 row_ror:8 row_mask:0xf bank_mask:0xf
    v_add_f32_dpp v126, v126, v126 row_ror:8 row_mask:0xf bank_mask:0xf
    v_add_f32_dpp v127, v127, v127 row_ror:8 row_mask:0xf bank_mask:0xf
    v_add_f32_dpp v128, v128, v128 row_ror:8 row_mask:0xf bank_mask:0xf
    v_add_f32_dpp v129, v129, v129 row_ror:8 row_mask:0xf bank_mask:0xf
    v_add_f32_dpp v130, v130, v130 row_ror:8 row_mask:0xf bank_mask:0xf
    v_add_f32_dpp v131, v131, v131 row_ror:8 row_mask:0xf bank_mask:0xf
    v_add_f32_dpp v132, v132, v132 row_ror:8 row_mask:0xf bank_mask:0xf
    v_add_f32_dpp v133, v133, v133 row_ror:8 row_mask:0xf bank_mask:0xf
    v_add_f32_dpp v134, v134, v134 row_ror:8 row_mask:0xf bank_mask:0xf
    v_add_f32_dpp v135, v135, v135 row_ror:8 row_mask:0xf bank_mask:0xf
    v_add_f32_dpp v136, v136, v136 row_ror:8 row_mask:0xf bank_mask:0xf
    v_add_f32_dpp v137, v137, v137 row_ror:8 row_mask:0xf bank_mask:0xf
    v_add_f32_dpp v138, v138, v138 row_ror:8 row_mask:0xf bank_mask:0xf
    v_add_f32_dpp v139, v139, v139 row_ror:8 row_mask:0xf bank_mask:0xf
    v_add_f32_dpp v140, v140, v140 row_ror:8 row_mask:0xf bank_mask:0xf
    v_add_f32_dpp v141, v141, v141 row_ror:8 row_mask:0xf bank_mask:0xf
    v_add_f32_dpp v142, v142, v142 row_ror:8 row_mask:0xf bank_mask:0xf
    v_add_f32_dpp v143, v143, v143 row_ror:8 row_mask:0xf bank_mask:0xf
    v_add_f32_dpp v112, v112, v112 row_ror:4 row_mask:0xf bank_mask:0xf
    v_add_f32_dpp v113, v113, v113 row_ror:4 row_mask:0xf bank_mask:0xf
    v_add_f32_dpp v114, v114, v114 row_ror:4 row_mask:0xf bank_mask:0xf
    v_add_f32_dpp v115, v115, v115 row_ror:4 row_mask:0xf bank_mask:0xf
    v_add_f32_dpp v116, v116, v116 row_ror:4 row_mask:0xf bank_mask:0xf
    v_add_f32_dpp v117, v117, v117 row_ror:4 row_mask:0xf bank_mask:0xf
    v_add_f32_dpp v118, v118, v118 row_ror:4 row_mask:0xf bank_mask:0xf
    v_add_f32_dpp v119, v119, v119 row_ror:4 row_mask:0xf bank_mask:0xf
    v_add_f32_dpp v120, v120, v120 row_ror:4 row_mask:0xf bank_mask:0xf
    v_add_f32_dpp v121, v121, v121 row_ror:4 row_mask:0xf bank_mask:0xf
    v_add_f32_dpp v122, v122, v122 row_ror:4 row_mask:0xf bank_mask:0xf
    v_add_f32_dpp v123, v123, v123 row_ror:4 row_mask:0xf bank_mask:0xf
    v_add_f32_dpp v124, v124, v124 row_ror:4 row_mask:0xf bank_mask:0xf
    v_add_f32_dpp v125, v125, v125 row_ror:4 row_mask:0xf bank_mask:0xf
    v_add_f32_dpp v126, v126, v126 row_ror:4 row_mask:0xf bank_mask:0xf
    v_add_f32_dpp v127, v127, v127 row_ror:4 row_mask:0xf bank_mask:0xf
    v_add_f32_dpp v128, v128, v128 row_ror:4 row_mask:0xf bank_mask:0xf
    v_add_f32_dpp v129, v129, v129 row_ror:4 row_mask:0xf bank_mask:0xf
    v_add_f32_dpp v130, v130, v130 row_ror:4 row_mask:0xf bank_mask:0xf
    v_add_f32_dpp v131, v131, v131 row_ror:4 row_mask:0xf bank_mask:0xf
    v_add_f32_dpp v132, v132, v132 row_ror:4 row_mask:0xf bank_mask:0xf
    v_add_f32_dpp v133, v133, v133 row_ror:4 row_mask:0xf bank_mask:0xf
    v_add_f32_dpp v134, v134, v134 row_ror:4 row_mask:0xf bank_mask:0xf
    v_add_f32_dpp v135, v135, v135 row_ror:4 row_mask:0xf bank_mask:0xf
    v_add_f32_dpp v136, v136, v136 row_ror:4 row_mask:0xf bank_mask:0xf
    v_add_f32_dpp v137, v137, v137 row_ror:4 row_mask:0xf bank_mask:0xf
    v_add_f32_dpp v138, v138, v138 row_ror:4 row_mask:0xf bank_mask:0xf
    v_add_f32_dpp v139, v139, v139 row_ror:4 row_mask:0xf bank_mask:0xf
    v_add_f32_dpp v140, v140, v140 row_ror:4 row_mask:0xf bank_mask:0xf
    v_add_f32_dpp v141, v141, v141 row_ror:4 row_mask:0xf bank_mask:0xf
    v_add_f32_dpp v142, v142, v142 row_ror:4 row_mask:0xf bank_mask:0xf
    v_add_f32_dpp v143, v143, v143 row_ror:4 row_mask:0xf bank_mask:0xf
    v_add_f32_dpp v112, v112, v112 row_ror:2 row_mask:0xf bank_mask:0xf
    v_add_f32_dpp v113, v113, v113 row_ror:2 row_mask:0xf bank_mask:0xf
    v_add_f32_dpp v114, v114, v114 row_ror:2 row_mask:0xf bank_mask:0xf
    v_add_f32_dpp v115, v115, v115 row_ror:2 row_mask:0xf bank_mask:0xf
    v_add_f32_dpp v116, v116, v116 row_ror:2 row_mask:0xf bank_mask:0xf
    v_add_f32_dpp v117, v117, v117 row_ror:2 row_mask:0xf bank_mask:0xf
    v_add_f32_dpp v118, v118, v118 row_ror:2 row_mask:0xf bank_mask:0xf
    v_add_f32_dpp v119, v119, v119 row_ror:2 row_mask:0xf bank_mask:0xf
    v_add_f32_dpp v120, v120, v120 row_ror:2 row_mask:0xf bank_mask:0xf
    v_add_f32_dpp v121, v121, v121 row_ror:2 row_mask:0xf bank_mask:0xf
    v_add_f32_dpp v122, v122, v122 row_ror:2 row_mask:0xf bank_mask:0xf
    v_add_f32_dpp v123, v123, v123 row_ror:2 row_mask:0xf bank_mask:0xf
    v_add_f32_dpp v124, v124, v124 row_ror:2 row_mask:0xf bank_mask:0xf
    v_add_f32_dpp v125, v125, v125 row_ror:2 row_mask:0xf bank_mask:0xf
    v_add_f32_dpp v126, v126, v126 row_ror:2 row_mask:0xf bank_mask:0xf
    v_add_f32_dpp v127, v127, v127 row_ror:2 row_mask:0xf bank_mask:0xf
    v_add_f32_dpp v128, v128, v128 row_ror:2 row_mask:0xf bank_mask:0xf
    v_add_f32_dpp v129, v129, v129 row_ror:2 row_mask:0xf bank_mask:0xf
    v_add_f32_dpp v130, v130, v130 row_ror:2 row_mask:0xf bank_mask:0xf
    v_add_f32_dpp v131, v131, v131 row_ror:2 row_mask:0xf bank_mask:0xf
    v_add_f32_dpp v132, v132, v132 row_ror:2 row_mask:0xf bank_mask:0xf
    v_add_f32_dpp v133, v133, v133 row_ror:2 row_mask:0xf bank_mask:0xf
    v_add_f32_dpp v134, v134, v134 row_ror:2 row_mask:0xf bank_mask:0xf
    v_add_f32_dpp v135, v135, v135 row_ror:2 row_mask:0xf bank_mask:0xf
    v_add_f32_dpp v136, v136, v136 row_ror:2 row_mask:0xf bank_mask:0xf
    v_add_f32_dpp v137, v137, v137 row_ror:2 row_mask:0xf bank_mask:0xf
    v_add_f32_dpp v138, v138, v138 row_ror:2 row_mask:0xf bank_mask:0xf
    v_add_f32_dpp v139, v139, v139 row_ror:2 row_mask:0xf bank_mask:0xf
    v_add_f32_dpp v140, v140, v140 row_ror:2 row_mask:0xf bank_mask:0xf
    v_add_f32_dpp v141, v141, v141 row_ror:2 row_mask:0xf bank_mask:0xf
    v_add_f32_dpp v142, v142, v142 row_ror:2 row_mask:0xf bank_mask:0xf
    v_add_f32_dpp v143, v143, v143 row_ror:2 row_mask:0xf bank_mask:0xf
    v_add_f32_dpp v112, v112, v112 row_ror:1 row_mask:0xf bank_mask:0xf
    v_add_f32_dpp v113, v113, v113 row_ror:1 row_mask:0xf bank_mask:0xf
    v_add_f32_dpp v114, v114, v114 row_ror:1 row_mask:0xf bank_mask:0xf
    v_add_f32_dpp v115, v115, v115 row_ror:1 row_mask:0xf bank_mask:0xf
    v_add_f32_dpp v116, v116, v116 row_ror:1 row_mask:0xf bank_mask:0xf
    v_add_f32_dpp v117, v117, v117 row_ror:1 row_mask:0xf bank_mask:0xf
    v_add_f32_dpp v118, v118, v118 row_ror:1 row_mask:0xf bank_mask:0xf
    v_add_f32_dpp v119, v119, v119 row_ror:1 row_mask:0xf bank_mask:0xf
    v_add_f32_dpp v120, v120, v120 row_ror:1 row_mask:0xf bank_mask:0xf
    v_add_f32_dpp v121, v121, v121 row_ror:1 row_mask:0xf bank_mask:0xf
    v_add_f32_dpp v122, v122, v122 row_ror:1 row_mask:0xf bank_mask:0xf
    v_add_f32_dpp v123, v123, v123 row_ror:1 row_mask:0xf bank_mask:0xf
    v_add_f32_dpp v124, v124, v124 row_ror:1 row_mask:0xf bank_mask:0xf
    v_add_f32_dpp v125, v125, v125 row_ror:1 row_mask:0xf bank_mask:0xf
    v_add_f32_dpp v126, v126, v126 row_ror:1 row_mask:0xf bank_mask:0xf
    v_add_f32_dpp v127, v127, v127 row_ror:1 row_mask:0xf bank_mask:0xf
    v_add_f32_dpp v128, v128, v128 row_ror:1 row_mask:0xf bank_mask:0xf
    v_add_f32_dpp v129, v129, v129 row_ror:1 row_mask:0xf bank_mask:0xf
    v_add_f32_dpp v130, v130, v130 row_ror:1 row_mask:0xf bank_mask:0xf
    v_add_f32_dpp v131, v131, v131 row_ror:1 row_mask:0xf bank_mask:0xf
    v_add_f32_dpp v132, v132, v132 row_ror:1 row_mask:0xf bank_mask:0xf
    v_add_f32_dpp v133, v133, v133 row_ror:1 row_mask:0xf bank_mask:0xf
    v_add_f32_dpp v134, v134, v134 row_ror:1 row_mask:0xf bank_mask:0xf
    v_add_f32_dpp v135, v135, v135 row_ror:1 row_mask:0xf bank_mask:0xf
    v_add_f32_dpp v136, v136, v136 row_ror:1 row_mask:0xf bank_mask:0xf
    v_add_f32_dpp v137, v137, v137 row_ror:1 row_mask:0xf bank_mask:0xf
    v_add_f32_dpp v138, v138, v138 row_ror:1 row_mask:0xf bank_mask:0xf
    v_add_f32_dpp v139, v139, v139 row_ror:1 row_mask:0xf bank_mask:0xf
    v_add_f32_dpp v140, v140, v140 row_ror:1 row_mask:0xf bank_mask:0xf
    v_add_f32_dpp v141, v141, v141 row_ror:1 row_mask:0xf bank_mask:0xf
    v_add_f32_dpp v142, v142, v142 row_ror:1 row_mask:0xf bank_mask:0xf
    v_add_f32_dpp v143, v143, v143 row_ror:1 row_mask:0xf bank_mask:0xf
    v_cmp_eq_u32 vcc, 0, v2
    s_and_saveexec_b64 s[66:67], vcc
    ds_add_f32 v42, v112 offset:3072
    ds_add_f32 v42, v128 offset:3584
    ds_add_f32 v42, v113 offset:3076
    ds_add_f32 v42, v129 offset:3588
    ds_add_f32 v42, v114 offset:3080
    ds_add_f32 v42, v130 offset:3592
    ds_add_f32 v42, v115 offset:3084
    ds_add_f32 v42, v131 offset:3596
    ds_add_f32 v42, v116 offset:3136
    ds_add_f32 v42, v132 offset:3648
    ds_add_f32 v42, v117 offset:3140
    ds_add_f32 v42, v133 offset:3652
    ds_add_f32 v42, v118 offset:3144
    ds_add_f32 v42, v134 offset:3656
    ds_add_f32 v42, v119 offset:3148
    ds_add_f32 v42, v135 offset:3660
    ds_add_f32 v43, v120 offset:3072
    ds_add_f32 v43, v136 offset:3584
    ds_add_f32 v43, v121 offset:3076
    ds_add_f32 v43, v137 offset:3588
    ds_add_f32 v43, v122 offset:3080
    ds_add_f32 v43, v138 offset:3592
    ds_add_f32 v43, v123 offset:3084
    ds_add_f32 v43, v139 offset:3596
    ds_add_f32 v43, v124 offset:3136
    ds_add_f32 v43, v140 offset:3648
    ds_add_f32 v43, v125 offset:3140
    ds_add_f32 v43, v141 offset:3652
    ds_add_f32 v43, v126 offset:3144
    ds_add_f32 v43, v142 offset:3656
    ds_add_f32 v43, v127 offset:3148
    ds_add_f32 v43, v143 offset:3660
    s_mov_b64 exec, s[66:67]
    s_waitcnt lgkmcnt(0)
    s_barrier
    v_and_b32 v40, 127, v0
    v_lshlrev_b32 v41, 2, v40
    ds_read_b32 v42, v41 offset:3072
    ds_read_b32 v43, v41 offset:3584
    s_lshl_b32 s48, s53, 11
    s_lshl_b32 s49, s36, 7
    s_add_u32 s48, s48, s49
    s_lshl_b32 s48, s48, 3
    v_lshlrev_b32 v41, 3, v40
    s_waitcnt lgkmcnt(0)
    buffer_store_dwordx2 v[42:43], v41, s[32:35], s48 offen
    s_endpgm
P1_exit:
    s_endpgm
.globl p2_kernel
.p2align 8
.type p2_kernel,@function
p2_kernel:
    s_cmp_ge_u32 s2, 256
    s_cbranch_scc1 p2_kernel_exit
    s_load_dwordx2 s[4:5], s[0:1], 0
    s_load_dwordx2 s[6:7], s[0:1], 24
    s_load_dwordx4 s[8:11], s[0:1], 48
    s_load_dwordx4 s[12:15], s[0:1], 64
    s_load_dwordx2 s[16:17], s[0:1], 88
    v_lshrrev_b32 v4, 6, v0
    v_and_b32 v1, 63, v0
    v_readfirstlane_b32 s38, v4
    v_and_b32 v2, 15, v0
    v_bfe_u32 v3, v0, 4, 2
    s_and_b32 s48, s2, 7
    s_lshl_b32 s48, s48, 2
    s_lshr_b32 s36, s2, 6
    s_add_u32 s36, s36, s48
    s_bfe_u32 s37, s2, 0x30003
    s_mul_i32 s39, s37, 11
    s_lshr_b32 s39, s39, 1
    s_lshl_b32 s48, s38, 12
    v_lshl_add_u32 v4, v1, 4, s48
    s_lshl_b32 s48, s39, 16
    s_lshl_b32 s49, s38, 14
    s_add_u32 s48, s48, s49
    v_lshl_add_u32 v7, v1, 4, s48
    s_lshl_b32 s48, s36, 18
    s_lshl_b32 s49, s38, 10
    s_add_u32 s48, s48, s49
    v_and_b32 v5, 7, v1
    v_xor_b32 v5, v5, v3
    v_lshl_add_u32 v5, v5, 4, s48
    v_lshrrev_b32 v6, 3, v1
    v_lshl_add_u32 v6, v6, 12, v5
    v_xor_b32 v5, 64, v6
    s_mul_i32 s55, s38, 24576
    s_add_u32 s55, s55, 16384
    s_mov_b32 s56, 0xffff0000
    s_mov_b32 s70, 0
    s_mov_b32 s71, 65536
    s_mov_b32 s72, 131072
    s_mov_b32 s73, 196608
    s_mov_b32 s74, 262144
    s_mov_b32 s75, 327680
    s_lshl_b32 s48, s38, 16
    s_xor_b32 s60, s48, 0
    s_xor_b32 s61, s48, 32768
    s_xor_b32 s62, s48, 65536
    s_xor_b32 s63, s48, 98304
    s_xor_b32 s64, s48, 131072
    s_xor_b32 s65, s48, 163840
    s_xor_b32 s66, s48, 196608
    s_xor_b32 s67, s48, 229376
    s_mov_b32 s22, 8388608
    s_mov_b32 s23, 0x00020000
    s_mov_b32 s26, 2818048
    s_mov_b32 s27, 0x00020000
    s_mov_b32 s30, 65536
    s_mov_b32 s31, 0x00020000
    s_waitcnt lgkmcnt(0)
    s_add_u32 s28, s16, 12582912
    s_addc_u32 s29, s17, 0
    s_movk_i32 s48, 0
    buffer_load_dwordx4 v[16:19], v4, s[28:31], s48 offen offset:0
    buffer_load_dwordx4 v[20:23], v4, s[28:31], s48 offen offset:1024
    buffer_load_dwordx4 v[24:27], v4, s[28:31], s48 offen offset:2048
    buffer_load_dwordx4 v[28:31], v4, s[28:31], s48 offen offset:3072
    s_movk_i32 s48, 16384
    buffer_load_dwordx4 v[32:35], v4, s[28:31], s48 offen offset:0
    buffer_load_dwordx4 v[36:39], v4, s[28:31], s48 offen offset:1024
    buffer_load_dwordx4 v[40:43], v4, s[28:31], s48 offen offset:2048
    buffer_load_dwordx4 v[44:47], v4, s[28:31], s48 offen offset:3072
    s_mov_b32 s48, 32768
    buffer_load_dwordx4 v[48:51], v4, s[28:31], s48 offen offset:0
    buffer_load_dwordx4 v[52:55], v4, s[28:31], s48 offen offset:1024
    buffer_load_dwordx4 v[56:59], v4, s[28:31], s48 offen offset:2048
    buffer_load_dwordx4 v[60:63], v4, s[28:31], s48 offen offset:3072
    s_mov_b32 s48, 49152
    buffer_load_dwordx4 v[64:67], v4, s[28:31], s48 offen offset:0
    buffer_load_dwordx4 v[68:71], v4, s[28:31], s48 offen offset:1024
    buffer_load_dwordx4 v[72:75], v4, s[28:31], s48 offen offset:2048
    buffer_load_dwordx4 v[76:79], v4, s[28:31], s48 offen offset:3072
    s_mov_b32 s20, s8
    s_mov_b32 s21, s9
    s_add_u32 s24, s16, 8388608
    s_addc_u32 s25, s17, 0
    s_add_u32 m0, s55, 0
    s_nop 0
    buffer_load_dwordx4 v6, s[20:23], s60 offen lds
    s_add_u32 m0, s55, 1024
    s_nop 0
    buffer_load_dwordx4 v5, s[20:23], s61 offen lds
    s_add_u32 m0, s55, 2048
    s_nop 0
    buffer_load_dwordx4 v6, s[20:23], s62 offen lds
    s_add_u32 m0, s55, 3072
    s_nop 0
    buffer_load_dwordx4 v5, s[20:23], s63 offen lds
    s_add_u32 m0, s55, 4096
    s_nop 0
    buffer_load_dwordx4 v6, s[20:23], s64 offen lds
    s_add_u32 m0, s55, 5120
    s_nop 0
    buffer_load_dwordx4 v5, s[20:23], s65 offen lds
    s_add_u32 m0, s55, 6144
    s_nop 0
    buffer_load_dwordx4 v6, s[20:23], s66 offen lds
    s_add_u32 m0, s55, 7168
    s_nop 0
    buffer_load_dwordx4 v5, s[20:23], s67 offen lds
    v_add_u32 v6, 128, v6
    v_add_u32 v5, 128, v5
    s_add_u32 m0, s55, 8192
    s_nop 0
    buffer_load_dwordx4 v6, s[20:23], s60 offen lds
    s_add_u32 m0, s55, 9216
    s_nop 0
    buffer_load_dwordx4 v5, s[20:23], s61 offen lds
    s_add_u32 m0, s55, 10240
    s_nop 0
    buffer_load_dwordx4 v6, s[20:23], s62 offen lds
    s_add_u32 m0, s55, 11264
    s_nop 0
    buffer_load_dwordx4 v5, s[20:23], s63 offen lds
    s_add_u32 m0, s55, 12288
    s_nop 0
    buffer_load_dwordx4 v6, s[20:23], s64 offen lds
    s_add_u32 m0, s55, 13312
    s_nop 0
    buffer_load_dwordx4 v5, s[20:23], s65 offen lds
    s_add_u32 m0, s55, 14336
    s_nop 0
    buffer_load_dwordx4 v6, s[20:23], s66 offen lds
    s_add_u32 m0, s55, 15360
    s_nop 0
    buffer_load_dwordx4 v5, s[20:23], s67 offen lds
    v_add_u32 v6, 128, v6
    v_add_u32 v5, 128, v5
    buffer_load_dwordx4 v[96:99], v7, s[24:27], s70 offen offset:0
    buffer_load_dwordx4 v[100:103], v7, s[24:27], s71 offen offset:0
    buffer_load_dwordx4 v[104:107], v7, s[24:27], s72 offen offset:0
    buffer_load_dwordx4 v[108:111], v7, s[24:27], s73 offen offset:0
    buffer_load_dwordx4 v[112:115], v7, s[24:27], s74 offen offset:0
    buffer_load_dwordx4 v[116:119], v7, s[24:27], s75 offen offset:0
    s_add_u32 s32, s16, 16777216
    s_addc_u32 s33, s17, 0
    s_mov_b32 s34, 4980736
    s_mov_b32 s35, 0x00020000
    s_add_u32 s40, s16, 4194304
    s_addc_u32 s41, s17, 0
    s_mov_b32 s42, 2883584
    s_mov_b32 s43, 0x00020000
    s_mov_b32 s44, s10
    s_mov_b32 s45, s11
    s_mov_b32 s46, 4096
    s_mov_b32 s47, 0x00020000
    s_add_u32 s76, s16, 13631488
    s_addc_u32 s77, s17, 0
    s_mov_b32 s78, 1114112
    s_mov_b32 s79, 0x00020000
    s_mov_b32 s80, s16
    s_mov_b32 s81, s17
    s_mov_b32 s82, 4194304
    s_mov_b32 s83, 0x00020000
    s_lshl_b32 s48, s38, 11
    v_lshl_add_u32 v8, v3, 4, s48
    v_lshl_add_u32 v9, v1, 3, s48
    v_lshrrev_b32 v10, 1, v3
    v_lshrrev_b32 v11, 1, v2
    v_xor_b32 v10, v10, v11
    v_lshl_add_u32 v10, v10, 4, s55
    v_lshl_add_u32 v10, v2, 7, v10
    v_and_b32 v11, 1, v3
    v_lshl_add_u32 v12, v11, 3, v10
    v_xor_b32 v13, 32, v12
    v_xor_b32 v14, 64, v12
    v_xor_b32 v15, 0x60, v12
    s_lshl_b32 s48, s38, 10
    v_lshl_add_u32 v10, v3, 6, s48
    v_bfe_u32 v11, v1, 1, 2
    v_lshl_add_u32 v10, v11, 4, v10
    v_bfe_u32 v11, v1, 3, 1
    v_lshl_add_u32 v10, v11, 3, v10
    v_and_b32 v11, 1, v1
    v_lshl_add_u32 v10, v11, 2, v10
    v_lshlrev_b32 v11, 12, v11
    v_lshl_add_u32 v11, v3, 4, v11
    v_add_u32 v11, s48, v11
    s_waitcnt vmcnt(22)
    buffer_load_dwordx4 v[120:123], v7, s[24:27], s70 offen offset:1024
    v_pk_add_f32 v[16:17], v[16:17], v[32:33]
    v_pk_add_f32 v[48:49], v[48:49], v[64:65]
    v_pk_add_f32 v[18:19], v[18:19], v[34:35]
    v_pk_add_f32 v[50:51], v[50:51], v[66:67]
    v_pk_add_f32 v[20:21], v[20:21], v[36:37]
    v_pk_add_f32 v[52:53], v[52:53], v[68:69]
    v_pk_add_f32 v[22:23], v[22:23], v[38:39]
    v_pk_add_f32 v[54:55], v[54:55], v[70:71]
    v_pk_add_f32 v[24:25], v[24:25], v[40:41]
    v_pk_add_f32 v[56:57], v[56:57], v[72:73]
    v_pk_add_f32 v[26:27], v[26:27], v[42:43]
    v_pk_add_f32 v[58:59], v[58:59], v[74:75]
    v_pk_add_f32 v[28:29], v[28:29], v[44:45]
    v_pk_add_f32 v[60:61], v[60:61], v[76:77]
    v_pk_add_f32 v[30:31], v[30:31], v[46:47]
    v_pk_add_f32 v[62:63], v[62:63], v[78:79]
    v_pk_add_f32 v[16:17], v[16:17], v[48:49]
    v_pk_add_f32 v[18:19], v[18:19], v[50:51]
    buffer_load_dwordx4 v[124:127], v7, s[24:27], s71 offen offset:1024
    v_pk_add_f32 v[20:21], v[20:21], v[52:53]
    v_pk_add_f32 v[22:23], v[22:23], v[54:55]
    v_pk_add_f32 v[24:25], v[24:25], v[56:57]
    v_pk_add_f32 v[26:27], v[26:27], v[58:59]
    v_pk_add_f32 v[28:29], v[28:29], v[60:61]
    v_pk_add_f32 v[30:31], v[30:31], v[62:63]
    v_mul_f32 v16, 0x3abe82fa, v16
    v_mul_f32 v17, 0x3abe82fa, v17
    v_mul_f32 v18, 0x3abe82fa, v18
    v_mul_f32 v19, 0x3abe82fa, v19
    v_mul_f32 v20, 0x3abe82fa, v20
    v_mul_f32 v21, 0x3abe82fa, v21
    v_mul_f32 v22, 0x3abe82fa, v22
    v_mul_f32 v23, 0x3abe82fa, v23
    v_mul_f32 v24, 0x3abe82fa, v24
    v_mul_f32 v25, 0x3abe82fa, v25
    v_mul_f32 v26, 0x3abe82fa, v26
    v_mul_f32 v27, 0x3abe82fa, v27
    buffer_load_dwordx4 v[128:131], v7, s[24:27], s72 offen offset:1024
    v_mul_f32 v28, 0x3abe82fa, v28
    v_mul_f32 v29, 0x3abe82fa, v29
    v_mul_f32 v30, 0x3abe82fa, v30
    v_mul_f32 v31, 0x3abe82fa, v31
    v_fma_f32 v17, -v16, v16, v17
    v_fma_f32 v19, -v18, v18, v19
    v_fma_f32 v21, -v20, v20, v21
    v_fma_f32 v23, -v22, v22, v23
    v_fma_f32 v25, -v24, v24, v25
    v_fma_f32 v27, -v26, v26, v27
    v_fma_f32 v29, -v28, v28, v29
    v_fma_f32 v31, -v30, v30, v31
    v_max_f32 v17, 0, v17
    v_max_f32 v19, 0, v19
    v_max_f32 v21, 0, v21
    v_max_f32 v23, 0, v23
    v_max_f32 v25, 0, v25
    v_max_f32 v27, 0, v27
    buffer_load_dwordx4 v[132:135], v7, s[24:27], s73 offen offset:1024
    v_max_f32 v29, 0, v29
    v_max_f32 v31, 0, v31
    v_add_f32 v17, 0x3727c5ac, v17
    v_add_f32 v19, 0x3727c5ac, v19
    v_add_f32 v21, 0x3727c5ac, v21
    v_add_f32 v23, 0x3727c5ac, v23
    v_add_f32 v25, 0x3727c5ac, v25
    v_add_f32 v27, 0x3727c5ac, v27
    v_add_f32 v29, 0x3727c5ac, v29
    v_add_f32 v31, 0x3727c5ac, v31
    v_rsq_f32 v32, v17
    v_rsq_f32 v33, v19
    v_rsq_f32 v34, v21
    v_rsq_f32 v35, v23
    v_rsq_f32 v36, v25
    v_rsq_f32 v37, v27
    v_rsq_f32 v38, v29
    v_rsq_f32 v39, v31
    buffer_load_dwordx4 v[136:139], v7, s[24:27], s74 offen offset:1024
    v_cvt_pk_bf16_f32 v40, v16, v18
    v_cvt_pk_bf16_f32 v41, v20, v22
    v_cvt_pk_bf16_f32 v42, v24, v26
    v_cvt_pk_bf16_f32 v43, v28, v30
    v_lshlrev_b32 v48, 16, v40
    v_and_b32 v49, s56, v40
    v_lshlrev_b32 v50, 16, v41
    v_and_b32 v51, s56, v41
    v_lshlrev_b32 v52, 16, v42
    v_and_b32 v53, s56, v42
    v_lshlrev_b32 v54, 16, v43
    v_and_b32 v55, s56, v43
    v_sub_f32 v48, v16, v48
    v_sub_f32 v49, v18, v49
    v_sub_f32 v50, v20, v50
    v_sub_f32 v51, v22, v51
    v_sub_f32 v52, v24, v52
    v_sub_f32 v53, v26, v53
    buffer_load_dwordx4 v[140:143], v7, s[24:27], s75 offen offset:1024
    v_sub_f32 v54, v28, v54
    v_sub_f32 v55, v30, v55
    v_cvt_pk_bf16_f32 v44, v48, v49
    v_cvt_pk_bf16_f32 v45, v50, v51
    v_cvt_pk_bf16_f32 v46, v52, v53
    v_cvt_pk_bf16_f32 v47, v54, v55
    ds_write_b64 v9, v[32:33] offset:0
    ds_write_b32 v10, v40 offset:8192
    ds_write_b32 v10, v44 offset:12288
    ds_write_b64 v9, v[34:35] offset:512
    ds_write_b32 v10, v41 offset:8448
    ds_write_b32 v10, v45 offset:12544
    ds_write_b64 v9, v[36:37] offset:1024
    ds_write_b32 v10, v42 offset:8704
    ds_write_b32 v10, v46 offset:12800
    ds_write_b64 v9, v[38:39] offset:1536
    ds_write_b32 v10, v43 offset:8960
    ds_write_b32 v10, v47 offset:13056
    s_waitcnt lgkmcnt(0)
    ds_read_b128 v[16:19], v8 offset:0
    ds_read_b128 v[20:23], v8 offset:64
    ds_read_b128 v[24:27], v8 offset:128
    ds_read_b128 v[28:31], v8 offset:192
    ds_read_b128 a[112:115], v11 offset:8192
    s_waitcnt vmcnt(20)
    ds_read_b64 v[48:49], v12 offset:0
    ds_read_b64 v[50:51], v13 offset:0
    ds_read_b64 v[52:53], v12 offset:2048
    ds_read_b64 v[54:55], v13 offset:2048
    ds_read_b64 v[56:57], v12 offset:4096
    ds_read_b64 v[58:59], v13 offset:4096
    ds_read_b64 v[60:61], v12 offset:6144
    ds_read_b64 v[62:63], v13 offset:6144
    ds_read_b64 v[64:65], v14 offset:0
    ds_read_b64 v[66:67], v15 offset:0
    ds_read_b64 v[68:69], v14 offset:2048
    ds_read_b64 v[70:71], v15 offset:2048
    ds_read_b64 v[72:73], v14 offset:4096
    ds_read_b64 v[74:75], v15 offset:4096
    ds_read_b64 v[76:77], v14 offset:6144
    ds_read_b64 v[78:79], v15 offset:6144
    s_waitcnt lgkmcnt(8)
    buffer_load_dwordx4 v[144:147], v7, s[24:27], s70 offen offset:2048
    v_lshlrev_b32 v32, 16, v48
    v_and_b32 v33, s56, v48
    v_lshlrev_b32 v34, 16, v49
    v_and_b32 v35, s56, v49
    v_lshlrev_b32 v36, 16, v50
    v_and_b32 v37, s56, v50
    v_lshlrev_b32 v38, 16, v51
    v_and_b32 v39, s56, v51
    v_mul_f32 v32, v32, v16
    v_mul_f32 v33, v33, v17
    v_mul_f32 v34, v34, v18
    v_mul_f32 v35, v35, v19
    v_mul_f32 v36, v36, v20
    v_mul_f32 v37, v37, v21
    buffer_load_dwordx4 v[148:151], v7, s[24:27], s71 offen offset:2048
    v_mul_f32 v38, v38, v22
    v_mul_f32 v39, v39, v23
    v_cvt_pk_bf16_f32 v48, v32, v33
    v_cvt_pk_bf16_f32 v49, v34, v35
    v_cvt_pk_bf16_f32 v50, v36, v37
    v_cvt_pk_bf16_f32 v51, v38, v39
    v_lshlrev_b32 v40, 16, v52
    v_and_b32 v41, s56, v52
    v_lshlrev_b32 v42, 16, v53
    v_and_b32 v43, s56, v53
    v_lshlrev_b32 v44, 16, v54
    v_and_b32 v45, s56, v54
    v_lshlrev_b32 v46, 16, v55
    buffer_load_dwordx4 v[152:155], v7, s[24:27], s72 offen offset:2048
    v_and_b32 v47, s56, v55
    v_mul_f32 v40, v40, v16
    v_mul_f32 v41, v41, v17
    v_mul_f32 v42, v42, v18
    v_mul_f32 v43, v43, v19
    v_mul_f32 v44, v44, v20
    v_mul_f32 v45, v45, v21
    v_mul_f32 v46, v46, v22
    v_mul_f32 v47, v47, v23
    v_cvt_pk_bf16_f32 v52, v40, v41
    v_cvt_pk_bf16_f32 v53, v42, v43
    v_cvt_pk_bf16_f32 v54, v44, v45
    v_cvt_pk_bf16_f32 v55, v46, v47
    buffer_load_dwordx4 v[156:159], v7, s[24:27], s73 offen offset:2048
    v_lshlrev_b32 v32, 16, v56
    v_and_b32 v33, s56, v56
    v_lshlrev_b32 v34, 16, v57
    v_and_b32 v35, s56, v57
    v_lshlrev_b32 v36, 16, v58
    v_and_b32 v37, s56, v58
    v_lshlrev_b32 v38, 16, v59
    v_and_b32 v39, s56, v59
    v_mul_f32 v32, v32, v16
    v_mul_f32 v33, v33, v17
    v_mul_f32 v34, v34, v18
    v_mul_f32 v35, v35, v19
    v_mul_f32 v36, v36, v20
    v_mul_f32 v37, v37, v21
    buffer_load_dwordx4 v[160:163], v7, s[24:27], s74 offen offset:2048
    v_mul_f32 v38, v38, v22
    v_mul_f32 v39, v39, v23
    v_cvt_pk_bf16_f32 v56, v32, v33
    v_cvt_pk_bf16_f32 v57, v34, v35
    v_cvt_pk_bf16_f32 v58, v36, v37
    v_cvt_pk_bf16_f32 v59, v38, v39
    v_lshlrev_b32 v40, 16, v60
    v_and_b32 v41, s56, v60
    v_lshlrev_b32 v42, 16, v61
    v_and_b32 v43, s56, v61
    v_lshlrev_b32 v44, 16, v62
    v_and_b32 v45, s56, v62
    v_lshlrev_b32 v46, 16, v63
    buffer_load_dwordx4 v[164:167], v7, s[24:27], s75 offen offset:2048
    v_and_b32 v47, s56, v63
    v_mul_f32 v40, v40, v16
    v_mul_f32 v41, v41, v17
    v_mul_f32 v42, v42, v18
    v_mul_f32 v43, v43, v19
    v_mul_f32 v44, v44, v20
    v_mul_f32 v45, v45, v21
    v_mul_f32 v46, v46, v22
    v_mul_f32 v47, v47, v23
    v_cvt_pk_bf16_f32 v60, v40, v41
    v_cvt_pk_bf16_f32 v61, v42, v43
    v_cvt_pk_bf16_f32 v62, v44, v45
    v_cvt_pk_bf16_f32 v63, v46, v47
    s_waitcnt vmcnt(12) lgkmcnt(0)
    v_mfma_f32_16x16x32_bf16 a[0:3], v[96:99], v[48:51], 0
    ds_read_b128 a[116:119], v11 offset:8256
    ds_read_b64 v[80:81], v12 offset:8192
    ds_read_b64 v[82:83], v13 offset:8192
    ds_read_b64 v[84:85], v12 offset:10240
    v_mfma_f32_16x16x32_bf16 a[24:27], v[96:99], v[52:55], 0
    ds_read_b64 v[86:87], v13 offset:10240
    ds_read_b64 v[88:89], v12 offset:12288
    ds_read_b64 v[90:91], v13 offset:12288
    ds_read_b64 v[92:93], v12 offset:14336
    v_mfma_f32_16x16x32_bf16 a[48:51], v[96:99], v[56:59], 0
    ds_read_b64 v[94:95], v13 offset:14336
    ds_read_b128 v[16:19], v8 offset:256
    ds_read_b128 v[20:23], v8 offset:320
    s_add_u32 m0, s55, 16384
    s_nop 0
    buffer_load_dwordx4 v6, s[20:23], s60 offen lds
    v_mfma_f32_16x16x32_bf16 a[72:75], v[96:99], v[60:63], 0
    v_lshlrev_b32 v32, 16, v64
    v_and_b32 v33, s56, v64
    v_lshlrev_b32 v34, 16, v65
    v_and_b32 v35, s56, v65
    v_mfma_f32_16x16x32_bf16 a[4:7], v[100:103], v[48:51], 0
    v_lshlrev_b32 v36, 16, v66
    v_and_b32 v37, s56, v66
    s_add_u32 m0, s55, 17408
    s_nop 0
    buffer_load_dwordx4 v5, s[20:23], s61 offen lds
    v_lshlrev_b32 v38, 16, v67
    v_mfma_f32_16x16x32_bf16 a[28:31], v[100:103], v[52:55], 0
    v_and_b32 v39, s56, v67
    v_mul_f32 v32, v32, v24
    v_mul_f32 v33, v33, v25
    v_mul_f32 v34, v34, v26
    v_mfma_f32_16x16x32_bf16 a[52:55], v[100:103], v[56:59], 0
    s_add_u32 m0, s55, 18432
    s_nop 0
    buffer_load_dwordx4 v6, s[20:23], s62 offen lds
    v_mul_f32 v35, v35, v27
    v_mul_f32 v36, v36, v28
    v_mul_f32 v37, v37, v29
    v_mfma_f32_16x16x32_bf16 a[76:79], v[100:103], v[60:63], 0
    v_mul_f32 v38, v38, v30
    v_mul_f32 v39, v39, v31
    s_add_u32 m0, s55, 19456
    s_nop 0
    buffer_load_dwordx4 v5, s[20:23], s63 offen lds
    v_cvt_pk_bf16_f32 v64, v32, v33
    v_mfma_f32_16x16x32_bf16 a[8:11], v[104:107], v[48:51], 0
    v_cvt_pk_bf16_f32 v65, v34, v35
    v_cvt_pk_bf16_f32 v66, v36, v37
    v_cvt_pk_bf16_f32 v67, v38, v39
    v_lshlrev_b32 v40, 16, v68
    v_mfma_f32_16x16x32_bf16 a[32:35], v[104:107], v[52:55], 0
    v_and_b32 v41, s56, v68
    s_add_u32 m0, s55, 20480
    s_nop 0
    buffer_load_dwordx4 v6, s[20:23], s64 offen lds
    v_lshlrev_b32 v42, 16, v69
    v_and_b32 v43, s56, v69
    v_mfma_f32_16x16x32_bf16 a[56:59], v[104:107], v[56:59], 0
    v_lshlrev_b32 v44, 16, v70
    v_and_b32 v45, s56, v70
    v_lshlrev_b32 v46, 16, v71
    s_add_u32 m0, s55, 21504
    s_nop 0
    buffer_load_dwordx4 v5, s[20:23], s65 offen lds
    v_mfma_f32_16x16x32_bf16 a[80:83], v[104:107], v[60:63], 0
    v_and_b32 v47, s56, v71
    v_mul_f32 v40, v40, v24
    v_mul_f32 v41, v41, v25
    v_mul_f32 v42, v42, v26
    v_mfma_f32_16x16x32_bf16 a[12:15], v[108:111], v[48:51], 0
    v_mul_f32 v43, v43, v27
    s_add_u32 m0, s55, 22528
    s_nop 0
    buffer_load_dwordx4 v6, s[20:23], s66 offen lds
    v_mul_f32 v44, v44, v28
    v_mul_f32 v45, v45, v29
    v_mfma_f32_16x16x32_bf16 a[36:39], v[108:111], v[52:55], 0
    v_mul_f32 v46, v46, v30
    v_mul_f32 v47, v47, v31
    v_cvt_pk_bf16_f32 v68, v40, v41
    v_cvt_pk_bf16_f32 v69, v42, v43
    v_mfma_f32_16x16x32_bf16 a[60:63], v[108:111], v[56:59], 0
    s_add_u32 m0, s55, 23552
    s_nop 0
    buffer_load_dwordx4 v5, s[20:23], s67 offen lds
    v_cvt_pk_bf16_f32 v70, v44, v45
    v_cvt_pk_bf16_f32 v71, v46, v47
    v_lshlrev_b32 v32, 16, v72
    v_mfma_f32_16x16x32_bf16 a[84:87], v[108:111], v[60:63], 0
    v_and_b32 v33, s56, v72
    v_lshlrev_b32 v34, 16, v73
    v_add_u32 v6, 128, v6
    v_add_u32 v5, 128, v5
    v_and_b32 v35, s56, v73
    v_mfma_f32_16x16x32_bf16 a[16:19], v[112:115], v[48:51], 0
    v_lshlrev_b32 v36, 16, v74
    v_and_b32 v37, s56, v74
    v_lshlrev_b32 v38, 16, v75
    v_and_b32 v39, s56, v75
    v_mfma_f32_16x16x32_bf16 a[40:43], v[112:115], v[52:55], 0
    buffer_load_dwordx4 v[168:171], v7, s[24:27], s70 offen offset:3072
    v_mul_f32 v32, v32, v24
    v_mul_f32 v33, v33, v25
    v_mul_f32 v34, v34, v26
    v_mfma_f32_16x16x32_bf16 a[64:67], v[112:115], v[56:59], 0
    v_mul_f32 v35, v35, v27
    v_mul_f32 v36, v36, v28
    v_mul_f32 v37, v37, v29
    buffer_load_dwordx4 v[172:175], v7, s[24:27], s71 offen offset:3072
    v_mfma_f32_16x16x32_bf16 a[88:91], v[112:115], v[60:63], 0
    v_mul_f32 v38, v38, v30
    v_mul_f32 v39, v39, v31
    v_cvt_pk_bf16_f32 v72, v32, v33
    v_cvt_pk_bf16_f32 v73, v34, v35
    v_mfma_f32_16x16x32_bf16 a[20:23], v[116:119], v[48:51], 0
    v_cvt_pk_bf16_f32 v74, v36, v37
    buffer_load_dwordx4 v[176:179], v7, s[24:27], s72 offen offset:3072
    v_cvt_pk_bf16_f32 v75, v38, v39
    v_lshlrev_b32 v40, 16, v76
    v_mfma_f32_16x16x32_bf16 a[44:47], v[116:119], v[52:55], 0
    v_and_b32 v41, s56, v76
    v_lshlrev_b32 v42, 16, v77
    v_and_b32 v43, s56, v77
    buffer_load_dwordx4 v[180:183], v7, s[24:27], s73 offen offset:3072
    v_mfma_f32_16x16x32_bf16 a[68:71], v[116:119], v[56:59], 0
    v_lshlrev_b32 v44, 16, v78
    v_and_b32 v45, s56, v78
    v_lshlrev_b32 v46, 16, v79
    v_and_b32 v47, s56, v79
    v_mfma_f32_16x16x32_bf16 a[92:95], v[116:119], v[60:63], 0
    v_mul_f32 v40, v40, v24
    v_mul_f32 v41, v41, v25
    buffer_load_dwordx4 v[184:187], v7, s[24:27], s74 offen offset:3072
    v_mul_f32 v42, v42, v26
    v_mfma_f32_16x16x32_bf16 a[120:123], a[112:115], v[48:51], 0
    v_mul_f32 v43, v43, v27
    v_mul_f32 v44, v44, v28
    v_mul_f32 v45, v45, v29
    v_mul_f32 v46, v46, v30
    v_mfma_f32_16x16x32_bf16 a[124:127], a[112:115], v[52:55], 0
    buffer_load_dwordx4 v[188:191], v7, s[24:27], s75 offen offset:3072
    v_mul_f32 v47, v47, v31
    v_cvt_pk_bf16_f32 v76, v40, v41
    v_cvt_pk_bf16_f32 v77, v42, v43
    v_mfma_f32_16x16x32_bf16 a[128:131], a[112:115], v[56:59], 0
    v_cvt_pk_bf16_f32 v78, v44, v45
    v_cvt_pk_bf16_f32 v79, v46, v47
    v_mfma_f32_16x16x32_bf16 a[132:135], a[112:115], v[60:63], 0
    s_nop 1
    s_waitcnt vmcnt(20) lgkmcnt(0)
    v_mfma_f32_16x16x32_bf16 a[0:3], v[120:123], v[64:67], a[0:3]
    ds_read_b128 a[112:115], v11 offset:8320
    ds_read_b64 v[48:49], v14 offset:8192
    ds_read_b64 v[50:51], v15 offset:8192
    ds_read_b64 v[52:53], v14 offset:10240
    v_mfma_f32_16x16x32_bf16 a[24:27], v[120:123], v[68:71], a[24:27]
    ds_read_b64 v[54:55], v15 offset:10240
    ds_read_b64 v[56:57], v14 offset:12288
    ds_read_b64 v[58:59], v15 offset:12288
    ds_read_b64 v[60:61], v14 offset:14336
    v_mfma_f32_16x16x32_bf16 a[48:51], v[120:123], v[72:75], a[48:51]
    ds_read_b64 v[62:63], v15 offset:14336
    ds_read_b128 v[24:27], v8 offset:384
    ds_read_b128 v[28:31], v8 offset:448
    v_add_u32 v7, 0x1000, v7
    v_mfma_f32_16x16x32_bf16 a[72:75], v[120:123], v[76:79], a[72:75]
    v_lshlrev_b32 v32, 16, v80
    v_and_b32 v33, s56, v80
    v_lshlrev_b32 v34, 16, v81
    v_and_b32 v35, s56, v81
    v_mfma_f32_16x16x32_bf16 a[4:7], v[124:127], v[64:67], a[4:7]
    v_lshlrev_b32 v36, 16, v82
    buffer_load_dwordx4 v[96:99], v7, s[24:27], s70 offen offset:0
    v_and_b32 v37, s56, v82
    v_lshlrev_b32 v38, 16, v83
    v_mfma_f32_16x16x32_bf16 a[28:31], v[124:127], v[68:71], a[28:31]
    v_and_b32 v39, s56, v83
    v_mul_f32 v32, v32, v16
    v_mul_f32 v33, v33, v17
    buffer_load_dwordx4 v[100:103], v7, s[24:27], s71 offen offset:0
    v_mfma_f32_16x16x32_bf16 a[52:55], v[124:127], v[72:75], a[52:55]
    v_mul_f32 v34, v34, v18
    v_mul_f32 v35, v35, v19
    v_mul_f32 v36, v36, v20
    v_mul_f32 v37, v37, v21
    v_mfma_f32_16x16x32_bf16 a[76:79], v[124:127], v[76:79], a[76:79]
    v_mul_f32 v38, v38, v22
    buffer_load_dwordx4 v[104:107], v7, s[24:27], s72 offen offset:0
    v_mul_f32 v39, v39, v23
    v_cvt_pk_bf16_f32 v80, v32, v33
    v_mfma_f32_16x16x32_bf16 a[8:11], v[128:131], v[64:67], a[8:11]
    v_cvt_pk_bf16_f32 v81, v34, v35
    v_cvt_pk_bf16_f32 v82, v36, v37
    v_cvt_pk_bf16_f32 v83, v38, v39
    buffer_load_dwordx4 v[108:111], v7, s[24:27], s73 offen offset:0
    v_mfma_f32_16x16x32_bf16 a[32:35], v[128:131], v[68:71], a[32:35]
    v_lshlrev_b32 v40, 16, v84
    v_and_b32 v41, s56, v84
    v_lshlrev_b32 v42, 16, v85
    v_and_b32 v43, s56, v85
    v_mfma_f32_16x16x32_bf16 a[56:59], v[128:131], v[72:75], a[56:59]
    v_lshlrev_b32 v44, 16, v86
    buffer_load_dwordx4 v[112:115], v7, s[24:27], s74 offen offset:0
    v_and_b32 v45, s56, v86
    v_lshlrev_b32 v46, 16, v87
    v_mfma_f32_16x16x32_bf16 a[80:83], v[128:131], v[76:79], a[80:83]
    v_and_b32 v47, s56, v87
    v_mul_f32 v40, v40, v16
    v_mul_f32 v41, v41, v17
    buffer_load_dwordx4 v[116:119], v7, s[24:27], s75 offen offset:0
    v_mfma_f32_16x16x32_bf16 a[12:15], v[132:135], v[64:67], a[12:15]
    v_mul_f32 v42, v42, v18
    v_mul_f32 v43, v43, v19
    v_mul_f32 v44, v44, v20
    v_mul_f32 v45, v45, v21
    v_mfma_f32_16x16x32_bf16 a[36:39], v[132:135], v[68:71], a[36:39]
    v_mul_f32 v46, v46, v22
    s_add_u32 m0, s55, 0
    s_nop 0
    buffer_load_dwordx4 v6, s[20:23], s60 offen lds
    v_mul_f32 v47, v47, v23
    v_cvt_pk_bf16_f32 v84, v40, v41
    v_mfma_f32_16x16x32_bf16 a[60:63], v[132:135], v[72:75], a[60:63]
    v_cvt_pk_bf16_f32 v85, v42, v43
    v_cvt_pk_bf16_f32 v86, v44, v45
    v_cvt_pk_bf16_f32 v87, v46, v47
    s_add_u32 m0, s55, 1024
    s_nop 0
    buffer_load_dwordx4 v5, s[20:23], s61 offen lds
    v_mfma_f32_16x16x32_bf16 a[84:87], v[132:135], v[76:79], a[84:87]
    v_lshlrev_b32 v32, 16, v88
    v_and_b32 v33, s56, v88
    v_lshlrev_b32 v34, 16, v89
    v_and_b32 v35, s56, v89
    v_mfma_f32_16x16x32_bf16 a[16:19], v[136:139], v[64:67], a[16:19]
    v_lshlrev_b32 v36, 16, v90
    s_add_u32 m0, s55, 2048
    s_nop 0
    buffer_load_dwordx4 v6, s[20:23], s62 offen lds
    v_and_b32 v37, s56, v90
    v_lshlrev_b32 v38, 16, v91
    v_mfma_f32_16x16x32_bf16 a[40:43], v[136:139], v[68:71], a[40:43]
    v_and_b32 v39, s56, v91
    v_mul_f32 v32, v32, v16
    v_mul_f32 v33, v33, v17
    s_add_u32 m0, s55, 3072
    s_nop 0
    buffer_load_dwordx4 v5, s[20:23], s63 offen lds
    v_mfma_f32_16x16x32_bf16 a[64:67], v[136:139], v[72:75], a[64:67]
    v_mul_f32 v34, v34, v18
    v_mul_f32 v35, v35, v19
    v_mul_f32 v36, v36, v20
    v_mul_f32 v37, v37, v21
    v_mfma_f32_16x16x32_bf16 a[88:91], v[136:139], v[76:79], a[88:91]
    v_mul_f32 v38, v38, v22
    s_add_u32 m0, s55, 4096
    s_nop 0
    buffer_load_dwordx4 v6, s[20:23], s64 offen lds
    v_mul_f32 v39, v39, v23
    v_cvt_pk_bf16_f32 v88, v32, v33
    v_mfma_f32_16x16x32_bf16 a[20:23], v[140:143], v[64:67], a[20:23]
    v_cvt_pk_bf16_f32 v89, v34, v35
    v_cvt_pk_bf16_f32 v90, v36, v37
    v_cvt_pk_bf16_f32 v91, v38, v39
    s_add_u32 m0, s55, 5120
    s_nop 0
    buffer_load_dwordx4 v5, s[20:23], s65 offen lds
    v_mfma_f32_16x16x32_bf16 a[44:47], v[140:143], v[68:71], a[44:47]
    v_lshlrev_b32 v40, 16, v92
    v_and_b32 v41, s56, v92
    v_lshlrev_b32 v42, 16, v93
    v_and_b32 v43, s56, v93
    v_mfma_f32_16x16x32_bf16 a[68:71], v[140:143], v[72:75], a[68:71]
    v_lshlrev_b32 v44, 16, v94
    s_add_u32 m0, s55, 6144
    s_nop 0
    buffer_load_dwordx4 v6, s[20:23], s66 offen lds
    v_and_b32 v45, s56, v94
    v_lshlrev_b32 v46, 16, v95
    v_mfma_f32_16x16x32_bf16 a[92:95], v[140:143], v[76:79], a[92:95]
    v_and_b32 v47, s56, v95
    v_mul_f32 v40, v40, v16
    v_mul_f32 v41, v41, v17
    s_add_u32 m0, s55, 7168
    s_nop 0
    buffer_load_dwordx4 v5, s[20:23], s67 offen lds
    v_mfma_f32_16x16x32_bf16 a[120:123], a[116:119], v[64:67], a[120:123]
    v_mul_f32 v42, v42, v18
    v_mul_f32 v43, v43, v19
    v_mul_f32 v44, v44, v20
    v_mul_f32 v45, v45, v21
    v_mfma_f32_16x16x32_bf16 a[124:127], a[116:119], v[68:71], a[124:127]
    v_mul_f32 v46, v46, v22
    v_add_u32 v6, 128, v6
    v_add_u32 v5, 128, v5
    v_mul_f32 v47, v47, v23
    v_cvt_pk_bf16_f32 v92, v40, v41
    v_mfma_f32_16x16x32_bf16 a[128:131], a[116:119], v[72:75], a[128:131]
    v_cvt_pk_bf16_f32 v93, v42, v43
    v_cvt_pk_bf16_f32 v94, v44, v45
    v_cvt_pk_bf16_f32 v95, v46, v47
    v_mfma_f32_16x16x32_bf16 a[132:135], a[116:119], v[76:79], a[132:135]
    s_nop 1
    s_waitcnt vmcnt(20) lgkmcnt(0)
    v_mfma_f32_16x16x32_bf16 a[0:3], v[144:147], v[80:83], a[0:3]
    ds_read_b128 a[116:119], v11 offset:8384
    ds_read_b64 v[64:65], v12 offset:16384
    ds_read_b64 v[66:67], v13 offset:16384
    ds_read_b64 v[68:69], v12 offset:18432
    v_mfma_f32_16x16x32_bf16 a[24:27], v[144:147], v[84:87], a[24:27]
    ds_read_b64 v[70:71], v13 offset:18432
    ds_read_b64 v[72:73], v12 offset:20480
    ds_read_b64 v[74:75], v13 offset:20480
    ds_read_b64 v[76:77], v12 offset:22528
    v_mfma_f32_16x16x32_bf16 a[48:51], v[144:147], v[88:91], a[48:51]
    ds_read_b64 v[78:79], v13 offset:22528
    ds_read_b128 v[16:19], v8 offset:512
    ds_read_b128 v[20:23], v8 offset:576
    buffer_load_dwordx4 v[120:123], v7, s[24:27], s70 offen offset:1024
    v_mfma_f32_16x16x32_bf16 a[72:75], v[144:147], v[92:95], a[72:75]
    v_lshlrev_b32 v32, 16, v48
    v_and_b32 v33, s56, v48
    v_lshlrev_b32 v34, 16, v49
    v_and_b32 v35, s56, v49
    v_mfma_f32_16x16x32_bf16 a[4:7], v[148:151], v[80:83], a[4:7]
    v_lshlrev_b32 v36, 16, v50
    v_and_b32 v37, s56, v50
    v_lshlrev_b32 v38, 16, v51
    v_and_b32 v39, s56, v51
    v_mfma_f32_16x16x32_bf16 a[28:31], v[148:151], v[84:87], a[28:31]
    v_mul_f32 v32, v32, v24
    v_mul_f32 v33, v33, v25
    v_mul_f32 v34, v34, v26
    v_mul_f32 v35, v35, v27
    v_mfma_f32_16x16x32_bf16 a[52:55], v[148:151], v[88:91], a[52:55]
    v_mul_f32 v36, v36, v28
    v_mul_f32 v37, v37, v29
    buffer_load_dwordx4 v[124:127], v7, s[24:27], s71 offen offset:1024
    v_mul_f32 v38, v38, v30
    v_mfma_f32_16x16x32_bf16 a[76:79], v[148:151], v[92:95], a[76:79]
    v_mul_f32 v39, v39, v31
    v_cvt_pk_bf16_f32 v48, v32, v33
    v_cvt_pk_bf16_f32 v49, v34, v35
    v_cvt_pk_bf16_f32 v50, v36, v37
    v_mfma_f32_16x16x32_bf16 a[8:11], v[152:155], v[80:83], a[8:11]
    v_cvt_pk_bf16_f32 v51, v38, v39
    v_lshlrev_b32 v40, 16, v52
    v_and_b32 v41, s56, v52
    v_lshlrev_b32 v42, 16, v53
    v_mfma_f32_16x16x32_bf16 a[32:35], v[152:155], v[84:87], a[32:35]
    v_and_b32 v43, s56, v53
    v_lshlrev_b32 v44, 16, v54
    v_and_b32 v45, s56, v54
    v_lshlrev_b32 v46, 16, v55
    v_mfma_f32_16x16x32_bf16 a[56:59], v[152:155], v[88:91], a[56:59]
    buffer_load_dwordx4 v[128:131], v7, s[24:27], s72 offen offset:1024
    v_and_b32 v47, s56, v55
    v_mul_f32 v40, v40, v24
    v_mul_f32 v41, v41, v25
    v_mfma_f32_16x16x32_bf16 a[80:83], v[152:155], v[92:95], a[80:83]
    v_mul_f32 v42, v42, v26
    v_mul_f32 v43, v43, v27
    v_mul_f32 v44, v44, v28
    v_mul_f32 v45, v45, v29
    v_mfma_f32_16x16x32_bf16 a[12:15], v[156:159], v[80:83], a[12:15]
    v_mul_f32 v46, v46, v30
    v_mul_f32 v47, v47, v31
    v_cvt_pk_bf16_f32 v52, v40, v41
    v_cvt_pk_bf16_f32 v53, v42, v43
    v_mfma_f32_16x16x32_bf16 a[36:39], v[156:159], v[84:87], a[36:39]
    v_cvt_pk_bf16_f32 v54, v44, v45
    v_cvt_pk_bf16_f32 v55, v46, v47
    buffer_load_dwordx4 v[132:135], v7, s[24:27], s73 offen offset:1024
    v_lshlrev_b32 v32, 16, v56
    v_mfma_f32_16x16x32_bf16 a[60:63], v[156:159], v[88:91], a[60:63]
    v_and_b32 v33, s56, v56
    v_lshlrev_b32 v34, 16, v57
    v_and_b32 v35, s56, v57
    v_lshlrev_b32 v36, 16, v58
    v_mfma_f32_16x16x32_bf16 a[84:87], v[156:159], v[92:95], a[84:87]
    v_and_b32 v37, s56, v58
    v_lshlrev_b32 v38, 16, v59
    v_and_b32 v39, s56, v59
    v_mul_f32 v32, v32, v24
    v_mfma_f32_16x16x32_bf16 a[16:19], v[160:163], v[80:83], a[16:19]
    v_mul_f32 v33, v33, v25
    v_mul_f32 v34, v34, v26
    v_mul_f32 v35, v35, v27
    v_mul_f32 v36, v36, v28
    v_mfma_f32_16x16x32_bf16 a[40:43], v[160:163], v[84:87], a[40:43]
    v_mul_f32 v37, v37, v29
    buffer_load_dwordx4 v[136:139], v7, s[24:27], s74 offen offset:1024
    v_mul_f32 v38, v38, v30
    v_mul_f32 v39, v39, v31
    v_mfma_f32_16x16x32_bf16 a[64:67], v[160:163], v[88:91], a[64:67]
    v_cvt_pk_bf16_f32 v56, v32, v33
    v_cvt_pk_bf16_f32 v57, v34, v35
    v_cvt_pk_bf16_f32 v58, v36, v37
    v_cvt_pk_bf16_f32 v59, v38, v39
    v_mfma_f32_16x16x32_bf16 a[88:91], v[160:163], v[92:95], a[88:91]
    v_lshlrev_b32 v40, 16, v60
    v_and_b32 v41, s56, v60
    v_lshlrev_b32 v42, 16, v61
    v_and_b32 v43, s56, v61
    v_mfma_f32_16x16x32_bf16 a[20:23], v[164:167], v[80:83], a[20:23]
    v_lshlrev_b32 v44, 16, v62
    v_and_b32 v45, s56, v62
    v_lshlrev_b32 v46, 16, v63
    buffer_load_dwordx4 v[140:143], v7, s[24:27], s75 offen offset:1024
    v_mfma_f32_16x16x32_bf16 a[44:47], v[164:167], v[84:87], a[44:47]
    v_and_b32 v47, s56, v63
    v_mul_f32 v40, v40, v24
    v_mul_f32 v41, v41, v25
    v_mul_f32 v42, v42, v26
    v_mfma_f32_16x16x32_bf16 a[68:71], v[164:167], v[88:91], a[68:71]
    v_mul_f32 v43, v43, v27
    v_mul_f32 v44, v44, v28
    v_mul_f32 v45, v45, v29
    v_mul_f32 v46, v46, v30
    v_mfma_f32_16x16x32_bf16 a[92:95], v[164:167], v[92:95], a[92:95]
    v_mul_f32 v47, v47, v31
    v_cvt_pk_bf16_f32 v60, v40, v41
    v_cvt_pk_bf16_f32 v61, v42, v43
    v_cvt_pk_bf16_f32 v62, v44, v45
    v_mfma_f32_16x16x32_bf16 a[120:123], a[112:115], v[80:83], a[120:123]
    v_cvt_pk_bf16_f32 v63, v46, v47
    v_mfma_f32_16x16x32_bf16 a[124:127], a[112:115], v[84:87], a[124:127]
    v_mfma_f32_16x16x32_bf16 a[128:131], a[112:115], v[88:91], a[128:131]
    v_mfma_f32_16x16x32_bf16 a[132:135], a[112:115], v[92:95], a[132:135]
    s_nop 1
    s_waitcnt vmcnt(20) lgkmcnt(0)
    v_mfma_f32_16x16x32_bf16 a[0:3], v[168:171], v[48:51], a[0:3]
    ds_read_b128 a[112:115], v11 offset:8448
    ds_read_b64 v[80:81], v14 offset:16384
    ds_read_b64 v[82:83], v15 offset:16384
    ds_read_b64 v[84:85], v14 offset:18432
    v_mfma_f32_16x16x32_bf16 a[24:27], v[168:171], v[52:55], a[24:27]
    ds_read_b64 v[86:87], v15 offset:18432
    ds_read_b64 v[88:89], v14 offset:20480
    ds_read_b64 v[90:91], v15 offset:20480
    ds_read_b64 v[92:93], v14 offset:22528
    v_mfma_f32_16x16x32_bf16 a[48:51], v[168:171], v[56:59], a[48:51]
    ds_read_b64 v[94:95], v15 offset:22528
    ds_read_b128 v[24:27], v8 offset:640
    ds_read_b128 v[28:31], v8 offset:704
    buffer_load_dwordx4 v[144:147], v7, s[24:27], s70 offen offset:2048
    v_mfma_f32_16x16x32_bf16 a[72:75], v[168:171], v[60:63], a[72:75]
    v_lshlrev_b32 v32, 16, v64
    v_and_b32 v33, s56, v64
    v_lshlrev_b32 v34, 16, v65
    v_and_b32 v35, s56, v65
    v_mfma_f32_16x16x32_bf16 a[4:7], v[172:175], v[48:51], a[4:7]
    v_lshlrev_b32 v36, 16, v66
    v_and_b32 v37, s56, v66
    buffer_load_dwordx4 v[148:151], v7, s[24:27], s71 offen offset:2048
    v_lshlrev_b32 v38, 16, v67
    v_mfma_f32_16x16x32_bf16 a[28:31], v[172:175], v[52:55], a[28:31]
    v_and_b32 v39, s56, v67
    v_mul_f32 v32, v32, v16
    v_mul_f32 v33, v33, v17
    v_mul_f32 v34, v34, v18
    v_mfma_f32_16x16x32_bf16 a[52:55], v[172:175], v[56:59], a[52:55]
    buffer_load_dwordx4 v[152:155], v7, s[24:27], s72 offen offset:2048
    v_mul_f32 v35, v35, v19
    v_mul_f32 v36, v36, v20
    v_mul_f32 v37, v37, v21
    v_mfma_f32_16x16x32_bf16 a[76:79], v[172:175], v[60:63], a[76:79]
    v_mul_f32 v38, v38, v22
    v_mul_f32 v39, v39, v23
    buffer_load_dwordx4 v[156:159], v7, s[24:27], s73 offen offset:2048
    v_cvt_pk_bf16_f32 v64, v32, v33
    v_mfma_f32_16x16x32_bf16 a[8:11], v[176:179], v[48:51], a[8:11]
    v_cvt_pk_bf16_f32 v65, v34, v35
    v_cvt_pk_bf16_f32 v66, v36, v37
    v_cvt_pk_bf16_f32 v67, v38, v39
    v_lshlrev_b32 v40, 16, v68
    v_mfma_f32_16x16x32_bf16 a[32:35], v[176:179], v[52:55], a[32:35]
    v_and_b32 v41, s56, v68
    buffer_load_dwordx4 v[160:163], v7, s[24:27], s74 offen offset:2048
    v_lshlrev_b32 v42, 16, v69
    v_and_b32 v43, s56, v69
    v_mfma_f32_16x16x32_bf16 a[56:59], v[176:179], v[56:59], a[56:59]
    v_lshlrev_b32 v44, 16, v70
    v_and_b32 v45, s56, v70
    v_lshlrev_b32 v46, 16, v71
    buffer_load_dwordx4 v[164:167], v7, s[24:27], s75 offen offset:2048
    v_mfma_f32_16x16x32_bf16 a[80:83], v[176:179], v[60:63], a[80:83]
    v_and_b32 v47, s56, v71
    v_mul_f32 v40, v40, v16
    v_mul_f32 v41, v41, v17
    v_mul_f32 v42, v42, v18
    v_mfma_f32_16x16x32_bf16 a[12:15], v[180:183], v[48:51], a[12:15]
    v_mul_f32 v43, v43, v19
    s_add_u32 m0, s55, 8192
    s_nop 0
    buffer_load_dwordx4 v6, s[20:23], s60 offen lds
    v_mul_f32 v44, v44, v20
    v_mul_f32 v45, v45, v21
    v_mfma_f32_16x16x32_bf16 a[36:39], v[180:183], v[52:55], a[36:39]
    v_mul_f32 v46, v46, v22
    v_mul_f32 v47, v47, v23
    v_cvt_pk_bf16_f32 v68, v40, v41
    v_cvt_pk_bf16_f32 v69, v42, v43
    v_mfma_f32_16x16x32_bf16 a[60:63], v[180:183], v[56:59], a[60:63]
    s_add_u32 m0, s55, 9216
    s_nop 0
    buffer_load_dwordx4 v5, s[20:23], s61 offen lds
    v_cvt_pk_bf16_f32 v70, v44, v45
    v_cvt_pk_bf16_f32 v71, v46, v47
    v_lshlrev_b32 v32, 16, v72
    v_mfma_f32_16x16x32_bf16 a[84:87], v[180:183], v[60:63], a[84:87]
    v_and_b32 v33, s56, v72
    v_lshlrev_b32 v34, 16, v73
    s_add_u32 m0, s55, 10240
    s_nop 0
    buffer_load_dwordx4 v6, s[20:23], s62 offen lds
    v_and_b32 v35, s56, v73
    v_mfma_f32_16x16x32_bf16 a[16:19], v[184:187], v[48:51], a[16:19]
    v_lshlrev_b32 v36, 16, v74
    v_and_b32 v37, s56, v74
    v_lshlrev_b32 v38, 16, v75
    v_and_b32 v39, s56, v75
    v_mfma_f32_16x16x32_bf16 a[40:43], v[184:187], v[52:55], a[40:43]
    s_add_u32 m0, s55, 11264
    s_nop 0
    buffer_load_dwordx4 v5, s[20:23], s63 offen lds
    v_mul_f32 v32, v32, v16
    v_mul_f32 v33, v33, v17
    v_mul_f32 v34, v34, v18
    v_mfma_f32_16x16x32_bf16 a[64:67], v[184:187], v[56:59], a[64:67]
    v_mul_f32 v35, v35, v19
    v_mul_f32 v36, v36, v20
    v_mul_f32 v37, v37, v21
    s_add_u32 m0, s55, 12288
    s_nop 0
    buffer_load_dwordx4 v6, s[20:23], s64 offen lds
    v_mfma_f32_16x16x32_bf16 a[88:91], v[184:187], v[60:63], a[88:91]
    v_mul_f32 v38, v38, v22
    v_mul_f32 v39, v39, v23
    v_cvt_pk_bf16_f32 v72, v32, v33
    v_cvt_pk_bf16_f32 v73, v34, v35
    v_mfma_f32_16x16x32_bf16 a[20:23], v[188:191], v[48:51], a[20:23]
    v_cvt_pk_bf16_f32 v74, v36, v37
    s_add_u32 m0, s55, 13312
    s_nop 0
    buffer_load_dwordx4 v5, s[20:23], s65 offen lds
    v_cvt_pk_bf16_f32 v75, v38, v39
    v_lshlrev_b32 v40, 16, v76
    v_mfma_f32_16x16x32_bf16 a[44:47], v[188:191], v[52:55], a[44:47]
    v_and_b32 v41, s56, v76
    v_lshlrev_b32 v42, 16, v77
    v_and_b32 v43, s56, v77
    s_add_u32 m0, s55, 14336
    s_nop 0
    buffer_load_dwordx4 v6, s[20:23], s66 offen lds
    v_mfma_f32_16x16x32_bf16 a[68:71], v[188:191], v[56:59], a[68:71]
    v_lshlrev_b32 v44, 16, v78
    v_and_b32 v45, s56, v78
    v_lshlrev_b32 v46, 16, v79
    v_and_b32 v47, s56, v79
    v_mfma_f32_16x16x32_bf16 a[92:95], v[188:191], v[60:63], a[92:95]
    v_mul_f32 v40, v40, v16
    v_mul_f32 v41, v41, v17
    s_add_u32 m0, s55, 15360
    s_nop 0
    buffer_load_dwordx4 v5, s[20:23], s67 offen lds
    v_mul_f32 v42, v42, v18
    v_mfma_f32_16x16x32_bf16 a[120:123], a[116:119], v[48:51], a[120:123]
    v_mul_f32 v43, v43, v19
    v_mul_f32 v44, v44, v20
    v_mul_f32 v45, v45, v21
    v_mul_f32 v46, v46, v22
    v_mfma_f32_16x16x32_bf16 a[124:127], a[116:119], v[52:55], a[124:127]
    v_add_u32 v6, 128, v6
    v_add_u32 v5, 128, v5
    v_mul_f32 v47, v47, v23
    v_cvt_pk_bf16_f32 v76, v40, v41
    v_cvt_pk_bf16_f32 v77, v42, v43
    v_mfma_f32_16x16x32_bf16 a[128:131], a[116:119], v[56:59], a[128:131]
    v_cvt_pk_bf16_f32 v78, v44, v45
    v_cvt_pk_bf16_f32 v79, v46, v47
    v_mfma_f32_16x16x32_bf16 a[132:135], a[116:119], v[60:63], a[132:135]
    s_nop 1
    s_waitcnt vmcnt(20) lgkmcnt(0)
    v_mfma_f32_16x16x32_bf16 a[0:3], v[96:99], v[64:67], a[0:3]
    ds_read_b128 a[116:119], v11 offset:8512
    ds_read_b64 v[48:49], v12 offset:0
    ds_read_b64 v[50:51], v13 offset:0
    ds_read_b64 v[52:53], v12 offset:2048
    v_mfma_f32_16x16x32_bf16 a[24:27], v[96:99], v[68:71], a[24:27]
    ds_read_b64 v[54:55], v13 offset:2048
    ds_read_b64 v[56:57], v12 offset:4096
    ds_read_b64 v[58:59], v13 offset:4096
    ds_read_b64 v[60:61], v12 offset:6144
    v_mfma_f32_16x16x32_bf16 a[48:51], v[96:99], v[72:75], a[48:51]
    ds_read_b64 v[62:63], v13 offset:6144
    ds_read_b128 v[16:19], v8 offset:768
    ds_read_b128 v[20:23], v8 offset:832
    buffer_load_dwordx4 v[168:171], v7, s[24:27], s70 offen offset:3072
    v_mfma_f32_16x16x32_bf16 a[72:75], v[96:99], v[76:79], a[72:75]
    v_lshlrev_b32 v32, 16, v80
    v_and_b32 v33, s56, v80
    v_lshlrev_b32 v34, 16, v81
    v_and_b32 v35, s56, v81
    v_mfma_f32_16x16x32_bf16 a[4:7], v[100:103], v[64:67], a[4:7]
    v_lshlrev_b32 v36, 16, v82
    v_and_b32 v37, s56, v82
    v_lshlrev_b32 v38, 16, v83
    v_and_b32 v39, s56, v83
    v_mfma_f32_16x16x32_bf16 a[28:31], v[100:103], v[68:71], a[28:31]
    v_mul_f32 v32, v32, v24
    v_mul_f32 v33, v33, v25
    v_mul_f32 v34, v34, v26
    v_mul_f32 v35, v35, v27
    v_mfma_f32_16x16x32_bf16 a[52:55], v[100:103], v[72:75], a[52:55]
    v_mul_f32 v36, v36, v28
    v_mul_f32 v37, v37, v29
    buffer_load_dwordx4 v[172:175], v7, s[24:27], s71 offen offset:3072
    v_mul_f32 v38, v38, v30
    v_mfma_f32_16x16x32_bf16 a[76:79], v[100:103], v[76:79], a[76:79]
    v_mul_f32 v39, v39, v31
    v_cvt_pk_bf16_f32 v80, v32, v33
    v_cvt_pk_bf16_f32 v81, v34, v35
    v_cvt_pk_bf16_f32 v82, v36, v37
    v_mfma_f32_16x16x32_bf16 a[8:11], v[104:107], v[64:67], a[8:11]
    v_cvt_pk_bf16_f32 v83, v38, v39
    v_lshlrev_b32 v40, 16, v84
    v_and_b32 v41, s56, v84
    v_lshlrev_b32 v42, 16, v85
    v_mfma_f32_16x16x32_bf16 a[32:35], v[104:107], v[68:71], a[32:35]
    v_and_b32 v43, s56, v85
    v_lshlrev_b32 v44, 16, v86
    v_and_b32 v45, s56, v86
    v_lshlrev_b32 v46, 16, v87
    v_mfma_f32_16x16x32_bf16 a[56:59], v[104:107], v[72:75], a[56:59]
    buffer_load_dwordx4 v[176:179], v7, s[24:27], s72 offen offset:3072
    v_and_b32 v47, s56, v87
    v_mul_f32 v40, v40, v24
    v_mul_f32 v41, v41, v25
    v_mfma_f32_16x16x32_bf16 a[80:83], v[104:107], v[76:79], a[80:83]
    v_mul_f32 v42, v42, v26
    v_mul_f32 v43, v43, v27
    v_mul_f32 v44, v44, v28
    v_mul_f32 v45, v45, v29
    v_mfma_f32_16x16x32_bf16 a[12:15], v[108:111], v[64:67], a[12:15]
    v_mul_f32 v46, v46, v30
    v_mul_f32 v47, v47, v31
    v_cvt_pk_bf16_f32 v84, v40, v41
    v_cvt_pk_bf16_f32 v85, v42, v43
    v_mfma_f32_16x16x32_bf16 a[36:39], v[108:111], v[68:71], a[36:39]
    v_cvt_pk_bf16_f32 v86, v44, v45
    v_cvt_pk_bf16_f32 v87, v46, v47
    buffer_load_dwordx4 v[180:183], v7, s[24:27], s73 offen offset:3072
    v_lshlrev_b32 v32, 16, v88
    v_mfma_f32_16x16x32_bf16 a[60:63], v[108:111], v[72:75], a[60:63]
    v_and_b32 v33, s56, v88
    v_lshlrev_b32 v34, 16, v89
    v_and_b32 v35, s56, v89
    v_lshlrev_b32 v36, 16, v90
    v_mfma_f32_16x16x32_bf16 a[84:87], v[108:111], v[76:79], a[84:87]
    v_and_b32 v37, s56, v90
    v_lshlrev_b32 v38, 16, v91
    v_and_b32 v39, s56, v91
    v_mul_f32 v32, v32, v24
    v_mfma_f32_16x16x32_bf16 a[16:19], v[112:115], v[64:67], a[16:19]
    v_mul_f32 v33, v33, v25
    v_mul_f32 v34, v34, v26
    v_mul_f32 v35, v35, v27
    v_mul_f32 v36, v36, v28
    v_mfma_f32_16x16x32_bf16 a[40:43], v[112:115], v[68:71], a[40:43]
    v_mul_f32 v37, v37, v29
    buffer_load_dwordx4 v[184:187], v7, s[24:27], s74 offen offset:3072
    v_mul_f32 v38, v38, v30
    v_mul_f32 v39, v39, v31
    v_mfma_f32_16x16x32_bf16 a[64:67], v[112:115], v[72:75], a[64:67]
    v_cvt_pk_bf16_f32 v88, v32, v33
    v_cvt_pk_bf16_f32 v89, v34, v35
    v_cvt_pk_bf16_f32 v90, v36, v37
    v_cvt_pk_bf16_f32 v91, v38, v39
    v_mfma_f32_16x16x32_bf16 a[88:91], v[112:115], v[76:79], a[88:91]
    v_lshlrev_b32 v40, 16, v92
    v_and_b32 v41, s56, v92
    v_lshlrev_b32 v42, 16, v93
    v_and_b32 v43, s56, v93
    v_mfma_f32_16x16x32_bf16 a[20:23], v[116:119], v[64:67], a[20:23]
    v_lshlrev_b32 v44, 16, v94
    v_and_b32 v45, s56, v94
    v_lshlrev_b32 v46, 16, v95
    buffer_load_dwordx4 v[188:191], v7, s[24:27], s75 offen offset:3072
    v_mfma_f32_16x16x32_bf16 a[44:47], v[116:119], v[68:71], a[44:47]
    v_and_b32 v47, s56, v95
    v_mul_f32 v40, v40, v24
    v_mul_f32 v41, v41, v25
    v_mul_f32 v42, v42, v26
    v_mfma_f32_16x16x32_bf16 a[68:71], v[116:119], v[72:75], a[68:71]
    v_mul_f32 v43, v43, v27
    v_mul_f32 v44, v44, v28
    v_mul_f32 v45, v45, v29
    v_mul_f32 v46, v46, v30
    v_mfma_f32_16x16x32_bf16 a[92:95], v[116:119], v[76:79], a[92:95]
    v_mul_f32 v47, v47, v31
    v_cvt_pk_bf16_f32 v92, v40, v41
    v_cvt_pk_bf16_f32 v93, v42, v43
    v_cvt_pk_bf16_f32 v94, v44, v45
    v_mfma_f32_16x16x32_bf16 a[120:123], a[112:115], v[64:67], a[120:123]
    v_cvt_pk_bf16_f32 v95, v46, v47
    v_mfma_f32_16x16x32_bf16 a[124:127], a[112:115], v[68:71], a[124:127]
    v_mfma_f32_16x16x32_bf16 a[128:131], a[112:115], v[72:75], a[128:131]
    v_mfma_f32_16x16x32_bf16 a[132:135], a[112:115], v[76:79], a[132:135]
    s_nop 1
    s_waitcnt vmcnt(20) lgkmcnt(0)
    v_mfma_f32_16x16x32_bf16 a[0:3], v[120:123], v[80:83], a[0:3]
    ds_read_b128 a[112:115], v11 offset:8576
    ds_read_b64 v[64:65], v14 offset:0
    ds_read_b64 v[66:67], v15 offset:0
    ds_read_b64 v[68:69], v14 offset:2048
    v_mfma_f32_16x16x32_bf16 a[24:27], v[120:123], v[84:87], a[24:27]
    ds_read_b64 v[70:71], v15 offset:2048
    ds_read_b64 v[72:73], v14 offset:4096
    ds_read_b64 v[74:75], v15 offset:4096
    ds_read_b64 v[76:77], v14 offset:6144
    v_mfma_f32_16x16x32_bf16 a[48:51], v[120:123], v[88:91], a[48:51]
    ds_read_b64 v[78:79], v15 offset:6144
    ds_read_b128 v[24:27], v8 offset:896
    ds_read_b128 v[28:31], v8 offset:960
    v_add_u32 v7, 0x1000, v7
    v_mfma_f32_16x16x32_bf16 a[72:75], v[120:123], v[92:95], a[72:75]
    v_lshlrev_b32 v32, 16, v48
    v_and_b32 v33, s56, v48
    v_lshlrev_b32 v34, 16, v49
    v_and_b32 v35, s56, v49
    v_mfma_f32_16x16x32_bf16 a[4:7], v[124:127], v[80:83], a[4:7]
    v_lshlrev_b32 v36, 16, v50
    buffer_load_dwordx4 v[96:99], v7, s[24:27], s70 offen offset:0
    v_and_b32 v37, s56, v50
    v_lshlrev_b32 v38, 16, v51
    v_mfma_f32_16x16x32_bf16 a[28:31], v[124:127], v[84:87], a[28:31]
    v_and_b32 v39, s56, v51
    v_mul_f32 v32, v32, v16
    v_mul_f32 v33, v33, v17
    buffer_load_dwordx4 v[100:103], v7, s[24:27], s71 offen offset:0
    v_mfma_f32_16x16x32_bf16 a[52:55], v[124:127], v[88:91], a[52:55]
    v_mul_f32 v34, v34, v18
    v_mul_f32 v35, v35, v19
    v_mul_f32 v36, v36, v20
    v_mul_f32 v37, v37, v21
    v_mfma_f32_16x16x32_bf16 a[76:79], v[124:127], v[92:95], a[76:79]
    v_mul_f32 v38, v38, v22
    buffer_load_dwordx4 v[104:107], v7, s[24:27], s72 offen offset:0
    v_mul_f32 v39, v39, v23
    v_cvt_pk_bf16_f32 v48, v32, v33
    v_mfma_f32_16x16x32_bf16 a[8:11], v[128:131], v[80:83], a[8:11]
    v_cvt_pk_bf16_f32 v49, v34, v35
    v_cvt_pk_bf16_f32 v50, v36, v37
    v_cvt_pk_bf16_f32 v51, v38, v39
    buffer_load_dwordx4 v[108:111], v7, s[24:27], s73 offen offset:0
    v_mfma_f32_16x16x32_bf16 a[32:35], v[128:131], v[84:87], a[32:35]
    v_lshlrev_b32 v40, 16, v52
    v_and_b32 v41, s56, v52
    v_lshlrev_b32 v42, 16, v53
    v_and_b32 v43, s56, v53
    v_mfma_f32_16x16x32_bf16 a[56:59], v[128:131], v[88:91], a[56:59]
    v_lshlrev_b32 v44, 16, v54
    buffer_load_dwordx4 v[112:115], v7, s[24:27], s74 offen offset:0
    v_and_b32 v45, s56, v54
    v_lshlrev_b32 v46, 16, v55
    v_mfma_f32_16x16x32_bf16 a[80:83], v[128:131], v[92:95], a[80:83]
    v_and_b32 v47, s56, v55
    v_mul_f32 v40, v40, v16
    v_mul_f32 v41, v41, v17
    buffer_load_dwordx4 v[116:119], v7, s[24:27], s75 offen offset:0
    v_mfma_f32_16x16x32_bf16 a[12:15], v[132:135], v[80:83], a[12:15]
    v_mul_f32 v42, v42, v18
    v_mul_f32 v43, v43, v19
    v_mul_f32 v44, v44, v20
    v_mul_f32 v45, v45, v21
    v_mfma_f32_16x16x32_bf16 a[36:39], v[132:135], v[84:87], a[36:39]
    v_mul_f32 v46, v46, v22
    s_add_u32 m0, s55, 16384
    s_nop 0
    buffer_load_dwordx4 v6, s[20:23], s60 offen lds
    v_mul_f32 v47, v47, v23
    v_cvt_pk_bf16_f32 v52, v40, v41
    v_mfma_f32_16x16x32_bf16 a[60:63], v[132:135], v[88:91], a[60:63]
    v_cvt_pk_bf16_f32 v53, v42, v43
    v_cvt_pk_bf16_f32 v54, v44, v45
    v_cvt_pk_bf16_f32 v55, v46, v47
    s_add_u32 m0, s55, 17408
    s_nop 0
    buffer_load_dwordx4 v5, s[20:23], s61 offen lds
    v_mfma_f32_16x16x32_bf16 a[84:87], v[132:135], v[92:95], a[84:87]
    v_lshlrev_b32 v32, 16, v56
    v_and_b32 v33, s56, v56
    v_lshlrev_b32 v34, 16, v57
    v_and_b32 v35, s56, v57
    v_mfma_f32_16x16x32_bf16 a[16:19], v[136:139], v[80:83], a[16:19]
    v_lshlrev_b32 v36, 16, v58
    s_add_u32 m0, s55, 18432
    s_nop 0
    buffer_load_dwordx4 v6, s[20:23], s62 offen lds
    v_and_b32 v37, s56, v58
    v_lshlrev_b32 v38, 16, v59
    v_mfma_f32_16x16x32_bf16 a[40:43], v[136:139], v[84:87], a[40:43]
    v_and_b32 v39, s56, v59
    v_mul_f32 v32, v32, v16
    v_mul_f32 v33, v33, v17
    s_add_u32 m0, s55, 19456
    s_nop 0
    buffer_load_dwordx4 v5, s[20:23], s63 offen lds
    v_mfma_f32_16x16x32_bf16 a[64:67], v[136:139], v[88:91], a[64:67]
    v_mul_f32 v34, v34, v18
    v_mul_f32 v35, v35, v19
    v_mul_f32 v36, v36, v20
    v_mul_f32 v37, v37, v21
    v_mfma_f32_16x16x32_bf16 a[88:91], v[136:139], v[92:95], a[88:91]
    v_mul_f32 v38, v38, v22
    s_add_u32 m0, s55, 20480
    s_nop 0
    buffer_load_dwordx4 v6, s[20:23], s64 offen lds
    v_mul_f32 v39, v39, v23
    v_cvt_pk_bf16_f32 v56, v32, v33
    v_mfma_f32_16x16x32_bf16 a[20:23], v[140:143], v[80:83], a[20:23]
    v_cvt_pk_bf16_f32 v57, v34, v35
    v_cvt_pk_bf16_f32 v58, v36, v37
    v_cvt_pk_bf16_f32 v59, v38, v39
    s_add_u32 m0, s55, 21504
    s_nop 0
    buffer_load_dwordx4 v5, s[20:23], s65 offen lds
    v_mfma_f32_16x16x32_bf16 a[44:47], v[140:143], v[84:87], a[44:47]
    v_lshlrev_b32 v40, 16, v60
    v_and_b32 v41, s56, v60
    v_lshlrev_b32 v42, 16, v61
    v_and_b32 v43, s56, v61
    v_mfma_f32_16x16x32_bf16 a[68:71], v[140:143], v[88:91], a[68:71]
    v_lshlrev_b32 v44, 16, v62
    s_add_u32 m0, s55, 22528
    s_nop 0
    buffer_load_dwordx4 v6, s[20:23], s66 offen lds
    v_and_b32 v45, s56, v62
    v_lshlrev_b32 v46, 16, v63
    v_mfma_f32_16x16x32_bf16 a[92:95], v[140:143], v[92:95], a[92:95]
    v_and_b32 v47, s56, v63
    v_mul_f32 v40, v40, v16
    v_mul_f32 v41, v41, v17
    s_add_u32 m0, s55, 23552
    s_nop 0
    buffer_load_dwordx4 v5, s[20:23], s67 offen lds
    v_mfma_f32_16x16x32_bf16 a[120:123], a[116:119], v[80:83], a[120:123]
    v_mul_f32 v42, v42, v18
    v_mul_f32 v43, v43, v19
    v_mul_f32 v44, v44, v20
    v_mul_f32 v45, v45, v21
    v_mfma_f32_16x16x32_bf16 a[124:127], a[116:119], v[84:87], a[124:127]
    v_mul_f32 v46, v46, v22
    v_add_u32 v6, 128, v6
    v_add_u32 v5, 128, v5
    v_mul_f32 v47, v47, v23
    v_cvt_pk_bf16_f32 v60, v40, v41
    v_mfma_f32_16x16x32_bf16 a[128:131], a[116:119], v[88:91], a[128:131]
    v_cvt_pk_bf16_f32 v61, v42, v43
    v_cvt_pk_bf16_f32 v62, v44, v45
    v_cvt_pk_bf16_f32 v63, v46, v47
    v_mfma_f32_16x16x32_bf16 a[132:135], a[116:119], v[92:95], a[132:135]
    s_nop 1
    s_waitcnt vmcnt(20) lgkmcnt(0)
    v_mfma_f32_16x16x32_bf16 a[0:3], v[144:147], v[48:51], a[0:3]
    ds_read_b128 a[116:119], v11 offset:8640
    ds_read_b64 v[80:81], v12 offset:8192
    ds_read_b64 v[82:83], v13 offset:8192
    ds_read_b64 v[84:85], v12 offset:10240
    v_mfma_f32_16x16x32_bf16 a[24:27], v[144:147], v[52:55], a[24:27]
    ds_read_b64 v[86:87], v13 offset:10240
    ds_read_b64 v[88:89], v12 offset:12288
    ds_read_b64 v[90:91], v13 offset:12288
    ds_read_b64 v[92:93], v12 offset:14336
    v_mfma_f32_16x16x32_bf16 a[48:51], v[144:147], v[56:59], a[48:51]
    ds_read_b64 v[94:95], v13 offset:14336
    ds_read_b128 v[16:19], v8 offset:1024
    ds_read_b128 v[20:23], v8 offset:1088
    buffer_load_dwordx4 v[120:123], v7, s[24:27], s70 offen offset:1024
    v_mfma_f32_16x16x32_bf16 a[72:75], v[144:147], v[60:63], a[72:75]
    v_lshlrev_b32 v32, 16, v64
    v_and_b32 v33, s56, v64
    v_lshlrev_b32 v34, 16, v65
    v_and_b32 v35, s56, v65
    v_mfma_f32_16x16x32_bf16 a[4:7], v[148:151], v[48:51], a[4:7]
    v_lshlrev_b32 v36, 16, v66
    v_and_b32 v37, s56, v66
    v_lshlrev_b32 v38, 16, v67
    v_and_b32 v39, s56, v67
    v_mfma_f32_16x16x32_bf16 a[28:31], v[148:151], v[52:55], a[28:31]
    v_mul_f32 v32, v32, v24
    v_mul_f32 v33, v33, v25
    v_mul_f32 v34, v34, v26
    v_mul_f32 v35, v35, v27
    v_mfma_f32_16x16x32_bf16 a[52:55], v[148:151], v[56:59], a[52:55]
    v_mul_f32 v36, v36, v28
    v_mul_f32 v37, v37, v29
    buffer_load_dwordx4 v[124:127], v7, s[24:27], s71 offen offset:1024
    v_mul_f32 v38, v38, v30
    v_mfma_f32_16x16x32_bf16 a[76:79], v[148:151], v[60:63], a[76:79]
    v_mul_f32 v39, v39, v31
    v_cvt_pk_bf16_f32 v64, v32, v33
    v_cvt_pk_bf16_f32 v65, v34, v35
    v_cvt_pk_bf16_f32 v66, v36, v37
    v_mfma_f32_16x16x32_bf16 a[8:11], v[152:155], v[48:51], a[8:11]
    v_cvt_pk_bf16_f32 v67, v38, v39
    v_lshlrev_b32 v40, 16, v68
    v_and_b32 v41, s56, v68
    v_lshlrev_b32 v42, 16, v69
    v_mfma_f32_16x16x32_bf16 a[32:35], v[152:155], v[52:55], a[32:35]
    v_and_b32 v43, s56, v69
    v_lshlrev_b32 v44, 16, v70
    v_and_b32 v45, s56, v70
    v_lshlrev_b32 v46, 16, v71
    v_mfma_f32_16x16x32_bf16 a[56:59], v[152:155], v[56:59], a[56:59]
    buffer_load_dwordx4 v[128:131], v7, s[24:27], s72 offen offset:1024
    v_and_b32 v47, s56, v71
    v_mul_f32 v40, v40, v24
    v_mul_f32 v41, v41, v25
    v_mfma_f32_16x16x32_bf16 a[80:83], v[152:155], v[60:63], a[80:83]
    v_mul_f32 v42, v42, v26
    v_mul_f32 v43, v43, v27
    v_mul_f32 v44, v44, v28
    v_mul_f32 v45, v45, v29
    v_mfma_f32_16x16x32_bf16 a[12:15], v[156:159], v[48:51], a[12:15]
    v_mul_f32 v46, v46, v30
    v_mul_f32 v47, v47, v31
    v_cvt_pk_bf16_f32 v68, v40, v41
    v_cvt_pk_bf16_f32 v69, v42, v43
    v_mfma_f32_16x16x32_bf16 a[36:39], v[156:159], v[52:55], a[36:39]
    v_cvt_pk_bf16_f32 v70, v44, v45
    v_cvt_pk_bf16_f32 v71, v46, v47
    buffer_load_dwordx4 v[132:135], v7, s[24:27], s73 offen offset:1024
    v_lshlrev_b32 v32, 16, v72
    v_mfma_f32_16x16x32_bf16 a[60:63], v[156:159], v[56:59], a[60:63]
    v_and_b32 v33, s56, v72
    v_lshlrev_b32 v34, 16, v73
    v_and_b32 v35, s56, v73
    v_lshlrev_b32 v36, 16, v74
    v_mfma_f32_16x16x32_bf16 a[84:87], v[156:159], v[60:63], a[84:87]
    v_and_b32 v37, s56, v74
    v_lshlrev_b32 v38, 16, v75
    v_and_b32 v39, s56, v75
    v_mul_f32 v32, v32, v24
    v_mfma_f32_16x16x32_bf16 a[16:19], v[160:163], v[48:51], a[16:19]
    v_mul_f32 v33, v33, v25
    v_mul_f32 v34, v34, v26
    v_mul_f32 v35, v35, v27
    v_mul_f32 v36, v36, v28
    v_mfma_f32_16x16x32_bf16 a[40:43], v[160:163], v[52:55], a[40:43]
    v_mul_f32 v37, v37, v29
    buffer_load_dwordx4 v[136:139], v7, s[24:27], s74 offen offset:1024
    v_mul_f32 v38, v38, v30
    v_mul_f32 v39, v39, v31
    v_mfma_f32_16x16x32_bf16 a[64:67], v[160:163], v[56:59], a[64:67]
    v_cvt_pk_bf16_f32 v72, v32, v33
    v_cvt_pk_bf16_f32 v73, v34, v35
    v_cvt_pk_bf16_f32 v74, v36, v37
    v_cvt_pk_bf16_f32 v75, v38, v39
    v_mfma_f32_16x16x32_bf16 a[88:91], v[160:163], v[60:63], a[88:91]
    v_lshlrev_b32 v40, 16, v76
    v_and_b32 v41, s56, v76
    v_lshlrev_b32 v42, 16, v77
    v_and_b32 v43, s56, v77
    v_mfma_f32_16x16x32_bf16 a[20:23], v[164:167], v[48:51], a[20:23]
    v_lshlrev_b32 v44, 16, v78
    v_and_b32 v45, s56, v78
    v_lshlrev_b32 v46, 16, v79
    buffer_load_dwordx4 v[140:143], v7, s[24:27], s75 offen offset:1024
    v_mfma_f32_16x16x32_bf16 a[44:47], v[164:167], v[52:55], a[44:47]
    v_and_b32 v47, s56, v79
    v_mul_f32 v40, v40, v24
    v_mul_f32 v41, v41, v25
    v_mul_f32 v42, v42, v26
    v_mfma_f32_16x16x32_bf16 a[68:71], v[164:167], v[56:59], a[68:71]
    v_mul_f32 v43, v43, v27
    v_mul_f32 v44, v44, v28
    v_mul_f32 v45, v45, v29
    v_mul_f32 v46, v46, v30
    v_mfma_f32_16x16x32_bf16 a[92:95], v[164:167], v[60:63], a[92:95]
    v_mul_f32 v47, v47, v31
    v_cvt_pk_bf16_f32 v76, v40, v41
    v_cvt_pk_bf16_f32 v77, v42, v43
    v_cvt_pk_bf16_f32 v78, v44, v45
    v_mfma_f32_16x16x32_bf16 a[120:123], a[112:115], v[48:51], a[120:123]
    v_cvt_pk_bf16_f32 v79, v46, v47
    v_mfma_f32_16x16x32_bf16 a[124:127], a[112:115], v[52:55], a[124:127]
    v_mfma_f32_16x16x32_bf16 a[128:131], a[112:115], v[56:59], a[128:131]
    v_mfma_f32_16x16x32_bf16 a[132:135], a[112:115], v[60:63], a[132:135]
    s_nop 1
    s_waitcnt vmcnt(20) lgkmcnt(0)
    v_mfma_f32_16x16x32_bf16 a[0:3], v[168:171], v[64:67], a[0:3]
    ds_read_b128 a[112:115], v11 offset:8704
    ds_read_b64 v[48:49], v14 offset:8192
    ds_read_b64 v[50:51], v15 offset:8192
    ds_read_b64 v[52:53], v14 offset:10240
    v_mfma_f32_16x16x32_bf16 a[24:27], v[168:171], v[68:71], a[24:27]
    ds_read_b64 v[54:55], v15 offset:10240
    ds_read_b64 v[56:57], v14 offset:12288
    ds_read_b64 v[58:59], v15 offset:12288
    ds_read_b64 v[60:61], v14 offset:14336
    v_mfma_f32_16x16x32_bf16 a[48:51], v[168:171], v[72:75], a[48:51]
    ds_read_b64 v[62:63], v15 offset:14336
    ds_read_b128 v[24:27], v8 offset:1152
    ds_read_b128 v[28:31], v8 offset:1216
    buffer_load_dwordx4 v[144:147], v7, s[24:27], s70 offen offset:2048
    v_mfma_f32_16x16x32_bf16 a[72:75], v[168:171], v[76:79], a[72:75]
    v_lshlrev_b32 v32, 16, v80
    v_and_b32 v33, s56, v80
    v_lshlrev_b32 v34, 16, v81
    v_and_b32 v35, s56, v81
    v_mfma_f32_16x16x32_bf16 a[4:7], v[172:175], v[64:67], a[4:7]
    v_lshlrev_b32 v36, 16, v82
    v_and_b32 v37, s56, v82
    buffer_load_dwordx4 v[148:151], v7, s[24:27], s71 offen offset:2048
    v_lshlrev_b32 v38, 16, v83
    v_mfma_f32_16x16x32_bf16 a[28:31], v[172:175], v[68:71], a[28:31]
    v_and_b32 v39, s56, v83
    v_mul_f32 v32, v32, v16
    v_mul_f32 v33, v33, v17
    v_mul_f32 v34, v34, v18
    v_mfma_f32_16x16x32_bf16 a[52:55], v[172:175], v[72:75], a[52:55]
    buffer_load_dwordx4 v[152:155], v7, s[24:27], s72 offen offset:2048
    v_mul_f32 v35, v35, v19
    v_mul_f32 v36, v36, v20
    v_mul_f32 v37, v37, v21
    v_mfma_f32_16x16x32_bf16 a[76:79], v[172:175], v[76:79], a[76:79]
    v_mul_f32 v38, v38, v22
    v_mul_f32 v39, v39, v23
    buffer_load_dwordx4 v[156:159], v7, s[24:27], s73 offen offset:2048
    v_cvt_pk_bf16_f32 v80, v32, v33
    v_mfma_f32_16x16x32_bf16 a[8:11], v[176:179], v[64:67], a[8:11]
    v_cvt_pk_bf16_f32 v81, v34, v35
    v_cvt_pk_bf16_f32 v82, v36, v37
    v_cvt_pk_bf16_f32 v83, v38, v39
    v_lshlrev_b32 v40, 16, v84
    v_mfma_f32_16x16x32_bf16 a[32:35], v[176:179], v[68:71], a[32:35]
    v_and_b32 v41, s56, v84
    buffer_load_dwordx4 v[160:163], v7, s[24:27], s74 offen offset:2048
    v_lshlrev_b32 v42, 16, v85
    v_and_b32 v43, s56, v85
    v_mfma_f32_16x16x32_bf16 a[56:59], v[176:179], v[72:75], a[56:59]
    v_lshlrev_b32 v44, 16, v86
    v_and_b32 v45, s56, v86
    v_lshlrev_b32 v46, 16, v87
    buffer_load_dwordx4 v[164:167], v7, s[24:27], s75 offen offset:2048
    v_mfma_f32_16x16x32_bf16 a[80:83], v[176:179], v[76:79], a[80:83]
    v_and_b32 v47, s56, v87
    v_mul_f32 v40, v40, v16
    v_mul_f32 v41, v41, v17
    v_mul_f32 v42, v42, v18
    v_mfma_f32_16x16x32_bf16 a[12:15], v[180:183], v[64:67], a[12:15]
    v_mul_f32 v43, v43, v19
    s_add_u32 m0, s55, 0
    s_nop 0
    buffer_load_dwordx4 v6, s[20:23], s60 offen lds
    v_mul_f32 v44, v44, v20
    v_mul_f32 v45, v45, v21
    v_mfma_f32_16x16x32_bf16 a[36:39], v[180:183], v[68:71], a[36:39]
    v_mul_f32 v46, v46, v22
    v_mul_f32 v47, v47, v23
    v_cvt_pk_bf16_f32 v84, v40, v41
    v_cvt_pk_bf16_f32 v85, v42, v43
    v_mfma_f32_16x16x32_bf16 a[60:63], v[180:183], v[72:75], a[60:63]
    s_add_u32 m0, s55, 1024
    s_nop 0
    buffer_load_dwordx4 v5, s[20:23], s61 offen lds
    v_cvt_pk_bf16_f32 v86, v44, v45
    v_cvt_pk_bf16_f32 v87, v46, v47
    v_lshlrev_b32 v32, 16, v88
    v_mfma_f32_16x16x32_bf16 a[84:87], v[180:183], v[76:79], a[84:87]
    v_and_b32 v33, s56, v88
    v_lshlrev_b32 v34, 16, v89
    s_add_u32 m0, s55, 2048
    s_nop 0
    buffer_load_dwordx4 v6, s[20:23], s62 offen lds
    v_and_b32 v35, s56, v89
    v_mfma_f32_16x16x32_bf16 a[16:19], v[184:187], v[64:67], a[16:19]
    v_lshlrev_b32 v36, 16, v90
    v_and_b32 v37, s56, v90
    v_lshlrev_b32 v38, 16, v91
    v_and_b32 v39, s56, v91
    v_mfma_f32_16x16x32_bf16 a[40:43], v[184:187], v[68:71], a[40:43]
    s_add_u32 m0, s55, 3072
    s_nop 0
    buffer_load_dwordx4 v5, s[20:23], s63 offen lds
    v_mul_f32 v32, v32, v16
    v_mul_f32 v33, v33, v17
    v_mul_f32 v34, v34, v18
    v_mfma_f32_16x16x32_bf16 a[64:67], v[184:187], v[72:75], a[64:67]
    v_mul_f32 v35, v35, v19
    v_mul_f32 v36, v36, v20
    v_mul_f32 v37, v37, v21
    s_add_u32 m0, s55, 4096
    s_nop 0
    buffer_load_dwordx4 v6, s[20:23], s64 offen lds
    v_mfma_f32_16x16x32_bf16 a[88:91], v[184:187], v[76:79], a[88:91]
    v_mul_f32 v38, v38, v22
    v_mul_f32 v39, v39, v23
    v_cvt_pk_bf16_f32 v88, v32, v33
    v_cvt_pk_bf16_f32 v89, v34, v35
    v_mfma_f32_16x16x32_bf16 a[20:23], v[188:191], v[64:67], a[20:23]
    v_cvt_pk_bf16_f32 v90, v36, v37
    s_add_u32 m0, s55, 5120
    s_nop 0
    buffer_load_dwordx4 v5, s[20:23], s65 offen lds
    v_cvt_pk_bf16_f32 v91, v38, v39
    v_lshlrev_b32 v40, 16, v92
    v_mfma_f32_16x16x32_bf16 a[44:47], v[188:191], v[68:71], a[44:47]
    v_and_b32 v41, s56, v92
    v_lshlrev_b32 v42, 16, v93
    v_and_b32 v43, s56, v93
    s_add_u32 m0, s55, 6144
    s_nop 0
    buffer_load_dwordx4 v6, s[20:23], s66 offen lds
    v_mfma_f32_16x16x32_bf16 a[68:71], v[188:191], v[72:75], a[68:71]
    v_lshlrev_b32 v44, 16, v94
    v_and_b32 v45, s56, v94
    v_lshlrev_b32 v46, 16, v95
    v_and_b32 v47, s56, v95
    v_mfma_f32_16x16x32_bf16 a[92:95], v[188:191], v[76:79], a[92:95]
    v_mul_f32 v40, v40, v16
    v_mul_f32 v41, v41, v17
    s_add_u32 m0, s55, 7168
    s_nop 0
    buffer_load_dwordx4 v5, s[20:23], s67 offen lds
    v_mul_f32 v42, v42, v18
    v_mfma_f32_16x16x32_bf16 a[120:123], a[116:119], v[64:67], a[120:123]
    v_mul_f32 v43, v43, v19
    v_mul_f32 v44, v44, v20
    v_mul_f32 v45, v45, v21
    v_mul_f32 v46, v46, v22
    v_mfma_f32_16x16x32_bf16 a[124:127], a[116:119], v[68:71], a[124:127]
    v_add_u32 v6, 128, v6
    v_add_u32 v5, 128, v5
    v_mul_f32 v47, v47, v23
    v_cvt_pk_bf16_f32 v92, v40, v41
    v_cvt_pk_bf16_f32 v93, v42, v43
    v_mfma_f32_16x16x32_bf16 a[128:131], a[116:119], v[72:75], a[128:131]
    v_cvt_pk_bf16_f32 v94, v44, v45
    v_cvt_pk_bf16_f32 v95, v46, v47
    v_mfma_f32_16x16x32_bf16 a[132:135], a[116:119], v[76:79], a[132:135]
    s_nop 1
    s_waitcnt vmcnt(20) lgkmcnt(0)
    v_mfma_f32_16x16x32_bf16 a[0:3], v[96:99], v[80:83], a[0:3]
    ds_read_b128 a[116:119], v11 offset:8768
    ds_read_b64 v[64:65], v12 offset:16384
    ds_read_b64 v[66:67], v13 offset:16384
    ds_read_b64 v[68:69], v12 offset:18432
    v_mfma_f32_16x16x32_bf16 a[24:27], v[96:99], v[84:87], a[24:27]
    ds_read_b64 v[70:71], v13 offset:18432
    ds_read_b64 v[72:73], v12 offset:20480
    ds_read_b64 v[74:75], v13 offset:20480
    ds_read_b64 v[76:77], v12 offset:22528
    v_mfma_f32_16x16x32_bf16 a[48:51], v[96:99], v[88:91], a[48:51]
    ds_read_b64 v[78:79], v13 offset:22528
    ds_read_b128 v[16:19], v8 offset:1280
    ds_read_b128 v[20:23], v8 offset:1344
    buffer_load_dwordx4 v[168:171], v7, s[24:27], s70 offen offset:3072
    v_mfma_f32_16x16x32_bf16 a[72:75], v[96:99], v[92:95], a[72:75]
    v_lshlrev_b32 v32, 16, v48
    v_and_b32 v33, s56, v48
    v_lshlrev_b32 v34, 16, v49
    v_and_b32 v35, s56, v49
    v_mfma_f32_16x16x32_bf16 a[4:7], v[100:103], v[80:83], a[4:7]
    v_lshlrev_b32 v36, 16, v50
    v_and_b32 v37, s56, v50
    v_lshlrev_b32 v38, 16, v51
    v_and_b32 v39, s56, v51
    v_mfma_f32_16x16x32_bf16 a[28:31], v[100:103], v[84:87], a[28:31]
    v_mul_f32 v32, v32, v24
    v_mul_f32 v33, v33, v25
    v_mul_f32 v34, v34, v26
    v_mul_f32 v35, v35, v27
    v_mfma_f32_16x16x32_bf16 a[52:55], v[100:103], v[88:91], a[52:55]
    v_mul_f32 v36, v36, v28
    v_mul_f32 v37, v37, v29
    buffer_load_dwordx4 v[172:175], v7, s[24:27], s71 offen offset:3072
    v_mul_f32 v38, v38, v30
    v_mfma_f32_16x16x32_bf16 a[76:79], v[100:103], v[92:95], a[76:79]
    v_mul_f32 v39, v39, v31
    v_cvt_pk_bf16_f32 v48, v32, v33
    v_cvt_pk_bf16_f32 v49, v34, v35
    v_cvt_pk_bf16_f32 v50, v36, v37
    v_mfma_f32_16x16x32_bf16 a[8:11], v[104:107], v[80:83], a[8:11]
    v_cvt_pk_bf16_f32 v51, v38, v39
    v_lshlrev_b32 v40, 16, v52
    v_and_b32 v41, s56, v52
    v_lshlrev_b32 v42, 16, v53
    v_mfma_f32_16x16x32_bf16 a[32:35], v[104:107], v[84:87], a[32:35]
    v_and_b32 v43, s56, v53
    v_lshlrev_b32 v44, 16, v54
    v_and_b32 v45, s56, v54
    v_lshlrev_b32 v46, 16, v55
    v_mfma_f32_16x16x32_bf16 a[56:59], v[104:107], v[88:91], a[56:59]
    buffer_load_dwordx4 v[176:179], v7, s[24:27], s72 offen offset:3072
    v_and_b32 v47, s56, v55
    v_mul_f32 v40, v40, v24
    v_mul_f32 v41, v41, v25
    v_mfma_f32_16x16x32_bf16 a[80:83], v[104:107], v[92:95], a[80:83]
    v_mul_f32 v42, v42, v26
    v_mul_f32 v43, v43, v27
    v_mul_f32 v44, v44, v28
    v_mul_f32 v45, v45, v29
    v_mfma_f32_16x16x32_bf16 a[12:15], v[108:111], v[80:83], a[12:15]
    v_mul_f32 v46, v46, v30
    v_mul_f32 v47, v47, v31
    v_cvt_pk_bf16_f32 v52, v40, v41
    v_cvt_pk_bf16_f32 v53, v42, v43
    v_mfma_f32_16x16x32_bf16 a[36:39], v[108:111], v[84:87], a[36:39]
    v_cvt_pk_bf16_f32 v54, v44, v45
    v_cvt_pk_bf16_f32 v55, v46, v47
    buffer_load_dwordx4 v[180:183], v7, s[24:27], s73 offen offset:3072
    v_lshlrev_b32 v32, 16, v56
    v_mfma_f32_16x16x32_bf16 a[60:63], v[108:111], v[88:91], a[60:63]
    v_and_b32 v33, s56, v56
    v_lshlrev_b32 v34, 16, v57
    v_and_b32 v35, s56, v57
    v_lshlrev_b32 v36, 16, v58
    v_mfma_f32_16x16x32_bf16 a[84:87], v[108:111], v[92:95], a[84:87]
    v_and_b32 v37, s56, v58
    v_lshlrev_b32 v38, 16, v59
    v_and_b32 v39, s56, v59
    v_mul_f32 v32, v32, v24
    v_mfma_f32_16x16x32_bf16 a[16:19], v[112:115], v[80:83], a[16:19]
    v_mul_f32 v33, v33, v25
    v_mul_f32 v34, v34, v26
    v_mul_f32 v35, v35, v27
    v_mul_f32 v36, v36, v28
    v_mfma_f32_16x16x32_bf16 a[40:43], v[112:115], v[84:87], a[40:43]
    v_mul_f32 v37, v37, v29
    buffer_load_dwordx4 v[184:187], v7, s[24:27], s74 offen offset:3072
    v_mul_f32 v38, v38, v30
    v_mul_f32 v39, v39, v31
    v_mfma_f32_16x16x32_bf16 a[64:67], v[112:115], v[88:91], a[64:67]
    v_cvt_pk_bf16_f32 v56, v32, v33
    v_cvt_pk_bf16_f32 v57, v34, v35
    v_cvt_pk_bf16_f32 v58, v36, v37
    v_cvt_pk_bf16_f32 v59, v38, v39
    v_mfma_f32_16x16x32_bf16 a[88:91], v[112:115], v[92:95], a[88:91]
    v_lshlrev_b32 v40, 16, v60
    v_and_b32 v41, s56, v60
    v_lshlrev_b32 v42, 16, v61
    v_and_b32 v43, s56, v61
    v_mfma_f32_16x16x32_bf16 a[20:23], v[116:119], v[80:83], a[20:23]
    v_lshlrev_b32 v44, 16, v62
    v_and_b32 v45, s56, v62
    v_lshlrev_b32 v46, 16, v63
    buffer_load_dwordx4 v[188:191], v7, s[24:27], s75 offen offset:3072
    v_mfma_f32_16x16x32_bf16 a[44:47], v[116:119], v[84:87], a[44:47]
    v_and_b32 v47, s56, v63
    v_mul_f32 v40, v40, v24
    v_mul_f32 v41, v41, v25
    v_mul_f32 v42, v42, v26
    v_mfma_f32_16x16x32_bf16 a[68:71], v[116:119], v[88:91], a[68:71]
    v_mul_f32 v43, v43, v27
    v_mul_f32 v44, v44, v28
    v_mul_f32 v45, v45, v29
    v_mul_f32 v46, v46, v30
    v_mfma_f32_16x16x32_bf16 a[92:95], v[116:119], v[92:95], a[92:95]
    v_mul_f32 v47, v47, v31
    v_cvt_pk_bf16_f32 v60, v40, v41
    v_cvt_pk_bf16_f32 v61, v42, v43
    v_cvt_pk_bf16_f32 v62, v44, v45
    v_mfma_f32_16x16x32_bf16 a[120:123], a[112:115], v[80:83], a[120:123]
    v_cvt_pk_bf16_f32 v63, v46, v47
    v_mfma_f32_16x16x32_bf16 a[124:127], a[112:115], v[84:87], a[124:127]
    v_mfma_f32_16x16x32_bf16 a[128:131], a[112:115], v[88:91], a[128:131]
    v_mfma_f32_16x16x32_bf16 a[132:135], a[112:115], v[92:95], a[132:135]
    s_nop 1
    s_waitcnt vmcnt(20) lgkmcnt(0)
    v_mfma_f32_16x16x32_bf16 a[0:3], v[120:123], v[48:51], a[0:3]
    ds_read_b128 a[112:115], v11 offset:8832
    ds_read_b64 v[80:81], v14 offset:16384
    ds_read_b64 v[82:83], v15 offset:16384
    ds_read_b64 v[84:85], v14 offset:18432
    v_mfma_f32_16x16x32_bf16 a[24:27], v[120:123], v[52:55], a[24:27]
    ds_read_b64 v[86:87], v15 offset:18432
    ds_read_b64 v[88:89], v14 offset:20480
    ds_read_b64 v[90:91], v15 offset:20480
    ds_read_b64 v[92:93], v14 offset:22528
    v_mfma_f32_16x16x32_bf16 a[48:51], v[120:123], v[56:59], a[48:51]
    ds_read_b64 v[94:95], v15 offset:22528
    ds_read_b128 v[24:27], v8 offset:1408
    ds_read_b128 v[28:31], v8 offset:1472
    v_add_u32 v7, 0x1000, v7
    v_mfma_f32_16x16x32_bf16 a[72:75], v[120:123], v[60:63], a[72:75]
    v_lshlrev_b32 v32, 16, v64
    v_and_b32 v33, s56, v64
    v_lshlrev_b32 v34, 16, v65
    v_and_b32 v35, s56, v65
    v_mfma_f32_16x16x32_bf16 a[4:7], v[124:127], v[48:51], a[4:7]
    v_lshlrev_b32 v36, 16, v66
    buffer_load_dwordx4 v[96:99], v7, s[24:27], s70 offen offset:0
    v_and_b32 v37, s56, v66
    v_lshlrev_b32 v38, 16, v67
    v_mfma_f32_16x16x32_bf16 a[28:31], v[124:127], v[52:55], a[28:31]
    v_and_b32 v39, s56, v67
    v_mul_f32 v32, v32, v16
    v_mul_f32 v33, v33, v17
    buffer_load_dwordx4 v[100:103], v7, s[24:27], s71 offen offset:0
    v_mfma_f32_16x16x32_bf16 a[52:55], v[124:127], v[56:59], a[52:55]
    v_mul_f32 v34, v34, v18
    v_mul_f32 v35, v35, v19
    v_mul_f32 v36, v36, v20
    v_mul_f32 v37, v37, v21
    v_mfma_f32_16x16x32_bf16 a[76:79], v[124:127], v[60:63], a[76:79]
    v_mul_f32 v38, v38, v22
    buffer_load_dwordx4 v[104:107], v7, s[24:27], s72 offen offset:0
    v_mul_f32 v39, v39, v23
    v_cvt_pk_bf16_f32 v64, v32, v33
    v_mfma_f32_16x16x32_bf16 a[8:11], v[128:131], v[48:51], a[8:11]
    v_cvt_pk_bf16_f32 v65, v34, v35
    v_cvt_pk_bf16_f32 v66, v36, v37
    v_cvt_pk_bf16_f32 v67, v38, v39
    buffer_load_dwordx4 v[108:111], v7, s[24:27], s73 offen offset:0
    v_mfma_f32_16x16x32_bf16 a[32:35], v[128:131], v[52:55], a[32:35]
    v_lshlrev_b32 v40, 16, v68
    v_and_b32 v41, s56, v68
    v_lshlrev_b32 v42, 16, v69
    v_and_b32 v43, s56, v69
    v_mfma_f32_16x16x32_bf16 a[56:59], v[128:131], v[56:59], a[56:59]
    v_lshlrev_b32 v44, 16, v70
    buffer_load_dwordx4 v[112:115], v7, s[24:27], s74 offen offset:0
    v_and_b32 v45, s56, v70
    v_lshlrev_b32 v46, 16, v71
    v_mfma_f32_16x16x32_bf16 a[80:83], v[128:131], v[60:63], a[80:83]
    v_and_b32 v47, s56, v71
    v_mul_f32 v40, v40, v16
    v_mul_f32 v41, v41, v17
    buffer_load_dwordx4 v[116:119], v7, s[24:27], s75 offen offset:0
    v_mfma_f32_16x16x32_bf16 a[12:15], v[132:135], v[48:51], a[12:15]
    v_mul_f32 v42, v42, v18
    v_mul_f32 v43, v43, v19
    v_mul_f32 v44, v44, v20
    v_mul_f32 v45, v45, v21
    v_mfma_f32_16x16x32_bf16 a[36:39], v[132:135], v[52:55], a[36:39]
    v_mul_f32 v46, v46, v22
    s_add_u32 m0, s55, 8192
    s_nop 0
    buffer_load_dwordx4 v6, s[20:23], s60 offen lds
    v_mul_f32 v47, v47, v23
    v_cvt_pk_bf16_f32 v68, v40, v41
    v_mfma_f32_16x16x32_bf16 a[60:63], v[132:135], v[56:59], a[60:63]
    v_cvt_pk_bf16_f32 v69, v42, v43
    v_cvt_pk_bf16_f32 v70, v44, v45
    v_cvt_pk_bf16_f32 v71, v46, v47
    s_add_u32 m0, s55, 9216
    s_nop 0
    buffer_load_dwordx4 v5, s[20:23], s61 offen lds
    v_mfma_f32_16x16x32_bf16 a[84:87], v[132:135], v[60:63], a[84:87]
    v_lshlrev_b32 v32, 16, v72
    v_and_b32 v33, s56, v72
    v_lshlrev_b32 v34, 16, v73
    v_and_b32 v35, s56, v73
    v_mfma_f32_16x16x32_bf16 a[16:19], v[136:139], v[48:51], a[16:19]
    v_lshlrev_b32 v36, 16, v74
    s_add_u32 m0, s55, 10240
    s_nop 0
    buffer_load_dwordx4 v6, s[20:23], s62 offen lds
    v_and_b32 v37, s56, v74
    v_lshlrev_b32 v38, 16, v75
    v_mfma_f32_16x16x32_bf16 a[40:43], v[136:139], v[52:55], a[40:43]
    v_and_b32 v39, s56, v75
    v_mul_f32 v32, v32, v16
    v_mul_f32 v33, v33, v17
    s_add_u32 m0, s55, 11264
    s_nop 0
    buffer_load_dwordx4 v5, s[20:23], s63 offen lds
    v_mfma_f32_16x16x32_bf16 a[64:67], v[136:139], v[56:59], a[64:67]
    v_mul_f32 v34, v34, v18
    v_mul_f32 v35, v35, v19
    v_mul_f32 v36, v36, v20
    v_mul_f32 v37, v37, v21
    v_mfma_f32_16x16x32_bf16 a[88:91], v[136:139], v[60:63], a[88:91]
    v_mul_f32 v38, v38, v22
    s_add_u32 m0, s55, 12288
    s_nop 0
    buffer_load_dwordx4 v6, s[20:23], s64 offen lds
    v_mul_f32 v39, v39, v23
    v_cvt_pk_bf16_f32 v72, v32, v33
    v_mfma_f32_16x16x32_bf16 a[20:23], v[140:143], v[48:51], a[20:23]
    v_cvt_pk_bf16_f32 v73, v34, v35
    v_cvt_pk_bf16_f32 v74, v36, v37
    v_cvt_pk_bf16_f32 v75, v38, v39
    s_add_u32 m0, s55, 13312
    s_nop 0
    buffer_load_dwordx4 v5, s[20:23], s65 offen lds
    v_mfma_f32_16x16x32_bf16 a[44:47], v[140:143], v[52:55], a[44:47]
    v_lshlrev_b32 v40, 16, v76
    v_and_b32 v41, s56, v76
    v_lshlrev_b32 v42, 16, v77
    v_and_b32 v43, s56, v77
    v_mfma_f32_16x16x32_bf16 a[68:71], v[140:143], v[56:59], a[68:71]
    v_lshlrev_b32 v44, 16, v78
    s_add_u32 m0, s55, 14336
    s_nop 0
    buffer_load_dwordx4 v6, s[20:23], s66 offen lds
    v_and_b32 v45, s56, v78
    v_lshlrev_b32 v46, 16, v79
    v_mfma_f32_16x16x32_bf16 a[92:95], v[140:143], v[60:63], a[92:95]
    v_and_b32 v47, s56, v79
    v_mul_f32 v40, v40, v16
    v_mul_f32 v41, v41, v17
    s_add_u32 m0, s55, 15360
    s_nop 0
    buffer_load_dwordx4 v5, s[20:23], s67 offen lds
    v_mfma_f32_16x16x32_bf16 a[120:123], a[116:119], v[48:51], a[120:123]
    v_mul_f32 v42, v42, v18
    v_mul_f32 v43, v43, v19
    v_mul_f32 v44, v44, v20
    v_mul_f32 v45, v45, v21
    v_mfma_f32_16x16x32_bf16 a[124:127], a[116:119], v[52:55], a[124:127]
    v_mul_f32 v46, v46, v22
    v_add_u32 v6, 128, v6
    v_add_u32 v5, 128, v5
    v_mul_f32 v47, v47, v23
    v_cvt_pk_bf16_f32 v76, v40, v41
    v_mfma_f32_16x16x32_bf16 a[128:131], a[116:119], v[56:59], a[128:131]
    v_cvt_pk_bf16_f32 v77, v42, v43
    v_cvt_pk_bf16_f32 v78, v44, v45
    v_cvt_pk_bf16_f32 v79, v46, v47
    v_mfma_f32_16x16x32_bf16 a[132:135], a[116:119], v[60:63], a[132:135]
    s_nop 1
    s_waitcnt vmcnt(20) lgkmcnt(0)
    v_mfma_f32_16x16x32_bf16 a[0:3], v[144:147], v[64:67], a[0:3]
    ds_read_b128 a[116:119], v11 offset:8896
    ds_read_b64 v[48:49], v12 offset:0
    ds_read_b64 v[50:51], v13 offset:0
    ds_read_b64 v[52:53], v12 offset:2048
    v_mfma_f32_16x16x32_bf16 a[24:27], v[144:147], v[68:71], a[24:27]
    ds_read_b64 v[54:55], v13 offset:2048
    ds_read_b64 v[56:57], v12 offset:4096
    ds_read_b64 v[58:59], v13 offset:4096
    ds_read_b64 v[60:61], v12 offset:6144
    v_mfma_f32_16x16x32_bf16 a[48:51], v[144:147], v[72:75], a[48:51]
    ds_read_b64 v[62:63], v13 offset:6144
    ds_read_b128 v[16:19], v8 offset:1536
    ds_read_b128 v[20:23], v8 offset:1600
    buffer_load_dwordx4 v[120:123], v7, s[24:27], s70 offen offset:1024
    v_mfma_f32_16x16x32_bf16 a[72:75], v[144:147], v[76:79], a[72:75]
    v_lshlrev_b32 v32, 16, v80
    v_and_b32 v33, s56, v80
    v_lshlrev_b32 v34, 16, v81
    v_and_b32 v35, s56, v81
    v_mfma_f32_16x16x32_bf16 a[4:7], v[148:151], v[64:67], a[4:7]
    v_lshlrev_b32 v36, 16, v82
    v_and_b32 v37, s56, v82
    v_lshlrev_b32 v38, 16, v83
    v_and_b32 v39, s56, v83
    v_mfma_f32_16x16x32_bf16 a[28:31], v[148:151], v[68:71], a[28:31]
    v_mul_f32 v32, v32, v24
    v_mul_f32 v33, v33, v25
    v_mul_f32 v34, v34, v26
    v_mul_f32 v35, v35, v27
    v_mfma_f32_16x16x32_bf16 a[52:55], v[148:151], v[72:75], a[52:55]
    v_mul_f32 v36, v36, v28
    v_mul_f32 v37, v37, v29
    buffer_load_dwordx4 v[124:127], v7, s[24:27], s71 offen offset:1024
    v_mul_f32 v38, v38, v30
    v_mfma_f32_16x16x32_bf16 a[76:79], v[148:151], v[76:79], a[76:79]
    v_mul_f32 v39, v39, v31
    v_cvt_pk_bf16_f32 v80, v32, v33
    v_cvt_pk_bf16_f32 v81, v34, v35
    v_cvt_pk_bf16_f32 v82, v36, v37
    v_mfma_f32_16x16x32_bf16 a[8:11], v[152:155], v[64:67], a[8:11]
    v_cvt_pk_bf16_f32 v83, v38, v39
    v_lshlrev_b32 v40, 16, v84
    v_and_b32 v41, s56, v84
    v_lshlrev_b32 v42, 16, v85
    v_mfma_f32_16x16x32_bf16 a[32:35], v[152:155], v[68:71], a[32:35]
    v_and_b32 v43, s56, v85
    v_lshlrev_b32 v44, 16, v86
    v_and_b32 v45, s56, v86
    v_lshlrev_b32 v46, 16, v87
    v_mfma_f32_16x16x32_bf16 a[56:59], v[152:155], v[72:75], a[56:59]
    buffer_load_dwordx4 v[128:131], v7, s[24:27], s72 offen offset:1024
    v_and_b32 v47, s56, v87
    v_mul_f32 v40, v40, v24
    v_mul_f32 v41, v41, v25
    v_mfma_f32_16x16x32_bf16 a[80:83], v[152:155], v[76:79], a[80:83]
    v_mul_f32 v42, v42, v26
    v_mul_f32 v43, v43, v27
    v_mul_f32 v44, v44, v28
    v_mul_f32 v45, v45, v29
    v_mfma_f32_16x16x32_bf16 a[12:15], v[156:159], v[64:67], a[12:15]
    v_mul_f32 v46, v46, v30
    v_mul_f32 v47, v47, v31
    v_cvt_pk_bf16_f32 v84, v40, v41
    v_cvt_pk_bf16_f32 v85, v42, v43
    v_mfma_f32_16x16x32_bf16 a[36:39], v[156:159], v[68:71], a[36:39]
    v_cvt_pk_bf16_f32 v86, v44, v45
    v_cvt_pk_bf16_f32 v87, v46, v47
    buffer_load_dwordx4 v[132:135], v7, s[24:27], s73 offen offset:1024
    v_lshlrev_b32 v32, 16, v88
    v_mfma_f32_16x16x32_bf16 a[60:63], v[156:159], v[72:75], a[60:63]
    v_and_b32 v33, s56, v88
    v_lshlrev_b32 v34, 16, v89
    v_and_b32 v35, s56, v89
    v_lshlrev_b32 v36, 16, v90
    v_mfma_f32_16x16x32_bf16 a[84:87], v[156:159], v[76:79], a[84:87]
    v_and_b32 v37, s56, v90
    v_lshlrev_b32 v38, 16, v91
    v_and_b32 v39, s56, v91
    v_mul_f32 v32, v32, v24
    v_mfma_f32_16x16x32_bf16 a[16:19], v[160:163], v[64:67], a[16:19]
    v_mul_f32 v33, v33, v25
    v_mul_f32 v34, v34, v26
    v_mul_f32 v35, v35, v27
    v_mul_f32 v36, v36, v28
    v_mfma_f32_16x16x32_bf16 a[40:43], v[160:163], v[68:71], a[40:43]
    v_mul_f32 v37, v37, v29
    buffer_load_dwordx4 v[136:139], v7, s[24:27], s74 offen offset:1024
    v_mul_f32 v38, v38, v30
    v_mul_f32 v39, v39, v31
    v_mfma_f32_16x16x32_bf16 a[64:67], v[160:163], v[72:75], a[64:67]
    v_cvt_pk_bf16_f32 v88, v32, v33
    v_cvt_pk_bf16_f32 v89, v34, v35
    v_cvt_pk_bf16_f32 v90, v36, v37
    v_cvt_pk_bf16_f32 v91, v38, v39
    v_mfma_f32_16x16x32_bf16 a[88:91], v[160:163], v[76:79], a[88:91]
    v_lshlrev_b32 v40, 16, v92
    v_and_b32 v41, s56, v92
    v_lshlrev_b32 v42, 16, v93
    v_and_b32 v43, s56, v93
    v_mfma_f32_16x16x32_bf16 a[20:23], v[164:167], v[64:67], a[20:23]
    v_lshlrev_b32 v44, 16, v94
    v_and_b32 v45, s56, v94
    v_lshlrev_b32 v46, 16, v95
    buffer_load_dwordx4 v[140:143], v7, s[24:27], s75 offen offset:1024
    v_mfma_f32_16x16x32_bf16 a[44:47], v[164:167], v[68:71], a[44:47]
    v_and_b32 v47, s56, v95
    v_mul_f32 v40, v40, v24
    v_mul_f32 v41, v41, v25
    v_mul_f32 v42, v42, v26
    v_mfma_f32_16x16x32_bf16 a[68:71], v[164:167], v[72:75], a[68:71]
    v_mul_f32 v43, v43, v27
    v_mul_f32 v44, v44, v28
    v_mul_f32 v45, v45, v29
    v_mul_f32 v46, v46, v30
    v_mfma_f32_16x16x32_bf16 a[92:95], v[164:167], v[76:79], a[92:95]
    v_mul_f32 v47, v47, v31
    v_cvt_pk_bf16_f32 v92, v40, v41
    v_cvt_pk_bf16_f32 v93, v42, v43
    v_cvt_pk_bf16_f32 v94, v44, v45
    v_mfma_f32_16x16x32_bf16 a[120:123], a[112:115], v[64:67], a[120:123]
    v_cvt_pk_bf16_f32 v95, v46, v47
    v_mfma_f32_16x16x32_bf16 a[124:127], a[112:115], v[68:71], a[124:127]
    v_mfma_f32_16x16x32_bf16 a[128:131], a[112:115], v[72:75], a[128:131]
    v_mfma_f32_16x16x32_bf16 a[132:135], a[112:115], v[76:79], a[132:135]
    s_nop 1
    s_waitcnt vmcnt(20) lgkmcnt(0)
    v_mfma_f32_16x16x32_bf16 a[0:3], v[168:171], v[80:83], a[0:3]
    ds_read_b128 a[112:115], v11 offset:8960
    ds_read_b64 v[64:65], v14 offset:0
    ds_read_b64 v[66:67], v15 offset:0
    ds_read_b64 v[68:69], v14 offset:2048
    v_mfma_f32_16x16x32_bf16 a[24:27], v[168:171], v[84:87], a[24:27]
    ds_read_b64 v[70:71], v15 offset:2048
    ds_read_b64 v[72:73], v14 offset:4096
    ds_read_b64 v[74:75], v15 offset:4096
    ds_read_b64 v[76:77], v14 offset:6144
    v_mfma_f32_16x16x32_bf16 a[48:51], v[168:171], v[88:91], a[48:51]
    ds_read_b64 v[78:79], v15 offset:6144
    ds_read_b128 v[24:27], v8 offset:1664
    ds_read_b128 v[28:31], v8 offset:1728
    buffer_load_dwordx4 v[144:147], v7, s[24:27], s70 offen offset:2048
    v_mfma_f32_16x16x32_bf16 a[72:75], v[168:171], v[92:95], a[72:75]
    v_lshlrev_b32 v32, 16, v48
    v_and_b32 v33, s56, v48
    v_lshlrev_b32 v34, 16, v49
    v_and_b32 v35, s56, v49
    v_mfma_f32_16x16x32_bf16 a[4:7], v[172:175], v[80:83], a[4:7]
    v_lshlrev_b32 v36, 16, v50
    v_and_b32 v37, s56, v50
    v_lshlrev_b32 v38, 16, v51
    v_and_b32 v39, s56, v51
    v_mfma_f32_16x16x32_bf16 a[28:31], v[172:175], v[84:87], a[28:31]
    v_mul_f32 v32, v32, v16
    v_mul_f32 v33, v33, v17
    v_mul_f32 v34, v34, v18
    v_mul_f32 v35, v35, v19
    v_mfma_f32_16x16x32_bf16 a[52:55], v[172:175], v[88:91], a[52:55]
    v_mul_f32 v36, v36, v20
    v_mul_f32 v37, v37, v21
    buffer_load_dwordx4 v[148:151], v7, s[24:27], s71 offen offset:2048
    v_mul_f32 v38, v38, v22
    v_mfma_f32_16x16x32_bf16 a[76:79], v[172:175], v[92:95], a[76:79]
    v_mul_f32 v39, v39, v23
    v_cvt_pk_bf16_f32 v48, v32, v33
    v_cvt_pk_bf16_f32 v49, v34, v35
    v_cvt_pk_bf16_f32 v50, v36, v37
    v_mfma_f32_16x16x32_bf16 a[8:11], v[176:179], v[80:83], a[8:11]
    v_cvt_pk_bf16_f32 v51, v38, v39
    v_lshlrev_b32 v40, 16, v52
    v_and_b32 v41, s56, v52
    v_lshlrev_b32 v42, 16, v53
    v_mfma_f32_16x16x32_bf16 a[32:35], v[176:179], v[84:87], a[32:35]
    v_and_b32 v43, s56, v53
    v_lshlrev_b32 v44, 16, v54
    v_and_b32 v45, s56, v54
    v_lshlrev_b32 v46, 16, v55
    v_mfma_f32_16x16x32_bf16 a[56:59], v[176:179], v[88:91], a[56:59]
    buffer_load_dwordx4 v[152:155], v7, s[24:27], s72 offen offset:2048
    v_and_b32 v47, s56, v55
    v_mul_f32 v40, v40, v16
    v_mul_f32 v41, v41, v17
    v_mfma_f32_16x16x32_bf16 a[80:83], v[176:179], v[92:95], a[80:83]
    v_mul_f32 v42, v42, v18
    v_mul_f32 v43, v43, v19
    v_mul_f32 v44, v44, v20
    v_mul_f32 v45, v45, v21
    v_mfma_f32_16x16x32_bf16 a[12:15], v[180:183], v[80:83], a[12:15]
    v_mul_f32 v46, v46, v22
    v_mul_f32 v47, v47, v23
    v_cvt_pk_bf16_f32 v52, v40, v41
    v_cvt_pk_bf16_f32 v53, v42, v43
    v_mfma_f32_16x16x32_bf16 a[36:39], v[180:183], v[84:87], a[36:39]
    v_cvt_pk_bf16_f32 v54, v44, v45
    v_cvt_pk_bf16_f32 v55, v46, v47
    buffer_load_dwordx4 v[156:159], v7, s[24:27], s73 offen offset:2048
    v_lshlrev_b32 v32, 16, v56
    v_mfma_f32_16x16x32_bf16 a[60:63], v[180:183], v[88:91], a[60:63]
    v_and_b32 v33, s56, v56
    v_lshlrev_b32 v34, 16, v57
    v_and_b32 v35, s56, v57
    v_lshlrev_b32 v36, 16, v58
    v_mfma_f32_16x16x32_bf16 a[84:87], v[180:183], v[92:95], a[84:87]
    v_and_b32 v37, s56, v58
    v_lshlrev_b32 v38, 16, v59
    v_and_b32 v39, s56, v59
    v_mul_f32 v32, v32, v16
    v_mfma_f32_16x16x32_bf16 a[16:19], v[184:187], v[80:83], a[16:19]
    v_mul_f32 v33, v33, v17
    v_mul_f32 v34, v34, v18
    v_mul_f32 v35, v35, v19
    v_mul_f32 v36, v36, v20
    v_mfma_f32_16x16x32_bf16 a[40:43], v[184:187], v[84:87], a[40:43]
    v_mul_f32 v37, v37, v21
    buffer_load_dwordx4 v[160:163], v7, s[24:27], s74 offen offset:2048
    v_mul_f32 v38, v38, v22
    v_mul_f32 v39, v39, v23
    v_mfma_f32_16x16x32_bf16 a[64:67], v[184:187], v[88:91], a[64:67]
    v_cvt_pk_bf16_f32 v56, v32, v33
    v_cvt_pk_bf16_f32 v57, v34, v35
    v_cvt_pk_bf16_f32 v58, v36, v37
    v_cvt_pk_bf16_f32 v59, v38, v39
    v_mfma_f32_16x16x32_bf16 a[88:91], v[184:187], v[92:95], a[88:91]
    v_lshlrev_b32 v40, 16, v60
    v_and_b32 v41, s56, v60
    v_lshlrev_b32 v42, 16, v61
    v_and_b32 v43, s56, v61
    v_mfma_f32_16x16x32_bf16 a[20:23], v[188:191], v[80:83], a[20:23]
    v_lshlrev_b32 v44, 16, v62
    v_and_b32 v45, s56, v62
    v_lshlrev_b32 v46, 16, v63
    buffer_load_dwordx4 v[164:167], v7, s[24:27], s75 offen offset:2048
    v_mfma_f32_16x16x32_bf16 a[44:47], v[188:191], v[84:87], a[44:47]
    v_and_b32 v47, s56, v63
    v_mul_f32 v40, v40, v16
    v_mul_f32 v41, v41, v17
    v_mul_f32 v42, v42, v18
    v_mfma_f32_16x16x32_bf16 a[68:71], v[188:191], v[88:91], a[68:71]
    v_mul_f32 v43, v43, v19
    v_mul_f32 v44, v44, v20
    v_mul_f32 v45, v45, v21
    v_mul_f32 v46, v46, v22
    v_mfma_f32_16x16x32_bf16 a[92:95], v[188:191], v[92:95], a[92:95]
    v_mul_f32 v47, v47, v23
    v_cvt_pk_bf16_f32 v60, v40, v41
    v_cvt_pk_bf16_f32 v61, v42, v43
    v_cvt_pk_bf16_f32 v62, v44, v45
    v_mfma_f32_16x16x32_bf16 a[120:123], a[116:119], v[80:83], a[120:123]
    v_cvt_pk_bf16_f32 v63, v46, v47
    v_mfma_f32_16x16x32_bf16 a[124:127], a[116:119], v[84:87], a[124:127]
    v_mfma_f32_16x16x32_bf16 a[128:131], a[116:119], v[88:91], a[128:131]
    v_mfma_f32_16x16x32_bf16 a[132:135], a[116:119], v[92:95], a[132:135]
    s_nop 1
    s_waitcnt vmcnt(12) lgkmcnt(0)
    v_mfma_f32_16x16x32_bf16 a[0:3], v[96:99], v[48:51], a[0:3]
    ds_read_b128 a[116:119], v11 offset:9024
    ds_read_b64 v[80:81], v12 offset:8192
    ds_read_b64 v[82:83], v13 offset:8192
    ds_read_b64 v[84:85], v12 offset:10240
    v_mfma_f32_16x16x32_bf16 a[24:27], v[96:99], v[52:55], a[24:27]
    ds_read_b64 v[86:87], v13 offset:10240
    ds_read_b64 v[88:89], v12 offset:12288
    ds_read_b64 v[90:91], v13 offset:12288
    ds_read_b64 v[92:93], v12 offset:14336
    v_mfma_f32_16x16x32_bf16 a[48:51], v[96:99], v[56:59], a[48:51]
    ds_read_b64 v[94:95], v13 offset:14336
    ds_read_b128 v[16:19], v8 offset:1792
    ds_read_b128 v[20:23], v8 offset:1856
    buffer_load_dwordx4 v[168:171], v7, s[24:27], s70 offen offset:3072
    v_mfma_f32_16x16x32_bf16 a[72:75], v[96:99], v[60:63], a[72:75]
    v_lshlrev_b32 v32, 16, v64
    v_and_b32 v33, s56, v64
    v_lshlrev_b32 v34, 16, v65
    v_and_b32 v35, s56, v65
    v_mfma_f32_16x16x32_bf16 a[4:7], v[100:103], v[48:51], a[4:7]
    v_lshlrev_b32 v36, 16, v66
    buffer_load_dwordx4 v[172:175], v7, s[24:27], s71 offen offset:3072
    v_and_b32 v37, s56, v66
    v_lshlrev_b32 v38, 16, v67
    v_mfma_f32_16x16x32_bf16 a[28:31], v[100:103], v[52:55], a[28:31]
    v_and_b32 v39, s56, v67
    v_mul_f32 v32, v32, v24
    v_mul_f32 v33, v33, v25
    buffer_load_dwordx4 v[176:179], v7, s[24:27], s72 offen offset:3072
    v_mfma_f32_16x16x32_bf16 a[52:55], v[100:103], v[56:59], a[52:55]
    v_mul_f32 v34, v34, v26
    v_mul_f32 v35, v35, v27
    v_mul_f32 v36, v36, v28
    v_mul_f32 v37, v37, v29
    v_mfma_f32_16x16x32_bf16 a[76:79], v[100:103], v[60:63], a[76:79]
    v_mul_f32 v38, v38, v30
    buffer_load_dwordx4 v[180:183], v7, s[24:27], s73 offen offset:3072
    v_mul_f32 v39, v39, v31
    v_cvt_pk_bf16_f32 v64, v32, v33
    v_mfma_f32_16x16x32_bf16 a[8:11], v[104:107], v[48:51], a[8:11]
    v_cvt_pk_bf16_f32 v65, v34, v35
    v_cvt_pk_bf16_f32 v66, v36, v37
    v_cvt_pk_bf16_f32 v67, v38, v39
    buffer_load_dwordx4 v[184:187], v7, s[24:27], s74 offen offset:3072
    v_mfma_f32_16x16x32_bf16 a[32:35], v[104:107], v[52:55], a[32:35]
    v_lshlrev_b32 v40, 16, v68
    v_and_b32 v41, s56, v68
    v_lshlrev_b32 v42, 16, v69
    v_and_b32 v43, s56, v69
    v_mfma_f32_16x16x32_bf16 a[56:59], v[104:107], v[56:59], a[56:59]
    v_lshlrev_b32 v44, 16, v70
    buffer_load_dwordx4 v[188:191], v7, s[24:27], s75 offen offset:3072
    v_and_b32 v45, s56, v70
    v_lshlrev_b32 v46, 16, v71
    v_mfma_f32_16x16x32_bf16 a[80:83], v[104:107], v[60:63], a[80:83]
    v_and_b32 v47, s56, v71
    v_mul_f32 v40, v40, v24
    v_mul_f32 v41, v41, v25
    s_lshr_b32 s57, s2, 3
    s_mul_i32 s58, s57, 34816
    v_lshlrev_b32 v224, 3, v0
    v_lshrrev_b32 v225, 4, v0
    v_mul_u32_u24 v225, 2176, v225
    v_lshl_add_u32 v225, v2, 3, v225
    v_mfma_f32_16x16x32_bf16 a[12:15], v[108:111], v[48:51], a[12:15]
    v_mul_f32 v42, v42, v26
    v_mul_f32 v43, v43, v27
    v_mul_f32 v44, v44, v28
    v_mul_f32 v45, v45, v29
    v_mfma_f32_16x16x32_bf16 a[36:39], v[108:111], v[52:55], a[36:39]
    v_mul_f32 v46, v46, v30
    buffer_load_dwordx2 v[254:255], v225, s[76:79], s58 offen offset:2048
    v_mul_f32 v47, v47, v31
    v_cvt_pk_bf16_f32 v68, v40, v41
    v_mfma_f32_16x16x32_bf16 a[60:63], v[108:111], v[56:59], a[60:63]
    v_cvt_pk_bf16_f32 v69, v42, v43
    v_cvt_pk_bf16_f32 v70, v44, v45
    v_cvt_pk_bf16_f32 v71, v46, v47
    buffer_load_dwordx2 v[192:193], v224, s[76:79], s58 offen
    s_add_u32 s58, s58, 2176
    v_mfma_f32_16x16x32_bf16 a[84:87], v[108:111], v[60:63], a[84:87]
    v_lshlrev_b32 v32, 16, v72
    v_and_b32 v33, s56, v72
    v_lshlrev_b32 v34, 16, v73
    v_and_b32 v35, s56, v73
    v_mfma_f32_16x16x32_bf16 a[16:19], v[112:115], v[48:51], a[16:19]
    v_lshlrev_b32 v36, 16, v74
    buffer_load_dwordx2 v[194:195], v224, s[76:79], s58 offen
    s_add_u32 s58, s58, 2176
    v_and_b32 v37, s56, v74
    v_lshlrev_b32 v38, 16, v75
    v_mfma_f32_16x16x32_bf16 a[40:43], v[112:115], v[52:55], a[40:43]
    v_and_b32 v39, s56, v75
    v_mul_f32 v32, v32, v24
    v_mul_f32 v33, v33, v25
    buffer_load_dwordx2 v[196:197], v224, s[76:79], s58 offen
    s_add_u32 s58, s58, 2176
    v_mfma_f32_16x16x32_bf16 a[64:67], v[112:115], v[56:59], a[64:67]
    v_mul_f32 v34, v34, v26
    v_mul_f32 v35, v35, v27
    v_mul_f32 v36, v36, v28
    v_mul_f32 v37, v37, v29
    v_mfma_f32_16x16x32_bf16 a[88:91], v[112:115], v[60:63], a[88:91]
    v_mul_f32 v38, v38, v30
    buffer_load_dwordx2 v[198:199], v224, s[76:79], s58 offen
    s_add_u32 s58, s58, 2176
    v_mul_f32 v39, v39, v31
    v_cvt_pk_bf16_f32 v72, v32, v33
    v_mfma_f32_16x16x32_bf16 a[20:23], v[116:119], v[48:51], a[20:23]
    v_cvt_pk_bf16_f32 v73, v34, v35
    v_cvt_pk_bf16_f32 v74, v36, v37
    v_cvt_pk_bf16_f32 v75, v38, v39
    buffer_load_dwordx2 v[200:201], v224, s[76:79], s58 offen
    s_add_u32 s58, s58, 2176
    v_mfma_f32_16x16x32_bf16 a[44:47], v[116:119], v[52:55], a[44:47]
    v_lshlrev_b32 v40, 16, v76
    v_and_b32 v41, s56, v76
    v_lshlrev_b32 v42, 16, v77
    v_and_b32 v43, s56, v77
    v_mfma_f32_16x16x32_bf16 a[68:71], v[116:119], v[56:59], a[68:71]
    v_lshlrev_b32 v44, 16, v78
    buffer_load_dwordx2 v[202:203], v224, s[76:79], s58 offen
    s_add_u32 s58, s58, 2176
    v_and_b32 v45, s56, v78
    v_lshlrev_b32 v46, 16, v79
    v_mfma_f32_16x16x32_bf16 a[92:95], v[116:119], v[60:63], a[92:95]
    v_and_b32 v47, s56, v79
    v_mul_f32 v40, v40, v24
    v_mul_f32 v41, v41, v25
    buffer_load_dwordx2 v[204:205], v224, s[76:79], s58 offen
    s_add_u32 s58, s58, 2176
    v_mfma_f32_16x16x32_bf16 a[120:123], a[112:115], v[48:51], a[120:123]
    v_mul_f32 v42, v42, v26
    v_mul_f32 v43, v43, v27
    v_mul_f32 v44, v44, v28
    v_mul_f32 v45, v45, v29
    v_mfma_f32_16x16x32_bf16 a[124:127], a[112:115], v[52:55], a[124:127]
    v_mul_f32 v46, v46, v30
    buffer_load_dwordx2 v[206:207], v224, s[76:79], s58 offen
    s_add_u32 s58, s58, 2176
    v_mul_f32 v47, v47, v31
    v_cvt_pk_bf16_f32 v76, v40, v41
    v_mfma_f32_16x16x32_bf16 a[128:131], a[112:115], v[56:59], a[128:131]
    v_cvt_pk_bf16_f32 v77, v42, v43
    v_cvt_pk_bf16_f32 v78, v44, v45
    v_cvt_pk_bf16_f32 v79, v46, v47
    v_mfma_f32_16x16x32_bf16 a[132:135], a[112:115], v[60:63], a[132:135]
    s_nop 1
    s_waitcnt vmcnt(21) lgkmcnt(0)
    v_mfma_f32_16x16x32_bf16 a[0:3], v[120:123], v[64:67], a[0:3]
    ds_read_b128 a[112:115], v11 offset:9088
    ds_read_b64 v[48:49], v14 offset:8192
    ds_read_b64 v[50:51], v15 offset:8192
    ds_read_b64 v[52:53], v14 offset:10240
    v_mfma_f32_16x16x32_bf16 a[24:27], v[120:123], v[68:71], a[24:27]
    ds_read_b64 v[54:55], v15 offset:10240
    ds_read_b64 v[56:57], v14 offset:12288
    ds_read_b64 v[58:59], v15 offset:12288
    ds_read_b64 v[60:61], v14 offset:14336
    v_mfma_f32_16x16x32_bf16 a[48:51], v[120:123], v[72:75], a[48:51]
    ds_read_b64 v[62:63], v15 offset:14336
    ds_read_b128 v[24:27], v8 offset:1920
    ds_read_b128 v[28:31], v8 offset:1984
    buffer_load_dwordx2 v[208:209], v224, s[76:79], s58 offen
    s_add_u32 s58, s58, 2176
    v_mfma_f32_16x16x32_bf16 a[72:75], v[120:123], v[76:79], a[72:75]
    v_lshlrev_b32 v32, 16, v80
    v_and_b32 v33, s56, v80
    v_lshlrev_b32 v34, 16, v81
    v_and_b32 v35, s56, v81
    v_mfma_f32_16x16x32_bf16 a[4:7], v[124:127], v[64:67], a[4:7]
    v_lshlrev_b32 v36, 16, v82
    v_and_b32 v37, s56, v82
    v_lshlrev_b32 v38, 16, v83
    v_and_b32 v39, s56, v83
    v_mfma_f32_16x16x32_bf16 a[28:31], v[124:127], v[68:71], a[28:31]
    v_mul_f32 v32, v32, v16
    v_mul_f32 v33, v33, v17
    buffer_load_dwordx2 v[210:211], v224, s[76:79], s58 offen
    s_add_u32 s58, s58, 2176
    v_mul_f32 v34, v34, v18
    v_mfma_f32_16x16x32_bf16 a[52:55], v[124:127], v[72:75], a[52:55]
    v_mul_f32 v35, v35, v19
    v_mul_f32 v36, v36, v20
    v_mul_f32 v37, v37, v21
    v_mul_f32 v38, v38, v22
    v_mfma_f32_16x16x32_bf16 a[76:79], v[124:127], v[76:79], a[76:79]
    v_mul_f32 v39, v39, v23
    v_cvt_pk_bf16_f32 v80, v32, v33
    v_cvt_pk_bf16_f32 v81, v34, v35
    v_cvt_pk_bf16_f32 v82, v36, v37
    v_mfma_f32_16x16x32_bf16 a[8:11], v[128:131], v[64:67], a[8:11]
    v_cvt_pk_bf16_f32 v83, v38, v39
    buffer_load_dwordx2 v[212:213], v224, s[76:79], s58 offen
    s_add_u32 s58, s58, 2176
    v_lshlrev_b32 v40, 16, v84
    v_and_b32 v41, s56, v84
    v_mfma_f32_16x16x32_bf16 a[32:35], v[128:131], v[68:71], a[32:35]
    v_lshlrev_b32 v42, 16, v85
    v_and_b32 v43, s56, v85
    v_lshlrev_b32 v44, 16, v86
    v_and_b32 v45, s56, v86
    v_mfma_f32_16x16x32_bf16 a[56:59], v[128:131], v[72:75], a[56:59]
    v_lshlrev_b32 v46, 16, v87
    v_and_b32 v47, s56, v87
    v_mul_f32 v40, v40, v16
    v_mul_f32 v41, v41, v17
    v_mfma_f32_16x16x32_bf16 a[80:83], v[128:131], v[76:79], a[80:83]
    buffer_load_dwordx2 v[214:215], v224, s[76:79], s58 offen
    s_add_u32 s58, s58, 2176
    v_mul_f32 v42, v42, v18
    v_mul_f32 v43, v43, v19
    v_mul_f32 v44, v44, v20
    v_mfma_f32_16x16x32_bf16 a[12:15], v[132:135], v[64:67], a[12:15]
    v_mul_f32 v45, v45, v21
    v_mul_f32 v46, v46, v22
    v_mul_f32 v47, v47, v23
    v_cvt_pk_bf16_f32 v84, v40, v41
    v_mfma_f32_16x16x32_bf16 a[36:39], v[132:135], v[68:71], a[36:39]
    v_cvt_pk_bf16_f32 v85, v42, v43
    v_cvt_pk_bf16_f32 v86, v44, v45
    v_cvt_pk_bf16_f32 v87, v46, v47
    buffer_load_dwordx2 v[216:217], v224, s[76:79], s58 offen
    s_add_u32 s58, s58, 2176
    v_mfma_f32_16x16x32_bf16 a[60:63], v[132:135], v[72:75], a[60:63]
    v_lshlrev_b32 v32, 16, v88
    v_and_b32 v33, s56, v88
    v_lshlrev_b32 v34, 16, v89
    v_and_b32 v35, s56, v89
    v_mfma_f32_16x16x32_bf16 a[84:87], v[132:135], v[76:79], a[84:87]
    v_lshlrev_b32 v36, 16, v90
    v_and_b32 v37, s56, v90
    v_lshlrev_b32 v38, 16, v91
    v_and_b32 v39, s56, v91
    v_mfma_f32_16x16x32_bf16 a[16:19], v[136:139], v[64:67], a[16:19]
    v_mul_f32 v32, v32, v16
    v_mul_f32 v33, v33, v17
    buffer_load_dwordx2 v[218:219], v224, s[76:79], s58 offen
    s_add_u32 s58, s58, 2176
    v_mul_f32 v34, v34, v18
    v_mfma_f32_16x16x32_bf16 a[40:43], v[136:139], v[68:71], a[40:43]
    v_mul_f32 v35, v35, v19
    v_mul_f32 v36, v36, v20
    v_mul_f32 v37, v37, v21
    v_mul_f32 v38, v38, v22
    v_mfma_f32_16x16x32_bf16 a[64:67], v[136:139], v[72:75], a[64:67]
    v_mul_f32 v39, v39, v23
    v_cvt_pk_bf16_f32 v88, v32, v33
    v_cvt_pk_bf16_f32 v89, v34, v35
    v_cvt_pk_bf16_f32 v90, v36, v37
    v_mfma_f32_16x16x32_bf16 a[88:91], v[136:139], v[76:79], a[88:91]
    v_cvt_pk_bf16_f32 v91, v38, v39
    buffer_load_dwordx2 v[220:221], v224, s[76:79], s58 offen
    s_add_u32 s58, s58, 2176
    v_lshlrev_b32 v40, 16, v92
    v_and_b32 v41, s56, v92
    v_mfma_f32_16x16x32_bf16 a[20:23], v[140:143], v[64:67], a[20:23]
    v_lshlrev_b32 v42, 16, v93
    v_and_b32 v43, s56, v93
    v_lshlrev_b32 v44, 16, v94
    v_and_b32 v45, s56, v94
    v_mfma_f32_16x16x32_bf16 a[44:47], v[140:143], v[68:71], a[44:47]
    v_lshlrev_b32 v46, 16, v95
    v_and_b32 v47, s56, v95
    v_mul_f32 v40, v40, v16
    v_mul_f32 v41, v41, v17
    v_mfma_f32_16x16x32_bf16 a[68:71], v[140:143], v[72:75], a[68:71]
    buffer_load_dwordx2 v[222:223], v224, s[76:79], s58 offen
    s_add_u32 s58, s58, 2176
    v_mul_f32 v42, v42, v18
    v_mul_f32 v43, v43, v19
    v_mul_f32 v44, v44, v20
    v_mfma_f32_16x16x32_bf16 a[92:95], v[140:143], v[76:79], a[92:95]
    v_mul_f32 v45, v45, v21
    v_mul_f32 v46, v46, v22
    v_mul_f32 v47, v47, v23
    v_cvt_pk_bf16_f32 v92, v40, v41
    v_mfma_f32_16x16x32_bf16 a[120:123], a[116:119], v[64:67], a[120:123]
    v_cvt_pk_bf16_f32 v93, v42, v43
    v_cvt_pk_bf16_f32 v94, v44, v45
    v_cvt_pk_bf16_f32 v95, v46, v47
    v_mfma_f32_16x16x32_bf16 a[124:127], a[116:119], v[68:71], a[124:127]
    v_mfma_f32_16x16x32_bf16 a[128:131], a[116:119], v[72:75], a[128:131]
    v_mfma_f32_16x16x32_bf16 a[132:135], a[116:119], v[76:79], a[132:135]
    s_nop 1
    s_waitcnt vmcnt(23) lgkmcnt(0)
    v_mfma_f32_16x16x32_bf16 a[0:3], v[144:147], v[80:83], a[0:3]
    ds_read_b128 a[116:119], v11 offset:9152
    s_lshl_b32 s92, s36, 2
    s_add_u32 s92, s92, s38
    s_mul_i32 s48, s92, 22528
    s_lshl_b32 s49, s39, 9
    s_add_u32 s48, s48, s49
    v_lshl_add_u32 v229, v1, 3, s48
    s_lshl_b32 s48, s92, 5
    v_lshl_add_u32 v230, v2, 1, s48
    buffer_load_ushort v252, v230, s[44:47], 0 offen
    s_mul_i32 s48, s92, 38912
    v_lshl_add_u32 v226, v1, 4, s48
    v_lshlrev_b32 v32, 16, v48
    v_and_b32 v33, s56, v48
    v_mfma_f32_16x16x32_bf16 a[24:27], v[144:147], v[84:87], a[24:27]
    v_lshlrev_b32 v34, 16, v49
    v_and_b32 v35, s56, v49
    v_lshlrev_b32 v36, 16, v50
    v_and_b32 v37, s56, v50
    v_mfma_f32_16x16x32_bf16 a[48:51], v[144:147], v[88:91], a[48:51]
    v_lshlrev_b32 v38, 16, v51
    v_and_b32 v39, s56, v51
    v_mul_f32 v32, v32, v24
    v_mul_f32 v33, v33, v25
    v_mfma_f32_16x16x32_bf16 a[72:75], v[144:147], v[92:95], a[72:75]
    v_mul_f32 v34, v34, v26
    v_mul_f32 v35, v35, v27
    buffer_load_dwordx2 v[240:241], v229, s[40:43], 0 offen offset:0
    v_mul_f32 v36, v36, v28
    v_mfma_f32_16x16x32_bf16 a[4:7], v[148:151], v[80:83], a[4:7]
    v_mul_f32 v37, v37, v29
    v_mul_f32 v38, v38, v30
    v_mul_f32 v39, v39, v31
    v_cvt_pk_bf16_f32 v48, v32, v33
    v_mfma_f32_16x16x32_bf16 a[28:31], v[148:151], v[84:87], a[28:31]
    v_cvt_pk_bf16_f32 v49, v34, v35
    v_cvt_pk_bf16_f32 v50, v36, v37
    v_cvt_pk_bf16_f32 v51, v38, v39
    v_lshlrev_b32 v40, 16, v52
    v_mfma_f32_16x16x32_bf16 a[52:55], v[148:151], v[88:91], a[52:55]
    v_and_b32 v41, s56, v52
    v_lshlrev_b32 v42, 16, v53
    buffer_load_dwordx2 v[242:243], v229, s[40:43], 0 offen offset:512
    v_and_b32 v43, s56, v53
    v_mfma_f32_16x16x32_bf16 a[76:79], v[148:151], v[92:95], a[76:79]
    v_lshlrev_b32 v44, 16, v54
    v_and_b32 v45, s56, v54
    v_lshlrev_b32 v46, 16, v55
    v_and_b32 v47, s56, v55
    v_mfma_f32_16x16x32_bf16 a[8:11], v[152:155], v[80:83], a[8:11]
    v_mul_f32 v40, v40, v24
    v_mul_f32 v41, v41, v25
    v_mul_f32 v42, v42, v26
    v_mul_f32 v43, v43, v27
    v_mfma_f32_16x16x32_bf16 a[32:35], v[152:155], v[84:87], a[32:35]
    v_mul_f32 v44, v44, v28
    v_mul_f32 v45, v45, v29
    v_mul_f32 v46, v46, v30
    buffer_load_dwordx2 v[244:245], v229, s[40:43], 0 offen offset:1024
    v_mfma_f32_16x16x32_bf16 a[56:59], v[152:155], v[88:91], a[56:59]
    v_mul_f32 v47, v47, v31
    v_cvt_pk_bf16_f32 v52, v40, v41
    v_cvt_pk_bf16_f32 v53, v42, v43
    v_cvt_pk_bf16_f32 v54, v44, v45
    v_mfma_f32_16x16x32_bf16 a[80:83], v[152:155], v[92:95], a[80:83]
    v_cvt_pk_bf16_f32 v55, v46, v47
    v_lshlrev_b32 v32, 16, v56
    v_and_b32 v33, s56, v56
    v_lshlrev_b32 v34, 16, v57
    v_mfma_f32_16x16x32_bf16 a[12:15], v[156:159], v[80:83], a[12:15]
    v_and_b32 v35, s56, v57
    v_lshlrev_b32 v36, 16, v58
    v_and_b32 v37, s56, v58
    buffer_load_dwordx2 v[246:247], v229, s[40:43], 0 offen offset:1536
    v_mfma_f32_16x16x32_bf16 a[36:39], v[156:159], v[84:87], a[36:39]
    v_lshlrev_b32 v38, 16, v59
    v_and_b32 v39, s56, v59
    v_mul_f32 v32, v32, v24
    v_mul_f32 v33, v33, v25
    v_mfma_f32_16x16x32_bf16 a[60:63], v[156:159], v[88:91], a[60:63]
    v_mul_f32 v34, v34, v26
    v_mul_f32 v35, v35, v27
    v_mul_f32 v36, v36, v28
    v_mul_f32 v37, v37, v29
    v_mfma_f32_16x16x32_bf16 a[84:87], v[156:159], v[92:95], a[84:87]
    v_mul_f32 v38, v38, v30
    v_mul_f32 v39, v39, v31
    v_cvt_pk_bf16_f32 v56, v32, v33
    v_cvt_pk_bf16_f32 v57, v34, v35
    v_mfma_f32_16x16x32_bf16 a[16:19], v[160:163], v[80:83], a[16:19]
    buffer_load_dwordx2 v[248:249], v229, s[40:43], 0 offen offset:2048
    v_cvt_pk_bf16_f32 v58, v36, v37
    v_cvt_pk_bf16_f32 v59, v38, v39
    v_lshlrev_b32 v40, 16, v60
    v_mfma_f32_16x16x32_bf16 a[40:43], v[160:163], v[84:87], a[40:43]
    v_and_b32 v41, s56, v60
    v_lshlrev_b32 v42, 16, v61
    v_and_b32 v43, s56, v61
    v_lshlrev_b32 v44, 16, v62
    v_mfma_f32_16x16x32_bf16 a[64:67], v[160:163], v[88:91], a[64:67]
    v_and_b32 v45, s56, v62
    v_lshlrev_b32 v46, 16, v63
    v_and_b32 v47, s56, v63
    v_mul_f32 v40, v40, v24
    v_mfma_f32_16x16x32_bf16 a[88:91], v[160:163], v[92:95], a[88:91]
    buffer_load_dwordx2 v[250:251], v229, s[40:43], 0 offen offset:2560
    v_mul_f32 v41, v41, v25
    v_mul_f32 v42, v42, v26
    v_mul_f32 v43, v43, v27
    v_mfma_f32_16x16x32_bf16 a[20:23], v[164:167], v[80:83], a[20:23]
    v_mul_f32 v44, v44, v28
    v_mul_f32 v45, v45, v29
    v_mul_f32 v46, v46, v30
    v_mul_f32 v47, v47, v31
    v_mfma_f32_16x16x32_bf16 a[44:47], v[164:167], v[84:87], a[44:47]
    v_cvt_pk_bf16_f32 v60, v40, v41
    v_cvt_pk_bf16_f32 v61, v42, v43
    v_cvt_pk_bf16_f32 v62, v44, v45
    v_cvt_pk_bf16_f32 v63, v46, v47
    v_mfma_f32_16x16x32_bf16 a[68:71], v[164:167], v[88:91], a[68:71]
    v_lshlrev_b32 v8, 2, v2
    v_lshl_add_u32 v8, v3, 8, v8
    v_add_u32 v8, 114688, v8
    v_lshlrev_b32 v12, 4, v3
    v_add_u32 v12, 114688, v12
    v_lshl_add_u32 v10, v1, 4, s55
    s_xor_b32 s48, s38, 1
    s_mul_i32 s48, s48, 24576
    s_add_u32 s48, s48, 16384
    v_lshl_add_u32 v13, v1, 4, s48
    s_xor_b32 s48, s38, 2
    s_mul_i32 s48, s48, 24576
    s_add_u32 s48, s48, 23552
    v_lshl_add_u32 v14, v1, 4, s48
    s_xor_b32 s48, s38, 3
    s_mul_i32 s48, s48, 24576
    s_add_u32 s48, s48, 30720
    v_lshl_add_u32 v15, v1, 4, s48
    v_mfma_f32_16x16x32_bf16 a[92:95], v[164:167], v[92:95], a[92:95]
    v_mfma_f32_16x16x32_bf16 a[120:123], a[112:115], v[80:83], a[120:123]
    v_mfma_f32_16x16x32_bf16 a[124:127], a[112:115], v[84:87], a[124:127]
    v_mfma_f32_16x16x32_bf16 a[128:131], a[112:115], v[88:91], a[128:131]
    v_mfma_f32_16x16x32_bf16 a[132:135], a[112:115], v[92:95], a[132:135]
    s_nop 1
    s_waitcnt vmcnt(24) lgkmcnt(0)
    v_mfma_f32_16x16x32_bf16 a[24:27], v[168:171], v[52:55], a[24:27]
    s_and_b32 s48, s2, 7
    s_lshl_b32 s48, s48, 4
    s_lshl_b32 s49, s38, 2
    s_add_u32 s48, s48, s49
    s_lshl_b32 s49, s48, 15
    v_lshl_add_u32 v227, v1, 4, s49
    s_mul_i32 s48, s48, 38912
    v_lshl_add_u32 v228, v1, 4, s48
    s_lshl_b32 s58, s57, 10
    buffer_load_dwordx4 a[96:99], v227, s[80:83], s58 offen
    s_add_u32 s58, s58, 32768
    v_mfma_f32_16x16x32_bf16 a[28:31], v[172:175], v[52:55], a[28:31]
    buffer_load_dwordx4 a[100:103], v227, s[80:83], s58 offen
    s_add_u32 s58, s58, 32768
    buffer_load_dwordx4 a[104:107], v227, s[80:83], s58 offen
    s_add_u32 s58, s58, 32768
    v_mfma_f32_16x16x32_bf16 a[32:35], v[176:179], v[52:55], a[32:35]
    buffer_load_dwordx4 a[108:111], v227, s[80:83], s58 offen
    s_add_u32 s58, s58, 32768
    s_cmp_ge_u32 s2, 64
    s_cselect_b32 s88, s12, s6
    s_cselect_b32 s89, s13, s7
    s_mov_b32 s90, 524288
    s_cmov_b32 s90, 704512
    s_mov_b32 s91, 0x00020000
    s_cselect_b32 s59, 524288, 0
    s_lshr_b32 s48, s2, 2
    s_and_b32 s49, s2, 3
    s_lshl_b32 s58, s48, 15
    s_lshl_b32 s49, s49, 12
    s_add_u32 s58, s58, s49
    s_sub_u32 s58, s58, s59
    s_add_u32 s59, s58, 16384
    v_lshlrev_b32 v225, 2, v0
    v_mfma_f32_16x16x32_bf16 a[36:39], v[180:183], v[52:55], a[36:39]
    buffer_load_dword v232, v225, s[88:91], s58 offen offset:0
    buffer_load_dword v233, v225, s[88:91], s58 offen offset:1024
    v_mfma_f32_16x16x32_bf16 a[40:43], v[184:187], v[52:55], a[40:43]
    buffer_load_dword v234, v225, s[88:91], s58 offen offset:2048
    buffer_load_dword v235, v225, s[88:91], s58 offen offset:3072
    v_mfma_f32_16x16x32_bf16 a[44:47], v[188:191], v[52:55], a[44:47]
    buffer_load_dword v236, v225, s[88:91], s59 offen offset:0
    buffer_load_dword v237, v225, s[88:91], s59 offen offset:1024
    v_mfma_f32_16x16x32_bf16 a[124:127], a[116:119], v[52:55], a[124:127]
    buffer_load_dword v238, v225, s[88:91], s59 offen offset:2048
    buffer_load_dword v239, v225, s[88:91], s59 offen offset:3072
    v_mfma_f32_16x16x32_bf16 a[48:51], v[168:171], v[56:59], a[48:51]
    ds_write_b128 v10, a[24:27] offset:0
    v_mfma_f32_16x16x32_bf16 a[52:55], v[172:175], v[56:59], a[52:55]
    ds_write_b128 v10, a[28:31] offset:1024
    v_mfma_f32_16x16x32_bf16 a[56:59], v[176:179], v[56:59], a[56:59]
    ds_write_b128 v10, a[32:35] offset:2048
    v_mfma_f32_16x16x32_bf16 a[60:63], v[180:183], v[56:59], a[60:63]
    ds_write_b128 v10, a[36:39] offset:3072
    v_mfma_f32_16x16x32_bf16 a[64:67], v[184:187], v[56:59], a[64:67]
    ds_write_b128 v10, a[40:43] offset:4096
    v_mfma_f32_16x16x32_bf16 a[68:71], v[188:191], v[56:59], a[68:71]
    ds_write_b128 v10, a[44:47] offset:5120
    v_mfma_f32_16x16x32_bf16 a[128:131], a[116:119], v[56:59], a[128:131]
    ds_write_b128 v10, a[124:127] offset:6144
    v_mfma_f32_16x16x32_bf16 a[72:75], v[168:171], v[60:63], a[72:75]
    ds_write_b128 v10, a[48:51] offset:7168
    v_mfma_f32_16x16x32_bf16 a[76:79], v[172:175], v[60:63], a[76:79]
    ds_write_b128 v10, a[52:55] offset:8192
    v_mfma_f32_16x16x32_bf16 a[80:83], v[176:179], v[60:63], a[80:83]
    ds_write_b128 v10, a[56:59] offset:9216
    v_mfma_f32_16x16x32_bf16 a[84:87], v[180:183], v[60:63], a[84:87]
    ds_write_b128 v10, a[60:63] offset:10240
    v_mfma_f32_16x16x32_bf16 a[88:91], v[184:187], v[60:63], a[88:91]
    ds_write_b128 v10, a[64:67] offset:11264
    v_mfma_f32_16x16x32_bf16 a[92:95], v[188:191], v[60:63], a[92:95]
    ds_write_b128 v10, a[68:71] offset:12288
    v_mfma_f32_16x16x32_bf16 a[132:135], a[116:119], v[60:63], a[132:135]
    ds_write_b128 v10, a[128:131] offset:13312
    v_mfma_f32_16x16x32_bf16 a[0:3], v[168:171], v[48:51], a[0:3]
    ds_write_b128 v10, a[72:75] offset:14336
    v_mfma_f32_16x16x32_bf16 a[4:7], v[172:175], v[48:51], a[4:7]
    ds_write_b128 v10, a[76:79] offset:15360
    v_mfma_f32_16x16x32_bf16 a[8:11], v[176:179], v[48:51], a[8:11]
    ds_write_b128 v10, a[80:83] offset:16384
    v_mfma_f32_16x16x32_bf16 a[12:15], v[180:183], v[48:51], a[12:15]
    ds_write_b128 v10, a[84:87] offset:17408
    v_mfma_f32_16x16x32_bf16 a[16:19], v[184:187], v[48:51], a[16:19]
    ds_write_b128 v10, a[88:91] offset:18432
    v_mfma_f32_16x16x32_bf16 a[20:23], v[188:191], v[48:51], a[20:23]
    ds_write_b128 v10, a[92:95] offset:19456
    v_mfma_f32_16x16x32_bf16 a[120:123], a[116:119], v[48:51], a[120:123]
    ds_write_b128 v10, a[132:135] offset:20480
    s_nop 1
    s_waitcnt vmcnt(19)
    v_add_f32 v192, v192, v208
    v_add_f32 v193, v193, v209
    v_add_f32 v194, v194, v210
    v_add_f32 v195, v195, v211
    v_add_f32 v196, v196, v212
    v_add_f32 v197, v197, v213
    v_add_f32 v198, v198, v214
    v_add_f32 v199, v199, v215
    v_add_f32 v200, v200, v216
    v_add_f32 v201, v201, v217
    v_add_f32 v202, v202, v218
    v_add_f32 v203, v203, v219
    v_add_f32 v204, v204, v220
    v_add_f32 v205, v205, v221
    v_add_f32 v206, v206, v222
    v_add_f32 v207, v207, v223
    v_add_f32 v192, v192, v200
    v_add_f32 v193, v193, v201
    v_add_f32 v194, v194, v202
    v_add_f32 v195, v195, v203
    v_add_f32 v196, v196, v204
    v_add_f32 v197, v197, v205
    v_add_f32 v198, v198, v206
    v_add_f32 v199, v199, v207
    v_add_f32 v192, v192, v196
    v_add_f32 v193, v193, v197
    v_add_f32 v194, v194, v198
    v_add_f32 v195, v195, v199
    v_add_f32 v192, v192, v194
    v_add_f32 v193, v193, v195
    v_permlane32_swap_b32 v254, v255
    v_add_u32 v4, 114688, v224
    s_lshl_b32 s48, s38, 7
    v_add_f32 v254, v254, v255
    v_lshl_add_u32 v5, v2, 3, s48
    v_mov_b32 v255, v254
    v_lshrrev_b32 v11, 1, v3
    s_nop 1
    v_permlane16_swap_b32 v254, v255
    v_lshl_add_u32 v5, v11, 2, v5
    v_add_u32 v5, 114688, v5
    v_add_f32 v254, v254, v255
    ds_write_b64 v4, v[192:193]
    ds_write_b32 v5, v254 offset:2048
    v_accvgpr_read_b32 v16, a0
    v_accvgpr_read_b32 v17, a1
    v_accvgpr_read_b32 v18, a2
    v_accvgpr_read_b32 v19, a3
    v_accvgpr_read_b32 v20, a4
    v_accvgpr_read_b32 v21, a5
    v_accvgpr_read_b32 v22, a6
    v_accvgpr_read_b32 v23, a7
    v_accvgpr_read_b32 v24, a8
    v_accvgpr_read_b32 v25, a9
    v_accvgpr_read_b32 v26, a10
    v_accvgpr_read_b32 v27, a11
    v_accvgpr_read_b32 v28, a12
    v_accvgpr_read_b32 v29, a13
    v_accvgpr_read_b32 v30, a14
    v_accvgpr_read_b32 v31, a15
    v_accvgpr_read_b32 v32, a16
    v_accvgpr_read_b32 v33, a17
    v_accvgpr_read_b32 v34, a18
    v_accvgpr_read_b32 v35, a19
    v_accvgpr_read_b32 v36, a20
    v_accvgpr_read_b32 v37, a21
    v_accvgpr_read_b32 v38, a22
    v_accvgpr_read_b32 v39, a23
    v_accvgpr_read_b32 v40, a120
    v_accvgpr_read_b32 v41, a121
    v_accvgpr_read_b32 v42, a122
    v_accvgpr_read_b32 v43, a123
    s_waitcnt lgkmcnt(0)
    s_barrier
    ds_read_b128 v[44:47], v13 offset:0
    ds_read_b128 v[48:51], v13 offset:1024
    ds_read_b128 v[52:55], v13 offset:2048
    ds_read_b128 v[56:59], v13 offset:3072
    ds_read_b128 v[60:63], v13 offset:4096
    ds_read_b128 v[64:67], v13 offset:5120
    ds_read_b128 v[68:71], v13 offset:6144
    ds_read_b128 v[72:75], v14 offset:0
    ds_read_b128 v[76:79], v14 offset:1024
    ds_read_b128 v[80:83], v14 offset:2048
    ds_read_b128 v[84:87], v14 offset:3072
    ds_read_b128 v[88:91], v14 offset:4096
    ds_read_b128 v[92:95], v14 offset:5120
    ds_read_b128 v[96:99], v14 offset:6144
    ds_read_b128 v[100:103], v15 offset:0
    ds_read_b128 v[104:107], v15 offset:1024
    ds_read_b128 v[108:111], v15 offset:2048
    ds_read_b128 v[112:115], v15 offset:3072
    ds_read_b128 v[116:119], v15 offset:4096
    ds_read_b128 v[120:123], v15 offset:5120
    ds_read_b128 v[124:127], v15 offset:6144
    ds_read_b32 v192, v8 offset:0
    ds_read_b32 v193, v8 offset:64
    ds_read_b32 v194, v8 offset:128
    ds_read_b32 v195, v8 offset:192
    ds_read_b128 v[160:163], v12 offset:2048
    ds_read_b128 v[168:171], v12 offset:2176
    ds_read_b128 v[176:179], v12 offset:2304
    ds_read_b128 v[184:187], v12 offset:2432
    ds_read_b32 v196, v8 offset:1024
    ds_read_b32 v197, v8 offset:1088
    ds_read_b32 v198, v8 offset:1152
    ds_read_b32 v199, v8 offset:1216
    ds_read_b128 v[164:167], v12 offset:2112
    ds_read_b128 v[172:175], v12 offset:2240
    ds_read_b128 v[180:183], v12 offset:2368
    ds_read_b128 v[188:191], v12 offset:2496
    s_waitcnt lgkmcnt(15)
    v_pk_add_f32 v[16:17], v[16:17], v[44:45]
    v_pk_add_f32 v[18:19], v[18:19], v[46:47]
    v_pk_add_f32 v[20:21], v[20:21], v[48:49]
    v_pk_add_f32 v[22:23], v[22:23], v[50:51]
    v_pk_add_f32 v[24:25], v[24:25], v[52:53]
    v_pk_add_f32 v[26:27], v[26:27], v[54:55]
    v_pk_add_f32 v[28:29], v[28:29], v[56:57]
    v_pk_add_f32 v[30:31], v[30:31], v[58:59]
    v_pk_add_f32 v[32:33], v[32:33], v[60:61]
    v_pk_add_f32 v[34:35], v[34:35], v[62:63]
    v_pk_add_f32 v[36:37], v[36:37], v[64:65]
    v_pk_add_f32 v[38:39], v[38:39], v[66:67]
    v_pk_add_f32 v[40:41], v[40:41], v[68:69]
    v_pk_add_f32 v[42:43], v[42:43], v[70:71]
    s_waitcnt lgkmcnt(15)
    v_pk_add_f32 v[16:17], v[16:17], v[72:73]
    v_pk_add_f32 v[18:19], v[18:19], v[74:75]
    v_pk_add_f32 v[20:21], v[20:21], v[76:77]
    v_pk_add_f32 v[22:23], v[22:23], v[78:79]
    v_pk_add_f32 v[24:25], v[24:25], v[80:81]
    v_pk_add_f32 v[26:27], v[26:27], v[82:83]
    v_pk_add_f32 v[28:29], v[28:29], v[84:85]
    v_pk_add_f32 v[30:31], v[30:31], v[86:87]
    v_pk_add_f32 v[32:33], v[32:33], v[88:89]
    v_pk_add_f32 v[34:35], v[34:35], v[90:91]
    v_pk_add_f32 v[36:37], v[36:37], v[92:93]
    v_pk_add_f32 v[38:39], v[38:39], v[94:95]
    v_pk_add_f32 v[40:41], v[40:41], v[96:97]
    v_pk_add_f32 v[42:43], v[42:43], v[98:99]
    s_waitcnt lgkmcnt(15)
    v_pk_add_f32 v[16:17], v[16:17], v[100:101]
    v_pk_add_f32 v[18:19], v[18:19], v[102:103]
    v_pk_add_f32 v[20:21], v[20:21], v[104:105]
    v_pk_add_f32 v[22:23], v[22:23], v[106:107]
    v_pk_add_f32 v[24:25], v[24:25], v[108:109]
    v_pk_add_f32 v[26:27], v[26:27], v[110:111]
    v_pk_add_f32 v[28:29], v[28:29], v[112:113]
    v_pk_add_f32 v[30:31], v[30:31], v[114:115]
    v_pk_add_f32 v[32:33], v[32:33], v[116:117]
    v_pk_add_f32 v[34:35], v[34:35], v[118:119]
    v_pk_add_f32 v[36:37], v[36:37], v[120:121]
    v_pk_add_f32 v[38:39], v[38:39], v[122:123]
    v_pk_add_f32 v[40:41], v[40:41], v[124:125]
    v_pk_add_f32 v[42:43], v[42:43], v[126:127]
    s_waitcnt vmcnt(12)
    v_lshlrev_b32 v252, 16, v252
    v_sub_f32 v252, v252, v40
    v_sub_f32 v252, v252, v41
    s_add_u32 s59, s39, 32
    v_lshlrev_b32 v112, 16, v240
    v_and_b32 v113, s56, v240
    v_lshlrev_b32 v114, 16, v241
    v_and_b32 v115, s56, v241
    v_add_f32 v16, v16, v252
    v_add_f32 v17, v17, v252
    v_add_f32 v18, v18, v252
    v_add_f32 v19, v19, v252
    v_pk_mul_f32 v[16:17], v[16:17], v[112:113]
    v_pk_mul_f32 v[18:19], v[18:19], v[114:115]
    v_cvt_pk_bf16_f32 v240, v16, v17
    v_cvt_pk_bf16_f32 v241, v18, v19
    s_lshr_b32 s48, s59, 1
    s_lshl_b32 s48, s48, 10
    s_and_b32 s49, s59, 1
    s_lshl_b32 s49, s49, 3
    s_add_u32 s48, s48, s49
    buffer_store_dwordx2 v[240:241], v226, s[32:35], s48 offen
    s_add_u32 s59, s59, 1
    v_lshlrev_b32 v112, 16, v242
    v_and_b32 v113, s56, v242
    v_lshlrev_b32 v114, 16, v243
    v_and_b32 v115, s56, v243
    v_add_f32 v20, v20, v252
    v_add_f32 v21, v21, v252
    v_add_f32 v22, v22, v252
    v_add_f32 v23, v23, v252
    v_pk_mul_f32 v[20:21], v[20:21], v[112:113]
    v_pk_mul_f32 v[22:23], v[22:23], v[114:115]
    v_cvt_pk_bf16_f32 v242, v20, v21
    v_cvt_pk_bf16_f32 v243, v22, v23
    s_lshr_b32 s48, s59, 1
    s_lshl_b32 s48, s48, 10
    s_and_b32 s49, s59, 1
    s_lshl_b32 s49, s49, 3
    s_add_u32 s48, s48, s49
    buffer_store_dwordx2 v[242:243], v226, s[32:35], s48 offen
    s_add_u32 s59, s59, 1
    v_lshlrev_b32 v112, 16, v244
    v_and_b32 v113, s56, v244
    v_lshlrev_b32 v114, 16, v245
    v_and_b32 v115, s56, v245
    v_add_f32 v24, v24, v252
    v_add_f32 v25, v25, v252
    v_add_f32 v26, v26, v252
    v_add_f32 v27, v27, v252
    v_pk_mul_f32 v[24:25], v[24:25], v[112:113]
    v_pk_mul_f32 v[26:27], v[26:27], v[114:115]
    v_cvt_pk_bf16_f32 v244, v24, v25
    v_cvt_pk_bf16_f32 v245, v26, v27
    s_lshr_b32 s48, s59, 1
    s_lshl_b32 s48, s48, 10
    s_and_b32 s49, s59, 1
    s_lshl_b32 s49, s49, 3
    s_add_u32 s48, s48, s49
    buffer_store_dwordx2 v[244:245], v226, s[32:35], s48 offen
    s_add_u32 s59, s59, 1
    v_lshlrev_b32 v112, 16, v246
    v_and_b32 v113, s56, v246
    v_lshlrev_b32 v114, 16, v247
    v_and_b32 v115, s56, v247
    v_add_f32 v28, v28, v252
    v_add_f32 v29, v29, v252
    v_add_f32 v30, v30, v252
    v_add_f32 v31, v31, v252
    v_pk_mul_f32 v[28:29], v[28:29], v[112:113]
    v_pk_mul_f32 v[30:31], v[30:31], v[114:115]
    v_cvt_pk_bf16_f32 v246, v28, v29
    v_cvt_pk_bf16_f32 v247, v30, v31
    s_lshr_b32 s48, s59, 1
    s_lshl_b32 s48, s48, 10
    s_and_b32 s49, s59, 1
    s_lshl_b32 s49, s49, 3
    s_add_u32 s48, s48, s49
    buffer_store_dwordx2 v[246:247], v226, s[32:35], s48 offen
    s_add_u32 s59, s59, 1
    v_lshlrev_b32 v112, 16, v248
    v_and_b32 v113, s56, v248
    v_lshlrev_b32 v114, 16, v249
    v_and_b32 v115, s56, v249
    v_add_f32 v32, v32, v252
    v_add_f32 v33, v33, v252
    v_add_f32 v34, v34, v252
    v_add_f32 v35, v35, v252
    v_pk_mul_f32 v[32:33], v[32:33], v[112:113]
    v_pk_mul_f32 v[34:35], v[34:35], v[114:115]
    v_cvt_pk_bf16_f32 v248, v32, v33
    v_cvt_pk_bf16_f32 v249, v34, v35
    s_lshr_b32 s48, s59, 1
    s_lshl_b32 s48, s48, 10
    s_and_b32 s49, s59, 1
    s_lshl_b32 s49, s49, 3
    s_add_u32 s48, s48, s49
    buffer_store_dwordx2 v[248:249], v226, s[32:35], s48 offen
    s_add_u32 s59, s59, 1
    v_lshlrev_b32 v112, 16, v250
    v_and_b32 v113, s56, v250
    v_lshlrev_b32 v114, 16, v251
    v_and_b32 v115, s56, v251
    v_add_f32 v36, v36, v252
    v_add_f32 v37, v37, v252
    v_add_f32 v38, v38, v252
    v_add_f32 v39, v39, v252
    v_pk_mul_f32 v[36:37], v[36:37], v[112:113]
    v_pk_mul_f32 v[38:39], v[38:39], v[114:115]
    v_cvt_pk_bf16_f32 v250, v36, v37
    v_cvt_pk_bf16_f32 v251, v38, v39
    s_lshr_b32 s48, s59, 1
    s_lshl_b32 s48, s48, 10
    s_and_b32 s49, s59, 1
    s_lshl_b32 s49, s49, 3
    s_add_u32 s48, s48, s49
    s_cmp_eq_u32 s59, 75
    s_cselect_b64 vcc, 0, -1
    v_cndmask_b32 v250, 0, v250, vcc
    v_cndmask_b32 v251, 0, v251, vcc
    buffer_store_dwordx2 v[250:251], v226, s[32:35], s48 offen
    s_add_u32 s59, s59, 1
    s_waitcnt lgkmcnt(0)
    v_add_f32 v160, v160, v176
    v_add_f32 v161, v161, v177
    v_add_f32 v162, v162, v178
    v_add_f32 v163, v163, v179
    v_add_f32 v164, v164, v180
    v_add_f32 v165, v165, v181
    v_add_f32 v166, v166, v182
    v_add_f32 v167, v167, v183
    v_add_f32 v168, v168, v184
    v_add_f32 v169, v169, v185
    v_add_f32 v170, v170, v186
    v_add_f32 v171, v171, v187
    v_add_f32 v172, v172, v188
    v_add_f32 v173, v173, v189
    v_add_f32 v174, v174, v190
    v_add_f32 v175, v175, v191
    v_add_f32 v200, v160, v168
    v_add_f32 v201, v161, v169
    v_add_f32 v202, v162, v170
    v_add_f32 v203, v163, v171
    v_add_f32 v204, v164, v172
    v_add_f32 v205, v165, v173
    v_add_f32 v206, v166, v174
    v_add_f32 v207, v167, v175
    v_cvt_pk_bf16_f32 v80, v192, v193
    v_cvt_pk_bf16_f32 v81, v194, v195
    v_cvt_pk_bf16_f32 v82, v196, v197
    v_cvt_pk_bf16_f32 v83, v198, v199
    v_cvt_pk_bf16_f32 v84, v200, v201
    v_cvt_pk_bf16_f32 v85, v202, v203
    v_cvt_pk_bf16_f32 v86, v204, v205
    v_cvt_pk_bf16_f32 v87, v206, v207
    s_waitcnt vmcnt(14)
    s_lshr_b32 s58, s57, 1
    s_lshl_b32 s58, s58, 10
    s_and_b32 s49, s57, 1
    s_lshl_b32 s49, s49, 3
    s_add_u32 s58, s58, s49
    v_mfma_f32_16x16x32_bf16 v[96:99], v[80:83], a[96:99], 0
    v_mfma_f32_16x16x32_bf16 v[112:115], v[84:87], a[96:99], 0
    v_mfma_f32_16x16x32_bf16 v[100:103], v[80:83], a[100:103], 0
    v_mfma_f32_16x16x32_bf16 v[116:119], v[84:87], a[100:103], 0
    v_mfma_f32_16x16x32_bf16 v[104:107], v[80:83], a[104:107], 0
    v_mfma_f32_16x16x32_bf16 v[120:123], v[84:87], a[104:107], 0
    v_mfma_f32_16x16x32_bf16 v[108:111], v[80:83], a[108:111], 0
    v_mfma_f32_16x16x32_bf16 v[124:127], v[84:87], a[108:111], 0
    s_nop 7
    v_add_f32 v112, 0x358637bd, v112
    v_add_f32 v113, 0x358637bd, v113
    v_add_f32 v114, 0x358637bd, v114
    v_add_f32 v115, 0x358637bd, v115
    v_add_f32 v116, 0x358637bd, v116
    v_add_f32 v117, 0x358637bd, v117
    v_add_f32 v118, 0x358637bd, v118
    v_add_f32 v119, 0x358637bd, v119
    v_add_f32 v120, 0x358637bd, v120
    v_add_f32 v121, 0x358637bd, v121
    v_add_f32 v122, 0x358637bd, v122
    v_add_f32 v123, 0x358637bd, v123
    v_add_f32 v124, 0x358637bd, v124
    v_add_f32 v125, 0x358637bd, v125
    v_add_f32 v126, 0x358637bd, v126
    v_add_f32 v127, 0x358637bd, v127
    v_rcp_f32 v112, v112
    v_rcp_f32 v113, v113
    v_rcp_f32 v114, v114
    v_rcp_f32 v115, v115
    v_rcp_f32 v116, v116
    v_rcp_f32 v117, v117
    v_rcp_f32 v118, v118
    v_rcp_f32 v119, v119
    v_rcp_f32 v120, v120
    v_rcp_f32 v121, v121
    v_rcp_f32 v122, v122
    v_rcp_f32 v123, v123
    v_rcp_f32 v124, v124
    v_rcp_f32 v125, v125
    v_rcp_f32 v126, v126
    v_rcp_f32 v127, v127
    v_mul_f32 v96, v96, v112
    v_mul_f32 v97, v97, v113
    v_mul_f32 v98, v98, v114
    v_mul_f32 v99, v99, v115
    v_mul_f32 v100, v100, v116
    v_mul_f32 v101, v101, v117
    v_mul_f32 v102, v102, v118
    v_mul_f32 v103, v103, v119
    v_mul_f32 v104, v104, v120
    v_mul_f32 v105, v105, v121
    v_mul_f32 v106, v106, v122
    v_mul_f32 v107, v107, v123
    v_mul_f32 v108, v108, v124
    v_mul_f32 v109, v109, v125
    v_mul_f32 v110, v110, v126
    v_mul_f32 v111, v111, v127
    v_cvt_pk_bf16_f32 v128, v96, v97
    v_cvt_pk_bf16_f32 v129, v98, v99
    buffer_store_dwordx2 v[128:129], v228, s[32:35], s58 offen
    s_add_u32 s58, s58, 38912
    v_cvt_pk_bf16_f32 v130, v100, v101
    v_cvt_pk_bf16_f32 v131, v102, v103
    buffer_store_dwordx2 v[130:131], v228, s[32:35], s58 offen
    s_add_u32 s58, s58, 38912
    v_cvt_pk_bf16_f32 v132, v104, v105
    v_cvt_pk_bf16_f32 v133, v106, v107
    buffer_store_dwordx2 v[132:133], v228, s[32:35], s58 offen
    s_add_u32 s58, s58, 38912
    v_cvt_pk_bf16_f32 v134, v108, v109
    v_cvt_pk_bf16_f32 v135, v110, v111
    buffer_store_dwordx2 v[134:135], v228, s[32:35], s58 offen
    s_add_u32 s58, s58, 38912
    s_cmp_ge_u32 s2, 152
    s_cbranch_scc1 p2_kernel_exit
    s_add_u32 s24, s16, 25165824
    s_addc_u32 s25, s17, 0
    s_mov_b32 s26, 1245184
    s_mov_b32 s27, 0x00020000
    s_lshr_b32 s57, s2, 2
    s_and_b32 s49, s2, 3
    s_lshl_b32 s58, s57, 10
    s_lshl_b32 s49, s49, 8
    s_add_u32 s58, s58, s49
    s_mov_b32 s48, 0x05040100
    s_mov_b32 s49, 0x07060302
    v_lshrrev_b32 v5, 3, v0
    v_mul_u32_u24 v5, 38912, v5
    v_and_b32 v6, 7, v0
    v_lshl_add_u32 v5, v6, 5, v5
    s_waitcnt vmcnt(10)
    v_perm_b32 v72, v233, v232, s48
    v_perm_b32 v76, v233, v232, s49
    v_perm_b32 v73, v235, v234, s48
    v_perm_b32 v77, v235, v234, s49
    v_perm_b32 v74, v237, v236, s48
    v_perm_b32 v78, v237, v236, s49
    v_perm_b32 v75, v239, v238, s48
    v_perm_b32 v79, v239, v238, s49
    buffer_store_dwordx4 v[72:75], v5, s[24:27], s58 offen
    buffer_store_dwordx4 v[76:79], v5, s[24:27], s58 offen offset:16
p2_kernel_exit:
    s_endpgm
.globl p3_kernel
.p2align 8
.type p3_kernel,@function
p3_kernel:
    s_cmp_ge_u32 s2, 256
    s_cbranch_scc1 p3_kernel_exit
    s_load_dwordx2 s[4:5], s[0:1], 0
    s_load_dwordx2 s[6:7], s[0:1], 24
    s_load_dwordx4 s[8:11], s[0:1], 48
    s_load_dwordx4 s[12:15], s[0:1], 64
    s_load_dwordx2 s[16:17], s[0:1], 88
    v_lshrrev_b32 v4, 6, v0
    v_and_b32 v1, 63, v0
    v_readfirstlane_b32 s38, v4
    v_and_b32 v2, 15, v0
    v_bfe_u32 v3, v0, 4, 2
    s_and_b32 s48, s2, 7
    s_lshl_b32 s48, s48, 2
    s_lshr_b32 s36, s2, 6
    s_add_u32 s36, s36, s48
    s_bfe_u32 s37, s2, 0x30003
    s_mul_i32 s48, s38, 10240
    s_cmp_eq_u32 s38, 3
    s_cselect_b32 s49, 1024, 0
    s_sub_u32 s48, s48, s49
    v_lshl_add_u32 v5, v1, 4, s48
    s_mul_i32 s48, s36, 155648
    v_add_u32 v6, s48, v5
    s_mul_i32 s48, s37, 155648
    v_add_u32 v7, s48, v5
    s_cmp_ge_u32 s38, 2
    s_cselect_b32 s58, 0x40000000, 0
    s_mov_b32 s50, 0
    s_add_u32 s54, s58, 0
    s_mov_b32 s51, 38912
    s_add_u32 s55, s58, 38912
    s_mov_b32 s52, 77824
    s_add_u32 s56, s58, 77824
    s_mov_b32 s53, 116736
    s_add_u32 s57, s58, 116736
    s_mov_b32 s22, 4980736
    s_mov_b32 s23, 0x00020000
    s_mov_b32 s26, 1245184
    s_mov_b32 s27, 0x00020000
    s_waitcnt lgkmcnt(0)
    s_add_u32 s20, s16, 16777216
    s_addc_u32 s21, s17, 0
    s_add_u32 s24, s16, 25165824
    s_addc_u32 s25, s17, 0
    buffer_load_dwordx4 v[32:35], v6, s[20:23], s50 offen offset:0
    buffer_load_dwordx4 v[48:51], v7, s[24:27], s50 offen offset:0
    buffer_load_dwordx4 v[36:39], v6, s[20:23], s51 offen offset:0
    buffer_load_dwordx4 v[52:55], v7, s[24:27], s51 offen offset:0
    buffer_load_dwordx4 v[40:43], v6, s[20:23], s52 offen offset:0
    buffer_load_dwordx4 v[56:59], v7, s[24:27], s52 offen offset:0
    buffer_load_dwordx4 v[44:47], v6, s[20:23], s53 offen offset:0
    buffer_load_dwordx4 v[60:63], v7, s[24:27], s53 offen offset:0
    buffer_load_dwordx4 v[64:67], v6, s[20:23], s50 offen offset:1024
    buffer_load_dwordx4 v[80:83], v7, s[24:27], s50 offen offset:1024
    buffer_load_dwordx4 v[68:71], v6, s[20:23], s51 offen offset:1024
    buffer_load_dwordx4 v[84:87], v7, s[24:27], s51 offen offset:1024
    buffer_load_dwordx4 v[72:75], v6, s[20:23], s52 offen offset:1024
    buffer_load_dwordx4 v[88:91], v7, s[24:27], s52 offen offset:1024
    buffer_load_dwordx4 v[76:79], v6, s[20:23], s53 offen offset:1024
    buffer_load_dwordx4 v[92:95], v7, s[24:27], s53 offen offset:1024
    buffer_load_dwordx4 v[96:99], v6, s[20:23], s50 offen offset:2048
    buffer_load_dwordx4 v[112:115], v7, s[24:27], s50 offen offset:2048
    buffer_load_dwordx4 v[100:103], v6, s[20:23], s51 offen offset:2048
    buffer_load_dwordx4 v[116:119], v7, s[24:27], s51 offen offset:2048
    buffer_load_dwordx4 v[104:107], v6, s[20:23], s52 offen offset:2048
    buffer_load_dwordx4 v[120:123], v7, s[24:27], s52 offen offset:2048
    buffer_load_dwordx4 v[108:111], v6, s[20:23], s53 offen offset:2048
    buffer_load_dwordx4 v[124:127], v7, s[24:27], s53 offen offset:2048
    buffer_load_dwordx4 v[128:131], v6, s[20:23], s50 offen offset:3072
    buffer_load_dwordx4 v[144:147], v7, s[24:27], s50 offen offset:3072
    buffer_load_dwordx4 v[132:135], v6, s[20:23], s51 offen offset:3072
    buffer_load_dwordx4 v[148:151], v7, s[24:27], s51 offen offset:3072
    buffer_load_dwordx4 v[136:139], v6, s[20:23], s52 offen offset:3072
    buffer_load_dwordx4 v[152:155], v7, s[24:27], s52 offen offset:3072
    buffer_load_dwordx4 v[140:143], v6, s[20:23], s53 offen offset:3072
    buffer_load_dwordx4 v[156:159], v7, s[24:27], s53 offen offset:3072
    s_mov_b32 s28, s4
    s_mov_b32 s29, s5
    s_mov_b32 s30, 2097152
    s_mov_b32 s31, 0x00020000
    s_mov_b32 s32, s14
    s_mov_b32 s33, s15
    s_mov_b32 s34, 2097152
    s_mov_b32 s35, 0x00020000
    v_add_u32 v6, 0x1000, v6
    v_add_u32 v7, 0x1000, v7
    buffer_load_dwordx4 v[160:163], v6, s[20:23], s50 offen offset:0
    buffer_load_dwordx4 v[176:179], v7, s[24:27], s50 offen offset:0
    buffer_load_dwordx4 v[164:167], v6, s[20:23], s51 offen offset:0
    buffer_load_dwordx4 v[180:183], v7, s[24:27], s51 offen offset:0
    buffer_load_dwordx4 v[168:171], v6, s[20:23], s52 offen offset:0
    buffer_load_dwordx4 v[184:187], v7, s[24:27], s52 offen offset:0
    buffer_load_dwordx4 v[172:175], v6, s[20:23], s53 offen offset:0
    buffer_load_dwordx4 v[188:191], v7, s[24:27], s53 offen offset:0
    buffer_load_dwordx4 v[192:195], v6, s[20:23], s50 offen offset:1024
    buffer_load_dwordx4 v[208:211], v7, s[24:27], s50 offen offset:1024
    buffer_load_dwordx4 v[196:199], v6, s[20:23], s51 offen offset:1024
    buffer_load_dwordx4 v[212:215], v7, s[24:27], s51 offen offset:1024
    buffer_load_dwordx4 v[200:203], v6, s[20:23], s52 offen offset:1024
    buffer_load_dwordx4 v[216:219], v7, s[24:27], s52 offen offset:1024
    buffer_load_dwordx4 v[204:207], v6, s[20:23], s53 offen offset:1024
    buffer_load_dwordx4 v[220:223], v7, s[24:27], s53 offen offset:1024
    s_lshl_b32 s48, s36, 6
    s_lshl_b32 s49, s38, 4
    s_add_u32 s48, s48, s49
    v_add_u32 v12, s48, v2
    v_lshlrev_b32 v12, 10, v12
    s_lshl_b32 s49, s37, 7
    v_lshl_add_u32 v15, v3, 3, s49
    v_add_u32 v12, v12, v15
    buffer_load_dwordx2 v[16:17], v12, s[28:31], 0 offen offset:0
    buffer_load_dwordx2 v[18:19], v12, s[28:31], 0 offen offset:32
    buffer_load_dwordx2 v[20:21], v12, s[28:31], 0 offen offset:64
    buffer_load_dwordx2 v[22:23], v12, s[28:31], 0 offen offset:96
    s_waitcnt vmcnt(44)
    v_mfma_f32_16x16x32_bf16 a[0:3], v[48:51], v[32:35], 0
    buffer_load_dwordx4 v[224:227], v6, s[20:23], s50 offen offset:2048
    v_mfma_f32_16x16x32_bf16 a[16:19], v[48:51], v[36:39], 0
    buffer_load_dwordx4 v[240:243], v7, s[24:27], s50 offen offset:2048
    v_mfma_f32_16x16x32_bf16 a[32:35], v[48:51], v[40:43], 0
    buffer_load_dwordx4 v[228:231], v6, s[20:23], s51 offen offset:2048
    v_mfma_f32_16x16x32_bf16 a[48:51], v[48:51], v[44:47], 0
    buffer_load_dwordx4 v[244:247], v7, s[24:27], s51 offen offset:2048
    v_mfma_f32_16x16x32_bf16 a[4:7], v[52:55], v[32:35], 0
    buffer_load_dwordx4 v[232:235], v6, s[20:23], s52 offen offset:2048
    v_mfma_f32_16x16x32_bf16 a[20:23], v[52:55], v[36:39], 0
    buffer_load_dwordx4 v[248:251], v7, s[24:27], s52 offen offset:2048
    v_mfma_f32_16x16x32_bf16 a[36:39], v[52:55], v[40:43], 0
    buffer_load_dwordx4 v[236:239], v6, s[20:23], s53 offen offset:2048
    v_mfma_f32_16x16x32_bf16 a[52:55], v[52:55], v[44:47], 0
    buffer_load_dwordx4 v[252:255], v7, s[24:27], s53 offen offset:2048
    v_mfma_f32_16x16x32_bf16 a[8:11], v[56:59], v[32:35], 0
    v_mfma_f32_16x16x32_bf16 a[24:27], v[56:59], v[36:39], 0
    v_mfma_f32_16x16x32_bf16 a[40:43], v[56:59], v[40:43], 0
    v_mfma_f32_16x16x32_bf16 a[56:59], v[56:59], v[44:47], 0
    v_mfma_f32_16x16x32_bf16 a[12:15], v[60:63], v[32:35], 0
    v_mfma_f32_16x16x32_bf16 a[28:31], v[60:63], v[36:39], 0
    v_mfma_f32_16x16x32_bf16 a[44:47], v[60:63], v[40:43], 0
    v_mfma_f32_16x16x32_bf16 a[60:63], v[60:63], v[44:47], 0
    s_waitcnt vmcnt(44)
    v_mfma_f32_16x16x32_bf16 a[0:3], v[80:83], v[64:67], a[0:3]
    buffer_load_dwordx4 v[32:35], v6, s[20:23], s50 offen offset:3072
    v_mfma_f32_16x16x32_bf16 a[16:19], v[80:83], v[68:71], a[16:19]
    buffer_load_dwordx4 v[48:51], v7, s[24:27], s50 offen offset:3072
    v_mfma_f32_16x16x32_bf16 a[32:35], v[80:83], v[72:75], a[32:35]
    buffer_load_dwordx4 v[36:39], v6, s[20:23], s51 offen offset:3072
    v_mfma_f32_16x16x32_bf16 a[48:51], v[80:83], v[76:79], a[48:51]
    buffer_load_dwordx4 v[52:55], v7, s[24:27], s51 offen offset:3072
    v_mfma_f32_16x16x32_bf16 a[4:7], v[84:87], v[64:67], a[4:7]
    buffer_load_dwordx4 v[40:43], v6, s[20:23], s52 offen offset:3072
    v_mfma_f32_16x16x32_bf16 a[20:23], v[84:87], v[68:71], a[20:23]
    buffer_load_dwordx4 v[56:59], v7, s[24:27], s52 offen offset:3072
    v_mfma_f32_16x16x32_bf16 a[36:39], v[84:87], v[72:75], a[36:39]
    buffer_load_dwordx4 v[44:47], v6, s[20:23], s53 offen offset:3072
    v_mfma_f32_16x16x32_bf16 a[52:55], v[84:87], v[76:79], a[52:55]
    buffer_load_dwordx4 v[60:63], v7, s[24:27], s53 offen offset:3072
    v_mfma_f32_16x16x32_bf16 a[8:11], v[88:91], v[64:67], a[8:11]
    v_mfma_f32_16x16x32_bf16 a[24:27], v[88:91], v[68:71], a[24:27]
    v_mfma_f32_16x16x32_bf16 a[40:43], v[88:91], v[72:75], a[40:43]
    v_mfma_f32_16x16x32_bf16 a[56:59], v[88:91], v[76:79], a[56:59]
    v_mfma_f32_16x16x32_bf16 a[12:15], v[92:95], v[64:67], a[12:15]
    v_mfma_f32_16x16x32_bf16 a[28:31], v[92:95], v[68:71], a[28:31]
    v_mfma_f32_16x16x32_bf16 a[44:47], v[92:95], v[72:75], a[44:47]
    v_mfma_f32_16x16x32_bf16 a[60:63], v[92:95], v[76:79], a[60:63]
    s_waitcnt vmcnt(44)
    v_mfma_f32_16x16x32_bf16 a[0:3], v[112:115], v[96:99], a[0:3]
    v_add_u32 v6, 0x1000, v6
    v_add_u32 v7, 0x1000, v7
    v_mfma_f32_16x16x32_bf16 a[16:19], v[112:115], v[100:103], a[16:19]
    buffer_load_dwordx4 v[64:67], v6, s[20:23], s50 offen offset:0
    v_mfma_f32_16x16x32_bf16 a[32:35], v[112:115], v[104:107], a[32:35]
    buffer_load_dwordx4 v[80:83], v7, s[24:27], s50 offen offset:0
    v_mfma_f32_16x16x32_bf16 a[48:51], v[112:115], v[108:111], a[48:51]
    buffer_load_dwordx4 v[68:71], v6, s[20:23], s51 offen offset:0
    v_mfma_f32_16x16x32_bf16 a[4:7], v[116:119], v[96:99], a[4:7]
    buffer_load_dwordx4 v[84:87], v7, s[24:27], s51 offen offset:0
    v_mfma_f32_16x16x32_bf16 a[20:23], v[116:119], v[100:103], a[20:23]
    buffer_load_dwordx4 v[72:75], v6, s[20:23], s52 offen offset:0
    v_mfma_f32_16x16x32_bf16 a[36:39], v[116:119], v[104:107], a[36:39]
    buffer_load_dwordx4 v[88:91], v7, s[24:27], s52 offen offset:0
    v_mfma_f32_16x16x32_bf16 a[52:55], v[116:119], v[108:111], a[52:55]
    buffer_load_dwordx4 v[76:79], v6, s[20:23], s53 offen offset:0
    v_mfma_f32_16x16x32_bf16 a[8:11], v[120:123], v[96:99], a[8:11]
    buffer_load_dwordx4 v[92:95], v7, s[24:27], s53 offen offset:0
    v_mfma_f32_16x16x32_bf16 a[24:27], v[120:123], v[100:103], a[24:27]
    v_mfma_f32_16x16x32_bf16 a[40:43], v[120:123], v[104:107], a[40:43]
    v_mfma_f32_16x16x32_bf16 a[56:59], v[120:123], v[108:111], a[56:59]
    v_mfma_f32_16x16x32_bf16 a[12:15], v[124:127], v[96:99], a[12:15]
    v_mfma_f32_16x16x32_bf16 a[28:31], v[124:127], v[100:103], a[28:31]
    v_mfma_f32_16x16x32_bf16 a[44:47], v[124:127], v[104:107], a[44:47]
    v_mfma_f32_16x16x32_bf16 a[60:63], v[124:127], v[108:111], a[60:63]
    s_waitcnt vmcnt(44)
    v_mfma_f32_16x16x32_bf16 a[0:3], v[144:147], v[128:131], a[0:3]
    buffer_load_dwordx4 v[96:99], v6, s[20:23], s54 offen offset:1024
    v_mfma_f32_16x16x32_bf16 a[16:19], v[144:147], v[132:135], a[16:19]
    buffer_load_dwordx4 v[112:115], v7, s[24:27], s54 offen offset:1024
    v_mfma_f32_16x16x32_bf16 a[32:35], v[144:147], v[136:139], a[32:35]
    buffer_load_dwordx4 v[100:103], v6, s[20:23], s55 offen offset:1024
    v_mfma_f32_16x16x32_bf16 a[48:51], v[144:147], v[140:143], a[48:51]
    buffer_load_dwordx4 v[116:119], v7, s[24:27], s55 offen offset:1024
    v_mfma_f32_16x16x32_bf16 a[4:7], v[148:151], v[128:131], a[4:7]
    buffer_load_dwordx4 v[104:107], v6, s[20:23], s56 offen offset:1024
    v_mfma_f32_16x16x32_bf16 a[20:23], v[148:151], v[132:135], a[20:23]
    buffer_load_dwordx4 v[120:123], v7, s[24:27], s56 offen offset:1024
    v_mfma_f32_16x16x32_bf16 a[36:39], v[148:151], v[136:139], a[36:39]
    buffer_load_dwordx4 v[108:111], v6, s[20:23], s57 offen offset:1024
    v_mfma_f32_16x16x32_bf16 a[52:55], v[148:151], v[140:143], a[52:55]
    buffer_load_dwordx4 v[124:127], v7, s[24:27], s57 offen offset:1024
    v_mfma_f32_16x16x32_bf16 a[8:11], v[152:155], v[128:131], a[8:11]
    v_mfma_f32_16x16x32_bf16 a[24:27], v[152:155], v[132:135], a[24:27]
    v_mfma_f32_16x16x32_bf16 a[40:43], v[152:155], v[136:139], a[40:43]
    v_mfma_f32_16x16x32_bf16 a[56:59], v[152:155], v[140:143], a[56:59]
    v_mfma_f32_16x16x32_bf16 a[12:15], v[156:159], v[128:131], a[12:15]
    v_mfma_f32_16x16x32_bf16 a[28:31], v[156:159], v[132:135], a[28:31]
    v_mfma_f32_16x16x32_bf16 a[44:47], v[156:159], v[136:139], a[44:47]
    v_mfma_f32_16x16x32_bf16 a[60:63], v[156:159], v[140:143], a[60:63]
    s_waitcnt vmcnt(44)
    v_mfma_f32_16x16x32_bf16 a[0:3], v[176:179], v[160:163], a[0:3]
    v_mfma_f32_16x16x32_bf16 a[16:19], v[176:179], v[164:167], a[16:19]
    v_mfma_f32_16x16x32_bf16 a[32:35], v[176:179], v[168:171], a[32:35]
    v_mfma_f32_16x16x32_bf16 a[48:51], v[176:179], v[172:175], a[48:51]
    v_mfma_f32_16x16x32_bf16 a[4:7], v[180:183], v[160:163], a[4:7]
    v_mfma_f32_16x16x32_bf16 a[20:23], v[180:183], v[164:167], a[20:23]
    v_mfma_f32_16x16x32_bf16 a[36:39], v[180:183], v[168:171], a[36:39]
    v_mfma_f32_16x16x32_bf16 a[52:55], v[180:183], v[172:175], a[52:55]
    v_mfma_f32_16x16x32_bf16 a[8:11], v[184:187], v[160:163], a[8:11]
    v_mfma_f32_16x16x32_bf16 a[24:27], v[184:187], v[164:167], a[24:27]
    v_mfma_f32_16x16x32_bf16 a[40:43], v[184:187], v[168:171], a[40:43]
    v_mfma_f32_16x16x32_bf16 a[56:59], v[184:187], v[172:175], a[56:59]
    v_mfma_f32_16x16x32_bf16 a[12:15], v[188:191], v[160:163], a[12:15]
    v_mfma_f32_16x16x32_bf16 a[28:31], v[188:191], v[164:167], a[28:31]
    v_mfma_f32_16x16x32_bf16 a[44:47], v[188:191], v[168:171], a[44:47]
    v_mfma_f32_16x16x32_bf16 a[60:63], v[188:191], v[172:175], a[60:63]
    s_waitcnt vmcnt(36)
    v_mfma_f32_16x16x32_bf16 a[0:3], v[208:211], v[192:195], a[0:3]
    v_mfma_f32_16x16x32_bf16 a[16:19], v[208:211], v[196:199], a[16:19]
    v_mfma_f32_16x16x32_bf16 a[32:35], v[208:211], v[200:203], a[32:35]
    v_mfma_f32_16x16x32_bf16 a[48:51], v[208:211], v[204:207], a[48:51]
    v_mfma_f32_16x16x32_bf16 a[4:7], v[212:215], v[192:195], a[4:7]
    v_mfma_f32_16x16x32_bf16 a[20:23], v[212:215], v[196:199], a[20:23]
    v_mfma_f32_16x16x32_bf16 a[36:39], v[212:215], v[200:203], a[36:39]
    v_mfma_f32_16x16x32_bf16 a[52:55], v[212:215], v[204:207], a[52:55]
    v_mfma_f32_16x16x32_bf16 a[8:11], v[216:219], v[192:195], a[8:11]
    v_mfma_f32_16x16x32_bf16 a[24:27], v[216:219], v[196:199], a[24:27]
    v_mfma_f32_16x16x32_bf16 a[40:43], v[216:219], v[200:203], a[40:43]
    v_mfma_f32_16x16x32_bf16 a[56:59], v[216:219], v[204:207], a[56:59]
    v_mfma_f32_16x16x32_bf16 a[12:15], v[220:223], v[192:195], a[12:15]
    v_mfma_f32_16x16x32_bf16 a[28:31], v[220:223], v[196:199], a[28:31]
    v_mfma_f32_16x16x32_bf16 a[44:47], v[220:223], v[200:203], a[44:47]
    v_mfma_f32_16x16x32_bf16 a[60:63], v[220:223], v[204:207], a[60:63]
    s_waitcnt vmcnt(24)
    v_mfma_f32_16x16x32_bf16 a[0:3], v[240:243], v[224:227], a[0:3]
    v_mfma_f32_16x16x32_bf16 a[16:19], v[240:243], v[228:231], a[16:19]
    v_mfma_f32_16x16x32_bf16 a[32:35], v[240:243], v[232:235], a[32:35]
    v_mfma_f32_16x16x32_bf16 a[48:51], v[240:243], v[236:239], a[48:51]
    v_mfma_f32_16x16x32_bf16 a[4:7], v[244:247], v[224:227], a[4:7]
    v_mfma_f32_16x16x32_bf16 a[20:23], v[244:247], v[228:231], a[20:23]
    v_mfma_f32_16x16x32_bf16 a[36:39], v[244:247], v[232:235], a[36:39]
    v_mfma_f32_16x16x32_bf16 a[52:55], v[244:247], v[236:239], a[52:55]
    v_mfma_f32_16x16x32_bf16 a[8:11], v[248:251], v[224:227], a[8:11]
    v_mfma_f32_16x16x32_bf16 a[24:27], v[248:251], v[228:231], a[24:27]
    v_mfma_f32_16x16x32_bf16 a[40:43], v[248:251], v[232:235], a[40:43]
    v_mfma_f32_16x16x32_bf16 a[56:59], v[248:251], v[236:239], a[56:59]
    v_mfma_f32_16x16x32_bf16 a[12:15], v[252:255], v[224:227], a[12:15]
    v_mfma_f32_16x16x32_bf16 a[28:31], v[252:255], v[228:231], a[28:31]
    v_mfma_f32_16x16x32_bf16 a[44:47], v[252:255], v[232:235], a[44:47]
    v_mfma_f32_16x16x32_bf16 a[60:63], v[252:255], v[236:239], a[60:63]
    s_waitcnt vmcnt(16)
    v_mfma_f32_16x16x32_bf16 a[0:3], v[48:51], v[32:35], a[0:3]
    v_mfma_f32_16x16x32_bf16 a[16:19], v[48:51], v[36:39], a[16:19]
    v_mfma_f32_16x16x32_bf16 a[32:35], v[48:51], v[40:43], a[32:35]
    v_mfma_f32_16x16x32_bf16 a[48:51], v[48:51], v[44:47], a[48:51]
    v_mfma_f32_16x16x32_bf16 a[4:7], v[52:55], v[32:35], a[4:7]
    v_mfma_f32_16x16x32_bf16 a[20:23], v[52:55], v[36:39], a[20:23]
    v_mfma_f32_16x16x32_bf16 a[36:39], v[52:55], v[40:43], a[36:39]
    v_mfma_f32_16x16x32_bf16 a[52:55], v[52:55], v[44:47], a[52:55]
    v_mfma_f32_16x16x32_bf16 a[8:11], v[56:59], v[32:35], a[8:11]
    v_mfma_f32_16x16x32_bf16 a[24:27], v[56:59], v[36:39], a[24:27]
    v_mfma_f32_16x16x32_bf16 a[40:43], v[56:59], v[40:43], a[40:43]
    v_mfma_f32_16x16x32_bf16 a[56:59], v[56:59], v[44:47], a[56:59]
    v_mfma_f32_16x16x32_bf16 a[12:15], v[60:63], v[32:35], a[12:15]
    v_mfma_f32_16x16x32_bf16 a[28:31], v[60:63], v[36:39], a[28:31]
    v_mfma_f32_16x16x32_bf16 a[44:47], v[60:63], v[40:43], a[44:47]
    v_mfma_f32_16x16x32_bf16 a[60:63], v[60:63], v[44:47], a[60:63]
    s_waitcnt vmcnt(8)
    v_mfma_f32_16x16x32_bf16 a[0:3], v[80:83], v[64:67], a[0:3]
    v_mfma_f32_16x16x32_bf16 a[16:19], v[80:83], v[68:71], a[16:19]
    v_mfma_f32_16x16x32_bf16 a[32:35], v[80:83], v[72:75], a[32:35]
    v_mfma_f32_16x16x32_bf16 a[48:51], v[80:83], v[76:79], a[48:51]
    v_mfma_f32_16x16x32_bf16 a[4:7], v[84:87], v[64:67], a[4:7]
    v_mfma_f32_16x16x32_bf16 a[20:23], v[84:87], v[68:71], a[20:23]
    v_mfma_f32_16x16x32_bf16 a[36:39], v[84:87], v[72:75], a[36:39]
    v_mfma_f32_16x16x32_bf16 a[52:55], v[84:87], v[76:79], a[52:55]
    v_mfma_f32_16x16x32_bf16 a[8:11], v[88:91], v[64:67], a[8:11]
    v_mfma_f32_16x16x32_bf16 a[24:27], v[88:91], v[68:71], a[24:27]
    v_mfma_f32_16x16x32_bf16 a[40:43], v[88:91], v[72:75], a[40:43]
    v_mfma_f32_16x16x32_bf16 a[56:59], v[88:91], v[76:79], a[56:59]
    v_mfma_f32_16x16x32_bf16 a[12:15], v[92:95], v[64:67], a[12:15]
    v_mfma_f32_16x16x32_bf16 a[28:31], v[92:95], v[68:71], a[28:31]
    v_mfma_f32_16x16x32_bf16 a[44:47], v[92:95], v[72:75], a[44:47]
    v_mfma_f32_16x16x32_bf16 a[60:63], v[92:95], v[76:79], a[60:63]
    s_waitcnt vmcnt(0)
    v_mfma_f32_16x16x32_bf16 a[0:3], v[112:115], v[96:99], a[0:3]
    v_mfma_f32_16x16x32_bf16 a[16:19], v[112:115], v[100:103], a[16:19]
    v_mfma_f32_16x16x32_bf16 a[32:35], v[112:115], v[104:107], a[32:35]
    v_mfma_f32_16x16x32_bf16 a[48:51], v[112:115], v[108:111], a[48:51]
    v_mfma_f32_16x16x32_bf16 a[4:7], v[116:119], v[96:99], a[4:7]
    v_mfma_f32_16x16x32_bf16 a[20:23], v[116:119], v[100:103], a[20:23]
    v_mfma_f32_16x16x32_bf16 a[36:39], v[116:119], v[104:107], a[36:39]
    v_mfma_f32_16x16x32_bf16 a[52:55], v[116:119], v[108:111], a[52:55]
    v_mfma_f32_16x16x32_bf16 a[8:11], v[120:123], v[96:99], a[8:11]
    v_mfma_f32_16x16x32_bf16 a[24:27], v[120:123], v[100:103], a[24:27]
    v_mfma_f32_16x16x32_bf16 a[40:43], v[120:123], v[104:107], a[40:43]
    v_mfma_f32_16x16x32_bf16 a[56:59], v[120:123], v[108:111], a[56:59]
    v_mfma_f32_16x16x32_bf16 a[12:15], v[124:127], v[96:99], a[12:15]
    v_mfma_f32_16x16x32_bf16 a[28:31], v[124:127], v[100:103], a[28:31]
    v_mfma_f32_16x16x32_bf16 a[44:47], v[124:127], v[104:107], a[44:47]
    v_mfma_f32_16x16x32_bf16 a[60:63], v[124:127], v[108:111], a[60:63]
    s_nop 7
    s_mul_i32 s48, s38, 16384
    s_add_u32 s48, s48, 0
    v_lshl_add_u32 v10, v1, 4, s48
    ds_write_b128 v10, a[0:3] offset:0
    ds_write_b128 v10, a[4:7] offset:1024
    ds_write_b128 v10, a[8:11] offset:2048
    ds_write_b128 v10, a[12:15] offset:3072
    ds_write_b128 v10, a[16:19] offset:4096
    ds_write_b128 v10, a[20:23] offset:5120
    ds_write_b128 v10, a[24:27] offset:6144
    ds_write_b128 v10, a[28:31] offset:7168
    ds_write_b128 v10, a[32:35] offset:8192
    ds_write_b128 v10, a[36:39] offset:9216
    ds_write_b128 v10, a[40:43] offset:10240
    ds_write_b128 v10, a[44:47] offset:11264
    ds_write_b128 v10, a[48:51] offset:12288
    ds_write_b128 v10, a[52:55] offset:13312
    ds_write_b128 v10, a[56:59] offset:14336
    ds_write_b128 v10, a[60:63] offset:15360
    s_mul_i32 s48, s38, 4096
    s_add_u32 s48, s48, 0
    v_lshl_add_u32 v10, v1, 4, s48
    v_add_u32 v11, 32768, v10
    s_waitcnt lgkmcnt(0)
    s_barrier
    ds_read_b128 v[64:67], v10 offset:0
    ds_read_b128 v[68:71], v10 offset:1024
    ds_read_b128 v[72:75], v10 offset:2048
    ds_read_b128 v[76:79], v10 offset:3072
    ds_read_b128 v[80:83], v10 offset:16384
    ds_read_b128 v[84:87], v10 offset:17408
    ds_read_b128 v[88:91], v10 offset:18432
    ds_read_b128 v[92:95], v10 offset:19456
    ds_read_b128 v[96:99], v11 offset:0
    ds_read_b128 v[100:103], v11 offset:1024
    ds_read_b128 v[104:107], v11 offset:2048
    ds_read_b128 v[108:111], v11 offset:3072
    ds_read_b128 v[112:115], v11 offset:16384
    ds_read_b128 v[116:119], v11 offset:17408
    ds_read_b128 v[120:123], v11 offset:18432
    ds_read_b128 v[124:127], v11 offset:19456
    s_waitcnt lgkmcnt(0)
    v_pk_add_f32 v[64:65], v[64:65], v[80:81]
    v_pk_add_f32 v[96:97], v[96:97], v[112:113]
    v_pk_add_f32 v[66:67], v[66:67], v[82:83]
    v_pk_add_f32 v[98:99], v[98:99], v[114:115]
    v_pk_add_f32 v[68:69], v[68:69], v[84:85]
    v_pk_add_f32 v[100:101], v[100:101], v[116:117]
    v_pk_add_f32 v[70:71], v[70:71], v[86:87]
    v_pk_add_f32 v[102:103], v[102:103], v[118:119]
    v_pk_add_f32 v[72:73], v[72:73], v[88:89]
    v_pk_add_f32 v[104:105], v[104:105], v[120:121]
    v_pk_add_f32 v[74:75], v[74:75], v[90:91]
    v_pk_add_f32 v[106:107], v[106:107], v[122:123]
    v_pk_add_f32 v[76:77], v[76:77], v[92:93]
    v_pk_add_f32 v[108:109], v[108:109], v[124:125]
    v_pk_add_f32 v[78:79], v[78:79], v[94:95]
    v_pk_add_f32 v[110:111], v[110:111], v[126:127]
    v_pk_add_f32 v[64:65], v[64:65], v[96:97]
    v_pk_add_f32 v[66:67], v[66:67], v[98:99]
    v_pk_add_f32 v[68:69], v[68:69], v[100:101]
    v_pk_add_f32 v[70:71], v[70:71], v[102:103]
    v_pk_add_f32 v[72:73], v[72:73], v[104:105]
    v_pk_add_f32 v[74:75], v[74:75], v[106:107]
    v_pk_add_f32 v[76:77], v[76:77], v[108:109]
    v_pk_add_f32 v[78:79], v[78:79], v[110:111]
    s_mov_b32 s56, 0xffff0000
    v_lshlrev_b32 v28, 16, v16
    v_and_b32 v29, s56, v16
    v_lshlrev_b32 v30, 16, v17
    v_and_b32 v31, s56, v17
    v_pk_add_f32 v[64:65], v[64:65], v[28:29]
    v_pk_add_f32 v[66:67], v[66:67], v[30:31]
    v_cvt_pk_bf16_f32 v16, v64, v65
    v_cvt_pk_bf16_f32 v17, v66, v67
    buffer_store_dwordx2 v[16:17], v12, s[32:35], 0 offen offset:0
    v_lshlrev_b32 v28, 16, v18
    v_and_b32 v29, s56, v18
    v_lshlrev_b32 v30, 16, v19
    v_and_b32 v31, s56, v19
    v_pk_add_f32 v[68:69], v[68:69], v[28:29]
    v_pk_add_f32 v[70:71], v[70:71], v[30:31]
    v_cvt_pk_bf16_f32 v18, v68, v69
    v_cvt_pk_bf16_f32 v19, v70, v71
    buffer_store_dwordx2 v[18:19], v12, s[32:35], 0 offen offset:32
    v_lshlrev_b32 v28, 16, v20
    v_and_b32 v29, s56, v20
    v_lshlrev_b32 v30, 16, v21
    v_and_b32 v31, s56, v21
    v_pk_add_f32 v[72:73], v[72:73], v[28:29]
    v_pk_add_f32 v[74:75], v[74:75], v[30:31]
    v_cvt_pk_bf16_f32 v20, v72, v73
    v_cvt_pk_bf16_f32 v21, v74, v75
    buffer_store_dwordx2 v[20:21], v12, s[32:35], 0 offen offset:64
    v_lshlrev_b32 v28, 16, v22
    v_and_b32 v29, s56, v22
    v_lshlrev_b32 v30, 16, v23
    v_and_b32 v31, s56, v23
    v_pk_add_f32 v[76:77], v[76:77], v[28:29]
    v_pk_add_f32 v[78:79], v[78:79], v[30:31]
    v_cvt_pk_bf16_f32 v22, v76, v77
    v_cvt_pk_bf16_f32 v23, v78, v79
    buffer_store_dwordx2 v[22:23], v12, s[32:35], 0 offen offset:96
p3_kernel_exit:
    s_endpgm
code_end:
    s_endpgm
.section .rodata,"a"
.p2align 6
.amdhsa_kernel p1_kernel
  .amdhsa_next_free_vgpr 288
  .amdhsa_next_free_sgpr 102
  .amdhsa_accum_offset 256
  .amdhsa_group_segment_fixed_size 0
  .amdhsa_kernarg_size 96
  .amdhsa_user_sgpr_count 2
  .amdhsa_user_sgpr_kernarg_segment_ptr 1
  .amdhsa_system_sgpr_workgroup_id_x 1
.end_amdhsa_kernel
.p2align 6
.amdhsa_kernel p2_kernel
  .amdhsa_next_free_vgpr 392
  .amdhsa_next_free_sgpr 102
  .amdhsa_accum_offset 256
  .amdhsa_group_segment_fixed_size 0
  .amdhsa_kernarg_size 96
  .amdhsa_user_sgpr_count 2
  .amdhsa_user_sgpr_kernarg_segment_ptr 1
  .amdhsa_system_sgpr_workgroup_id_x 1
.end_amdhsa_kernel
.p2align 6
.amdhsa_kernel p3_kernel
  .amdhsa_next_free_vgpr 320
  .amdhsa_next_free_sgpr 102
  .amdhsa_accum_offset 256
  .amdhsa_group_segment_fixed_size 0
  .amdhsa_kernarg_size 96
  .amdhsa_user_sgpr_count 2
  .amdhsa_user_sgpr_kernarg_segment_ptr 1
  .amdhsa_system_sgpr_workgroup_id_x 1
.end_amdhsa_kernel
```
